```python
import torch

def _softmax(x, axis=-1):
    return torch.softmax(x, dim=axis)
def _gelu(x):
    return torch.nn.functional.gelu(x, approximate="tanh")
def _silu(x):
    return torch.nn.functional.silu(x)
def _sigmoid(x):
    return torch.sigmoid(x)
def _layernorm(x, axis=-1, eps=1e-5):
    m = x.mean(dim=axis, keepdim=True)
    v = x.var(dim=axis, keepdim=True, unbiased=False)
    return (x - m) / torch.sqrt(v + eps)
def _scatter_add(tgt, idx, src, axis=0):
    return tgt.clone().index_add_(axis, idx, src)
def _segment_sum(src, seg, n):
    out = torch.zeros((n,) + src.shape[1:], dtype=src.dtype)
    return out.index_add_(0, seg, src)
def _pad(x, pw):
    flat = tuple(v for pair in reversed(pw) for v in pair)
    return torch.nn.functional.pad(x, flat)

kernel_name = 'concat_heads__mha_block_cached__gqa_block_cached__near_ridge'

def setup_inputs():

    _w = (lambda a: (lambda t: t.to(torch.bfloat16) if t.is_floating_point() else t)(torch.as_tensor(a)))
    def _A_setup():
        B, Sq, D = 16, 96, 448
        H, Sk, Dh = 16, 512, 256
        return {
            "x": _w((lambda *s: torch.randn(*s, dtype=torch.bfloat16) * 0.8)(B, Sq, D)),
            "k_cache": _w((lambda *s: torch.randn(*s, dtype=torch.bfloat16) * 0.8)(B, H, Sk, Dh)),
            "v_cache": _w((lambda *s: torch.randn(*s, dtype=torch.bfloat16) * 0.05)(B, H, Sk, Dh)),
            "wq": _w((lambda *s: torch.randn(*s, dtype=torch.bfloat16) * 0.8)(D, H * Dh) * (D ** -0.5)),
            "wo": _w((lambda *s: torch.randn(*s, dtype=torch.bfloat16) * 0.05)(H * Dh, D) * ((H * Dh) ** -0.5)),
        }
    _A_in = _A_setup()

    def _B_setup():
        B, Sq, D = 16, 96, 448
        Hq, Hkv, Sk, Dh = 16, 16, 512, 256
        assert Hq % Hkv == 0, (Hq, Hkv)
        return {
            "x": _w((lambda *s: torch.randn(*s, dtype=torch.bfloat16) * 0.8)(B, Sq, D)),
            "k_cache": _w((lambda *s: torch.randn(*s, dtype=torch.bfloat16) * 0.8)(B, Hkv, Sk, Dh)),
            "v_cache": _w((lambda *s: torch.randn(*s, dtype=torch.bfloat16) * 0.05)(B, Hkv, Sk, Dh)),
            "wq": _w((lambda *s: torch.randn(*s, dtype=torch.bfloat16) * 0.8)(D, Hq * Dh) * (D ** -0.5)),
            "wo": _w((lambda *s: torch.randn(*s, dtype=torch.bfloat16) * 0.05)(Hq * Dh, D) * ((Hq * Dh) ** -0.5)),
        }
    _B_in = _B_setup()

    return {
        "A_x": _A_in["x"],
        "A_k_cache": _A_in["k_cache"],
        "A_v_cache": _A_in["v_cache"],
        "A_wq": _A_in["wq"],
        "A_wo": _A_in["wo"],
        "B_x": _B_in["x"],
        "B_k_cache": _B_in["k_cache"],
        "B_v_cache": _B_in["v_cache"],
        "B_wq": _B_in["wq"],
        "B_wo": _B_in["wo"],
    }

def reference(A_x, A_k_cache, A_v_cache, A_wq, A_wo, B_x, B_k_cache, B_v_cache, B_wq, B_wo):
    def _A_ref(x, k_cache, v_cache, wq, wo):
        B, Sq, D = x.shape
        H, Dh = 16, 256
        q = (lambda x, *d: x.permute(*d))((x @ wq).reshape(B, Sq, H, Dh), 0, 2, 1, 3)
        scores = torch.einsum("bhqd,bhkd->bhqk", q, k_cache) * (Dh ** -0.5)
        p = _softmax(scores, axis=-1)
        o = torch.einsum("bhqk,bhkd->bhqd", p, v_cache)
        return (lambda x, *d: x.permute(*d))(o, 0, 2, 1, 3).reshape(B, Sq, H * Dh) @ wo

    def _B_ref(x, k_cache, v_cache, wq, wo):
        B, Sq, D = x.shape
        Hq, Dh = 16, 256
        Hkv = k_cache.shape[1]
        rep = Hq // Hkv
        q = (lambda x, *d: x.permute(*d))((x @ wq).reshape(B, Sq, Hq, Dh), 0, 2, 1, 3)
        k = (lambda x, n, axis: torch.repeat_interleave(x, n, dim=axis))(k_cache, rep, axis=1)
        v = (lambda x, n, axis: torch.repeat_interleave(x, n, dim=axis))(v_cache, rep, axis=1)
        scores = torch.einsum("bhqd,bhkd->bhqk", q, k) * (Dh ** -0.5)
        p = _softmax(scores, axis=-1)
        o = torch.einsum("bhqk,bhkd->bhqd", p, v)
        return (lambda x, *d: x.permute(*d))(o, 0, 2, 1, 3).reshape(B, Sq, Hq * Dh) @ wo

    a = _A_ref(A_x, A_k_cache, A_v_cache, A_wq, A_wo)
    b = _B_ref(B_x, B_k_cache, B_v_cache, B_wq, B_wo)
    return torch.concatenate([a, b], axis=-1)
```

```asm
; @launch grid=(256,1,1) block=(256,1,1) lds=163840
.amdgcn_target "amdgcn-amd-amdhsa--gfx950"
.text
.globl concat_heads__mha_block_cached__gqa_block_cached__near_ridge_kernel
.p2align 8
.type concat_heads__mha_block_cached__gqa_block_cached__near_ridge_kernel,@function
concat_heads__mha_block_cached__gqa_block_cached__near_ridge_kernel:
s_cmp_lt_u32 s2, 256
s_cbranch_scc1 L_go
s_endpgm
L_go:
s_bfe_u32 s60, s2, 0x10002
s_mul_i32 s3, s60, 40
s_add_u32 s4, s0, s3
s_addc_u32 s5, s1, 0
s_load_dwordx8 s[8:15], s[4:5], 0
s_load_dwordx2 s[16:17], s[4:5], 32
s_load_dwordx2 s[56:57], s[0:1], 80
s_load_dwordx2 s[40:41], s[0:1], 96
v_lshrrev_b32 v1, 6, v0
v_and_b32 v2, 63, v0
v_readfirstlane_b32 s63, v1
s_getpc_b64 s[52:53]
L_pc:
s_mov_b32 s54, L_codeend-L_pc+512
s_mov_b32 s55, 0x20000
s_lshr_b32 s3, s2, 3
v_lshl_add_u32 v240, s3, 2, v1
v_lshlrev_b32 v240, 7, v240
buffer_load_dword v241, v240, s[52:55], 0 offen
s_bfe_u32 s62, s2, 0x40003
v_lshrrev_b32 v16, 3, v2
v_and_b32 v17, 7, v2
v_mad_u32_u24 v18, v1, 24, v16
s_mul_i32 s68, s63, 3072
v_bfe_u32 v19, v18, 1, 3
v_xor_b32 v19, v17, v19
v_mul_u32_u24 v4, 896, v18
v_lshl_add_u32 v4, v19, 4, v4
v_xor_b32 v5, 64, v4
v_add_u32 v5, 6144, v5
v_add_u32 v6, 12288, v4
s_mul_i32 s3, s62, 86016
s_mov_b32 s22, 86016
s_mov_b32 s23, 0x20000
s_and_b32 s61, s2, 3
s_lshl_b32 s61, s61, 1
s_lshr_b32 s18, s2, 7
s_add_u32 s61, s61, s18
s_waitcnt lgkmcnt(0)
s_add_u32 s20, s8, s3
s_addc_u32 s21, s9, 0
s_add_u32 m0, s68, 77824
s_movk_i32 s69, 0
buffer_load_dwordx4 v4, s[20:23], s69 offen offset:0 lds
buffer_load_dwordx4 v5, s[20:23], s69 offen offset:1024 lds
buffer_load_dwordx4 v6, s[20:23], s69 offen offset:2048 lds
s_add_u32 m0, s68, 90112
s_movk_i32 s69, 128
buffer_load_dwordx4 v4, s[20:23], s69 offen offset:0 lds
buffer_load_dwordx4 v5, s[20:23], s69 offen offset:1024 lds
buffer_load_dwordx4 v6, s[20:23], s69 offen offset:2048 lds
s_lshl_b32 s3, s62, 2
s_add_u32 s3, s3, s63
s_mul_i32 s3, s3, 28
v_min_u32 v19, 27, v2
v_add_u32 v19, s3, v19
v_lshlrev_b32 v239, 7, v19
v_lshrrev_b32 v20, 2, v19
v_lshlrev_b32 v20, 13, v20
v_and_b32 v19, 3, v19
v_lshl_add_u32 v238, v19, 7, v20
s_lshl_b32 s3, s61, 10
s_add_u32 s32, s14, s3
s_addc_u32 s33, s15, 0
s_sub_u32 s34, 3670016, s3
s_mov_b32 s35, 0x20000
buffer_load_dword v241, v238, s[32:35], 0 offen
s_add_u32 m0, s68, 102400
s_movk_i32 s69, 256
buffer_load_dwordx4 v4, s[20:23], s69 offen offset:0 lds
buffer_load_dwordx4 v5, s[20:23], s69 offen offset:1024 lds
buffer_load_dwordx4 v6, s[20:23], s69 offen offset:2048 lds
s_add_u32 m0, s68, 114688
s_movk_i32 s69, 384
buffer_load_dwordx4 v4, s[20:23], s69 offen offset:0 lds
buffer_load_dwordx4 v5, s[20:23], s69 offen offset:1024 lds
buffer_load_dwordx4 v6, s[20:23], s69 offen offset:2048 lds
v_lshl_add_u32 v18, v1, 4, v16
v_and_b32 v19, 6, v16
v_xor_b32 v19, v17, v19
v_lshlrev_b32 v19, 4, v19
v_lshl_add_u32 v224, v18, 9, v19
v_lshl_add_u32 v226, v18, 13, v19
v_xor_b32 v227, 16, v226
v_add_u32 v227, 64512, v227
s_lshl_b32 s67, s63, 11
s_and_b32 s3, s62, 3
s_lshl_b32 s72, s3, 7
s_mov_b32 s42, 285868032
s_mov_b32 s43, 0x20000
v_and_b32 v24, 15, v2
v_lshrrev_b32 v25, 4, v2
v_lshrrev_b32 v21, 1, v25
v_and_b32 v22, 1, v25
v_lshrrev_b32 v20, 1, v24
v_xor_b32 v20, v20, v21
v_lshlrev_b32 v20, 4, v20
v_lshl_add_u32 v20, v22, 3, v20
v_lshl_add_u32 v20, v24, 7, v20
s_lshr_b32 s89, s63, 1
s_mul_i32 s3, s89, 6144
s_add_u32 s3, s3, 77824
v_add_u32 v8, s3, v20
v_xor_b32 v9, 32, v8
v_xor_b32 v10, 64, v8
v_xor_b32 v11, 0x60, v8
s_add_u32 m0, s68, 126976
s_movk_i32 s69, 512
buffer_load_dwordx4 v4, s[20:23], s69 offen offset:0 lds
buffer_load_dwordx4 v5, s[20:23], s69 offen offset:1024 lds
buffer_load_dwordx4 v6, s[20:23], s69 offen offset:2048 lds
s_waitcnt vmcnt(13)
s_barrier
ds_read_b64 a[88:89], v8 offset:0
ds_read_b64 a[90:91], v9 offset:0
s_add_u32 m0, s68, 139264
s_movk_i32 s69, 640
buffer_load_dwordx4 v4, s[20:23], s69 offen offset:0 lds
buffer_load_dwordx4 v5, s[20:23], s69 offen offset:1024 lds
buffer_load_dwordx4 v6, s[20:23], s69 offen offset:2048 lds
s_add_u32 m0, s68, 151552
s_movk_i32 s69, 768
buffer_load_dwordx4 v4, s[20:23], s69 offen offset:0 lds
buffer_load_dwordx4 v5, s[20:23], s69 offen offset:1024 lds
buffer_load_dwordx4 v6, s[20:23], s69 offen offset:2048 lds
ds_read_b64 a[92:93], v8 offset:2048
ds_read_b64 a[94:95], v9 offset:2048
ds_read_b64 a[96:97], v8 offset:4096
ds_read_b64 a[98:99], v9 offset:4096
ds_read_b64 a[100:101], v10 offset:0
ds_read_b64 a[102:103], v11 offset:0
ds_read_b64 a[104:105], v10 offset:2048
ds_read_b64 a[106:107], v11 offset:2048
ds_read_b64 a[108:109], v10 offset:4096
ds_read_b64 a[110:111], v11 offset:4096
v_add_u32 v12, 49152, v8
v_add_u32 v13, 49152, v9
v_add_u32 v14, 49152, v10
v_add_u32 v15, 49152, v11
s_mul_i32 s3, s61, 458752
s_add_u32 s36, s16, s3
s_addc_u32 s37, s17, 0
s_mov_b32 s38, 458752
s_mov_b32 s39, 0x20000
s_lshl_b32 s3, s62, 3
s_add_u32 s3, s3, s61
s_lshl_b32 s3, s3, 19
s_add_u32 s24, s10, s3
s_addc_u32 s25, s11, 0
s_mov_b32 s26, 0x80000
s_mov_b32 s27, 0x20000
s_add_u32 s28, s12, s3
s_addc_u32 s29, s13, 0
s_mov_b32 s30, 0x80000
s_mov_b32 s31, 0x20000
v_xor_b32 v225, 16, v224
v_add_u32 v225, 3072, v225
s_waitcnt vmcnt(16)
s_barrier
ds_read_b64 a[112:113], v8 offset:12288
ds_read_b64 a[114:115], v9 offset:12288
s_add_u32 m0, s67, 0
s_add_u32 s69, s72, 0
buffer_load_dwordx4 v226, s[32:35], s69 offen offset:0 lds
buffer_load_dwordx4 v227, s[32:35], s69 offen offset:1024 lds
ds_read_b64 a[116:117], v8 offset:14336
ds_read_b64 a[118:119], v9 offset:14336
ds_read_b64 a[120:121], v8 offset:16384
ds_read_b64 a[122:123], v9 offset:16384
ds_read_b64 a[124:125], v10 offset:12288
ds_read_b64 a[126:127], v11 offset:12288
ds_read_b64 a[128:129], v10 offset:14336
ds_read_b64 a[130:131], v11 offset:14336
ds_read_b64 a[132:133], v10 offset:16384
ds_read_b64 a[134:135], v11 offset:16384
s_and_b32 s88, s63, 1
v_bfe_u32 v18, v2, 2, 2
v_and_b32 v19, 3, v2
v_lshl_add_u32 v20, v25, 2, v18
v_bfe_u32 v23, v20, 1, 2
s_lshl_b32 s3, s88, 1
v_xor_b32 v23, s3, v23
v_lshlrev_b32 v20, 7, v20
v_lshl_add_u32 v20, v23, 5, v20
v_and_b32 v23, 2, v25
v_xor_b32 v23, v19, v23
v_lshl_add_u32 v216, v23, 3, v20
v_xor_b32 v217, 32, v216
s_lshl_b32 s18, s88, 12
s_add_u32 s18, s18, 57344
v_add_u32 v218, s18, v216
v_xor_b32 v219, 32, v218
v_xor_b32 v220, 64, v218
v_xor_b32 v221, 0x60, v218
s_waitcnt vmcnt(14) lgkmcnt(12)
s_barrier
ds_read_b64 a[136:137], v8 offset:24576
ds_read_b64 a[138:139], v9 offset:24576
s_add_u32 m0, s67, 8192
s_add_u32 s69, s72, 524288
buffer_load_dwordx4 v226, s[32:35], s69 offen offset:0 lds
buffer_load_dwordx4 v227, s[32:35], s69 offen offset:1024 lds
ds_read_b64 a[140:141], v8 offset:26624
ds_read_b64 a[142:143], v9 offset:26624
ds_read_b64 a[144:145], v8 offset:28672
ds_read_b64 a[146:147], v9 offset:28672
ds_read_b64 a[148:149], v10 offset:24576
ds_read_b64 a[150:151], v11 offset:24576
ds_read_b64 a[152:153], v10 offset:26624
ds_read_b64 a[154:155], v11 offset:26624
ds_read_b64 a[156:157], v10 offset:28672
ds_read_b64 a[158:159], v11 offset:28672
v_and_b32 v20, 6, v24
v_lshrrev_b32 v23, 3, v24
v_or_b32 v20, v20, v23
v_lshl_or_b32 v23, v22, 1, v21
v_xor_b32 v20, v20, v23
v_lshlrev_b32 v20, 4, v20
v_lshl_add_u32 v20, v24, 7, v20
v_add_u32 v222, s18, v20
v_xor_b32 v223, 64, v222
s_mul_i32 s3, s63, 10240
s_add_u32 s3, s3, 122880
v_lshl_add_u32 v228, v2, 4, s3
s_xor_b32 s3, s63, 1
s_mul_i32 s3, s3, 10240
s_add_u32 s3, s3, 122880
v_lshl_add_u32 v229, v2, 4, s3
s_mul_i32 s3, s89, 20480
s_add_u32 s3, s3, 122880
v_lshl_add_u32 v230, v2, 4, s3
s_waitcnt vmcnt(13) lgkmcnt(12)
s_barrier
ds_read_b64 a[160:161], v8 offset:36864
ds_read_b64 a[162:163], v9 offset:36864
s_add_u32 m0, s67, 16384
s_add_u32 s69, s72, 1048576
buffer_load_dwordx4 v226, s[32:35], s69 offen offset:0 lds
buffer_load_dwordx4 v227, s[32:35], s69 offen offset:1024 lds
ds_read_b64 a[164:165], v8 offset:38912
ds_read_b64 a[166:167], v9 offset:38912
ds_read_b64 a[168:169], v8 offset:40960
ds_read_b64 a[170:171], v9 offset:40960
ds_read_b64 a[172:173], v10 offset:36864
ds_read_b64 a[174:175], v11 offset:36864
ds_read_b64 a[176:177], v10 offset:38912
ds_read_b64 a[178:179], v11 offset:38912
ds_read_b64 a[180:181], v10 offset:40960
ds_read_b64 a[182:183], v11 offset:40960
s_add_u32 s3, s62, 0
s_and_b32 s3, s3, 3
s_lshl_b32 s72, s3, 7
s_mul_i32 s76, s3, 57344
s_add_u32 s3, s62, 1
s_and_b32 s3, s3, 3
s_lshl_b32 s73, s3, 7
s_mul_i32 s77, s3, 57344
s_add_u32 s3, s62, 2
s_and_b32 s3, s3, 3
s_lshl_b32 s74, s3, 7
s_mul_i32 s78, s3, 57344
s_add_u32 s3, s62, 3
s_and_b32 s3, s3, 3
s_lshl_b32 s75, s3, 7
s_mul_i32 s79, s3, 57344
s_mov_b32 s64, 0x3db8aa3b
v_lshlrev_b32 v243, 2, v2
v_mov_b32 v242, 0
s_waitcnt vmcnt(12) lgkmcnt(12)
s_barrier
ds_read_b64 a[184:185], v12 offset:0
ds_read_b64 a[186:187], v13 offset:0
s_add_u32 m0, s67, 24576
s_add_u32 s69, s72, 1572864
buffer_load_dwordx4 v226, s[32:35], s69 offen offset:0 lds
buffer_load_dwordx4 v227, s[32:35], s69 offen offset:1024 lds
ds_read_b64 a[188:189], v12 offset:2048
ds_read_b64 a[190:191], v13 offset:2048
ds_read_b64 a[192:193], v12 offset:4096
ds_read_b64 a[194:195], v13 offset:4096
ds_read_b64 a[196:197], v14 offset:0
ds_read_b64 a[198:199], v15 offset:0
ds_read_b64 a[200:201], v14 offset:2048
ds_read_b64 a[202:203], v15 offset:2048
ds_read_b64 a[204:205], v14 offset:4096
ds_read_b64 a[206:207], v15 offset:4096
s_waitcnt vmcnt(11) lgkmcnt(12)
s_barrier
ds_read_b64 a[208:209], v12 offset:12288
ds_read_b64 a[210:211], v13 offset:12288
s_mov_b32 s69, 512
buffer_load_dword v241, v238, s[32:35], s69 offen
v_and_b32 v235, 0x300, v228
v_lshl_add_u32 v240, v235, 6, v240
s_movk_i32 s69, 0x4000
buffer_load_dword v241, v240, s[52:55], s69 offen
s_add_u32 m0, s67, 32768
s_add_u32 s69, s72, 2097152
buffer_load_dwordx4 v226, s[32:35], s69 offen offset:0 lds
buffer_load_dwordx4 v227, s[32:35], s69 offen offset:1024 lds
ds_read_b64 a[212:213], v12 offset:14336
ds_read_b64 a[214:215], v13 offset:14336
ds_read_b64 a[216:217], v12 offset:16384
ds_read_b64 a[218:219], v13 offset:16384
ds_read_b64 a[220:221], v14 offset:12288
ds_read_b64 a[222:223], v15 offset:12288
ds_read_b64 a[224:225], v14 offset:14336
ds_read_b64 a[226:227], v15 offset:14336
ds_read_b64 a[228:229], v14 offset:16384
ds_read_b64 a[230:231], v15 offset:16384
s_waitcnt vmcnt(12) lgkmcnt(12)
s_barrier
ds_read_b64 a[232:233], v12 offset:24576
ds_read_b64 a[234:235], v13 offset:24576
s_add_u32 m0, s67, 40960
s_add_u32 s69, s72, 2621440
buffer_load_dwordx4 v226, s[32:35], s69 offen offset:0 lds
buffer_load_dwordx4 v227, s[32:35], s69 offen offset:1024 lds
ds_read_b64 a[236:237], v12 offset:26624
ds_read_b64 a[238:239], v13 offset:26624
ds_read_b64 a[240:241], v12 offset:28672
ds_read_b64 a[242:243], v13 offset:28672
ds_read_b64 a[244:245], v14 offset:24576
ds_read_b64 a[246:247], v15 offset:24576
ds_read_b64 a[248:249], v14 offset:26624
ds_read_b64 a[250:251], v15 offset:26624
ds_read_b64 a[252:253], v14 offset:28672
ds_read_b64 a[254:255], v15 offset:28672
s_waitcnt vmcnt(10) lgkmcnt(12)
s_barrier
ds_read_b64_tr_b16 a[0:1], v216 offset:0
ds_read_b64_tr_b16 a[2:3], v216 offset:2048
ds_read_b64_tr_b16 a[4:5], v216 offset:4096
ds_read_b64_tr_b16 a[6:7], v216 offset:6144
s_waitcnt lgkmcnt(0)
v_mfma_f32_16x16x32_bf16 v[192:195], a[0:3], a[88:91], 0
ds_read_b64_tr_b16 a[8:9], v217 offset:0
s_mov_b32 s69, 0
v_mfma_f32_16x16x32_bf16 v[192:195], a[4:7], a[100:103], v[192:195]
ds_read_b64_tr_b16 a[10:11], v217 offset:2048
buffer_load_dword v241, v239, s[36:39], s69 offen
v_mfma_f32_16x16x32_bf16 v[200:203], a[4:7], a[104:107], 0
ds_read_b64_tr_b16 a[12:13], v217 offset:4096
s_add_u32 m0, s67, 49152
v_mfma_f32_16x16x32_bf16 v[200:203], a[0:3], a[92:95], v[200:203]
ds_read_b64_tr_b16 a[14:15], v217 offset:6144
s_add_u32 s69, s72, 3145728
v_mfma_f32_16x16x32_bf16 v[208:211], a[0:3], a[96:99], 0
ds_read_b64_tr_b16 v[248:249], v217 offset:8192
ds_read_b64_tr_b16 v[250:251], v217 offset:10240
ds_read_b64_tr_b16 v[252:253], v217 offset:12288
ds_read_b64_tr_b16 v[254:255], v217 offset:14336
v_mfma_f32_16x16x32_bf16 v[208:211], a[4:7], a[108:111], v[208:211]
buffer_load_dwordx4 v226, s[32:35], s69 offen offset:0 lds
s_waitcnt lgkmcnt(4)
v_mfma_f32_16x16x32_bf16 v[196:199], a[8:11], a[88:91], 0
ds_read_b64_tr_b16 a[0:1], v216 offset:8192
buffer_load_dwordx4 v227, s[32:35], s69 offen offset:1024 lds
s_lshl_b32 s87, s60, 4
v_mfma_f32_16x16x32_bf16 v[196:199], a[12:15], a[100:103], v[196:199]
ds_read_b64_tr_b16 a[2:3], v216 offset:10240
s_add_u32 s87, s87, s62
v_mfma_f32_16x16x32_bf16 v[204:207], a[12:15], a[104:107], 0
ds_read_b64_tr_b16 a[4:5], v216 offset:12288
s_add_u32 s19, s61, s62
v_mfma_f32_16x16x32_bf16 v[204:207], a[8:11], a[92:95], v[204:207]
ds_read_b64_tr_b16 a[6:7], v216 offset:14336
s_and_b32 s19, s19, 7
v_mfma_f32_16x16x32_bf16 v[212:215], a[8:11], a[96:99], 0
s_lshl_b32 s3, s87, 2
s_add_u32 s3, s3, s63
v_mfma_f32_16x16x32_bf16 v[212:215], a[12:15], a[108:111], v[212:215]
s_waitcnt vmcnt(9) lgkmcnt(4)
s_barrier
v_mfma_f32_16x16x32_bf16 v[212:215], v[248:251], a[120:123], v[212:215]
ds_read_b64_tr_b16 a[8:9], v216 offset:16384
s_add_u32 m0, s67, 0
v_mfma_f32_16x16x32_bf16 v[212:215], v[252:255], a[132:135], v[212:215]
ds_read_b64_tr_b16 a[10:11], v216 offset:18432
s_add_u32 s69, s73, 0
v_mfma_f32_16x16x32_bf16 v[204:207], v[252:255], a[128:131], v[204:207]
ds_read_b64_tr_b16 a[12:13], v216 offset:20480
buffer_load_dwordx4 v226, s[32:35], s69 offen offset:0 lds
v_mfma_f32_16x16x32_bf16 v[204:207], v[248:251], a[116:119], v[204:207]
ds_read_b64_tr_b16 a[14:15], v216 offset:22528
buffer_load_dwordx4 v227, s[32:35], s69 offen offset:1024 lds
v_mfma_f32_16x16x32_bf16 v[196:199], v[248:251], a[112:115], v[196:199]
s_lshl_b32 s71, s3, 10
s_lshl_b32 s91, s19, 7
v_mfma_f32_16x16x32_bf16 v[196:199], v[252:255], a[124:127], v[196:199]
s_add_u32 s91, s91, s71
s_waitcnt lgkmcnt(4)
v_mfma_f32_16x16x32_bf16 v[208:211], a[0:3], a[120:123], v[208:211]
ds_read_b64_tr_b16 v[248:249], v217 offset:16384
s_mov_b32 s44, s56
v_mfma_f32_16x16x32_bf16 v[208:211], a[4:7], a[132:135], v[208:211]
ds_read_b64_tr_b16 v[250:251], v217 offset:18432
s_mov_b32 s45, s57
v_mfma_f32_16x16x32_bf16 v[200:203], a[4:7], a[128:131], v[200:203]
ds_read_b64_tr_b16 v[252:253], v217 offset:20480
s_mov_b32 s46, 2752512
v_mfma_f32_16x16x32_bf16 v[200:203], a[0:3], a[116:119], v[200:203]
ds_read_b64_tr_b16 v[254:255], v217 offset:22528
s_mov_b32 s47, 0x20000
v_mfma_f32_16x16x32_bf16 v[192:195], a[0:3], a[112:115], v[192:195]
s_mov_b32 s66, 80000000
s_mov_b32 s65, 0x42000000
v_mfma_f32_16x16x32_bf16 v[192:195], a[4:7], a[124:127], v[192:195]
v_mov_b32 v232, 0
s_waitcnt lgkmcnt(4)
v_mfma_f32_16x16x32_bf16 v[192:195], a[8:11], a[136:139], v[192:195]
ds_read_b64_tr_b16 a[0:1], v217 offset:24576
v_mov_b32 v233, 0
v_mfma_f32_16x16x32_bf16 v[192:195], a[12:15], a[148:151], v[192:195]
ds_read_b64_tr_b16 a[2:3], v217 offset:26624
v_mov_b32 v234, 0
v_mfma_f32_16x16x32_bf16 v[200:203], a[12:15], a[152:155], v[200:203]
ds_read_b64_tr_b16 a[4:5], v217 offset:28672
v_mfma_f32_16x16x32_bf16 v[200:203], a[8:11], a[140:143], v[200:203]
ds_read_b64_tr_b16 a[6:7], v217 offset:30720
v_mfma_f32_16x16x32_bf16 v[208:211], a[8:11], a[144:147], v[208:211]
s_cmp_eq_u32 s19, 7
s_cselect_b32 s11, 0, s19
v_mfma_f32_16x16x32_bf16 v[208:211], a[12:15], a[156:159], v[208:211]
s_mul_i32 s12, s87, 688128
s_waitcnt lgkmcnt(4)
v_mfma_f32_16x16x32_bf16 v[196:199], v[248:251], a[136:139], v[196:199]
ds_read_b64_tr_b16 a[8:9], v216 offset:24576
s_mul_i32 s3, s63, 3072
v_mfma_f32_16x16x32_bf16 v[196:199], v[252:255], a[148:151], v[196:199]
ds_read_b64_tr_b16 a[10:11], v216 offset:26624
s_add_u32 s12, s12, s3
v_mfma_f32_16x16x32_bf16 v[204:207], v[252:255], a[152:155], v[204:207]
ds_read_b64_tr_b16 a[12:13], v216 offset:28672
s_add_u32 s12, s12, 131072
v_mfma_f32_16x16x32_bf16 v[204:207], v[248:251], a[140:143], v[204:207]
ds_read_b64_tr_b16 a[14:15], v216 offset:30720
s_mul_i32 s13, s19, 12288
v_mfma_f32_16x16x32_bf16 v[212:215], v[248:251], a[144:147], v[212:215]
s_add_u32 s13, s13, s12
s_add_u32 s11, s11, 1
v_mfma_f32_16x16x32_bf16 v[212:215], v[252:255], a[156:159], v[212:215]
s_waitcnt vmcnt(5) lgkmcnt(4)
s_barrier
v_mfma_f32_16x16x32_bf16 v[212:215], a[0:3], a[168:171], v[212:215]
ds_read_b64_tr_b16 v[248:249], v216 offset:32768
s_mov_b32 s69, 229376
v_mfma_f32_16x16x32_bf16 v[212:215], a[4:7], a[180:183], v[212:215]
ds_read_b64_tr_b16 v[250:251], v216 offset:34816
buffer_load_dword v241, v239, s[36:39], s69 offen
v_mfma_f32_16x16x32_bf16 v[204:207], a[4:7], a[176:179], v[204:207]
ds_read_b64_tr_b16 v[252:253], v216 offset:36864
s_add_u32 m0, s67, 8192
v_mfma_f32_16x16x32_bf16 v[204:207], a[0:3], a[164:167], v[204:207]
ds_read_b64_tr_b16 v[254:255], v216 offset:38912
s_add_u32 s69, s73, 524288
v_mfma_f32_16x16x32_bf16 v[196:199], a[0:3], a[160:163], v[196:199]
buffer_load_dwordx4 v226, s[32:35], s69 offen offset:0 lds
buffer_load_dwordx4 v227, s[32:35], s69 offen offset:1024 lds
v_mfma_f32_16x16x32_bf16 v[196:199], a[4:7], a[172:175], v[196:199]
s_add_u32 m0, s67, 16384
s_waitcnt lgkmcnt(4)
v_mfma_f32_16x16x32_bf16 v[208:211], a[8:11], a[168:171], v[208:211]
ds_read_b64_tr_b16 a[0:1], v217 offset:32768
s_add_u32 s69, s73, 1048576
v_mfma_f32_16x16x32_bf16 v[208:211], a[12:15], a[180:183], v[208:211]
ds_read_b64_tr_b16 a[2:3], v217 offset:34816
buffer_load_dwordx4 v226, s[32:35], s69 offen offset:0 lds
v_mfma_f32_16x16x32_bf16 v[200:203], a[12:15], a[176:179], v[200:203]
ds_read_b64_tr_b16 a[4:5], v217 offset:36864
buffer_load_dwordx4 v227, s[32:35], s69 offen offset:1024 lds
v_mfma_f32_16x16x32_bf16 v[200:203], a[8:11], a[164:167], v[200:203]
ds_read_b64_tr_b16 a[6:7], v217 offset:38912
v_mfma_f32_16x16x32_bf16 v[192:195], a[8:11], a[160:163], v[192:195]
s_cmp_eq_u32 s11, 7
s_cselect_b32 s11, 0, s11
v_mfma_f32_16x16x32_bf16 v[192:195], a[12:15], a[172:175], v[192:195]
s_lshl_b32 s80, s11, 7
s_waitcnt lgkmcnt(4)
v_mfma_f32_16x16x32_bf16 v[192:195], v[248:251], a[184:187], v[192:195]
ds_read_b64_tr_b16 a[8:9], v217 offset:40960
s_mul_i32 s3, s11, 98304
v_mfma_f32_16x16x32_bf16 v[192:195], v[252:255], a[196:199], v[192:195]
ds_read_b64_tr_b16 a[10:11], v217 offset:43008
s_add_u32 s4, s3, s13
v_mfma_f32_16x16x32_bf16 v[200:203], v[252:255], a[200:203], v[200:203]
ds_read_b64_tr_b16 a[12:13], v217 offset:45056
s_add_u32 s11, s11, 1
v_mfma_f32_16x16x32_bf16 v[200:203], v[248:251], a[188:191], v[200:203]
ds_read_b64_tr_b16 a[14:15], v217 offset:47104
v_mfma_f32_16x16x32_bf16 v[208:211], v[248:251], a[192:195], v[208:211]
s_cmp_eq_u32 s11, 7
s_cselect_b32 s11, 0, s11
v_mfma_f32_16x16x32_bf16 v[208:211], v[252:255], a[204:207], v[208:211]
s_lshl_b32 s81, s11, 7
s_waitcnt lgkmcnt(4)
v_mfma_f32_16x16x32_bf16 v[196:199], a[0:3], a[184:187], v[196:199]
ds_read_b64_tr_b16 v[248:249], v216 offset:40960
s_mul_i32 s3, s11, 98304
v_mfma_f32_16x16x32_bf16 v[196:199], a[4:7], a[196:199], v[196:199]
ds_read_b64_tr_b16 v[250:251], v216 offset:43008
s_add_u32 s5, s3, s13
v_mfma_f32_16x16x32_bf16 v[204:207], a[4:7], a[200:203], v[204:207]
ds_read_b64_tr_b16 v[252:253], v216 offset:45056
s_add_u32 s11, s11, 1
v_mfma_f32_16x16x32_bf16 v[204:207], a[0:3], a[188:191], v[204:207]
ds_read_b64_tr_b16 v[254:255], v216 offset:47104
v_mfma_f32_16x16x32_bf16 v[212:215], a[0:3], a[192:195], v[212:215]
s_cmp_eq_u32 s11, 7
s_cselect_b32 s11, 0, s11
v_mfma_f32_16x16x32_bf16 v[212:215], a[4:7], a[204:207], v[212:215]
s_lshl_b32 s82, s11, 7
s_waitcnt vmcnt(5) lgkmcnt(4)
s_barrier
v_mfma_f32_16x16x32_bf16 v[212:215], a[8:11], a[216:219], v[212:215]
ds_read_b64_tr_b16 a[0:1], v216 offset:49152
s_add_u32 m0, s67, 24576
s_mul_i32 s3, s11, 98304
s_add_u32 s6, s3, s13
v_mfma_f32_16x16x32_bf16 v[212:215], a[12:15], a[228:231], v[212:215]
ds_read_b64_tr_b16 a[2:3], v216 offset:51200
s_add_u32 s69, s73, 1572864
s_add_u32 s11, s11, 1
s_cmp_eq_u32 s11, 7
s_cselect_b32 s11, 0, s11
v_mfma_f32_16x16x32_bf16 v[204:207], a[12:15], a[224:227], v[204:207]
ds_read_b64_tr_b16 a[4:5], v216 offset:53248
buffer_load_dwordx4 v226, s[32:35], s69 offen offset:0 lds
s_lshl_b32 s83, s11, 7
v_mfma_f32_16x16x32_bf16 v[204:207], a[8:11], a[212:215], v[204:207]
ds_read_b64_tr_b16 a[6:7], v216 offset:55296
buffer_load_dwordx4 v227, s[32:35], s69 offen offset:1024 lds
s_mul_i32 s3, s11, 98304
s_add_u32 s7, s3, s13
s_add_u32 s11, s11, 1
v_mfma_f32_16x16x32_bf16 v[196:199], a[8:11], a[208:211], v[196:199]
s_add_u32 m0, s67, 57344
s_add_u32 s69, s72, 0
s_cmp_eq_u32 s11, 7
s_cselect_b32 s11, 0, s11
v_mfma_f32_16x16x32_bf16 v[196:199], a[12:15], a[220:223], v[196:199]
buffer_load_dwordx4 v224, s[24:27], s69 offen offset:0 nt lds
s_lshl_b32 s84, s11, 7
s_mul_i32 s3, s11, 98304
s_add_u32 s8, s3, s13
s_waitcnt lgkmcnt(4)
v_mfma_f32_16x16x32_bf16 v[208:211], v[248:251], a[216:219], v[208:211]
ds_read_b64_tr_b16 a[8:9], v217 offset:49152
buffer_load_dwordx4 v225, s[24:27], s69 offen offset:1024 nt lds
s_add_u32 s11, s11, 1
s_cmp_eq_u32 s11, 7
s_cselect_b32 s11, 0, s11
v_mfma_f32_16x16x32_bf16 v[208:211], v[252:255], a[228:231], v[208:211]
ds_read_b64_tr_b16 a[10:11], v217 offset:51200
s_add_u32 m0, s67, 65536
s_lshl_b32 s85, s11, 7
s_mul_i32 s3, s11, 98304
v_mfma_f32_16x16x32_bf16 v[200:203], v[252:255], a[224:227], v[200:203]
ds_read_b64_tr_b16 a[12:13], v217 offset:53248
s_add_u32 s69, s72, 32768
s_add_u32 s9, s3, s13
s_add_u32 s11, s11, 1
s_cmp_eq_u32 s11, 7
s_cselect_b32 s11, 0, s11
v_mfma_f32_16x16x32_bf16 v[200:203], v[248:251], a[212:215], v[200:203]
ds_read_b64_tr_b16 a[14:15], v217 offset:55296
buffer_load_dwordx4 v224, s[24:27], s69 offen offset:0 nt lds
s_lshl_b32 s86, s11, 7
s_mul_i32 s3, s11, 98304
v_mfma_f32_16x16x32_bf16 v[192:195], v[248:251], a[208:211], v[192:195]
buffer_load_dwordx4 v225, s[24:27], s69 offen offset:1024 nt lds
s_add_u32 m0, s67, 73728
s_add_u32 s10, s3, s13
v_mfma_f32_16x16x32_bf16 v[192:195], v[252:255], a[220:223], v[192:195]
s_add_u32 s69, s72, 65536
s_waitcnt lgkmcnt(4)
v_mfma_f32_16x16x32_bf16 v[192:195], a[0:3], a[232:235], v[192:195]
ds_read_b64_tr_b16 v[248:249], v216 offset:0
buffer_load_dwordx4 v224, s[24:27], s69 offen offset:0 nt lds
v_mfma_f32_16x16x32_bf16 v[192:195], a[4:7], a[244:247], v[192:195]
ds_read_b64_tr_b16 v[250:251], v216 offset:2048
buffer_load_dwordx4 v225, s[24:27], s69 offen offset:1024 nt lds
v_mfma_f32_16x16x32_bf16 v[200:203], a[4:7], a[248:251], v[200:203]
ds_read_b64_tr_b16 v[252:253], v216 offset:4096
s_add_u32 m0, s67, 81920
v_mfma_f32_16x16x32_bf16 v[200:203], a[0:3], a[236:239], v[200:203]
ds_read_b64_tr_b16 v[254:255], v216 offset:6144
s_add_u32 s69, s72, 98304
v_mfma_f32_16x16x32_bf16 v[208:211], a[0:3], a[240:243], v[208:211]
buffer_load_dwordx4 v224, s[24:27], s69 offen offset:0 nt lds
buffer_load_dwordx4 v225, s[24:27], s69 offen offset:1024 nt lds
v_mul_f32 v192, s64, v192
v_mul_f32 v193, s64, v193
v_mul_f32 v194, s64, v194
v_mul_f32 v195, s64, v195
v_cvt_pk_bf16_f32 v192, v192, v193
v_cvt_pk_bf16_f32 v193, v194, v195
v_mfma_f32_16x16x32_bf16 v[208:211], a[4:7], a[252:255], v[208:211]
s_waitcnt lgkmcnt(4)
v_mfma_f32_16x16x32_bf16 v[196:199], a[8:11], a[232:235], v[196:199]
ds_read_b64_tr_b16 a[0:1], v217 offset:0
v_mul_f32 v200, s64, v200
v_mul_f32 v201, s64, v201
v_mul_f32 v202, s64, v202
v_mul_f32 v203, s64, v203
v_mfma_f32_16x16x32_bf16 v[196:199], a[12:15], a[244:247], v[196:199]
ds_read_b64_tr_b16 a[2:3], v217 offset:2048
v_mfma_f32_16x16x32_bf16 v[204:207], a[12:15], a[248:251], v[204:207]
ds_read_b64_tr_b16 a[4:5], v217 offset:4096
v_mul_f32 v208, s64, v208
v_mul_f32 v209, s64, v209
v_mul_f32 v210, s64, v210
v_mul_f32 v211, s64, v211
v_mfma_f32_16x16x32_bf16 v[204:207], a[8:11], a[236:239], v[204:207]
ds_read_b64_tr_b16 a[6:7], v217 offset:6144
v_mfma_f32_16x16x32_bf16 v[212:215], a[8:11], a[240:243], v[212:215]
v_mul_f32 v196, s64, v196
v_mul_f32 v197, s64, v197
v_mul_f32 v198, s64, v198
v_mul_f32 v199, s64, v199
v_cvt_pk_bf16_f32 v194, v196, v197
v_cvt_pk_bf16_f32 v195, v198, v199
v_cvt_pk_bf16_f32 v196, v200, v201
v_permlane16_swap_b32 v192, v194
v_permlane16_swap_b32 v193, v195
v_cvt_pk_bf16_f32 v197, v202, v203
v_cvt_pk_bf16_f32 v200, v208, v209
v_cvt_pk_bf16_f32 v201, v210, v211
v_mfma_f32_16x16x32_bf16 v[212:215], a[12:15], a[252:255], v[212:215]
ds_write_b64 v228, v[192:193] offset:6144
s_waitcnt vmcnt(8) lgkmcnt(5)
s_barrier
ds_write_b64 v228, v[194:195] offset:6152
v_mfma_f32_16x16x32_bf16 v[192:195], v[248:251], a[88:91], 0
ds_read_b64_tr_b16 a[8:9], v217 offset:8192
s_add_u32 m0, s67, 32768
v_mul_f32 v204, s64, v204
v_mul_f32 v205, s64, v205
v_mul_f32 v206, s64, v206
v_mul_f32 v207, s64, v207
v_cvt_pk_bf16_f32 v198, v204, v205
v_cvt_pk_bf16_f32 v199, v206, v207
v_mfma_f32_16x16x32_bf16 v[192:195], v[252:255], a[100:103], v[192:195]
ds_read_b64_tr_b16 a[10:11], v217 offset:10240
s_add_u32 s69, s73, 2097152
v_permlane16_swap_b32 v196, v198
v_permlane16_swap_b32 v197, v199
v_mul_f32 v212, s64, v212
v_mul_f32 v213, s64, v213
v_mul_f32 v214, s64, v214
v_mul_f32 v215, s64, v215
v_cvt_pk_bf16_f32 v202, v212, v213
v_cvt_pk_bf16_f32 v203, v214, v215
s_nop 0
v_permlane16_swap_b32 v200, v202
v_permlane16_swap_b32 v201, v203
ds_write_b64 v228, v[196:197] offset:7168
ds_write_b64 v228, v[198:199] offset:7176
ds_write_b64 v228, v[200:201] offset:8192
ds_write_b64 v228, v[202:203] offset:8200
v_mfma_f32_16x16x32_bf16 v[200:203], v[252:255], a[104:107], 0
ds_read_b64_tr_b16 a[12:13], v217 offset:12288
buffer_load_dwordx4 v226, s[32:35], s69 offen offset:0 lds
v_mfma_f32_16x16x32_bf16 v[200:203], v[248:251], a[92:95], v[200:203]
ds_read_b64_tr_b16 a[14:15], v217 offset:14336
buffer_load_dwordx4 v227, s[32:35], s69 offen offset:1024 lds
v_mfma_f32_16x16x32_bf16 v[208:211], v[248:251], a[96:99], 0
s_add_u32 m0, s67, 40960
s_add_u32 s69, s73, 2621440
v_mfma_f32_16x16x32_bf16 v[208:211], v[252:255], a[108:111], v[208:211]
buffer_load_dwordx4 v226, s[32:35], s69 offen offset:0 lds
s_waitcnt lgkmcnt(10)
v_mfma_f32_16x16x32_bf16 v[196:199], a[0:3], a[88:91], 0
ds_read_b64_tr_b16 v[248:249], v216 offset:8192
buffer_load_dwordx4 v227, s[32:35], s69 offen offset:1024 lds
v_mfma_f32_16x16x32_bf16 v[196:199], a[4:7], a[100:103], v[196:199]
ds_read_b64_tr_b16 v[250:251], v216 offset:10240
s_add_u32 m0, s67, 49152
v_mfma_f32_16x16x32_bf16 v[204:207], a[4:7], a[104:107], 0
ds_read_b64_tr_b16 v[252:253], v216 offset:12288
s_add_u32 s69, s73, 3145728
v_mfma_f32_16x16x32_bf16 v[204:207], a[0:3], a[92:95], v[204:207]
ds_read_b64_tr_b16 v[254:255], v216 offset:14336
buffer_load_dwordx4 v226, s[32:35], s69 offen offset:0 lds
v_mfma_f32_16x16x32_bf16 v[212:215], a[0:3], a[96:99], 0
buffer_load_dwordx4 v227, s[32:35], s69 offen offset:1024 lds
v_mfma_f32_16x16x32_bf16 v[212:215], a[4:7], a[108:111], v[212:215]
s_waitcnt lgkmcnt(4)
v_mfma_f32_16x16x32_bf16 v[212:215], a[8:11], a[120:123], v[212:215]
ds_read_b64_tr_b16 a[0:1], v216 offset:16384
v_mfma_f32_16x16x32_bf16 v[212:215], a[12:15], a[132:135], v[212:215]
ds_read_b64_tr_b16 a[2:3], v216 offset:18432
v_mfma_f32_16x16x32_bf16 v[204:207], a[12:15], a[128:131], v[204:207]
ds_read_b64_tr_b16 a[4:5], v216 offset:20480
v_mfma_f32_16x16x32_bf16 v[204:207], a[8:11], a[116:119], v[204:207]
ds_read_b64_tr_b16 a[6:7], v216 offset:22528
v_mfma_f32_16x16x32_bf16 v[196:199], a[8:11], a[112:115], v[196:199]
v_mfma_f32_16x16x32_bf16 v[196:199], a[12:15], a[124:127], v[196:199]
s_waitcnt lgkmcnt(4)
v_mfma_f32_16x16x32_bf16 v[208:211], v[248:251], a[120:123], v[208:211]
ds_read_b64_tr_b16 a[8:9], v217 offset:16384
v_mfma_f32_16x16x32_bf16 v[208:211], v[252:255], a[132:135], v[208:211]
ds_read_b64_tr_b16 a[10:11], v217 offset:18432
v_mfma_f32_16x16x32_bf16 v[200:203], v[252:255], a[128:131], v[200:203]
ds_read_b64_tr_b16 a[12:13], v217 offset:20480
v_mfma_f32_16x16x32_bf16 v[200:203], v[248:251], a[116:119], v[200:203]
ds_read_b64_tr_b16 a[14:15], v217 offset:22528
v_mfma_f32_16x16x32_bf16 v[192:195], v[248:251], a[112:115], v[192:195]
v_mfma_f32_16x16x32_bf16 v[192:195], v[252:255], a[124:127], v[192:195]
s_waitcnt lgkmcnt(4)
v_mfma_f32_16x16x32_bf16 v[192:195], a[0:3], a[136:139], v[192:195]
ds_read_b64_tr_b16 v[248:249], v217 offset:24576
v_mfma_f32_16x16x32_bf16 v[192:195], a[4:7], a[148:151], v[192:195]
ds_read_b64_tr_b16 v[250:251], v217 offset:26624
v_mfma_f32_16x16x32_bf16 v[200:203], a[4:7], a[152:155], v[200:203]
ds_read_b64_tr_b16 v[252:253], v217 offset:28672
v_mfma_f32_16x16x32_bf16 v[200:203], a[0:3], a[140:143], v[200:203]
ds_read_b64_tr_b16 v[254:255], v217 offset:30720
v_mfma_f32_16x16x32_bf16 v[208:211], a[0:3], a[144:147], v[208:211]
v_mfma_f32_16x16x32_bf16 v[208:211], a[4:7], a[156:159], v[208:211]
s_waitcnt lgkmcnt(4)
v_mfma_f32_16x16x32_bf16 v[196:199], a[8:11], a[136:139], v[196:199]
ds_read_b64_tr_b16 a[0:1], v216 offset:24576
v_mfma_f32_16x16x32_bf16 v[196:199], a[12:15], a[148:151], v[196:199]
ds_read_b64_tr_b16 a[2:3], v216 offset:26624
v_mfma_f32_16x16x32_bf16 v[204:207], a[12:15], a[152:155], v[204:207]
ds_read_b64_tr_b16 a[4:5], v216 offset:28672
v_mfma_f32_16x16x32_bf16 v[204:207], a[8:11], a[140:143], v[204:207]
ds_read_b64_tr_b16 a[6:7], v216 offset:30720
v_mfma_f32_16x16x32_bf16 v[212:215], a[8:11], a[144:147], v[212:215]
v_mfma_f32_16x16x32_bf16 v[212:215], a[12:15], a[156:159], v[212:215]
s_waitcnt vmcnt(10) lgkmcnt(4)
s_barrier
v_mfma_f32_16x16x32_bf16 v[212:215], v[248:251], a[168:171], v[212:215]
ds_read_b128 a[8:11], v222 offset:0
s_add_u32 m0, s67, 90112
ds_read_b128 a[16:19], v230 offset:6144
v_mfma_f32_16x16x32_bf16 v[212:215], v[252:255], a[180:183], v[212:215]
ds_read_b128 a[12:15], v223 offset:0
s_add_u32 s69, s72, 131072
ds_read_b128 a[28:31], v230 offset:16384
v_mfma_f32_16x16x32_bf16 v[204:207], v[252:255], a[176:179], v[204:207]
buffer_load_dwordx4 v224, s[24:27], s69 offen offset:0 nt lds
buffer_load_dwordx4 v225, s[24:27], s69 offen offset:1024 nt lds
ds_read_b128 a[32:35], v230 offset:17408
v_mfma_f32_16x16x32_bf16 v[204:207], v[248:251], a[164:167], v[204:207]
s_add_u32 m0, s67, 98304
s_add_u32 s69, s72, 163840
ds_read_b128 a[20:23], v230 offset:7168
v_mfma_f32_16x16x32_bf16 v[196:199], v[248:251], a[160:163], v[196:199]
buffer_load_dwordx4 v224, s[24:27], s69 offen offset:0 nt lds
buffer_load_dwordx4 v225, s[24:27], s69 offen offset:1024 nt lds
ds_read_b128 a[24:27], v230 offset:8192
v_mfma_f32_16x16x32_bf16 v[196:199], v[252:255], a[172:175], v[196:199]
ds_read_b128 a[36:39], v230 offset:18432
s_waitcnt lgkmcnt(8)
v_mfma_f32_16x16x32_bf16 v[208:211], a[0:3], a[168:171], v[208:211]
ds_read_b128 v[248:251], v222 offset:2048
v_mfma_f32_16x16x32_bf16 v[208:211], a[4:7], a[180:183], v[208:211]
ds_read_b128 v[252:255], v223 offset:2048
v_mfma_f32_16x16x32_bf16 v[200:203], a[4:7], a[176:179], v[200:203]
v_mfma_f32_16x16x32_bf16 v[200:203], a[0:3], a[164:167], v[200:203]
v_mfma_f32_16x16x32_bf16 v[192:195], a[0:3], a[160:163], v[192:195]
v_mfma_f32_16x16x32_bf16 v[192:195], a[4:7], a[172:175], v[192:195]
s_waitcnt lgkmcnt(7)
v_mfma_f32_16x16x32_bf16 v[0:3], a[8:11], a[16:19], 0
ds_read_b128 a[0:3], v222 offset:8192
s_waitcnt lgkmcnt(7)
v_mfma_f32_16x16x32_bf16 v[0:3], a[12:15], a[28:31], v[0:3]
ds_read_b128 a[4:7], v223 offset:8192
s_waitcnt lgkmcnt(7)
v_mfma_f32_16x16x32_bf16 v[8:11], a[12:15], a[32:35], 0
s_waitcnt lgkmcnt(6)
v_mfma_f32_16x16x32_bf16 v[8:11], a[8:11], a[20:23], v[8:11]
s_waitcnt lgkmcnt(5)
v_mfma_f32_16x16x32_bf16 v[16:19], a[8:11], a[24:27], 0
s_waitcnt lgkmcnt(4)
v_mfma_f32_16x16x32_bf16 v[16:19], a[12:15], a[36:39], v[16:19]
s_waitcnt lgkmcnt(2)
v_mfma_f32_16x16x32_bf16 v[4:7], v[248:251], a[16:19], 0
ds_read_b128 a[8:11], v222 offset:10240
v_mfma_f32_16x16x32_bf16 v[4:7], v[252:255], a[28:31], v[4:7]
ds_read_b128 a[12:15], v223 offset:10240
v_mfma_f32_16x16x32_bf16 v[12:15], v[252:255], a[32:35], 0
v_mfma_f32_16x16x32_bf16 v[12:15], v[248:251], a[20:23], v[12:15]
v_mfma_f32_16x16x32_bf16 v[20:23], v[248:251], a[24:27], 0
v_mfma_f32_16x16x32_bf16 v[20:23], v[252:255], a[36:39], v[20:23]
s_waitcnt vmcnt(10) lgkmcnt(2)
s_barrier
v_mfma_f32_16x16x32_bf16 v[24:27], a[0:3], a[16:19], 0
ds_read_b128 v[248:251], v222 offset:16384
s_add_u32 m0, s67, 106496
v_mfma_f32_16x16x32_bf16 v[24:27], a[4:7], a[28:31], v[24:27]
ds_read_b128 v[252:255], v223 offset:16384
s_add_u32 s69, s72, 196608
v_mfma_f32_16x16x32_bf16 v[32:35], a[4:7], a[32:35], 0
buffer_load_dwordx4 v224, s[24:27], s69 offen offset:0 nt lds
buffer_load_dwordx4 v225, s[24:27], s69 offen offset:1024 nt lds
v_mfma_f32_16x16x32_bf16 v[32:35], a[0:3], a[20:23], v[32:35]
s_add_u32 m0, s67, 114688
s_add_u32 s69, s72, 229376
v_mfma_f32_16x16x32_bf16 v[40:43], a[0:3], a[24:27], 0
buffer_load_dwordx4 v224, s[24:27], s69 offen offset:0 nt lds
buffer_load_dwordx4 v225, s[24:27], s69 offen offset:1024 nt lds
v_mfma_f32_16x16x32_bf16 v[40:43], a[4:7], a[36:39], v[40:43]
s_waitcnt lgkmcnt(2)
v_mfma_f32_16x16x32_bf16 v[28:31], a[8:11], a[16:19], 0
ds_read_b128 a[0:3], v222 offset:18432
v_mfma_f32_16x16x32_bf16 v[28:31], a[12:15], a[28:31], v[28:31]
ds_read_b128 a[4:7], v223 offset:18432
v_mfma_f32_16x16x32_bf16 v[36:39], a[12:15], a[32:35], 0
v_mfma_f32_16x16x32_bf16 v[36:39], a[8:11], a[20:23], v[36:39]
v_mfma_f32_16x16x32_bf16 v[44:47], a[8:11], a[24:27], 0
v_mfma_f32_16x16x32_bf16 v[44:47], a[12:15], a[36:39], v[44:47]
s_waitcnt lgkmcnt(2)
v_mfma_f32_16x16x32_bf16 v[48:51], v[248:251], a[16:19], 0
ds_read_b128 a[8:11], v222 offset:24576
v_mfma_f32_16x16x32_bf16 v[48:51], v[252:255], a[28:31], v[48:51]
ds_read_b128 a[12:15], v223 offset:24576
v_mfma_f32_16x16x32_bf16 v[56:59], v[252:255], a[32:35], 0
v_mfma_f32_16x16x32_bf16 v[56:59], v[248:251], a[20:23], v[56:59]
v_mfma_f32_16x16x32_bf16 v[64:67], v[248:251], a[24:27], 0
v_mfma_f32_16x16x32_bf16 v[64:67], v[252:255], a[36:39], v[64:67]
s_waitcnt lgkmcnt(2)
v_mfma_f32_16x16x32_bf16 v[52:55], a[0:3], a[16:19], 0
ds_read_b128 v[248:251], v222 offset:26624
v_mfma_f32_16x16x32_bf16 v[52:55], a[4:7], a[28:31], v[52:55]
ds_read_b128 v[252:255], v223 offset:26624
v_mfma_f32_16x16x32_bf16 v[60:63], a[4:7], a[32:35], 0
v_mfma_f32_16x16x32_bf16 v[60:63], a[0:3], a[20:23], v[60:63]
v_mfma_f32_16x16x32_bf16 v[68:71], a[0:3], a[24:27], 0
v_mfma_f32_16x16x32_bf16 v[68:71], a[4:7], a[36:39], v[68:71]
s_waitcnt vmcnt(8) lgkmcnt(2)
s_barrier
v_mfma_f32_16x16x32_bf16 v[72:75], a[8:11], a[16:19], 0
ds_read_b64_tr_b16 a[0:1], v216 offset:32768
s_add_u32 m0, s67, 0
v_mfma_f32_16x16x32_bf16 v[72:75], a[12:15], a[28:31], v[72:75]
ds_read_b64_tr_b16 a[2:3], v216 offset:34816
s_add_u32 s69, s74, 0
v_mfma_f32_16x16x32_bf16 v[80:83], a[12:15], a[32:35], 0
ds_read_b64_tr_b16 a[4:5], v216 offset:36864
buffer_load_dwordx4 v226, s[32:35], s69 offen offset:0 lds
v_mfma_f32_16x16x32_bf16 v[80:83], a[8:11], a[20:23], v[80:83]
ds_read_b64_tr_b16 a[6:7], v216 offset:38912
buffer_load_dwordx4 v227, s[32:35], s69 offen offset:1024 lds
v_mfma_f32_16x16x32_bf16 v[88:91], a[8:11], a[24:27], 0
s_add_u32 m0, s67, 8192
s_add_u32 s69, s74, 524288
v_mfma_f32_16x16x32_bf16 v[88:91], a[12:15], a[36:39], v[88:91]
buffer_load_dwordx4 v226, s[32:35], s69 offen offset:0 lds
s_waitcnt lgkmcnt(4)
v_mfma_f32_16x16x32_bf16 v[76:79], v[248:251], a[16:19], 0
ds_read_b64_tr_b16 a[8:9], v217 offset:32768
buffer_load_dwordx4 v227, s[32:35], s69 offen offset:1024 lds
v_mfma_f32_16x16x32_bf16 v[76:79], v[252:255], a[28:31], v[76:79]
ds_read_b64_tr_b16 a[10:11], v217 offset:34816
s_add_u32 m0, s67, 16384
v_mfma_f32_16x16x32_bf16 v[84:87], v[252:255], a[32:35], 0
ds_read_b64_tr_b16 a[12:13], v217 offset:36864
s_add_u32 s69, s74, 1048576
v_mfma_f32_16x16x32_bf16 v[84:87], v[248:251], a[20:23], v[84:87]
ds_read_b64_tr_b16 a[14:15], v217 offset:38912
buffer_load_dwordx4 v226, s[32:35], s69 offen offset:0 lds
v_mfma_f32_16x16x32_bf16 v[92:95], v[248:251], a[24:27], 0
buffer_load_dwordx4 v227, s[32:35], s69 offen offset:1024 lds
v_mfma_f32_16x16x32_bf16 v[92:95], v[252:255], a[36:39], v[92:95]
s_waitcnt lgkmcnt(4)
v_mfma_f32_16x16x32_bf16 v[192:195], a[0:3], a[184:187], v[192:195]
ds_read_b64_tr_b16 v[248:249], v217 offset:40960
v_mfma_f32_16x16x32_bf16 v[192:195], a[4:7], a[196:199], v[192:195]
ds_read_b64_tr_b16 v[250:251], v217 offset:43008
v_mfma_f32_16x16x32_bf16 v[200:203], a[4:7], a[200:203], v[200:203]
ds_read_b64_tr_b16 v[252:253], v217 offset:45056
v_mfma_f32_16x16x32_bf16 v[200:203], a[0:3], a[188:191], v[200:203]
ds_read_b64_tr_b16 v[254:255], v217 offset:47104
v_mfma_f32_16x16x32_bf16 v[208:211], a[0:3], a[192:195], v[208:211]
v_mfma_f32_16x16x32_bf16 v[208:211], a[4:7], a[204:207], v[208:211]
s_waitcnt lgkmcnt(4)
v_mfma_f32_16x16x32_bf16 v[196:199], a[8:11], a[184:187], v[196:199]
ds_read_b64_tr_b16 a[0:1], v216 offset:40960
v_mfma_f32_16x16x32_bf16 v[196:199], a[12:15], a[196:199], v[196:199]
ds_read_b64_tr_b16 a[2:3], v216 offset:43008
v_mfma_f32_16x16x32_bf16 v[204:207], a[12:15], a[200:203], v[204:207]
ds_read_b64_tr_b16 a[4:5], v216 offset:45056
v_mfma_f32_16x16x32_bf16 v[204:207], a[8:11], a[188:191], v[204:207]
ds_read_b64_tr_b16 a[6:7], v216 offset:47104
v_mfma_f32_16x16x32_bf16 v[212:215], a[8:11], a[192:195], v[212:215]
v_mfma_f32_16x16x32_bf16 v[212:215], a[12:15], a[204:207], v[212:215]
s_waitcnt lgkmcnt(4)
v_mfma_f32_16x16x32_bf16 v[212:215], v[248:251], a[216:219], v[212:215]
ds_read_b64_tr_b16 a[8:9], v216 offset:49152
v_mfma_f32_16x16x32_bf16 v[212:215], v[252:255], a[228:231], v[212:215]
ds_read_b64_tr_b16 a[10:11], v216 offset:51200
v_mfma_f32_16x16x32_bf16 v[204:207], v[252:255], a[224:227], v[204:207]
ds_read_b64_tr_b16 a[12:13], v216 offset:53248
v_mfma_f32_16x16x32_bf16 v[204:207], v[248:251], a[212:215], v[204:207]
ds_read_b64_tr_b16 a[14:15], v216 offset:55296
v_mfma_f32_16x16x32_bf16 v[196:199], v[248:251], a[208:211], v[196:199]
v_mfma_f32_16x16x32_bf16 v[196:199], v[252:255], a[220:223], v[196:199]
s_waitcnt lgkmcnt(4)
v_mfma_f32_16x16x32_bf16 v[208:211], a[0:3], a[216:219], v[208:211]
ds_read_b64_tr_b16 v[248:249], v217 offset:49152
v_mfma_f32_16x16x32_bf16 v[208:211], a[4:7], a[228:231], v[208:211]
ds_read_b64_tr_b16 v[250:251], v217 offset:51200
v_mfma_f32_16x16x32_bf16 v[200:203], a[4:7], a[224:227], v[200:203]
ds_read_b64_tr_b16 v[252:253], v217 offset:53248
v_mfma_f32_16x16x32_bf16 v[200:203], a[0:3], a[212:215], v[200:203]
ds_read_b64_tr_b16 v[254:255], v217 offset:55296
v_mfma_f32_16x16x32_bf16 v[192:195], a[0:3], a[208:211], v[192:195]
v_mfma_f32_16x16x32_bf16 v[192:195], a[4:7], a[220:223], v[192:195]
s_waitcnt vmcnt(10) lgkmcnt(4)
s_barrier
v_mfma_f32_16x16x32_bf16 v[192:195], a[8:11], a[232:235], v[192:195]
ds_read_b128 a[0:3], v222 offset:32768
s_add_u32 m0, s67, 57344
v_mfma_f32_16x16x32_bf16 v[192:195], a[12:15], a[244:247], v[192:195]
ds_read_b128 a[4:7], v223 offset:32768
s_add_u32 s69, s73, 0
v_mfma_f32_16x16x32_bf16 v[200:203], a[12:15], a[248:251], v[200:203]
buffer_load_dwordx4 v224, s[24:27], s69 offen offset:0 nt lds
buffer_load_dwordx4 v225, s[24:27], s69 offen offset:1024 nt lds
v_mfma_f32_16x16x32_bf16 v[200:203], a[8:11], a[236:239], v[200:203]
s_add_u32 m0, s67, 65536
s_add_u32 s69, s73, 32768
v_mfma_f32_16x16x32_bf16 v[208:211], a[8:11], a[240:243], v[208:211]
buffer_load_dwordx4 v224, s[24:27], s69 offen offset:0 nt lds
buffer_load_dwordx4 v225, s[24:27], s69 offen offset:1024 nt lds
v_mul_f32 v192, s64, v192
v_mul_f32 v193, s64, v193
v_mfma_f32_16x16x32_bf16 v[208:211], a[12:15], a[252:255], v[208:211]
v_mul_f32 v194, s64, v194
s_waitcnt lgkmcnt(2)
v_mfma_f32_16x16x32_bf16 v[196:199], v[248:251], a[232:235], v[196:199]
ds_read_b128 a[8:11], v222 offset:34816
v_mul_f32 v195, s64, v195
v_mfma_f32_16x16x32_bf16 v[196:199], v[252:255], a[244:247], v[196:199]
ds_read_b128 a[12:15], v223 offset:34816
v_cvt_pk_bf16_f32 v192, v192, v193
v_mfma_f32_16x16x32_bf16 v[204:207], v[252:255], a[248:251], v[204:207]
v_cvt_pk_bf16_f32 v193, v194, v195
v_mul_f32 v200, s64, v200
v_mfma_f32_16x16x32_bf16 v[204:207], v[248:251], a[236:239], v[204:207]
v_mul_f32 v201, s64, v201
v_mul_f32 v202, s64, v202
v_mfma_f32_16x16x32_bf16 v[212:215], v[248:251], a[240:243], v[212:215]
v_mul_f32 v196, s64, v196
v_mul_f32 v197, s64, v197
v_mfma_f32_16x16x32_bf16 v[212:215], v[252:255], a[252:255], v[212:215]
v_mul_f32 v198, s64, v198
s_waitcnt lgkmcnt(2)
v_mfma_f32_16x16x32_bf16 v[96:99], a[0:3], a[16:19], 0
ds_read_b128 v[248:251], v222 offset:40960
v_mul_f32 v199, s64, v199
v_mfma_f32_16x16x32_bf16 v[96:99], a[4:7], a[28:31], v[96:99]
ds_read_b128 v[252:255], v223 offset:40960
v_cvt_pk_bf16_f32 v194, v196, v197
v_mfma_f32_16x16x32_bf16 v[104:107], a[4:7], a[32:35], 0
v_cvt_pk_bf16_f32 v195, v198, v199
v_mul_f32 v203, s64, v203
v_mfma_f32_16x16x32_bf16 v[104:107], a[0:3], a[20:23], v[104:107]
v_permlane16_swap_b32 v192, v194
v_mfma_f32_16x16x32_bf16 v[112:115], a[0:3], a[24:27], 0
v_permlane16_swap_b32 v193, v195
v_mfma_f32_16x16x32_bf16 v[112:115], a[4:7], a[36:39], v[112:115]
ds_write_b64 v228, v[192:193] offset:6144
s_waitcnt lgkmcnt(3)
v_mfma_f32_16x16x32_bf16 v[100:103], a[8:11], a[16:19], 0
ds_read_b128 a[0:3], v222 offset:43008
v_mul_f32 v204, s64, v204
v_mfma_f32_16x16x32_bf16 v[100:103], a[12:15], a[28:31], v[100:103]
ds_read_b128 a[4:7], v223 offset:43008
ds_write_b64 v228, v[194:195] offset:6152
v_mfma_f32_16x16x32_bf16 v[108:111], a[12:15], a[32:35], 0
v_mul_f32 v205, s64, v205
v_mul_f32 v206, s64, v206
v_mfma_f32_16x16x32_bf16 v[108:111], a[8:11], a[20:23], v[108:111]
v_mul_f32 v207, s64, v207
v_cvt_pk_bf16_f32 v196, v200, v201
v_mfma_f32_16x16x32_bf16 v[116:119], a[8:11], a[24:27], 0
v_cvt_pk_bf16_f32 v197, v202, v203
v_cvt_pk_bf16_f32 v198, v204, v205
v_mfma_f32_16x16x32_bf16 v[116:119], a[12:15], a[36:39], v[116:119]
s_waitcnt vmcnt(10) lgkmcnt(4)
s_barrier
v_mfma_f32_16x16x32_bf16 v[120:123], v[248:251], a[16:19], 0
ds_read_b128 a[8:11], v222 offset:49152
s_add_u32 m0, s67, 73728
v_mfma_f32_16x16x32_bf16 v[120:123], v[252:255], a[28:31], v[120:123]
ds_read_b128 a[12:15], v223 offset:49152
s_add_u32 s69, s73, 65536
v_mfma_f32_16x16x32_bf16 v[128:131], v[252:255], a[32:35], 0
buffer_load_dwordx4 v224, s[24:27], s69 offen offset:0 nt lds
buffer_load_dwordx4 v225, s[24:27], s69 offen offset:1024 nt lds
v_mfma_f32_16x16x32_bf16 v[128:131], v[248:251], a[20:23], v[128:131]
s_add_u32 m0, s67, 81920
s_add_u32 s69, s73, 98304
v_mfma_f32_16x16x32_bf16 v[136:139], v[248:251], a[24:27], 0
buffer_load_dwordx4 v224, s[24:27], s69 offen offset:0 nt lds
buffer_load_dwordx4 v225, s[24:27], s69 offen offset:1024 nt lds
v_cvt_pk_bf16_f32 v199, v206, v207
v_mfma_f32_16x16x32_bf16 v[136:139], v[252:255], a[36:39], v[136:139]
v_mul_f32 v208, s64, v208
s_waitcnt lgkmcnt(3)
v_mfma_f32_16x16x32_bf16 v[124:127], a[0:3], a[16:19], 0
ds_read_b128 v[248:251], v222 offset:51200
v_mul_f32 v209, s64, v209
v_mfma_f32_16x16x32_bf16 v[124:127], a[4:7], a[28:31], v[124:127]
ds_read_b128 v[252:255], v223 offset:51200
v_mul_f32 v210, s64, v210
v_mfma_f32_16x16x32_bf16 v[132:135], a[4:7], a[32:35], 0
v_permlane16_swap_b32 v196, v198
v_mfma_f32_16x16x32_bf16 v[132:135], a[0:3], a[20:23], v[132:135]
v_permlane16_swap_b32 v197, v199
v_mfma_f32_16x16x32_bf16 v[140:143], a[0:3], a[24:27], 0
ds_write_b64 v228, v[196:197] offset:7168
v_mul_f32 v211, s64, v211
v_mfma_f32_16x16x32_bf16 v[140:143], a[4:7], a[36:39], v[140:143]
v_mul_f32 v212, s64, v212
s_waitcnt lgkmcnt(3)
v_mfma_f32_16x16x32_bf16 v[144:147], a[8:11], a[16:19], 0
ds_read_b128 a[0:3], v222 offset:57344
ds_write_b64 v228, v[198:199] offset:7176
v_mfma_f32_16x16x32_bf16 v[144:147], a[12:15], a[28:31], v[144:147]
ds_read_b128 a[4:7], v223 offset:57344
v_mul_f32 v213, s64, v213
v_mfma_f32_16x16x32_bf16 v[152:155], a[12:15], a[32:35], 0
v_mul_f32 v214, s64, v214
v_mul_f32 v215, s64, v215
v_mfma_f32_16x16x32_bf16 v[152:155], a[8:11], a[20:23], v[152:155]
v_cvt_pk_bf16_f32 v200, v208, v209
v_cvt_pk_bf16_f32 v201, v210, v211
v_mfma_f32_16x16x32_bf16 v[160:163], a[8:11], a[24:27], 0
v_cvt_pk_bf16_f32 v202, v212, v213
v_cvt_pk_bf16_f32 v203, v214, v215
v_mfma_f32_16x16x32_bf16 v[160:163], a[12:15], a[36:39], v[160:163]
s_waitcnt lgkmcnt(4)
v_mfma_f32_16x16x32_bf16 v[148:151], v[248:251], a[16:19], 0
ds_read_b128 a[8:11], v222 offset:59392
v_mfma_f32_16x16x32_bf16 v[148:151], v[252:255], a[28:31], v[148:151]
ds_read_b128 a[12:15], v223 offset:59392
v_mfma_f32_16x16x32_bf16 v[156:159], v[252:255], a[32:35], 0
v_permlane16_swap_b32 v200, v202
v_mfma_f32_16x16x32_bf16 v[156:159], v[248:251], a[20:23], v[156:159]
v_permlane16_swap_b32 v201, v203
v_mfma_f32_16x16x32_bf16 v[164:167], v[248:251], a[24:27], 0
ds_write_b64 v228, v[200:201] offset:8192
v_mfma_f32_16x16x32_bf16 v[164:167], v[252:255], a[36:39], v[164:167]
s_waitcnt vmcnt(8) lgkmcnt(3)
s_barrier
v_mfma_f32_16x16x32_bf16 v[168:171], a[0:3], a[16:19], 0
ds_read_b64_tr_b16 v[248:249], v216 offset:0
s_add_u32 m0, s67, 24576
ds_write_b64 v228, v[202:203] offset:8200
v_mfma_f32_16x16x32_bf16 v[168:171], a[4:7], a[28:31], v[168:171]
ds_read_b64_tr_b16 v[250:251], v216 offset:2048
s_add_u32 s69, s74, 1572864
v_mfma_f32_16x16x32_bf16 v[176:179], a[4:7], a[32:35], 0
ds_read_b64_tr_b16 v[252:253], v216 offset:4096
buffer_load_dwordx4 v226, s[32:35], s69 offen offset:0 lds
v_mfma_f32_16x16x32_bf16 v[176:179], a[0:3], a[20:23], v[176:179]
ds_read_b64_tr_b16 v[254:255], v216 offset:6144
buffer_load_dwordx4 v227, s[32:35], s69 offen offset:1024 lds
v_mfma_f32_16x16x32_bf16 v[184:187], a[0:3], a[24:27], 0
s_add_u32 m0, s67, 32768
s_add_u32 s69, s74, 2097152
s_waitcnt lgkmcnt(3)
s_barrier
ds_read_b128 a[40:43], v230 offset:6144
v_mfma_f32_16x16x32_bf16 v[184:187], a[4:7], a[36:39], v[184:187]
buffer_load_dwordx4 v226, s[32:35], s69 offen offset:0 lds
buffer_load_dwordx4 v227, s[32:35], s69 offen offset:1024 lds
ds_read_b128 a[52:55], v230 offset:16384
v_mfma_f32_16x16x32_bf16 v[172:175], a[8:11], a[16:19], 0
ds_read_b64_tr_b16 a[0:1], v217 offset:0
s_add_u32 m0, s67, 40960
ds_read_b128 a[56:59], v230 offset:17408
v_mfma_f32_16x16x32_bf16 v[172:175], a[12:15], a[28:31], v[172:175]
ds_read_b64_tr_b16 a[2:3], v217 offset:2048
s_add_u32 s69, s74, 2621440
ds_read_b128 a[44:47], v230 offset:7168
v_mfma_f32_16x16x32_bf16 v[180:183], a[12:15], a[32:35], 0
ds_read_b64_tr_b16 a[4:5], v217 offset:4096
buffer_load_dwordx4 v226, s[32:35], s69 offen offset:0 lds
ds_read_b128 a[48:51], v230 offset:8192
v_mfma_f32_16x16x32_bf16 v[180:183], a[8:11], a[20:23], v[180:183]
ds_read_b64_tr_b16 a[6:7], v217 offset:6144
buffer_load_dwordx4 v227, s[32:35], s69 offen offset:1024 lds
ds_read_b128 a[60:63], v230 offset:18432
v_mfma_f32_16x16x32_bf16 v[188:191], a[8:11], a[24:27], 0
v_mfma_f32_16x16x32_bf16 v[188:191], a[12:15], a[36:39], v[188:191]
s_waitcnt lgkmcnt(10)
v_mfma_f32_16x16x32_bf16 v[192:195], v[248:251], a[88:91], 0
ds_read_b64_tr_b16 a[8:9], v217 offset:8192
v_mfma_f32_16x16x32_bf16 v[192:195], v[252:255], a[100:103], v[192:195]
ds_read_b64_tr_b16 a[10:11], v217 offset:10240
v_mfma_f32_16x16x32_bf16 v[200:203], v[252:255], a[104:107], 0
ds_read_b64_tr_b16 a[12:13], v217 offset:12288
v_mfma_f32_16x16x32_bf16 v[200:203], v[248:251], a[92:95], v[200:203]
ds_read_b64_tr_b16 a[14:15], v217 offset:14336
v_mfma_f32_16x16x32_bf16 v[208:211], v[248:251], a[96:99], 0
v_mfma_f32_16x16x32_bf16 v[208:211], v[252:255], a[108:111], v[208:211]
s_waitcnt lgkmcnt(5)
v_mfma_f32_16x16x32_bf16 v[196:199], a[0:3], a[88:91], 0
ds_read_b64_tr_b16 v[248:249], v216 offset:8192
v_mfma_f32_16x16x32_bf16 v[196:199], a[4:7], a[100:103], v[196:199]
ds_read_b64_tr_b16 v[250:251], v216 offset:10240
v_mfma_f32_16x16x32_bf16 v[204:207], a[4:7], a[104:107], 0
ds_read_b64_tr_b16 v[252:253], v216 offset:12288
v_mfma_f32_16x16x32_bf16 v[204:207], a[0:3], a[92:95], v[204:207]
ds_read_b64_tr_b16 v[254:255], v216 offset:14336
v_mfma_f32_16x16x32_bf16 v[212:215], a[0:3], a[96:99], 0
v_mfma_f32_16x16x32_bf16 v[212:215], a[4:7], a[108:111], v[212:215]
s_waitcnt lgkmcnt(4)
v_mfma_f32_16x16x32_bf16 v[212:215], a[8:11], a[120:123], v[212:215]
ds_read_b64_tr_b16 a[0:1], v216 offset:16384
v_mfma_f32_16x16x32_bf16 v[212:215], a[12:15], a[132:135], v[212:215]
ds_read_b64_tr_b16 a[2:3], v216 offset:18432
v_mfma_f32_16x16x32_bf16 v[204:207], a[12:15], a[128:131], v[204:207]
ds_read_b64_tr_b16 a[4:5], v216 offset:20480
v_mfma_f32_16x16x32_bf16 v[204:207], a[8:11], a[116:119], v[204:207]
ds_read_b64_tr_b16 a[6:7], v216 offset:22528
v_mfma_f32_16x16x32_bf16 v[196:199], a[8:11], a[112:115], v[196:199]
v_mfma_f32_16x16x32_bf16 v[196:199], a[12:15], a[124:127], v[196:199]
s_waitcnt lgkmcnt(4)
v_mfma_f32_16x16x32_bf16 v[208:211], v[248:251], a[120:123], v[208:211]
ds_read_b64_tr_b16 a[8:9], v217 offset:16384
v_mfma_f32_16x16x32_bf16 v[208:211], v[252:255], a[132:135], v[208:211]
ds_read_b64_tr_b16 a[10:11], v217 offset:18432
v_mfma_f32_16x16x32_bf16 v[200:203], v[252:255], a[128:131], v[200:203]
ds_read_b64_tr_b16 a[12:13], v217 offset:20480
v_mfma_f32_16x16x32_bf16 v[200:203], v[248:251], a[116:119], v[200:203]
ds_read_b64_tr_b16 a[14:15], v217 offset:22528
v_mfma_f32_16x16x32_bf16 v[192:195], v[248:251], a[112:115], v[192:195]
v_mfma_f32_16x16x32_bf16 v[192:195], v[252:255], a[124:127], v[192:195]
s_waitcnt vmcnt(10) lgkmcnt(4)
s_barrier
v_mfma_f32_16x16x32_bf16 v[192:195], a[0:3], a[136:139], v[192:195]
ds_read_b128 v[248:251], v222 offset:0
s_add_u32 m0, s67, 49152
v_mfma_f32_16x16x32_bf16 v[192:195], a[4:7], a[148:151], v[192:195]
ds_read_b128 v[252:255], v223 offset:0
s_add_u32 s69, s74, 3145728
v_mfma_f32_16x16x32_bf16 v[200:203], a[4:7], a[152:155], v[200:203]
buffer_load_dwordx4 v226, s[32:35], s69 offen offset:0 lds
buffer_load_dwordx4 v227, s[32:35], s69 offen offset:1024 lds
v_mfma_f32_16x16x32_bf16 v[200:203], a[0:3], a[140:143], v[200:203]
s_add_u32 m0, s67, 90112
s_add_u32 s69, s73, 131072
v_mfma_f32_16x16x32_bf16 v[208:211], a[0:3], a[144:147], v[208:211]
buffer_load_dwordx4 v224, s[24:27], s69 offen offset:0 nt lds
buffer_load_dwordx4 v225, s[24:27], s69 offen offset:1024 nt lds
v_mfma_f32_16x16x32_bf16 v[208:211], a[4:7], a[156:159], v[208:211]
s_add_u32 m0, s67, 98304
s_waitcnt lgkmcnt(2)
v_mfma_f32_16x16x32_bf16 v[196:199], a[8:11], a[136:139], v[196:199]
ds_read_b128 a[0:3], v222 offset:2048
s_add_u32 s69, s73, 163840
v_mfma_f32_16x16x32_bf16 v[196:199], a[12:15], a[148:151], v[196:199]
ds_read_b128 a[4:7], v223 offset:2048
buffer_load_dwordx4 v224, s[24:27], s69 offen offset:0 nt lds
v_mfma_f32_16x16x32_bf16 v[204:207], a[12:15], a[152:155], v[204:207]
buffer_load_dwordx4 v225, s[24:27], s69 offen offset:1024 nt lds
v_mfma_f32_16x16x32_bf16 v[204:207], a[8:11], a[140:143], v[204:207]
v_mfma_f32_16x16x32_bf16 v[212:215], a[8:11], a[144:147], v[212:215]
v_mfma_f32_16x16x32_bf16 v[212:215], a[12:15], a[156:159], v[212:215]
s_waitcnt lgkmcnt(2)
v_mfma_f32_16x16x32_bf16 v[0:3], v[248:251], a[40:43], v[0:3]
ds_read_b128 a[8:11], v222 offset:8192
v_mfma_f32_16x16x32_bf16 v[0:3], v[252:255], a[52:55], v[0:3]
ds_read_b128 a[12:15], v223 offset:8192
v_mfma_f32_16x16x32_bf16 v[8:11], v[252:255], a[56:59], v[8:11]
v_mfma_f32_16x16x32_bf16 v[8:11], v[248:251], a[44:47], v[8:11]
v_mfma_f32_16x16x32_bf16 v[16:19], v[248:251], a[48:51], v[16:19]
v_mfma_f32_16x16x32_bf16 v[16:19], v[252:255], a[60:63], v[16:19]
s_waitcnt lgkmcnt(2)
v_mfma_f32_16x16x32_bf16 v[4:7], a[0:3], a[40:43], v[4:7]
ds_read_b128 v[248:251], v222 offset:10240
v_mfma_f32_16x16x32_bf16 v[4:7], a[4:7], a[52:55], v[4:7]
ds_read_b128 v[252:255], v223 offset:10240
v_mfma_f32_16x16x32_bf16 v[12:15], a[4:7], a[56:59], v[12:15]
v_mfma_f32_16x16x32_bf16 v[12:15], a[0:3], a[44:47], v[12:15]
v_mfma_f32_16x16x32_bf16 v[20:23], a[0:3], a[48:51], v[20:23]
v_mfma_f32_16x16x32_bf16 v[20:23], a[4:7], a[60:63], v[20:23]
s_waitcnt vmcnt(12) lgkmcnt(2)
s_barrier
v_mfma_f32_16x16x32_bf16 v[24:27], a[8:11], a[40:43], v[24:27]
ds_read_b128 a[0:3], v222 offset:16384
s_add_u32 m0, s67, 106496
v_mfma_f32_16x16x32_bf16 v[24:27], a[12:15], a[52:55], v[24:27]
ds_read_b128 a[4:7], v223 offset:16384
s_add_u32 s69, s73, 196608
v_mfma_f32_16x16x32_bf16 v[32:35], a[12:15], a[56:59], v[32:35]
buffer_load_dwordx4 v224, s[24:27], s69 offen offset:0 nt lds
buffer_load_dwordx4 v225, s[24:27], s69 offen offset:1024 nt lds
v_mfma_f32_16x16x32_bf16 v[32:35], a[8:11], a[44:47], v[32:35]
s_add_u32 m0, s67, 114688
s_add_u32 s69, s73, 229376
v_mfma_f32_16x16x32_bf16 v[40:43], a[8:11], a[48:51], v[40:43]
buffer_load_dwordx4 v224, s[24:27], s69 offen offset:0 nt lds
buffer_load_dwordx4 v225, s[24:27], s69 offen offset:1024 nt lds
v_mfma_f32_16x16x32_bf16 v[40:43], a[12:15], a[60:63], v[40:43]
s_waitcnt lgkmcnt(2)
v_mfma_f32_16x16x32_bf16 v[28:31], v[248:251], a[40:43], v[28:31]
ds_read_b128 a[8:11], v222 offset:18432
v_mfma_f32_16x16x32_bf16 v[28:31], v[252:255], a[52:55], v[28:31]
ds_read_b128 a[12:15], v223 offset:18432
v_mfma_f32_16x16x32_bf16 v[36:39], v[252:255], a[56:59], v[36:39]
v_mfma_f32_16x16x32_bf16 v[36:39], v[248:251], a[44:47], v[36:39]
v_mfma_f32_16x16x32_bf16 v[44:47], v[248:251], a[48:51], v[44:47]
v_mfma_f32_16x16x32_bf16 v[44:47], v[252:255], a[60:63], v[44:47]
s_waitcnt lgkmcnt(2)
v_mfma_f32_16x16x32_bf16 v[48:51], a[0:3], a[40:43], v[48:51]
ds_read_b128 v[248:251], v222 offset:24576
v_mfma_f32_16x16x32_bf16 v[48:51], a[4:7], a[52:55], v[48:51]
ds_read_b128 v[252:255], v223 offset:24576
v_mfma_f32_16x16x32_bf16 v[56:59], a[4:7], a[56:59], v[56:59]
v_mfma_f32_16x16x32_bf16 v[56:59], a[0:3], a[44:47], v[56:59]
v_mfma_f32_16x16x32_bf16 v[64:67], a[0:3], a[48:51], v[64:67]
v_mfma_f32_16x16x32_bf16 v[64:67], a[4:7], a[60:63], v[64:67]
s_waitcnt lgkmcnt(2)
v_mfma_f32_16x16x32_bf16 v[52:55], a[8:11], a[40:43], v[52:55]
ds_read_b128 a[0:3], v222 offset:26624
v_mfma_f32_16x16x32_bf16 v[52:55], a[12:15], a[52:55], v[52:55]
ds_read_b128 a[4:7], v223 offset:26624
v_mfma_f32_16x16x32_bf16 v[60:63], a[12:15], a[56:59], v[60:63]
v_mfma_f32_16x16x32_bf16 v[60:63], a[8:11], a[44:47], v[60:63]
v_mfma_f32_16x16x32_bf16 v[68:71], a[8:11], a[48:51], v[68:71]
v_mfma_f32_16x16x32_bf16 v[68:71], a[12:15], a[60:63], v[68:71]
s_waitcnt vmcnt(12) lgkmcnt(2)
s_barrier
v_mfma_f32_16x16x32_bf16 v[72:75], v[248:251], a[40:43], v[72:75]
ds_read_b64_tr_b16 a[8:9], v217 offset:24576
s_add_u32 m0, s67, 0
v_mfma_f32_16x16x32_bf16 v[72:75], v[252:255], a[52:55], v[72:75]
ds_read_b64_tr_b16 a[10:11], v217 offset:26624
s_add_u32 s69, s75, 0
v_mfma_f32_16x16x32_bf16 v[80:83], v[252:255], a[56:59], v[80:83]
ds_read_b64_tr_b16 a[12:13], v217 offset:28672
buffer_load_dwordx4 v226, s[32:35], s69 offen offset:0 lds
v_mfma_f32_16x16x32_bf16 v[80:83], v[248:251], a[44:47], v[80:83]
ds_read_b64_tr_b16 a[14:15], v217 offset:30720
buffer_load_dwordx4 v227, s[32:35], s69 offen offset:1024 lds
v_mfma_f32_16x16x32_bf16 v[88:91], v[248:251], a[48:51], v[88:91]
v_mfma_f32_16x16x32_bf16 v[88:91], v[252:255], a[60:63], v[88:91]
s_waitcnt lgkmcnt(4)
v_mfma_f32_16x16x32_bf16 v[76:79], a[0:3], a[40:43], v[76:79]
ds_read_b64_tr_b16 v[248:249], v216 offset:24576
v_mfma_f32_16x16x32_bf16 v[76:79], a[4:7], a[52:55], v[76:79]
ds_read_b64_tr_b16 v[250:251], v216 offset:26624
v_mfma_f32_16x16x32_bf16 v[84:87], a[4:7], a[56:59], v[84:87]
ds_read_b64_tr_b16 v[252:253], v216 offset:28672
v_mfma_f32_16x16x32_bf16 v[84:87], a[0:3], a[44:47], v[84:87]
ds_read_b64_tr_b16 v[254:255], v216 offset:30720
v_mfma_f32_16x16x32_bf16 v[92:95], a[0:3], a[48:51], v[92:95]
v_mfma_f32_16x16x32_bf16 v[92:95], a[4:7], a[60:63], v[92:95]
s_waitcnt lgkmcnt(4)
v_mfma_f32_16x16x32_bf16 v[212:215], a[8:11], a[168:171], v[212:215]
ds_read_b64_tr_b16 a[0:1], v216 offset:32768
v_mfma_f32_16x16x32_bf16 v[212:215], a[12:15], a[180:183], v[212:215]
ds_read_b64_tr_b16 a[2:3], v216 offset:34816
v_mfma_f32_16x16x32_bf16 v[204:207], a[12:15], a[176:179], v[204:207]
ds_read_b64_tr_b16 a[4:5], v216 offset:36864
v_mfma_f32_16x16x32_bf16 v[204:207], a[8:11], a[164:167], v[204:207]
ds_read_b64_tr_b16 a[6:7], v216 offset:38912
v_mfma_f32_16x16x32_bf16 v[196:199], a[8:11], a[160:163], v[196:199]
v_mfma_f32_16x16x32_bf16 v[196:199], a[12:15], a[172:175], v[196:199]
s_waitcnt lgkmcnt(4)
v_mfma_f32_16x16x32_bf16 v[208:211], v[248:251], a[168:171], v[208:211]
ds_read_b64_tr_b16 a[8:9], v217 offset:32768
v_mfma_f32_16x16x32_bf16 v[208:211], v[252:255], a[180:183], v[208:211]
ds_read_b64_tr_b16 a[10:11], v217 offset:34816
v_mfma_f32_16x16x32_bf16 v[200:203], v[252:255], a[176:179], v[200:203]
ds_read_b64_tr_b16 a[12:13], v217 offset:36864
v_mfma_f32_16x16x32_bf16 v[200:203], v[248:251], a[164:167], v[200:203]
ds_read_b64_tr_b16 a[14:15], v217 offset:38912
v_mfma_f32_16x16x32_bf16 v[192:195], v[248:251], a[160:163], v[192:195]
v_mfma_f32_16x16x32_bf16 v[192:195], v[252:255], a[172:175], v[192:195]
s_waitcnt vmcnt(10) lgkmcnt(4)
s_barrier
v_mfma_f32_16x16x32_bf16 v[192:195], a[0:3], a[184:187], v[192:195]
ds_read_b64_tr_b16 v[248:249], v217 offset:40960
s_add_u32 m0, s67, 8192
v_mfma_f32_16x16x32_bf16 v[192:195], a[4:7], a[196:199], v[192:195]
ds_read_b64_tr_b16 v[250:251], v217 offset:43008
s_add_u32 s69, s75, 524288
v_mfma_f32_16x16x32_bf16 v[200:203], a[4:7], a[200:203], v[200:203]
ds_read_b64_tr_b16 v[252:253], v217 offset:45056
buffer_load_dwordx4 v226, s[32:35], s69 offen offset:0 lds
v_mfma_f32_16x16x32_bf16 v[200:203], a[0:3], a[188:191], v[200:203]
ds_read_b64_tr_b16 v[254:255], v217 offset:47104
buffer_load_dwordx4 v227, s[32:35], s69 offen offset:1024 lds
v_mfma_f32_16x16x32_bf16 v[208:211], a[0:3], a[192:195], v[208:211]
s_add_u32 m0, s67, 16384
s_add_u32 s69, s75, 1048576
v_mfma_f32_16x16x32_bf16 v[208:211], a[4:7], a[204:207], v[208:211]
buffer_load_dwordx4 v226, s[32:35], s69 offen offset:0 lds
s_waitcnt lgkmcnt(4)
v_mfma_f32_16x16x32_bf16 v[196:199], a[8:11], a[184:187], v[196:199]
ds_read_b64_tr_b16 a[0:1], v216 offset:40960
buffer_load_dwordx4 v227, s[32:35], s69 offen offset:1024 lds
v_mfma_f32_16x16x32_bf16 v[196:199], a[12:15], a[196:199], v[196:199]
ds_read_b64_tr_b16 a[2:3], v216 offset:43008
v_mfma_f32_16x16x32_bf16 v[204:207], a[12:15], a[200:203], v[204:207]
ds_read_b64_tr_b16 a[4:5], v216 offset:45056
v_mfma_f32_16x16x32_bf16 v[204:207], a[8:11], a[188:191], v[204:207]
ds_read_b64_tr_b16 a[6:7], v216 offset:47104
v_mfma_f32_16x16x32_bf16 v[212:215], a[8:11], a[192:195], v[212:215]
v_mfma_f32_16x16x32_bf16 v[212:215], a[12:15], a[204:207], v[212:215]
s_waitcnt lgkmcnt(4)
v_mfma_f32_16x16x32_bf16 v[212:215], v[248:251], a[216:219], v[212:215]
ds_read_b64_tr_b16 a[8:9], v216 offset:49152
v_mfma_f32_16x16x32_bf16 v[212:215], v[252:255], a[228:231], v[212:215]
ds_read_b64_tr_b16 a[10:11], v216 offset:51200
v_mfma_f32_16x16x32_bf16 v[204:207], v[252:255], a[224:227], v[204:207]
ds_read_b64_tr_b16 a[12:13], v216 offset:53248
v_mfma_f32_16x16x32_bf16 v[204:207], v[248:251], a[212:215], v[204:207]
ds_read_b64_tr_b16 a[14:15], v216 offset:55296
v_mfma_f32_16x16x32_bf16 v[196:199], v[248:251], a[208:211], v[196:199]
v_mfma_f32_16x16x32_bf16 v[196:199], v[252:255], a[220:223], v[196:199]
s_waitcnt lgkmcnt(4)
v_mfma_f32_16x16x32_bf16 v[208:211], a[0:3], a[216:219], v[208:211]
ds_read_b64_tr_b16 v[248:249], v217 offset:49152
v_mfma_f32_16x16x32_bf16 v[208:211], a[4:7], a[228:231], v[208:211]
ds_read_b64_tr_b16 v[250:251], v217 offset:51200
v_mfma_f32_16x16x32_bf16 v[200:203], a[4:7], a[224:227], v[200:203]
ds_read_b64_tr_b16 v[252:253], v217 offset:53248
v_mfma_f32_16x16x32_bf16 v[200:203], a[0:3], a[212:215], v[200:203]
ds_read_b64_tr_b16 v[254:255], v217 offset:55296
v_mfma_f32_16x16x32_bf16 v[192:195], a[0:3], a[208:211], v[192:195]
v_mfma_f32_16x16x32_bf16 v[192:195], a[4:7], a[220:223], v[192:195]
s_waitcnt vmcnt(10) lgkmcnt(4)
s_barrier
v_mfma_f32_16x16x32_bf16 v[192:195], a[8:11], a[232:235], v[192:195]
ds_read_b128 a[0:3], v222 offset:32768
s_mov_b32 exec_hi, 0
buffer_store_dword v242, v243, s[40:43], s91 offen sc1
s_mov_b32 exec_hi, -1
v_mfma_f32_16x16x32_bf16 v[192:195], a[12:15], a[244:247], v[192:195]
ds_read_b128 a[4:7], v223 offset:32768
s_add_u32 m0, s67, 57344
v_mfma_f32_16x16x32_bf16 v[200:203], a[12:15], a[248:251], v[200:203]
s_add_u32 s69, s74, 0
buffer_load_dwordx4 v224, s[24:27], s69 offen offset:0 nt lds
v_mfma_f32_16x16x32_bf16 v[200:203], a[8:11], a[236:239], v[200:203]
buffer_load_dwordx4 v225, s[24:27], s69 offen offset:1024 nt lds
s_add_u32 m0, s67, 65536
v_mfma_f32_16x16x32_bf16 v[208:211], a[8:11], a[240:243], v[208:211]
s_add_u32 s69, s74, 32768
buffer_load_dwordx4 v224, s[24:27], s69 offen offset:0 nt lds
v_mul_f32 v192, s64, v192
v_mul_f32 v193, s64, v193
v_mfma_f32_16x16x32_bf16 v[208:211], a[12:15], a[252:255], v[208:211]
buffer_load_dwordx4 v225, s[24:27], s69 offen offset:1024 nt lds
v_mul_f32 v194, s64, v194
s_waitcnt lgkmcnt(2)
v_mfma_f32_16x16x32_bf16 v[196:199], v[248:251], a[232:235], v[196:199]
ds_read_b128 a[8:11], v222 offset:34816
s_add_u32 m0, s67, 73728
v_mul_f32 v195, s64, v195
v_mfma_f32_16x16x32_bf16 v[196:199], v[252:255], a[244:247], v[196:199]
ds_read_b128 a[12:15], v223 offset:34816
s_add_u32 s69, s74, 65536
v_cvt_pk_bf16_f32 v192, v192, v193
v_mfma_f32_16x16x32_bf16 v[204:207], v[252:255], a[248:251], v[204:207]
buffer_load_dwordx4 v224, s[24:27], s69 offen offset:0 nt lds
buffer_load_dwordx4 v225, s[24:27], s69 offen offset:1024 nt lds
v_cvt_pk_bf16_f32 v193, v194, v195
v_mfma_f32_16x16x32_bf16 v[204:207], v[248:251], a[236:239], v[204:207]
v_mul_f32 v200, s64, v200
v_mul_f32 v201, s64, v201
v_mfma_f32_16x16x32_bf16 v[212:215], v[248:251], a[240:243], v[212:215]
v_mul_f32 v196, s64, v196
v_mul_f32 v197, s64, v197
v_mfma_f32_16x16x32_bf16 v[212:215], v[252:255], a[252:255], v[212:215]
v_mul_f32 v198, s64, v198
s_waitcnt lgkmcnt(2)
v_mfma_f32_16x16x32_bf16 v[96:99], a[0:3], a[40:43], v[96:99]
ds_read_b128 v[248:251], v222 offset:40960
v_mul_f32 v199, s64, v199
v_mfma_f32_16x16x32_bf16 v[96:99], a[4:7], a[52:55], v[96:99]
ds_read_b128 v[252:255], v223 offset:40960
v_cvt_pk_bf16_f32 v194, v196, v197
v_mfma_f32_16x16x32_bf16 v[104:107], a[4:7], a[56:59], v[104:107]
v_cvt_pk_bf16_f32 v195, v198, v199
v_mul_f32 v202, s64, v202
v_mfma_f32_16x16x32_bf16 v[104:107], a[0:3], a[44:47], v[104:107]
v_permlane16_swap_b32 v192, v194
v_mfma_f32_16x16x32_bf16 v[112:115], a[0:3], a[48:51], v[112:115]
v_permlane16_swap_b32 v193, v195
v_mfma_f32_16x16x32_bf16 v[112:115], a[4:7], a[60:63], v[112:115]
ds_write_b64 v228, v[192:193] offset:6144
s_waitcnt lgkmcnt(3)
v_mfma_f32_16x16x32_bf16 v[100:103], a[8:11], a[40:43], v[100:103]
ds_read_b128 a[0:3], v222 offset:43008
v_mul_f32 v203, s64, v203
v_mfma_f32_16x16x32_bf16 v[100:103], a[12:15], a[52:55], v[100:103]
ds_read_b128 a[4:7], v223 offset:43008
ds_write_b64 v228, v[194:195] offset:6152
v_mfma_f32_16x16x32_bf16 v[108:111], a[12:15], a[56:59], v[108:111]
v_mul_f32 v204, s64, v204
v_mul_f32 v205, s64, v205
v_mfma_f32_16x16x32_bf16 v[108:111], a[8:11], a[44:47], v[108:111]
v_mul_f32 v206, s64, v206
v_mul_f32 v207, s64, v207
v_mfma_f32_16x16x32_bf16 v[116:119], a[8:11], a[48:51], v[116:119]
v_cvt_pk_bf16_f32 v196, v200, v201
v_cvt_pk_bf16_f32 v197, v202, v203
v_mfma_f32_16x16x32_bf16 v[116:119], a[12:15], a[60:63], v[116:119]
s_waitcnt vmcnt(13) lgkmcnt(4)
s_barrier
v_mfma_f32_16x16x32_bf16 v[120:123], v[248:251], a[40:43], v[120:123]
ds_read_b128 a[8:11], v222 offset:49152
s_add_u32 m0, s67, 81920
v_mfma_f32_16x16x32_bf16 v[120:123], v[252:255], a[52:55], v[120:123]
ds_read_b128 a[12:15], v223 offset:49152
s_add_u32 s69, s74, 98304
v_mfma_f32_16x16x32_bf16 v[128:131], v[252:255], a[56:59], v[128:131]
buffer_load_dwordx4 v224, s[24:27], s69 offen offset:0 nt lds
buffer_load_dwordx4 v225, s[24:27], s69 offen offset:1024 nt lds
v_mfma_f32_16x16x32_bf16 v[128:131], v[248:251], a[44:47], v[128:131]
s_add_u32 m0, s67, 24576
s_add_u32 s69, s75, 1572864
v_mfma_f32_16x16x32_bf16 v[136:139], v[248:251], a[48:51], v[136:139]
buffer_load_dwordx4 v226, s[32:35], s69 offen offset:0 lds
buffer_load_dwordx4 v227, s[32:35], s69 offen offset:1024 lds
v_cvt_pk_bf16_f32 v198, v204, v205
v_mfma_f32_16x16x32_bf16 v[136:139], v[252:255], a[60:63], v[136:139]
v_cvt_pk_bf16_f32 v199, v206, v207
v_mul_f32 v208, s64, v208
s_waitcnt lgkmcnt(3)
v_mfma_f32_16x16x32_bf16 v[124:127], a[0:3], a[40:43], v[124:127]
ds_read_b128 v[248:251], v222 offset:51200
v_mul_f32 v209, s64, v209
v_mfma_f32_16x16x32_bf16 v[124:127], a[4:7], a[52:55], v[124:127]
ds_read_b128 v[252:255], v223 offset:51200
v_mul_f32 v210, s64, v210
v_mfma_f32_16x16x32_bf16 v[132:135], a[4:7], a[56:59], v[132:135]
v_permlane16_swap_b32 v196, v198
v_mfma_f32_16x16x32_bf16 v[132:135], a[0:3], a[44:47], v[132:135]
v_permlane16_swap_b32 v197, v199
v_mfma_f32_16x16x32_bf16 v[140:143], a[0:3], a[48:51], v[140:143]
ds_write_b64 v228, v[196:197] offset:7168
v_mul_f32 v211, s64, v211
v_mfma_f32_16x16x32_bf16 v[140:143], a[4:7], a[60:63], v[140:143]
v_mul_f32 v212, s64, v212
s_waitcnt lgkmcnt(3)
v_mfma_f32_16x16x32_bf16 v[144:147], a[8:11], a[40:43], v[144:147]
ds_read_b128 a[0:3], v222 offset:57344
ds_write_b64 v228, v[198:199] offset:7176
v_mfma_f32_16x16x32_bf16 v[144:147], a[12:15], a[52:55], v[144:147]
ds_read_b128 a[4:7], v223 offset:57344
v_mul_f32 v213, s64, v213
v_mfma_f32_16x16x32_bf16 v[152:155], a[12:15], a[56:59], v[152:155]
v_mul_f32 v214, s64, v214
v_mul_f32 v215, s64, v215
v_mfma_f32_16x16x32_bf16 v[152:155], a[8:11], a[44:47], v[152:155]
v_cvt_pk_bf16_f32 v200, v208, v209
v_cvt_pk_bf16_f32 v201, v210, v211
v_mfma_f32_16x16x32_bf16 v[160:163], a[8:11], a[48:51], v[160:163]
v_cvt_pk_bf16_f32 v202, v212, v213
v_cvt_pk_bf16_f32 v203, v214, v215
v_mfma_f32_16x16x32_bf16 v[160:163], a[12:15], a[60:63], v[160:163]
s_waitcnt lgkmcnt(4)
v_mfma_f32_16x16x32_bf16 v[148:151], v[248:251], a[40:43], v[148:151]
ds_read_b128 a[8:11], v222 offset:59392
v_mfma_f32_16x16x32_bf16 v[148:151], v[252:255], a[52:55], v[148:151]
ds_read_b128 a[12:15], v223 offset:59392
v_mfma_f32_16x16x32_bf16 v[156:159], v[252:255], a[56:59], v[156:159]
v_permlane16_swap_b32 v200, v202
v_mfma_f32_16x16x32_bf16 v[156:159], v[248:251], a[44:47], v[156:159]
v_permlane16_swap_b32 v201, v203
v_mfma_f32_16x16x32_bf16 v[164:167], v[248:251], a[48:51], v[164:167]
ds_write_b64 v228, v[200:201] offset:8192
v_mfma_f32_16x16x32_bf16 v[164:167], v[252:255], a[60:63], v[164:167]
s_waitcnt vmcnt(11) lgkmcnt(3)
s_barrier
v_mfma_f32_16x16x32_bf16 v[168:171], a[0:3], a[40:43], v[168:171]
ds_read_b64_tr_b16 v[248:249], v216 offset:0
s_add_u32 m0, s67, 32768
ds_write_b64 v228, v[202:203] offset:8200
v_mfma_f32_16x16x32_bf16 v[168:171], a[4:7], a[52:55], v[168:171]
ds_read_b64_tr_b16 v[250:251], v216 offset:2048
s_add_u32 s69, s75, 2097152
v_mfma_f32_16x16x32_bf16 v[176:179], a[4:7], a[56:59], v[176:179]
ds_read_b64_tr_b16 v[252:253], v216 offset:4096
buffer_load_dwordx4 v226, s[32:35], s69 offen offset:0 lds
v_mfma_f32_16x16x32_bf16 v[176:179], a[0:3], a[44:47], v[176:179]
ds_read_b64_tr_b16 v[254:255], v216 offset:6144
buffer_load_dwordx4 v227, s[32:35], s69 offen offset:1024 lds
v_mfma_f32_16x16x32_bf16 v[184:187], a[0:3], a[48:51], v[184:187]
s_add_u32 m0, s67, 40960
s_add_u32 s69, s75, 2621440
s_waitcnt lgkmcnt(3)
s_barrier
ds_read_b128 a[16:19], v230 offset:6144
v_mfma_f32_16x16x32_bf16 v[184:187], a[4:7], a[60:63], v[184:187]
buffer_load_dwordx4 v226, s[32:35], s69 offen offset:0 lds
buffer_load_dwordx4 v227, s[32:35], s69 offen offset:1024 lds
ds_read_b128 a[28:31], v230 offset:16384
v_mfma_f32_16x16x32_bf16 v[172:175], a[8:11], a[40:43], v[172:175]
ds_read_b64_tr_b16 a[0:1], v217 offset:0
ds_read_b128 a[32:35], v230 offset:17408
v_mfma_f32_16x16x32_bf16 v[172:175], a[12:15], a[52:55], v[172:175]
ds_read_b64_tr_b16 a[2:3], v217 offset:2048
ds_read_b128 a[20:23], v230 offset:7168
v_mfma_f32_16x16x32_bf16 v[180:183], a[12:15], a[56:59], v[180:183]
ds_read_b64_tr_b16 a[4:5], v217 offset:4096
ds_read_b128 a[24:27], v230 offset:8192
v_mfma_f32_16x16x32_bf16 v[180:183], a[8:11], a[44:47], v[180:183]
ds_read_b64_tr_b16 a[6:7], v217 offset:6144
ds_read_b128 a[36:39], v230 offset:18432
v_mfma_f32_16x16x32_bf16 v[188:191], a[8:11], a[48:51], v[188:191]
v_mfma_f32_16x16x32_bf16 v[188:191], a[12:15], a[60:63], v[188:191]
s_waitcnt lgkmcnt(10)
v_mfma_f32_16x16x32_bf16 v[192:195], v[248:251], a[88:91], 0
ds_read_b64_tr_b16 a[8:9], v217 offset:8192
v_mfma_f32_16x16x32_bf16 v[192:195], v[252:255], a[100:103], v[192:195]
ds_read_b64_tr_b16 a[10:11], v217 offset:10240
v_mfma_f32_16x16x32_bf16 v[200:203], v[252:255], a[104:107], 0
ds_read_b64_tr_b16 a[12:13], v217 offset:12288
v_mfma_f32_16x16x32_bf16 v[200:203], v[248:251], a[92:95], v[200:203]
ds_read_b64_tr_b16 a[14:15], v217 offset:14336
v_mfma_f32_16x16x32_bf16 v[208:211], v[248:251], a[96:99], 0
v_mfma_f32_16x16x32_bf16 v[208:211], v[252:255], a[108:111], v[208:211]
s_waitcnt lgkmcnt(5)
v_mfma_f32_16x16x32_bf16 v[196:199], a[0:3], a[88:91], 0
ds_read_b64_tr_b16 v[248:249], v216 offset:8192
v_mfma_f32_16x16x32_bf16 v[196:199], a[4:7], a[100:103], v[196:199]
ds_read_b64_tr_b16 v[250:251], v216 offset:10240
v_mfma_f32_16x16x32_bf16 v[204:207], a[4:7], a[104:107], 0
ds_read_b64_tr_b16 v[252:253], v216 offset:12288
v_mfma_f32_16x16x32_bf16 v[204:207], a[0:3], a[92:95], v[204:207]
ds_read_b64_tr_b16 v[254:255], v216 offset:14336
v_mfma_f32_16x16x32_bf16 v[212:215], a[0:3], a[96:99], 0
v_mfma_f32_16x16x32_bf16 v[212:215], a[4:7], a[108:111], v[212:215]
s_waitcnt lgkmcnt(4)
v_mfma_f32_16x16x32_bf16 v[212:215], a[8:11], a[120:123], v[212:215]
ds_read_b64_tr_b16 a[0:1], v216 offset:16384
v_mfma_f32_16x16x32_bf16 v[212:215], a[12:15], a[132:135], v[212:215]
ds_read_b64_tr_b16 a[2:3], v216 offset:18432
v_mfma_f32_16x16x32_bf16 v[204:207], a[12:15], a[128:131], v[204:207]
ds_read_b64_tr_b16 a[4:5], v216 offset:20480
v_mfma_f32_16x16x32_bf16 v[204:207], a[8:11], a[116:119], v[204:207]
ds_read_b64_tr_b16 a[6:7], v216 offset:22528
v_mfma_f32_16x16x32_bf16 v[196:199], a[8:11], a[112:115], v[196:199]
v_mfma_f32_16x16x32_bf16 v[196:199], a[12:15], a[124:127], v[196:199]
s_waitcnt lgkmcnt(4)
v_mfma_f32_16x16x32_bf16 v[208:211], v[248:251], a[120:123], v[208:211]
ds_read_b64_tr_b16 a[8:9], v217 offset:16384
v_mfma_f32_16x16x32_bf16 v[208:211], v[252:255], a[132:135], v[208:211]
ds_read_b64_tr_b16 a[10:11], v217 offset:18432
v_mfma_f32_16x16x32_bf16 v[200:203], v[252:255], a[128:131], v[200:203]
ds_read_b64_tr_b16 a[12:13], v217 offset:20480
v_mfma_f32_16x16x32_bf16 v[200:203], v[248:251], a[116:119], v[200:203]
ds_read_b64_tr_b16 a[14:15], v217 offset:22528
v_mfma_f32_16x16x32_bf16 v[192:195], v[248:251], a[112:115], v[192:195]
v_mfma_f32_16x16x32_bf16 v[192:195], v[252:255], a[124:127], v[192:195]
s_waitcnt vmcnt(10) lgkmcnt(4)
s_barrier
v_mfma_f32_16x16x32_bf16 v[192:195], a[0:3], a[136:139], v[192:195]
ds_read_b128 v[248:251], v222 offset:0
s_add_u32 m0, s67, 49152
v_mfma_f32_16x16x32_bf16 v[192:195], a[4:7], a[148:151], v[192:195]
ds_read_b128 v[252:255], v223 offset:0
s_add_u32 s69, s75, 3145728
v_mfma_f32_16x16x32_bf16 v[200:203], a[4:7], a[152:155], v[200:203]
buffer_load_dwordx4 v226, s[32:35], s69 offen offset:0 lds
buffer_load_dwordx4 v227, s[32:35], s69 offen offset:1024 lds
v_mfma_f32_16x16x32_bf16 v[200:203], a[0:3], a[140:143], v[200:203]
s_add_u32 m0, s67, 90112
s_add_u32 s69, s74, 131072
v_mfma_f32_16x16x32_bf16 v[208:211], a[0:3], a[144:147], v[208:211]
buffer_load_dwordx4 v224, s[24:27], s69 offen offset:0 nt lds
buffer_load_dwordx4 v225, s[24:27], s69 offen offset:1024 nt lds
v_mfma_f32_16x16x32_bf16 v[208:211], a[4:7], a[156:159], v[208:211]
s_waitcnt lgkmcnt(2)
v_mfma_f32_16x16x32_bf16 v[196:199], a[8:11], a[136:139], v[196:199]
ds_read_b128 a[0:3], v222 offset:2048
v_mfma_f32_16x16x32_bf16 v[196:199], a[12:15], a[148:151], v[196:199]
ds_read_b128 a[4:7], v223 offset:2048
v_mfma_f32_16x16x32_bf16 v[204:207], a[12:15], a[152:155], v[204:207]
v_mfma_f32_16x16x32_bf16 v[204:207], a[8:11], a[140:143], v[204:207]
v_mfma_f32_16x16x32_bf16 v[212:215], a[8:11], a[144:147], v[212:215]
v_mfma_f32_16x16x32_bf16 v[212:215], a[12:15], a[156:159], v[212:215]
s_waitcnt lgkmcnt(2)
v_mfma_f32_16x16x32_bf16 v[0:3], v[248:251], a[16:19], v[0:3]
ds_read_b128 a[8:11], v222 offset:8192
v_mfma_f32_16x16x32_bf16 v[0:3], v[252:255], a[28:31], v[0:3]
ds_read_b128 a[12:15], v223 offset:8192
v_mfma_f32_16x16x32_bf16 v[8:11], v[252:255], a[32:35], v[8:11]
v_mfma_f32_16x16x32_bf16 v[8:11], v[248:251], a[20:23], v[8:11]
v_mfma_f32_16x16x32_bf16 v[16:19], v[248:251], a[24:27], v[16:19]
v_mfma_f32_16x16x32_bf16 v[16:19], v[252:255], a[36:39], v[16:19]
s_waitcnt lgkmcnt(2)
v_mfma_f32_16x16x32_bf16 v[4:7], a[0:3], a[16:19], v[4:7]
ds_read_b128 v[248:251], v222 offset:10240
v_mfma_f32_16x16x32_bf16 v[4:7], a[4:7], a[28:31], v[4:7]
ds_read_b128 v[252:255], v223 offset:10240
v_mfma_f32_16x16x32_bf16 v[12:15], a[4:7], a[32:35], v[12:15]
v_mfma_f32_16x16x32_bf16 v[12:15], a[0:3], a[20:23], v[12:15]
v_mfma_f32_16x16x32_bf16 v[20:23], a[0:3], a[24:27], v[20:23]
v_mfma_f32_16x16x32_bf16 v[20:23], a[4:7], a[36:39], v[20:23]
s_waitcnt vmcnt(10) lgkmcnt(2)
s_barrier
v_mfma_f32_16x16x32_bf16 v[24:27], a[8:11], a[16:19], v[24:27]
ds_read_b128 a[0:3], v222 offset:16384
s_add_u32 m0, s67, 98304
v_mfma_f32_16x16x32_bf16 v[24:27], a[12:15], a[28:31], v[24:27]
ds_read_b128 a[4:7], v223 offset:16384
s_add_u32 s69, s74, 163840
v_mfma_f32_16x16x32_bf16 v[32:35], a[12:15], a[32:35], v[32:35]
buffer_load_dwordx4 v224, s[24:27], s69 offen offset:0 nt lds
buffer_load_dwordx4 v225, s[24:27], s69 offen offset:1024 nt lds
v_mfma_f32_16x16x32_bf16 v[32:35], a[8:11], a[20:23], v[32:35]
s_add_u32 m0, s67, 106496
s_add_u32 s69, s74, 196608
v_mfma_f32_16x16x32_bf16 v[40:43], a[8:11], a[24:27], v[40:43]
buffer_load_dwordx4 v224, s[24:27], s69 offen offset:0 nt lds
buffer_load_dwordx4 v225, s[24:27], s69 offen offset:1024 nt lds
v_mfma_f32_16x16x32_bf16 v[40:43], a[12:15], a[36:39], v[40:43]
s_waitcnt lgkmcnt(2)
v_mfma_f32_16x16x32_bf16 v[28:31], v[248:251], a[16:19], v[28:31]
ds_read_b128 a[8:11], v222 offset:18432
v_mfma_f32_16x16x32_bf16 v[28:31], v[252:255], a[28:31], v[28:31]
ds_read_b128 a[12:15], v223 offset:18432
v_mfma_f32_16x16x32_bf16 v[36:39], v[252:255], a[32:35], v[36:39]
v_mfma_f32_16x16x32_bf16 v[36:39], v[248:251], a[20:23], v[36:39]
v_mfma_f32_16x16x32_bf16 v[44:47], v[248:251], a[24:27], v[44:47]
v_mfma_f32_16x16x32_bf16 v[44:47], v[252:255], a[36:39], v[44:47]
s_waitcnt lgkmcnt(2)
v_mfma_f32_16x16x32_bf16 v[48:51], a[0:3], a[16:19], v[48:51]
ds_read_b128 v[248:251], v222 offset:24576
v_mfma_f32_16x16x32_bf16 v[48:51], a[4:7], a[28:31], v[48:51]
ds_read_b128 v[252:255], v223 offset:24576
v_mfma_f32_16x16x32_bf16 v[56:59], a[4:7], a[32:35], v[56:59]
v_mfma_f32_16x16x32_bf16 v[56:59], a[0:3], a[20:23], v[56:59]
v_mfma_f32_16x16x32_bf16 v[64:67], a[0:3], a[24:27], v[64:67]
v_mfma_f32_16x16x32_bf16 v[64:67], a[4:7], a[36:39], v[64:67]
s_waitcnt lgkmcnt(2)
v_mfma_f32_16x16x32_bf16 v[52:55], a[8:11], a[16:19], v[52:55]
ds_read_b128 a[0:3], v222 offset:26624
v_mfma_f32_16x16x32_bf16 v[52:55], a[12:15], a[28:31], v[52:55]
ds_read_b128 a[4:7], v223 offset:26624
v_mfma_f32_16x16x32_bf16 v[60:63], a[12:15], a[32:35], v[60:63]
v_mfma_f32_16x16x32_bf16 v[60:63], a[8:11], a[20:23], v[60:63]
v_mfma_f32_16x16x32_bf16 v[68:71], a[8:11], a[24:27], v[68:71]
v_mfma_f32_16x16x32_bf16 v[68:71], a[12:15], a[36:39], v[68:71]
s_waitcnt vmcnt(10) lgkmcnt(2)
s_barrier
v_mfma_f32_16x16x32_bf16 v[72:75], v[248:251], a[16:19], v[72:75]
ds_read_b64_tr_b16 a[8:9], v217 offset:24576
s_add_u32 m0, s67, 114688
v_mfma_f32_16x16x32_bf16 v[72:75], v[252:255], a[28:31], v[72:75]
ds_read_b64_tr_b16 a[10:11], v217 offset:26624
s_add_u32 s69, s74, 229376
v_mfma_f32_16x16x32_bf16 v[80:83], v[252:255], a[32:35], v[80:83]
ds_read_b64_tr_b16 a[12:13], v217 offset:28672
buffer_load_dwordx4 v224, s[24:27], s69 offen offset:0 nt lds
v_mfma_f32_16x16x32_bf16 v[80:83], v[248:251], a[20:23], v[80:83]
ds_read_b64_tr_b16 a[14:15], v217 offset:30720
buffer_load_dwordx4 v225, s[24:27], s69 offen offset:1024 nt lds
v_mfma_f32_16x16x32_bf16 v[88:91], v[248:251], a[24:27], v[88:91]
s_add_u32 m0, s67, 0
s_add_u32 s69, s72, 512
v_mfma_f32_16x16x32_bf16 v[88:91], v[252:255], a[36:39], v[88:91]
buffer_load_dwordx4 v226, s[32:35], s69 offen offset:0 lds
s_waitcnt lgkmcnt(4)
v_mfma_f32_16x16x32_bf16 v[76:79], a[0:3], a[16:19], v[76:79]
ds_read_b64_tr_b16 v[248:249], v216 offset:24576
buffer_load_dwordx4 v227, s[32:35], s69 offen offset:1024 lds
v_mfma_f32_16x16x32_bf16 v[76:79], a[4:7], a[28:31], v[76:79]
ds_read_b64_tr_b16 v[250:251], v216 offset:26624
v_mfma_f32_16x16x32_bf16 v[84:87], a[4:7], a[32:35], v[84:87]
ds_read_b64_tr_b16 v[252:253], v216 offset:28672
v_mfma_f32_16x16x32_bf16 v[84:87], a[0:3], a[20:23], v[84:87]
ds_read_b64_tr_b16 v[254:255], v216 offset:30720
v_mfma_f32_16x16x32_bf16 v[92:95], a[0:3], a[24:27], v[92:95]
v_mfma_f32_16x16x32_bf16 v[92:95], a[4:7], a[36:39], v[92:95]
s_waitcnt lgkmcnt(4)
v_mfma_f32_16x16x32_bf16 v[212:215], a[8:11], a[168:171], v[212:215]
ds_read_b64_tr_b16 a[0:1], v216 offset:32768
v_mfma_f32_16x16x32_bf16 v[212:215], a[12:15], a[180:183], v[212:215]
ds_read_b64_tr_b16 a[2:3], v216 offset:34816
v_mfma_f32_16x16x32_bf16 v[204:207], a[12:15], a[176:179], v[204:207]
ds_read_b64_tr_b16 a[4:5], v216 offset:36864
v_mfma_f32_16x16x32_bf16 v[204:207], a[8:11], a[164:167], v[204:207]
ds_read_b64_tr_b16 a[6:7], v216 offset:38912
v_mfma_f32_16x16x32_bf16 v[196:199], a[8:11], a[160:163], v[196:199]
v_mfma_f32_16x16x32_bf16 v[196:199], a[12:15], a[172:175], v[196:199]
s_waitcnt lgkmcnt(4)
v_mfma_f32_16x16x32_bf16 v[208:211], v[248:251], a[168:171], v[208:211]
ds_read_b64_tr_b16 a[8:9], v217 offset:32768
v_mfma_f32_16x16x32_bf16 v[208:211], v[252:255], a[180:183], v[208:211]
ds_read_b64_tr_b16 a[10:11], v217 offset:34816
v_mfma_f32_16x16x32_bf16 v[200:203], v[252:255], a[176:179], v[200:203]
ds_read_b64_tr_b16 a[12:13], v217 offset:36864
v_mfma_f32_16x16x32_bf16 v[200:203], v[248:251], a[164:167], v[200:203]
ds_read_b64_tr_b16 a[14:15], v217 offset:38912
v_mfma_f32_16x16x32_bf16 v[192:195], v[248:251], a[160:163], v[192:195]
v_mfma_f32_16x16x32_bf16 v[192:195], v[252:255], a[172:175], v[192:195]
s_waitcnt vmcnt(10) lgkmcnt(4)
s_barrier
v_mfma_f32_16x16x32_bf16 v[192:195], a[0:3], a[184:187], v[192:195]
ds_read_b64_tr_b16 v[248:249], v217 offset:40960
s_add_u32 m0, s67, 8192
v_mfma_f32_16x16x32_bf16 v[192:195], a[4:7], a[196:199], v[192:195]
ds_read_b64_tr_b16 v[250:251], v217 offset:43008
s_add_u32 s69, s72, 524800
v_mfma_f32_16x16x32_bf16 v[200:203], a[4:7], a[200:203], v[200:203]
ds_read_b64_tr_b16 v[252:253], v217 offset:45056
buffer_load_dwordx4 v226, s[32:35], s69 offen offset:0 lds
v_mfma_f32_16x16x32_bf16 v[200:203], a[0:3], a[188:191], v[200:203]
ds_read_b64_tr_b16 v[254:255], v217 offset:47104
buffer_load_dwordx4 v227, s[32:35], s69 offen offset:1024 lds
v_mfma_f32_16x16x32_bf16 v[208:211], a[0:3], a[192:195], v[208:211]
s_add_u32 m0, s67, 16384
s_add_u32 s69, s72, 1049088
v_mfma_f32_16x16x32_bf16 v[208:211], a[4:7], a[204:207], v[208:211]
buffer_load_dwordx4 v226, s[32:35], s69 offen offset:0 lds
s_waitcnt lgkmcnt(4)
v_mfma_f32_16x16x32_bf16 v[196:199], a[8:11], a[184:187], v[196:199]
ds_read_b64_tr_b16 a[0:1], v216 offset:40960
buffer_load_dwordx4 v227, s[32:35], s69 offen offset:1024 lds
v_mfma_f32_16x16x32_bf16 v[196:199], a[12:15], a[196:199], v[196:199]
ds_read_b64_tr_b16 a[2:3], v216 offset:43008
v_mfma_f32_16x16x32_bf16 v[204:207], a[12:15], a[200:203], v[204:207]
ds_read_b64_tr_b16 a[4:5], v216 offset:45056
v_mfma_f32_16x16x32_bf16 v[204:207], a[8:11], a[188:191], v[204:207]
ds_read_b64_tr_b16 a[6:7], v216 offset:47104
v_mfma_f32_16x16x32_bf16 v[212:215], a[8:11], a[192:195], v[212:215]
v_mfma_f32_16x16x32_bf16 v[212:215], a[12:15], a[204:207], v[212:215]
s_waitcnt lgkmcnt(4)
v_mfma_f32_16x16x32_bf16 v[212:215], v[248:251], a[216:219], v[212:215]
ds_read_b64_tr_b16 a[8:9], v216 offset:49152
v_mfma_f32_16x16x32_bf16 v[212:215], v[252:255], a[228:231], v[212:215]
ds_read_b64_tr_b16 a[10:11], v216 offset:51200
v_mfma_f32_16x16x32_bf16 v[204:207], v[252:255], a[224:227], v[204:207]
ds_read_b64_tr_b16 a[12:13], v216 offset:53248
v_mfma_f32_16x16x32_bf16 v[204:207], v[248:251], a[212:215], v[204:207]
ds_read_b64_tr_b16 a[14:15], v216 offset:55296
v_mfma_f32_16x16x32_bf16 v[196:199], v[248:251], a[208:211], v[196:199]
v_mfma_f32_16x16x32_bf16 v[196:199], v[252:255], a[220:223], v[196:199]
s_waitcnt lgkmcnt(4)
v_mfma_f32_16x16x32_bf16 v[208:211], a[0:3], a[216:219], v[208:211]
ds_read_b64_tr_b16 v[248:249], v217 offset:49152
v_mfma_f32_16x16x32_bf16 v[208:211], a[4:7], a[228:231], v[208:211]
ds_read_b64_tr_b16 v[250:251], v217 offset:51200
v_mfma_f32_16x16x32_bf16 v[200:203], a[4:7], a[224:227], v[200:203]
ds_read_b64_tr_b16 v[252:253], v217 offset:53248
v_mfma_f32_16x16x32_bf16 v[200:203], a[0:3], a[212:215], v[200:203]
ds_read_b64_tr_b16 v[254:255], v217 offset:55296
v_mfma_f32_16x16x32_bf16 v[192:195], a[0:3], a[208:211], v[192:195]
v_mfma_f32_16x16x32_bf16 v[192:195], a[4:7], a[220:223], v[192:195]
s_waitcnt vmcnt(10) lgkmcnt(4)
s_barrier
v_mfma_f32_16x16x32_bf16 v[192:195], a[8:11], a[232:235], v[192:195]
ds_read_b128 a[0:3], v222 offset:32768
s_add_u32 m0, s67, 57344
v_mfma_f32_16x16x32_bf16 v[192:195], a[12:15], a[244:247], v[192:195]
ds_read_b128 a[4:7], v223 offset:32768
s_add_u32 s69, s75, 0
v_mfma_f32_16x16x32_bf16 v[200:203], a[12:15], a[248:251], v[200:203]
buffer_load_dwordx4 v224, s[24:27], s69 offen offset:0 nt lds
buffer_load_dwordx4 v225, s[24:27], s69 offen offset:1024 nt lds
v_mfma_f32_16x16x32_bf16 v[200:203], a[8:11], a[236:239], v[200:203]
s_add_u32 m0, s67, 65536
s_add_u32 s69, s75, 32768
v_mfma_f32_16x16x32_bf16 v[208:211], a[8:11], a[240:243], v[208:211]
buffer_load_dwordx4 v224, s[24:27], s69 offen offset:0 nt lds
buffer_load_dwordx4 v225, s[24:27], s69 offen offset:1024 nt lds
v_mul_f32 v192, s64, v192
v_mul_f32 v193, s64, v193
v_mfma_f32_16x16x32_bf16 v[208:211], a[12:15], a[252:255], v[208:211]
v_mul_f32 v194, s64, v194
s_waitcnt lgkmcnt(2)
v_mfma_f32_16x16x32_bf16 v[196:199], v[248:251], a[232:235], v[196:199]
ds_read_b128 a[8:11], v222 offset:34816
v_mul_f32 v195, s64, v195
v_mfma_f32_16x16x32_bf16 v[196:199], v[252:255], a[244:247], v[196:199]
ds_read_b128 a[12:15], v223 offset:34816
v_cvt_pk_bf16_f32 v192, v192, v193
v_mfma_f32_16x16x32_bf16 v[204:207], v[252:255], a[248:251], v[204:207]
v_cvt_pk_bf16_f32 v193, v194, v195
v_mul_f32 v200, s64, v200
v_mfma_f32_16x16x32_bf16 v[204:207], v[248:251], a[236:239], v[204:207]
v_mul_f32 v201, s64, v201
v_mul_f32 v202, s64, v202
v_mfma_f32_16x16x32_bf16 v[212:215], v[248:251], a[240:243], v[212:215]
v_mul_f32 v196, s64, v196
v_mul_f32 v197, s64, v197
v_mfma_f32_16x16x32_bf16 v[212:215], v[252:255], a[252:255], v[212:215]
v_mul_f32 v198, s64, v198
s_waitcnt lgkmcnt(2)
v_mfma_f32_16x16x32_bf16 v[96:99], a[0:3], a[16:19], v[96:99]
ds_read_b128 v[248:251], v222 offset:40960
v_mul_f32 v199, s64, v199
v_mfma_f32_16x16x32_bf16 v[96:99], a[4:7], a[28:31], v[96:99]
ds_read_b128 v[252:255], v223 offset:40960
v_cvt_pk_bf16_f32 v194, v196, v197
v_mfma_f32_16x16x32_bf16 v[104:107], a[4:7], a[32:35], v[104:107]
v_cvt_pk_bf16_f32 v195, v198, v199
v_mul_f32 v203, s64, v203
v_mfma_f32_16x16x32_bf16 v[104:107], a[0:3], a[20:23], v[104:107]
v_permlane16_swap_b32 v192, v194
v_mfma_f32_16x16x32_bf16 v[112:115], a[0:3], a[24:27], v[112:115]
v_permlane16_swap_b32 v193, v195
v_mfma_f32_16x16x32_bf16 v[112:115], a[4:7], a[36:39], v[112:115]
ds_write_b64 v228, v[192:193] offset:6144
s_waitcnt lgkmcnt(3)
v_mfma_f32_16x16x32_bf16 v[100:103], a[8:11], a[16:19], v[100:103]
ds_read_b128 a[0:3], v222 offset:43008
v_mul_f32 v204, s64, v204
v_mfma_f32_16x16x32_bf16 v[100:103], a[12:15], a[28:31], v[100:103]
ds_read_b128 a[4:7], v223 offset:43008
ds_write_b64 v228, v[194:195] offset:6152
v_mfma_f32_16x16x32_bf16 v[108:111], a[12:15], a[32:35], v[108:111]
v_mul_f32 v205, s64, v205
v_mul_f32 v206, s64, v206
v_mfma_f32_16x16x32_bf16 v[108:111], a[8:11], a[20:23], v[108:111]
v_mul_f32 v207, s64, v207
v_cvt_pk_bf16_f32 v196, v200, v201
v_mfma_f32_16x16x32_bf16 v[116:119], a[8:11], a[24:27], v[116:119]
v_cvt_pk_bf16_f32 v197, v202, v203
v_cvt_pk_bf16_f32 v198, v204, v205
v_mfma_f32_16x16x32_bf16 v[116:119], a[12:15], a[36:39], v[116:119]
s_waitcnt vmcnt(10) lgkmcnt(4)
s_barrier
v_mfma_f32_16x16x32_bf16 v[120:123], v[248:251], a[16:19], v[120:123]
ds_read_b128 a[8:11], v222 offset:49152
s_add_u32 m0, s67, 73728
v_mfma_f32_16x16x32_bf16 v[120:123], v[252:255], a[28:31], v[120:123]
ds_read_b128 a[12:15], v223 offset:49152
s_add_u32 s69, s75, 65536
v_mfma_f32_16x16x32_bf16 v[128:131], v[252:255], a[32:35], v[128:131]
buffer_load_dwordx4 v224, s[24:27], s69 offen offset:0 nt lds
buffer_load_dwordx4 v225, s[24:27], s69 offen offset:1024 nt lds
v_mfma_f32_16x16x32_bf16 v[128:131], v[248:251], a[20:23], v[128:131]
s_add_u32 m0, s67, 81920
s_add_u32 s69, s75, 98304
v_mfma_f32_16x16x32_bf16 v[136:139], v[248:251], a[24:27], v[136:139]
buffer_load_dwordx4 v224, s[24:27], s69 offen offset:0 nt lds
buffer_load_dwordx4 v225, s[24:27], s69 offen offset:1024 nt lds
v_cvt_pk_bf16_f32 v199, v206, v207
v_mfma_f32_16x16x32_bf16 v[136:139], v[252:255], a[36:39], v[136:139]
v_mul_f32 v208, s64, v208
s_waitcnt lgkmcnt(3)
v_mfma_f32_16x16x32_bf16 v[124:127], a[0:3], a[16:19], v[124:127]
ds_read_b128 v[248:251], v222 offset:51200
v_mul_f32 v209, s64, v209
v_mfma_f32_16x16x32_bf16 v[124:127], a[4:7], a[28:31], v[124:127]
ds_read_b128 v[252:255], v223 offset:51200
v_mul_f32 v210, s64, v210
v_mfma_f32_16x16x32_bf16 v[132:135], a[4:7], a[32:35], v[132:135]
v_permlane16_swap_b32 v196, v198
v_mfma_f32_16x16x32_bf16 v[132:135], a[0:3], a[20:23], v[132:135]
v_permlane16_swap_b32 v197, v199
v_mfma_f32_16x16x32_bf16 v[140:143], a[0:3], a[24:27], v[140:143]
ds_write_b64 v228, v[196:197] offset:7168
v_mul_f32 v211, s64, v211
v_mfma_f32_16x16x32_bf16 v[140:143], a[4:7], a[36:39], v[140:143]
v_mul_f32 v212, s64, v212
s_waitcnt lgkmcnt(3)
v_mfma_f32_16x16x32_bf16 v[144:147], a[8:11], a[16:19], v[144:147]
ds_read_b128 a[0:3], v222 offset:57344
ds_write_b64 v228, v[198:199] offset:7176
v_mfma_f32_16x16x32_bf16 v[144:147], a[12:15], a[28:31], v[144:147]
ds_read_b128 a[4:7], v223 offset:57344
v_mul_f32 v213, s64, v213
v_mfma_f32_16x16x32_bf16 v[152:155], a[12:15], a[32:35], v[152:155]
v_mul_f32 v214, s64, v214
v_mul_f32 v215, s64, v215
v_mfma_f32_16x16x32_bf16 v[152:155], a[8:11], a[20:23], v[152:155]
v_cvt_pk_bf16_f32 v200, v208, v209
v_cvt_pk_bf16_f32 v201, v210, v211
v_mfma_f32_16x16x32_bf16 v[160:163], a[8:11], a[24:27], v[160:163]
v_cvt_pk_bf16_f32 v202, v212, v213
v_cvt_pk_bf16_f32 v203, v214, v215
v_mfma_f32_16x16x32_bf16 v[160:163], a[12:15], a[36:39], v[160:163]
s_waitcnt lgkmcnt(4)
v_mfma_f32_16x16x32_bf16 v[148:151], v[248:251], a[16:19], v[148:151]
ds_read_b128 a[8:11], v222 offset:59392
v_mfma_f32_16x16x32_bf16 v[148:151], v[252:255], a[28:31], v[148:151]
ds_read_b128 a[12:15], v223 offset:59392
v_mfma_f32_16x16x32_bf16 v[156:159], v[252:255], a[32:35], v[156:159]
v_permlane16_swap_b32 v200, v202
v_mfma_f32_16x16x32_bf16 v[156:159], v[248:251], a[20:23], v[156:159]
v_permlane16_swap_b32 v201, v203
v_mfma_f32_16x16x32_bf16 v[164:167], v[248:251], a[24:27], v[164:167]
ds_write_b64 v228, v[200:201] offset:8192
v_mfma_f32_16x16x32_bf16 v[164:167], v[252:255], a[36:39], v[164:167]
s_waitcnt vmcnt(8) lgkmcnt(3)
s_barrier
v_mfma_f32_16x16x32_bf16 v[168:171], a[0:3], a[16:19], v[168:171]
ds_read_b64_tr_b16 v[248:249], v216 offset:0
s_add_u32 m0, s67, 24576
ds_write_b64 v228, v[202:203] offset:8200
v_mfma_f32_16x16x32_bf16 v[168:171], a[4:7], a[28:31], v[168:171]
ds_read_b64_tr_b16 v[250:251], v216 offset:2048
s_add_u32 s69, s72, 1573376
v_mfma_f32_16x16x32_bf16 v[176:179], a[4:7], a[32:35], v[176:179]
ds_read_b64_tr_b16 v[252:253], v216 offset:4096
buffer_load_dwordx4 v226, s[32:35], s69 offen offset:0 lds
v_mfma_f32_16x16x32_bf16 v[176:179], a[0:3], a[20:23], v[176:179]
ds_read_b64_tr_b16 v[254:255], v216 offset:6144
buffer_load_dwordx4 v227, s[32:35], s69 offen offset:1024 lds
v_mfma_f32_16x16x32_bf16 v[184:187], a[0:3], a[24:27], v[184:187]
s_add_u32 m0, s67, 32768
s_add_u32 s69, s72, 2097664
s_waitcnt lgkmcnt(3)
s_barrier
ds_read_b128 a[40:43], v230 offset:6144
v_mfma_f32_16x16x32_bf16 v[184:187], a[4:7], a[36:39], v[184:187]
buffer_load_dwordx4 v226, s[32:35], s69 offen offset:0 lds
buffer_load_dwordx4 v227, s[32:35], s69 offen offset:1024 lds
ds_read_b128 a[52:55], v230 offset:16384
v_mfma_f32_16x16x32_bf16 v[172:175], a[8:11], a[16:19], v[172:175]
ds_read_b64_tr_b16 a[0:1], v217 offset:0
s_add_u32 m0, s67, 90112
ds_read_b128 a[56:59], v230 offset:17408
v_mfma_f32_16x16x32_bf16 v[172:175], a[12:15], a[28:31], v[172:175]
ds_read_b64_tr_b16 a[2:3], v217 offset:2048
s_add_u32 s69, s75, 131072
ds_read_b128 a[44:47], v230 offset:7168
v_mfma_f32_16x16x32_bf16 v[180:183], a[12:15], a[32:35], v[180:183]
ds_read_b64_tr_b16 a[4:5], v217 offset:4096
buffer_load_dwordx4 v224, s[24:27], s69 offen offset:0 nt lds
ds_read_b128 a[48:51], v230 offset:8192
v_mfma_f32_16x16x32_bf16 v[180:183], a[8:11], a[20:23], v[180:183]
ds_read_b64_tr_b16 a[6:7], v217 offset:6144
buffer_load_dwordx4 v225, s[24:27], s69 offen offset:1024 nt lds
ds_read_b128 a[60:63], v230 offset:18432
v_mfma_f32_16x16x32_bf16 v[188:191], a[8:11], a[24:27], v[188:191]
v_mfma_f32_16x16x32_bf16 v[188:191], a[12:15], a[36:39], v[188:191]
s_waitcnt lgkmcnt(10)
v_mfma_f32_16x16x32_bf16 v[192:195], v[248:251], a[88:91], 0
ds_read_b64_tr_b16 a[8:9], v217 offset:8192
v_mfma_f32_16x16x32_bf16 v[192:195], v[252:255], a[100:103], v[192:195]
ds_read_b64_tr_b16 a[10:11], v217 offset:10240
v_mfma_f32_16x16x32_bf16 v[200:203], v[252:255], a[104:107], 0
ds_read_b64_tr_b16 a[12:13], v217 offset:12288
v_mfma_f32_16x16x32_bf16 v[200:203], v[248:251], a[92:95], v[200:203]
ds_read_b64_tr_b16 a[14:15], v217 offset:14336
v_mfma_f32_16x16x32_bf16 v[208:211], v[248:251], a[96:99], 0
v_mfma_f32_16x16x32_bf16 v[208:211], v[252:255], a[108:111], v[208:211]
s_waitcnt lgkmcnt(5)
v_mfma_f32_16x16x32_bf16 v[196:199], a[0:3], a[88:91], 0
ds_read_b64_tr_b16 v[248:249], v216 offset:8192
v_mfma_f32_16x16x32_bf16 v[196:199], a[4:7], a[100:103], v[196:199]
ds_read_b64_tr_b16 v[250:251], v216 offset:10240
v_mfma_f32_16x16x32_bf16 v[204:207], a[4:7], a[104:107], 0
ds_read_b64_tr_b16 v[252:253], v216 offset:12288
v_mfma_f32_16x16x32_bf16 v[204:207], a[0:3], a[92:95], v[204:207]
ds_read_b64_tr_b16 v[254:255], v216 offset:14336
v_mfma_f32_16x16x32_bf16 v[212:215], a[0:3], a[96:99], 0
v_mfma_f32_16x16x32_bf16 v[212:215], a[4:7], a[108:111], v[212:215]
s_waitcnt lgkmcnt(4)
v_mfma_f32_16x16x32_bf16 v[212:215], a[8:11], a[120:123], v[212:215]
ds_read_b64_tr_b16 a[0:1], v216 offset:16384
v_mfma_f32_16x16x32_bf16 v[212:215], a[12:15], a[132:135], v[212:215]
ds_read_b64_tr_b16 a[2:3], v216 offset:18432
v_mfma_f32_16x16x32_bf16 v[204:207], a[12:15], a[128:131], v[204:207]
ds_read_b64_tr_b16 a[4:5], v216 offset:20480
v_mfma_f32_16x16x32_bf16 v[204:207], a[8:11], a[116:119], v[204:207]
ds_read_b64_tr_b16 a[6:7], v216 offset:22528
v_mfma_f32_16x16x32_bf16 v[196:199], a[8:11], a[112:115], v[196:199]
v_mfma_f32_16x16x32_bf16 v[196:199], a[12:15], a[124:127], v[196:199]
s_waitcnt lgkmcnt(4)
v_mfma_f32_16x16x32_bf16 v[208:211], v[248:251], a[120:123], v[208:211]
ds_read_b64_tr_b16 a[8:9], v217 offset:16384
v_mfma_f32_16x16x32_bf16 v[208:211], v[252:255], a[132:135], v[208:211]
ds_read_b64_tr_b16 a[10:11], v217 offset:18432
v_mfma_f32_16x16x32_bf16 v[200:203], v[252:255], a[128:131], v[200:203]
ds_read_b64_tr_b16 a[12:13], v217 offset:20480
v_mfma_f32_16x16x32_bf16 v[200:203], v[248:251], a[116:119], v[200:203]
ds_read_b64_tr_b16 a[14:15], v217 offset:22528
v_mfma_f32_16x16x32_bf16 v[192:195], v[248:251], a[112:115], v[192:195]
v_mfma_f32_16x16x32_bf16 v[192:195], v[252:255], a[124:127], v[192:195]
s_waitcnt vmcnt(10) lgkmcnt(4)
s_barrier
v_mfma_f32_16x16x32_bf16 v[192:195], a[0:3], a[136:139], v[192:195]
ds_read_b128 v[248:251], v222 offset:0
s_add_u32 m0, s67, 98304
v_mfma_f32_16x16x32_bf16 v[192:195], a[4:7], a[148:151], v[192:195]
ds_read_b128 v[252:255], v223 offset:0
s_add_u32 s69, s75, 163840
v_mfma_f32_16x16x32_bf16 v[200:203], a[4:7], a[152:155], v[200:203]
buffer_load_dwordx4 v224, s[24:27], s69 offen offset:0 nt lds
buffer_load_dwordx4 v225, s[24:27], s69 offen offset:1024 nt lds
v_mfma_f32_16x16x32_bf16 v[200:203], a[0:3], a[140:143], v[200:203]
s_add_u32 m0, s67, 106496
s_add_u32 s69, s75, 196608
v_mfma_f32_16x16x32_bf16 v[208:211], a[0:3], a[144:147], v[208:211]
buffer_load_dwordx4 v224, s[24:27], s69 offen offset:0 nt lds
buffer_load_dwordx4 v225, s[24:27], s69 offen offset:1024 nt lds
v_mfma_f32_16x16x32_bf16 v[208:211], a[4:7], a[156:159], v[208:211]
s_waitcnt lgkmcnt(2)
v_mfma_f32_16x16x32_bf16 v[196:199], a[8:11], a[136:139], v[196:199]
ds_read_b128 a[0:3], v222 offset:2048
v_mfma_f32_16x16x32_bf16 v[196:199], a[12:15], a[148:151], v[196:199]
ds_read_b128 a[4:7], v223 offset:2048
v_mfma_f32_16x16x32_bf16 v[204:207], a[12:15], a[152:155], v[204:207]
v_mfma_f32_16x16x32_bf16 v[204:207], a[8:11], a[140:143], v[204:207]
v_mfma_f32_16x16x32_bf16 v[212:215], a[8:11], a[144:147], v[212:215]
v_mfma_f32_16x16x32_bf16 v[212:215], a[12:15], a[156:159], v[212:215]
s_waitcnt lgkmcnt(2)
v_mfma_f32_16x16x32_bf16 v[0:3], v[248:251], a[40:43], v[0:3]
ds_read_b128 a[8:11], v222 offset:8192
v_mfma_f32_16x16x32_bf16 v[0:3], v[252:255], a[52:55], v[0:3]
ds_read_b128 a[12:15], v223 offset:8192
v_mfma_f32_16x16x32_bf16 v[8:11], v[252:255], a[56:59], v[8:11]
v_mfma_f32_16x16x32_bf16 v[8:11], v[248:251], a[44:47], v[8:11]
v_mfma_f32_16x16x32_bf16 v[16:19], v[248:251], a[48:51], v[16:19]
s_nop 3
v_max3_f32 v244, v0, v1, v2
v_mfma_f32_16x16x32_bf16 v[16:19], v[252:255], a[60:63], v[16:19]
s_waitcnt lgkmcnt(2)
v_mfma_f32_16x16x32_bf16 v[4:7], a[0:3], a[40:43], v[4:7]
ds_read_b128 v[248:251], v222 offset:10240
v_max3_f32 v245, v8, v9, v10
v_mfma_f32_16x16x32_bf16 v[4:7], a[4:7], a[52:55], v[4:7]
ds_read_b128 v[252:255], v223 offset:10240
v_mfma_f32_16x16x32_bf16 v[12:15], a[4:7], a[56:59], v[12:15]
s_nop 0
v_max3_f32 v231, v16, v17, v18
v_mfma_f32_16x16x32_bf16 v[12:15], a[0:3], a[44:47], v[12:15]
v_mfma_f32_16x16x32_bf16 v[20:23], a[0:3], a[48:51], v[20:23]
s_nop 1
v_max3_f32 v244, v3, v4, v244
v_max3_f32 v244, v5, v6, v244
v_max_f32 v244, v7, v244
v_mfma_f32_16x16x32_bf16 v[20:23], a[4:7], a[60:63], v[20:23]
s_waitcnt vmcnt(10) lgkmcnt(2)
s_barrier
v_mfma_f32_16x16x32_bf16 v[24:27], a[8:11], a[40:43], v[24:27]
ds_read_b128 a[0:3], v222 offset:16384
s_add_u32 m0, s67, 114688
v_max3_f32 v245, v11, v12, v245
v_max3_f32 v245, v13, v14, v245
v_max_f32 v245, v15, v245
v_mfma_f32_16x16x32_bf16 v[24:27], a[12:15], a[52:55], v[24:27]
ds_read_b128 a[4:7], v223 offset:16384
s_add_u32 s69, s75, 229376
v_mfma_f32_16x16x32_bf16 v[32:35], a[12:15], a[56:59], v[32:35]
buffer_load_dwordx4 v224, s[24:27], s69 offen offset:0 nt lds
buffer_load_dwordx4 v225, s[24:27], s69 offen offset:1024 nt lds
v_max3_f32 v231, v19, v20, v231
v_max3_f32 v231, v21, v22, v231
v_max_f32 v231, v23, v231
v_max3_f32 v244, abs(v244), abs(v245), abs(v231)
v_mfma_f32_16x16x32_bf16 v[32:35], a[8:11], a[44:47], v[32:35]
s_add_u32 m0, s67, 40960
s_add_u32 s69, s72, 2621952
v_cmp_lt_f32 vcc, s65, v244
s_cbranch_vccnz L_rare0_0
L_back0_0:
v_exp_f32 v0, v0
v_mfma_f32_16x16x32_bf16 v[40:43], a[8:11], a[48:51], v[40:43]
buffer_load_dwordx4 v226, s[32:35], s69 offen offset:0 lds
buffer_load_dwordx4 v227, s[32:35], s69 offen offset:1024 lds
v_exp_f32 v1, v1
v_exp_f32 v2, v2
v_cvt_pk_bf16_f32 v0, v0, v1
v_mfma_f32_16x16x32_bf16 v[40:43], a[12:15], a[60:63], v[40:43]
v_max3_f32 v244, v24, v25, v26
v_exp_f32 v3, v3
v_exp_f32 v4, v4
s_waitcnt lgkmcnt(2)
v_mfma_f32_16x16x32_bf16 v[28:31], v[248:251], a[40:43], v[28:31]
ds_read_b128 a[8:11], v222 offset:18432
v_cvt_pk_bf16_f32 v1, v2, v3
v_exp_f32 v5, v5
v_mfma_f32_16x16x32_bf16 v[28:31], v[252:255], a[52:55], v[28:31]
ds_read_b128 a[12:15], v223 offset:18432
v_cvt_pk_bf16_f32 v2, v4, v5
v_exp_f32 v6, v6
v_exp_f32 v7, v7
v_mfma_f32_16x16x32_bf16 v[36:39], v[252:255], a[56:59], v[36:39]
v_exp_f32 v8, v8
v_exp_f32 v9, v9
v_cvt_pk_bf16_f32 v3, v6, v7
v_mfma_f32_16x16x32_bf16 v[36:39], v[248:251], a[44:47], v[36:39]
v_exp_f32 v10, v10
v_exp_f32 v11, v11
v_mfma_f32_16x16x32_bf16 v[44:47], v[248:251], a[48:51], v[44:47]
v_cvt_pk_bf16_f32 v4, v8, v9
v_cvt_pk_bf16_f32 v5, v10, v11
v_exp_f32 v12, v12
v_max3_f32 v244, v27, v28, v244
v_mfma_f32_16x16x32_bf16 v[44:47], v[252:255], a[60:63], v[44:47]
v_max3_f32 v244, v29, v30, v244
v_exp_f32 v13, v13
v_exp_f32 v14, v14
s_waitcnt lgkmcnt(2)
v_mfma_f32_16x16x32_bf16 v[48:51], a[0:3], a[40:43], v[48:51]
ds_read_b128 v[248:251], v222 offset:24576
v_cvt_pk_bf16_f32 v6, v12, v13
v_exp_f32 v15, v15
v_exp_f32 v16, v16
v_mfma_f32_16x16x32_bf16 v[48:51], a[4:7], a[52:55], v[48:51]
ds_read_b128 v[252:255], v223 offset:24576
v_cvt_pk_bf16_f32 v7, v14, v15
v_exp_f32 v17, v17
v_max3_f32 v244, v31, v32, v244
v_mfma_f32_16x16x32_bf16 v[56:59], a[4:7], a[56:59], v[56:59]
v_exp_f32 v18, v18
v_exp_f32 v19, v19
v_exp_f32 v20, v20
v_mfma_f32_16x16x32_bf16 v[56:59], a[0:3], a[44:47], v[56:59]
v_exp_f32 v21, v21
v_exp_f32 v22, v22
v_mfma_f32_16x16x32_bf16 v[64:67], a[0:3], a[48:51], v[64:67]
v_exp_f32 v23, v23
v_cvt_pk_bf16_f32 v8, v16, v17
v_cvt_pk_bf16_f32 v9, v18, v19
v_cvt_pk_bf16_f32 v10, v20, v21
v_cvt_pk_bf16_f32 v11, v22, v23
v_mfma_f32_16x16x32_bf16 v[64:67], a[4:7], a[60:63], v[64:67]
v_max3_f32 v244, v33, v34, v244
v_max3_f32 v244, v35, v36, v244
v_max3_f32 v244, v37, v38, v244
v_max3_f32 v244, v39, v40, v244
s_waitcnt lgkmcnt(2)
v_mfma_f32_16x16x32_bf16 v[52:55], a[8:11], a[40:43], v[52:55]
ds_read_b128 a[0:3], v222 offset:26624
v_max3_f32 v244, v41, v42, v244
v_max3_f32 v244, v43, v44, v244
v_max3_f32 v244, v45, v46, v244
v_max_f32 v244, v47, v244
v_mfma_f32_16x16x32_bf16 v[52:55], a[12:15], a[52:55], v[52:55]
ds_read_b128 a[4:7], v223 offset:26624
v_cmp_lt_f32 vcc, s65, v244
s_cbranch_vccnz L_rare0_1
L_back0_1:
v_exp_f32 v24, v24
v_max3_f32 v244, v48, v49, v50
v_mfma_f32_16x16x32_bf16 v[60:63], a[12:15], a[56:59], v[60:63]
v_exp_f32 v25, v25
v_exp_f32 v26, v26
v_mfma_f32_16x16x32_bf16 v[60:63], a[8:11], a[44:47], v[60:63]
v_exp_f32 v27, v27
v_exp_f32 v28, v28
v_mfma_f32_16x16x32_bf16 v[68:71], a[8:11], a[48:51], v[68:71]
v_exp_f32 v29, v29
v_exp_f32 v30, v30
v_mfma_f32_16x16x32_bf16 v[68:71], a[12:15], a[60:63], v[68:71]
v_exp_f32 v31, v31
v_exp_f32 v32, v32
s_waitcnt vmcnt(10) lgkmcnt(2)
s_barrier
v_mfma_f32_16x16x32_bf16 v[72:75], v[248:251], a[40:43], v[72:75]
ds_read_b64_tr_b16 a[8:9], v217 offset:24576
s_add_u32 m0, s67, 49152
v_exp_f32 v33, v33
v_exp_f32 v34, v34
v_mfma_f32_16x16x32_bf16 v[72:75], v[252:255], a[52:55], v[72:75]
ds_read_b64_tr_b16 a[10:11], v217 offset:26624
s_add_u32 s69, s72, 3146240
v_exp_f32 v35, v35
v_exp_f32 v36, v36
v_mfma_f32_16x16x32_bf16 v[80:83], v[252:255], a[56:59], v[80:83]
ds_read_b64_tr_b16 a[12:13], v217 offset:28672
buffer_load_dwordx4 v226, s[32:35], s69 offen offset:0 lds
v_exp_f32 v37, v37
v_exp_f32 v38, v38
v_mfma_f32_16x16x32_bf16 v[80:83], v[248:251], a[44:47], v[80:83]
ds_read_b64_tr_b16 a[14:15], v217 offset:30720
buffer_load_dwordx4 v227, s[32:35], s69 offen offset:1024 lds
v_exp_f32 v39, v39
v_exp_f32 v40, v40
v_mfma_f32_16x16x32_bf16 v[88:91], v[248:251], a[48:51], v[88:91]
s_add_u32 m0, s67, 57344
s_add_u32 s69, s72, 0
v_exp_f32 v41, v41
v_exp_f32 v42, v42
v_cvt_pk_bf16_f32 v12, v24, v25
v_mfma_f32_16x16x32_bf16 v[88:91], v[252:255], a[60:63], v[88:91]
buffer_load_dwordx4 v224, s[28:31], s69 offen offset:0 nt lds
v_exp_f32 v43, v43
v_exp_f32 v44, v44
s_waitcnt lgkmcnt(4)
v_mfma_f32_16x16x32_bf16 v[76:79], a[0:3], a[40:43], v[76:79]
ds_read_b64_tr_b16 v[248:249], v216 offset:24576
buffer_load_dwordx4 v225, s[28:31], s69 offen offset:1024 nt lds
v_exp_f32 v45, v45
v_exp_f32 v46, v46
v_mfma_f32_16x16x32_bf16 v[76:79], a[4:7], a[52:55], v[76:79]
ds_read_b64_tr_b16 v[250:251], v216 offset:26624
v_cvt_pk_bf16_f32 v13, v26, v27
v_exp_f32 v47, v47
v_cvt_pk_bf16_f32 v14, v28, v29
v_mfma_f32_16x16x32_bf16 v[84:87], a[4:7], a[56:59], v[84:87]
ds_read_b64_tr_b16 v[252:253], v216 offset:28672
v_cvt_pk_bf16_f32 v15, v30, v31
v_cvt_pk_bf16_f32 v16, v32, v33
v_cvt_pk_bf16_f32 v17, v34, v35
v_cvt_pk_bf16_f32 v18, v36, v37
v_mfma_f32_16x16x32_bf16 v[84:87], a[0:3], a[44:47], v[84:87]
ds_read_b64_tr_b16 v[254:255], v216 offset:30720
v_cvt_pk_bf16_f32 v19, v38, v39
v_cvt_pk_bf16_f32 v20, v40, v41
v_cvt_pk_bf16_f32 v21, v42, v43
v_cvt_pk_bf16_f32 v22, v44, v45
v_mfma_f32_16x16x32_bf16 v[92:95], a[0:3], a[48:51], v[92:95]
v_cvt_pk_bf16_f32 v23, v46, v47
v_max3_f32 v244, v51, v52, v244
v_max3_f32 v244, v53, v54, v244
v_max3_f32 v244, v55, v56, v244
v_mfma_f32_16x16x32_bf16 v[92:95], a[4:7], a[60:63], v[92:95]
v_max3_f32 v244, v57, v58, v244
v_max3_f32 v244, v59, v60, v244
v_max3_f32 v244, v61, v62, v244
v_max3_f32 v244, v63, v64, v244
s_waitcnt lgkmcnt(4)
v_mfma_f32_16x16x32_bf16 v[212:215], a[8:11], a[168:171], v[212:215]
ds_read_b64_tr_b16 a[0:1], v216 offset:32768
v_max3_f32 v244, v65, v66, v244
v_max3_f32 v244, v67, v68, v244
v_max3_f32 v244, v69, v70, v244
v_max_f32 v244, v71, v244
v_mfma_f32_16x16x32_bf16 v[212:215], a[12:15], a[180:183], v[212:215]
ds_read_b64_tr_b16 a[2:3], v216 offset:34816
v_cmp_lt_f32 vcc, s65, v244
s_cbranch_vccnz L_rare0_2
L_back0_2:
v_exp_f32 v48, v48
v_max3_f32 v244, v72, v73, v74
v_mfma_f32_16x16x32_bf16 v[204:207], a[12:15], a[176:179], v[204:207]
ds_read_b64_tr_b16 a[4:5], v216 offset:36864
v_max3_f32 v244, v75, v76, v244
v_exp_f32 v49, v49
v_max3_f32 v244, v77, v78, v244
v_mfma_f32_16x16x32_bf16 v[204:207], a[8:11], a[164:167], v[204:207]
ds_read_b64_tr_b16 a[6:7], v216 offset:38912
v_cvt_pk_bf16_f32 v24, v48, v49
v_exp_f32 v50, v50
v_exp_f32 v51, v51
v_mfma_f32_16x16x32_bf16 v[196:199], a[8:11], a[160:163], v[196:199]
v_exp_f32 v52, v52
v_exp_f32 v53, v53
v_mfma_f32_16x16x32_bf16 v[196:199], a[12:15], a[172:175], v[196:199]
v_cvt_pk_bf16_f32 v25, v50, v51
v_exp_f32 v54, v54
v_cvt_pk_bf16_f32 v26, v52, v53
s_waitcnt lgkmcnt(4)
v_mfma_f32_16x16x32_bf16 v[208:211], v[248:251], a[168:171], v[208:211]
ds_read_b64_tr_b16 a[8:9], v217 offset:32768
v_max3_f32 v244, v79, v80, v244
v_exp_f32 v55, v55
v_max3_f32 v244, v81, v82, v244
v_mfma_f32_16x16x32_bf16 v[208:211], v[252:255], a[180:183], v[208:211]
ds_read_b64_tr_b16 a[10:11], v217 offset:34816
v_cvt_pk_bf16_f32 v27, v54, v55
v_exp_f32 v56, v56
v_exp_f32 v57, v57
v_mfma_f32_16x16x32_bf16 v[200:203], v[252:255], a[176:179], v[200:203]
ds_read_b64_tr_b16 a[12:13], v217 offset:36864
v_cvt_pk_bf16_f32 v28, v56, v57
v_exp_f32 v58, v58
v_max3_f32 v244, v83, v84, v244
v_mfma_f32_16x16x32_bf16 v[200:203], v[248:251], a[164:167], v[200:203]
ds_read_b64_tr_b16 a[14:15], v217 offset:38912
v_max3_f32 v244, v85, v86, v244
v_exp_f32 v59, v59
v_exp_f32 v60, v60
v_mfma_f32_16x16x32_bf16 v[192:195], v[248:251], a[160:163], v[192:195]
v_exp_f32 v61, v61
v_exp_f32 v62, v62
v_mfma_f32_16x16x32_bf16 v[192:195], v[252:255], a[172:175], v[192:195]
v_exp_f32 v63, v63
v_exp_f32 v64, v64
v_exp_f32 v65, v65
s_waitcnt vmcnt(10) lgkmcnt(4)
s_barrier
v_mfma_f32_16x16x32_bf16 v[192:195], a[0:3], a[184:187], v[192:195]
ds_read_b128 v[248:251], v222 offset:32768
s_add_u32 m0, s67, 65536
v_exp_f32 v66, v66
v_exp_f32 v67, v67
v_mfma_f32_16x16x32_bf16 v[192:195], a[4:7], a[196:199], v[192:195]
ds_read_b128 v[252:255], v223 offset:32768
s_add_u32 s69, s72, 32768
v_exp_f32 v68, v68
v_exp_f32 v69, v69
v_exp_f32 v70, v70
v_mfma_f32_16x16x32_bf16 v[200:203], a[4:7], a[200:203], v[200:203]
buffer_load_dwordx4 v224, s[28:31], s69 offen offset:0 nt lds
buffer_load_dwordx4 v225, s[28:31], s69 offen offset:1024 nt lds
v_exp_f32 v71, v71
v_cvt_pk_bf16_f32 v29, v58, v59
v_cvt_pk_bf16_f32 v30, v60, v61
v_mfma_f32_16x16x32_bf16 v[200:203], a[0:3], a[188:191], v[200:203]
s_add_u32 m0, s67, 73728
s_add_u32 s69, s72, 65536
v_cvt_pk_bf16_f32 v31, v62, v63
v_cvt_pk_bf16_f32 v32, v64, v65
v_cvt_pk_bf16_f32 v33, v66, v67
v_cvt_pk_bf16_f32 v34, v68, v69
v_cvt_pk_bf16_f32 v35, v70, v71
v_mfma_f32_16x16x32_bf16 v[208:211], a[0:3], a[192:195], v[208:211]
buffer_load_dwordx4 v224, s[28:31], s69 offen offset:0 nt lds
buffer_load_dwordx4 v225, s[28:31], s69 offen offset:1024 nt lds
v_max3_f32 v244, v87, v88, v244
v_max3_f32 v244, v89, v90, v244
v_max3_f32 v244, v91, v92, v244
v_max3_f32 v244, v93, v94, v244
v_mfma_f32_16x16x32_bf16 v[208:211], a[4:7], a[204:207], v[208:211]
v_max_f32 v244, v95, v244
v_cmp_lt_f32 vcc, s65, v244
s_cbranch_vccnz L_rare0_3
L_back0_3:
v_mov_b32 v246, 0x3f803f80
s_waitcnt lgkmcnt(2)
v_mfma_f32_16x16x32_bf16 v[196:199], a[8:11], a[184:187], v[196:199]
ds_read_b128 a[0:3], v222 offset:34816
v_accvgpr_write_b32 a76, v246
v_exp_f32 v72, v72
v_accvgpr_write_b32 a77, v246
v_mfma_f32_16x16x32_bf16 v[196:199], a[12:15], a[196:199], v[196:199]
ds_read_b128 a[4:7], v223 offset:34816
v_accvgpr_write_b32 a78, v246
v_exp_f32 v73, v73
v_accvgpr_write_b32 a79, v246
v_mfma_f32_16x16x32_bf16 v[204:207], a[12:15], a[200:203], v[204:207]
v_exp_f32 v74, v74
v_exp_f32 v75, v75
v_mfma_f32_16x16x32_bf16 v[204:207], a[8:11], a[188:191], v[204:207]
v_exp_f32 v76, v76
v_exp_f32 v77, v77
v_mfma_f32_16x16x32_bf16 v[212:215], a[8:11], a[192:195], v[212:215]
v_exp_f32 v78, v78
v_exp_f32 v79, v79
v_mfma_f32_16x16x32_bf16 v[212:215], a[12:15], a[204:207], v[212:215]
v_cvt_pk_bf16_f32 v36, v72, v73
v_exp_f32 v80, v80
v_exp_f32 v81, v81
s_waitcnt lgkmcnt(2)
v_mfma_f32_16x16x32_bf16 v[96:99], v[248:251], a[40:43], v[96:99]
ds_read_b128 a[8:11], v222 offset:40960
v_cvt_pk_bf16_f32 v37, v74, v75
v_exp_f32 v82, v82
v_mfma_f32_16x16x32_bf16 v[96:99], v[252:255], a[52:55], v[96:99]
ds_read_b128 a[12:15], v223 offset:40960
v_cvt_pk_bf16_f32 v38, v76, v77
v_exp_f32 v83, v83
v_exp_f32 v84, v84
v_mfma_f32_16x16x32_bf16 v[104:107], v[252:255], a[56:59], v[104:107]
v_exp_f32 v85, v85
v_exp_f32 v86, v86
v_mfma_f32_16x16x32_bf16 v[104:107], v[248:251], a[44:47], v[104:107]
v_exp_f32 v87, v87
v_exp_f32 v88, v88
v_mfma_f32_16x16x32_bf16 v[112:115], v[248:251], a[48:51], v[112:115]
v_exp_f32 v89, v89
v_exp_f32 v90, v90
v_mfma_f32_16x16x32_bf16 v[112:115], v[252:255], a[60:63], v[112:115]
v_cvt_pk_bf16_f32 v39, v78, v79
v_exp_f32 v91, v91
v_exp_f32 v92, v92
s_waitcnt lgkmcnt(2)
v_mfma_f32_16x16x32_bf16 v[100:103], a[0:3], a[40:43], v[100:103]
ds_read_b128 v[248:251], v222 offset:43008
v_cvt_pk_bf16_f32 v40, v80, v81
v_exp_f32 v93, v93
v_mfma_f32_16x16x32_bf16 v[100:103], a[4:7], a[52:55], v[100:103]
ds_read_b128 v[252:255], v223 offset:43008
v_cvt_pk_bf16_f32 v41, v82, v83
v_exp_f32 v94, v94
v_exp_f32 v95, v95
v_mfma_f32_16x16x32_bf16 v[108:111], a[4:7], a[56:59], v[108:111]
v_cvt_pk_bf16_f32 v42, v84, v85
v_cvt_pk_bf16_f32 v43, v86, v87
v_cvt_pk_bf16_f32 v44, v88, v89
v_cvt_pk_bf16_f32 v45, v90, v91
v_mfma_f32_16x16x32_bf16 v[108:111], a[0:3], a[44:47], v[108:111]
v_cvt_pk_bf16_f32 v46, v92, v93
v_cvt_pk_bf16_f32 v47, v94, v95
v_max3_f32 v244, v96, v97, v98
v_and_b32 v246, 0xf0, v228
v_mfma_f32_16x16x32_bf16 v[116:119], a[0:3], a[48:51], v[116:119]
v_max3_f32 v244, v99, v100, v244
v_max3_f32 v244, v101, v102, v244
v_max3_f32 v244, v103, v104, v244
v_max3_f32 v244, v105, v106, v244
v_mfma_f32_16x16x32_bf16 v[116:119], a[4:7], a[60:63], v[116:119]
v_lshlrev_b32 v247, 1, v246
v_and_b32 v246, 0xfffffc00, v228
v_add_u32 v246, v246, v247
s_waitcnt vmcnt(10) lgkmcnt(2)
s_barrier
v_mfma_f32_16x16x32_bf16 v[120:123], a[8:11], a[40:43], v[120:123]
ds_read_b128 a[0:3], v222 offset:49152
s_add_u32 m0, s67, 81920
v_max3_f32 v244, v107, v108, v244
v_max3_f32 v244, v109, v110, v244
v_max3_f32 v244, v111, v112, v244
v_max3_f32 v244, v113, v114, v244
v_mfma_f32_16x16x32_bf16 v[120:123], a[12:15], a[52:55], v[120:123]
ds_read_b128 a[4:7], v223 offset:49152
s_add_u32 s69, s72, 98304
v_mfma_f32_16x16x32_bf16 v[128:131], a[12:15], a[56:59], v[128:131]
buffer_load_dwordx4 v224, s[28:31], s69 offen offset:0 nt lds
buffer_load_dwordx4 v225, s[28:31], s69 offen offset:1024 nt lds
v_max3_f32 v244, v115, v116, v244
v_max3_f32 v244, v117, v118, v244
v_max_f32 v244, v119, v244
v_cmp_lt_f32 vcc, s65, v244
s_cbranch_vccnz L_rare0_4
L_back0_4:
v_mfma_f32_16x16x32_bf16 v[128:131], a[8:11], a[44:47], v[128:131]
s_add_u32 m0, s67, 0
s_add_u32 s69, s73, 512
v_exp_f32 v96, v96
v_exp_f32 v97, v97
v_mfma_f32_16x16x32_bf16 v[136:139], a[8:11], a[48:51], v[136:139]
buffer_load_dwordx4 v226, s[32:35], s69 offen offset:0 lds
buffer_load_dwordx4 v227, s[32:35], s69 offen offset:1024 lds
v_exp_f32 v98, v98
v_exp_f32 v99, v99
v_exp_f32 v100, v100
v_mfma_f32_16x16x32_bf16 v[136:139], a[12:15], a[60:63], v[136:139]
v_cvt_pk_bf16_f32 v48, v96, v97
v_exp_f32 v101, v101
v_cvt_pk_bf16_f32 v49, v98, v99
s_waitcnt lgkmcnt(2)
v_mfma_f32_16x16x32_bf16 v[124:127], v[248:251], a[40:43], v[124:127]
ds_read_b128 a[8:11], v222 offset:51200
v_cvt_pk_bf16_f32 v50, v100, v101
v_exp_f32 v102, v102
v_exp_f32 v103, v103
v_mfma_f32_16x16x32_bf16 v[124:127], v[252:255], a[52:55], v[124:127]
ds_read_b128 a[12:15], v223 offset:51200
v_cvt_pk_bf16_f32 v51, v102, v103
v_exp_f32 v104, v104
v_max3_f32 v244, v120, v121, v122
v_mfma_f32_16x16x32_bf16 v[132:135], v[252:255], a[56:59], v[132:135]
v_exp_f32 v105, v105
v_exp_f32 v106, v106
v_cvt_pk_bf16_f32 v52, v104, v105
v_mfma_f32_16x16x32_bf16 v[132:135], v[248:251], a[44:47], v[132:135]
v_exp_f32 v107, v107
v_exp_f32 v108, v108
v_mfma_f32_16x16x32_bf16 v[140:143], v[248:251], a[48:51], v[140:143]
v_exp_f32 v109, v109
v_exp_f32 v110, v110
v_exp_f32 v111, v111
v_mfma_f32_16x16x32_bf16 v[140:143], v[252:255], a[60:63], v[140:143]
v_cvt_pk_bf16_f32 v53, v106, v107
v_exp_f32 v112, v112
v_cvt_pk_bf16_f32 v54, v108, v109
s_waitcnt lgkmcnt(2)
v_mfma_f32_16x16x32_bf16 v[144:147], a[0:3], a[40:43], v[144:147]
ds_read_b128 v[248:251], v222 offset:57344
v_cvt_pk_bf16_f32 v55, v110, v111
v_exp_f32 v113, v113
v_exp_f32 v114, v114
v_mfma_f32_16x16x32_bf16 v[144:147], a[4:7], a[52:55], v[144:147]
ds_read_b128 v[252:255], v223 offset:57344
v_cvt_pk_bf16_f32 v56, v112, v113
v_exp_f32 v115, v115
v_exp_f32 v116, v116
v_mfma_f32_16x16x32_bf16 v[152:155], a[4:7], a[56:59], v[152:155]
v_exp_f32 v117, v117
v_exp_f32 v118, v118
v_mfma_f32_16x16x32_bf16 v[152:155], a[0:3], a[44:47], v[152:155]
v_exp_f32 v119, v119
v_cvt_pk_bf16_f32 v57, v114, v115
v_cvt_pk_bf16_f32 v58, v116, v117
v_cvt_pk_bf16_f32 v59, v118, v119
v_mfma_f32_16x16x32_bf16 v[160:163], a[0:3], a[48:51], v[160:163]
v_max3_f32 v244, v123, v124, v244
v_max3_f32 v244, v125, v126, v244
v_max3_f32 v244, v127, v128, v244
v_max3_f32 v244, v129, v130, v244
v_mfma_f32_16x16x32_bf16 v[160:163], a[4:7], a[60:63], v[160:163]
v_max3_f32 v244, v131, v132, v244
v_max3_f32 v244, v133, v134, v244
v_max3_f32 v244, v135, v136, v244
v_max3_f32 v244, v137, v138, v244
s_waitcnt lgkmcnt(2)
v_mfma_f32_16x16x32_bf16 v[148:151], a[8:11], a[40:43], v[148:151]
ds_read_b128 a[0:3], v222 offset:59392
v_max3_f32 v244, v139, v140, v244
v_max3_f32 v244, v141, v142, v244
v_max_f32 v244, v143, v244
v_cmp_lt_f32 vcc, s65, v244
s_cbranch_vccnz L_rare0_5
L_back0_5:
v_mfma_f32_16x16x32_bf16 v[148:151], a[12:15], a[52:55], v[148:151]
ds_read_b128 a[4:7], v223 offset:59392
v_max3_f32 v244, v144, v145, v146
v_exp_f32 v120, v120
v_mfma_f32_16x16x32_bf16 v[156:159], a[12:15], a[56:59], v[156:159]
v_exp_f32 v121, v121
v_exp_f32 v122, v122
v_cvt_pk_bf16_f32 v60, v120, v121
v_mfma_f32_16x16x32_bf16 v[156:159], a[8:11], a[44:47], v[156:159]
v_exp_f32 v123, v123
v_exp_f32 v124, v124
v_mfma_f32_16x16x32_bf16 v[164:167], a[8:11], a[48:51], v[164:167]
v_exp_f32 v125, v125
v_exp_f32 v126, v126
v_cvt_pk_bf16_f32 v61, v122, v123
v_mfma_f32_16x16x32_bf16 v[164:167], a[12:15], a[60:63], v[164:167]
v_exp_f32 v127, v127
v_exp_f32 v128, v128
s_waitcnt vmcnt(10) lgkmcnt(2)
s_barrier
v_mfma_f32_16x16x32_bf16 v[168:171], v[248:251], a[40:43], v[168:171]
ds_read_b64_tr_b16 a[8:9], v217 offset:40960
s_add_u32 m0, s67, 8192
v_exp_f32 v129, v129
v_exp_f32 v130, v130
v_cvt_pk_bf16_f32 v62, v124, v125
v_mfma_f32_16x16x32_bf16 v[168:171], v[252:255], a[52:55], v[168:171]
ds_read_b64_tr_b16 a[10:11], v217 offset:43008
s_add_u32 s69, s73, 524800
v_exp_f32 v131, v131
v_exp_f32 v132, v132
v_mfma_f32_16x16x32_bf16 v[176:179], v[252:255], a[56:59], v[176:179]
ds_read_b64_tr_b16 a[12:13], v217 offset:45056
buffer_load_dwordx4 v226, s[32:35], s69 offen offset:0 lds
v_exp_f32 v133, v133
v_exp_f32 v134, v134
v_mfma_f32_16x16x32_bf16 v[176:179], v[248:251], a[44:47], v[176:179]
ds_read_b64_tr_b16 a[14:15], v217 offset:47104
buffer_load_dwordx4 v227, s[32:35], s69 offen offset:1024 lds
v_exp_f32 v135, v135
v_exp_f32 v136, v136
v_cvt_pk_bf16_f32 v63, v126, v127
v_mfma_f32_16x16x32_bf16 v[184:187], v[248:251], a[48:51], v[184:187]
s_add_u32 m0, s67, 90112
s_add_u32 s69, s72, 131072
v_exp_f32 v137, v137
v_exp_f32 v138, v138
v_mfma_f32_16x16x32_bf16 v[184:187], v[252:255], a[60:63], v[184:187]
buffer_load_dwordx4 v224, s[28:31], s69 offen offset:0 nt lds
v_exp_f32 v139, v139
v_exp_f32 v140, v140
v_cvt_pk_bf16_f32 v64, v128, v129
s_waitcnt lgkmcnt(4)
v_mfma_f32_16x16x32_bf16 v[172:175], a[0:3], a[40:43], v[172:175]
ds_read_b64_tr_b16 v[248:249], v216 offset:40960
buffer_load_dwordx4 v225, s[28:31], s69 offen offset:1024 nt lds
v_exp_f32 v141, v141
v_exp_f32 v142, v142
v_mfma_f32_16x16x32_bf16 v[172:175], a[4:7], a[52:55], v[172:175]
ds_read_b64_tr_b16 v[250:251], v216 offset:43008
v_cvt_pk_bf16_f32 v65, v130, v131
v_exp_f32 v143, v143
v_cvt_pk_bf16_f32 v66, v132, v133
v_cvt_pk_bf16_f32 v67, v134, v135
v_mfma_f32_16x16x32_bf16 v[180:183], a[4:7], a[56:59], v[180:183]
ds_read_b64_tr_b16 v[252:253], v216 offset:45056
v_cvt_pk_bf16_f32 v68, v136, v137
v_cvt_pk_bf16_f32 v69, v138, v139
v_cvt_pk_bf16_f32 v70, v140, v141
v_cvt_pk_bf16_f32 v71, v142, v143
v_mfma_f32_16x16x32_bf16 v[180:183], a[0:3], a[44:47], v[180:183]
ds_read_b64_tr_b16 v[254:255], v216 offset:47104
v_max3_f32 v244, v147, v148, v244
v_max3_f32 v244, v149, v150, v244
v_max3_f32 v244, v151, v152, v244
v_max3_f32 v244, v153, v154, v244
v_mfma_f32_16x16x32_bf16 v[188:191], a[0:3], a[48:51], v[188:191]
v_max3_f32 v244, v155, v156, v244
v_max3_f32 v244, v157, v158, v244
v_max3_f32 v244, v159, v160, v244
v_max3_f32 v244, v161, v162, v244
v_mfma_f32_16x16x32_bf16 v[188:191], a[4:7], a[60:63], v[188:191]
v_max3_f32 v244, v163, v164, v244
v_max3_f32 v244, v165, v166, v244
v_max_f32 v244, v167, v244
v_cmp_lt_f32 vcc, s65, v244
s_cbranch_vccnz L_rare0_6
L_back0_6:
s_waitcnt lgkmcnt(4)
v_mfma_f32_16x16x32_bf16 v[212:215], a[8:11], a[216:219], v[212:215]
ds_read_b64_tr_b16 a[0:1], v216 offset:49152
v_max3_f32 v244, v168, v169, v170
v_exp_f32 v144, v144
v_max3_f32 v244, v171, v172, v244
v_mfma_f32_16x16x32_bf16 v[212:215], a[12:15], a[228:231], v[212:215]
ds_read_b64_tr_b16 a[2:3], v216 offset:51200
v_max3_f32 v244, v173, v174, v244
v_exp_f32 v145, v145
v_max3_f32 v244, v175, v176, v244
v_mfma_f32_16x16x32_bf16 v[204:207], a[12:15], a[224:227], v[204:207]
ds_read_b64_tr_b16 a[4:5], v216 offset:53248
v_cvt_pk_bf16_f32 v72, v144, v145
v_exp_f32 v146, v146
v_exp_f32 v147, v147
v_mfma_f32_16x16x32_bf16 v[204:207], a[8:11], a[212:215], v[204:207]
ds_read_b64_tr_b16 a[6:7], v216 offset:55296
v_cvt_pk_bf16_f32 v73, v146, v147
v_exp_f32 v148, v148
v_mfma_f32_16x16x32_bf16 v[196:199], a[8:11], a[208:211], v[196:199]
v_exp_f32 v149, v149
v_exp_f32 v150, v150
v_cvt_pk_bf16_f32 v74, v148, v149
v_mfma_f32_16x16x32_bf16 v[196:199], a[12:15], a[220:223], v[196:199]
v_max3_f32 v244, v177, v178, v244
v_exp_f32 v151, v151
v_exp_f32 v152, v152
s_waitcnt lgkmcnt(4)
v_mfma_f32_16x16x32_bf16 v[208:211], v[248:251], a[216:219], v[208:211]
ds_read_b64_tr_b16 a[8:9], v217 offset:49152
v_cvt_pk_bf16_f32 v75, v150, v151
v_exp_f32 v153, v153
v_mfma_f32_16x16x32_bf16 v[208:211], v[252:255], a[228:231], v[208:211]
ds_read_b64_tr_b16 a[10:11], v217 offset:51200
v_cvt_pk_bf16_f32 v76, v152, v153
v_exp_f32 v154, v154
v_exp_f32 v155, v155
v_mfma_f32_16x16x32_bf16 v[200:203], v[252:255], a[224:227], v[200:203]
ds_read_b64_tr_b16 a[12:13], v217 offset:53248
v_cvt_pk_bf16_f32 v77, v154, v155
v_exp_f32 v156, v156
v_exp_f32 v157, v157
v_mfma_f32_16x16x32_bf16 v[200:203], v[248:251], a[212:215], v[200:203]
ds_read_b64_tr_b16 a[14:15], v217 offset:55296
v_cvt_pk_bf16_f32 v78, v156, v157
v_exp_f32 v158, v158
v_max3_f32 v244, v179, v180, v244
v_mfma_f32_16x16x32_bf16 v[192:195], v[248:251], a[208:211], v[192:195]
v_exp_f32 v159, v159
v_exp_f32 v160, v160
v_mfma_f32_16x16x32_bf16 v[192:195], v[252:255], a[220:223], v[192:195]
v_exp_f32 v161, v161
v_exp_f32 v162, v162
v_exp_f32 v163, v163
s_waitcnt vmcnt(10) lgkmcnt(4)
s_barrier
v_mfma_f32_16x16x32_bf16 v[192:195], a[0:3], a[232:235], v[192:195]
ds_read_b64_tr_b16 v[248:249], v220 offset:0
s_add_u32 m0, s67, 98304
v_exp_f32 v164, v164
v_exp_f32 v165, v165
v_mfma_f32_16x16x32_bf16 v[192:195], a[4:7], a[244:247], v[192:195]
ds_read_b64_tr_b16 v[250:251], v220 offset:2048
s_add_u32 s69, s72, 163840
v_exp_f32 v166, v166
v_exp_f32 v167, v167
v_mfma_f32_16x16x32_bf16 v[200:203], a[4:7], a[248:251], v[200:203]
ds_read_b64_tr_b16 v[252:253], v220 offset:8192
buffer_load_dwordx4 v224, s[28:31], s69 offen offset:0 nt lds
v_cvt_pk_bf16_f32 v79, v158, v159
v_cvt_pk_bf16_f32 v80, v160, v161
v_cvt_pk_bf16_f32 v81, v162, v163
v_cvt_pk_bf16_f32 v82, v164, v165
v_cvt_pk_bf16_f32 v83, v166, v167
v_mfma_f32_16x16x32_bf16 v[200:203], a[0:3], a[236:239], v[200:203]
ds_read_b64_tr_b16 v[254:255], v220 offset:10240
buffer_load_dwordx4 v225, s[28:31], s69 offen offset:1024 nt lds
v_max3_f32 v244, v181, v182, v244
v_max3_f32 v244, v183, v184, v244
v_max3_f32 v244, v185, v186, v244
v_max3_f32 v244, v187, v188, v244
v_mfma_f32_16x16x32_bf16 v[208:211], a[0:3], a[240:243], v[208:211]
s_add_u32 m0, s67, 106496
s_add_u32 s69, s72, 196608
v_max3_f32 v244, v189, v190, v244
v_max_f32 v244, v191, v244
v_cmp_lt_f32 vcc, s65, v244
s_cbranch_vccnz L_rare0_7
L_back0_7:
v_mfma_f32_16x16x32_bf16 v[208:211], a[4:7], a[252:255], v[208:211]
buffer_load_dwordx4 v224, s[28:31], s69 offen offset:0 nt lds
v_exp_f32 v168, v168
v_exp_f32 v169, v169
s_waitcnt lgkmcnt(4)
v_mfma_f32_16x16x32_bf16 v[196:199], a[8:11], a[232:235], v[196:199]
ds_read_b64_tr_b16 a[0:1], v221 offset:0
buffer_load_dwordx4 v225, s[28:31], s69 offen offset:1024 nt lds
v_exp_f32 v170, v170
v_exp_f32 v171, v171
v_mfma_f32_16x16x32_bf16 v[196:199], a[12:15], a[244:247], v[196:199]
ds_read_b64_tr_b16 a[2:3], v221 offset:2048
s_add_u32 m0, s67, 114688
v_exp_f32 v172, v172
v_exp_f32 v173, v173
v_mfma_f32_16x16x32_bf16 v[204:207], a[12:15], a[248:251], v[204:207]
ds_read_b64_tr_b16 a[4:5], v221 offset:8192
s_add_u32 s69, s72, 229376
v_exp_f32 v174, v174
v_exp_f32 v175, v175
v_mfma_f32_16x16x32_bf16 v[204:207], a[8:11], a[236:239], v[204:207]
ds_read_b64_tr_b16 a[6:7], v221 offset:10240
buffer_load_dwordx4 v224, s[28:31], s69 offen offset:0 nt lds
v_exp_f32 v176, v176
v_exp_f32 v177, v177
v_mfma_f32_16x16x32_bf16 v[212:215], a[8:11], a[240:243], v[212:215]
buffer_load_dwordx4 v225, s[28:31], s69 offen offset:1024 nt lds
ds_write_b64 v246, v[232:233] offset:9216
v_exp_f32 v178, v178
v_exp_f32 v179, v179
v_mfma_f32_16x16x32_bf16 v[212:215], a[12:15], a[252:255], v[212:215]
v_cvt_pk_bf16_f32 v84, v168, v169
v_exp_f32 v180, v180
v_cvt_pk_bf16_f32 v85, v170, v171
s_waitcnt lgkmcnt(5)
v_mfma_f32_16x16x32_bf16 v[120:123], v[248:251], v[0:3], 0
ds_read_b64_tr_b16 a[8:9], v218 offset:0
v_cvt_pk_bf16_f32 v86, v172, v173
v_exp_f32 v181, v181
v_cvt_pk_bf16_f32 v87, v174, v175
v_mfma_f32_16x16x32_bf16 v[120:123], v[252:255], v[12:15], v[120:123]
ds_read_b64_tr_b16 a[10:11], v218 offset:2048
v_cvt_pk_bf16_f32 v88, v176, v177
v_exp_f32 v182, v182
v_cvt_pk_bf16_f32 v89, v178, v179
v_mfma_f32_16x16x32_bf16 v[128:131], v[252:255], v[16:19], 0
ds_read_b64_tr_b16 a[12:13], v218 offset:8192
v_cvt_pk_bf16_f32 v90, v180, v181
v_exp_f32 v183, v183
v_mul_f32 v192, s64, v192
v_mfma_f32_16x16x32_bf16 v[128:131], v[248:251], v[4:7], v[128:131]
ds_read_b64_tr_b16 a[14:15], v218 offset:10240
v_cvt_pk_bf16_f32 v91, v182, v183
v_exp_f32 v184, v184
v_exp_f32 v185, v185
v_mfma_f32_16x16x32_bf16 v[136:139], v[248:251], v[8:11], 0
v_exp_f32 v186, v186
v_exp_f32 v187, v187
v_mfma_f32_16x16x32_bf16 v[136:139], v[252:255], v[20:23], v[136:139]
v_cvt_pk_bf16_f32 v92, v184, v185
v_exp_f32 v188, v188
s_waitcnt lgkmcnt(5)
v_mfma_f32_16x16x32_bf16 v[124:127], a[0:3], v[0:3], 0
ds_read_b64_tr_b16 v[248:249], v219 offset:0
v_cvt_pk_bf16_f32 v93, v186, v187
v_exp_f32 v189, v189
v_exp_f32 v190, v190
v_mfma_f32_16x16x32_bf16 v[124:127], a[4:7], v[12:15], v[124:127]
ds_read_b64_tr_b16 v[250:251], v219 offset:2048
v_cvt_pk_bf16_f32 v94, v188, v189
v_exp_f32 v191, v191
v_mul_f32 v193, s64, v193
v_mfma_f32_16x16x32_bf16 v[132:135], a[4:7], v[16:19], 0
ds_read_b64_tr_b16 v[252:253], v219 offset:8192
v_cvt_pk_bf16_f32 v95, v190, v191
v_mfma_f32_16x16x32_bf16 v[132:135], a[0:3], v[4:7], v[132:135]
ds_read_b64_tr_b16 v[254:255], v219 offset:10240
v_mul_f32 v194, s64, v194
v_mul_f32 v195, s64, v195
v_mfma_f32_16x16x32_bf16 v[140:143], a[0:3], v[8:11], 0
v_cvt_pk_bf16_f32 v192, v192, v193
v_mul_f32 v196, s64, v196
v_mfma_f32_16x16x32_bf16 v[140:143], a[4:7], v[20:23], v[140:143]
v_mul_f32 v197, s64, v197
s_waitcnt vmcnt(12)
s_barrier
v_mfma_f32_16x16x32_bf16 a[64:67], a[76:79], v[0:3], 0
s_add_u32 m0, s67, 16384
s_add_u32 s69, s73, 1049088
v_mul_f32 v198, s64, v198
v_mul_f32 v199, s64, v199
v_mfma_f32_16x16x32_bf16 a[64:67], a[76:79], v[12:15], a[64:67]
buffer_load_dwordx4 v226, s[32:35], s69 offen offset:0 lds
buffer_load_dwordx4 v227, s[32:35], s69 offen offset:1024 lds
v_cvt_pk_bf16_f32 v193, v194, v195
v_cvt_pk_bf16_f32 v194, v196, v197
v_mfma_f32_16x16x32_bf16 a[68:71], a[76:79], v[16:19], 0
s_add_u32 m0, s67, 24576
s_add_u32 s69, s73, 1573376
v_cvt_pk_bf16_f32 v195, v198, v199
v_mul_f32 v200, s64, v200
v_mfma_f32_16x16x32_bf16 a[68:71], a[76:79], v[4:7], a[68:71]
buffer_load_dwordx4 v226, s[32:35], s69 offen offset:0 lds
buffer_load_dwordx4 v227, s[32:35], s69 offen offset:1024 lds
v_permlane16_swap_b32 v192, v194
v_mfma_f32_16x16x32_bf16 a[72:75], a[76:79], v[8:11], 0
v_permlane16_swap_b32 v193, v195
v_mfma_f32_16x16x32_bf16 a[72:75], a[76:79], v[20:23], a[72:75]
ds_write_b64 v228, v[192:193] offset:6144
v_mul_f32 v201, s64, v201
s_waitcnt lgkmcnt(5)
v_mfma_f32_16x16x32_bf16 v[96:99], a[8:11], v[0:3], 0
ds_read_b64_tr_b16 a[0:1], v220 offset:16384
v_mul_f32 v202, s64, v202
v_mfma_f32_16x16x32_bf16 v[96:99], a[12:15], v[12:15], v[96:99]
ds_read_b64_tr_b16 a[2:3], v220 offset:18432
ds_write_b64 v228, v[194:195] offset:6152
v_mul_f32 v203, s64, v203
v_mul_f32 v204, s64, v204
v_mfma_f32_16x16x32_bf16 v[104:107], a[12:15], v[16:19], 0
ds_read_b64_tr_b16 a[4:5], v220 offset:24576
v_mul_f32 v205, s64, v205
v_mul_f32 v206, s64, v206
v_mfma_f32_16x16x32_bf16 v[104:107], a[8:11], v[4:7], v[104:107]
ds_read_b64_tr_b16 a[6:7], v220 offset:26624
v_mul_f32 v207, s64, v207
v_mfma_f32_16x16x32_bf16 v[112:115], a[8:11], v[8:11], 0
v_cvt_pk_bf16_f32 v196, v200, v201
v_cvt_pk_bf16_f32 v197, v202, v203
v_mfma_f32_16x16x32_bf16 v[112:115], a[12:15], v[20:23], v[112:115]
v_cvt_pk_bf16_f32 v198, v204, v205
v_cvt_pk_bf16_f32 v199, v206, v207
s_waitcnt lgkmcnt(6)
v_mfma_f32_16x16x32_bf16 v[100:103], v[248:251], v[0:3], 0
ds_read_b64_tr_b16 a[8:9], v221 offset:16384
v_mul_f32 v208, s64, v208
v_mul_f32 v209, s64, v209
v_mfma_f32_16x16x32_bf16 v[100:103], v[252:255], v[12:15], v[100:103]
ds_read_b64_tr_b16 a[10:11], v221 offset:18432
v_mul_f32 v210, s64, v210
v_mfma_f32_16x16x32_bf16 v[108:111], v[252:255], v[16:19], 0
ds_read_b64_tr_b16 a[12:13], v221 offset:24576
v_mul_f32 v211, s64, v211
v_permlane16_swap_b32 v196, v198
v_mfma_f32_16x16x32_bf16 v[108:111], v[248:251], v[4:7], v[108:111]
ds_read_b64_tr_b16 a[14:15], v221 offset:26624
v_mul_f32 v212, s64, v212
v_mfma_f32_16x16x32_bf16 v[116:119], v[248:251], v[8:11], 0
v_permlane16_swap_b32 v197, v199
v_mfma_f32_16x16x32_bf16 v[116:119], v[252:255], v[20:23], v[116:119]
ds_write_b64 v228, v[196:197] offset:7168
v_mul_f32 v213, s64, v213
v_mfma_f32_16x16x32_bf16 a[64:67], a[76:79], v[24:27], a[64:67]
v_mul_f32 v214, s64, v214
v_mul_f32 v215, s64, v215
v_mfma_f32_16x16x32_bf16 a[64:67], a[76:79], v[36:39], a[64:67]
ds_write_b64 v228, v[198:199] offset:7176
v_cvt_pk_bf16_f32 v200, v208, v209
v_mfma_f32_16x16x32_bf16 a[68:71], a[76:79], v[40:43], a[68:71]
v_cvt_pk_bf16_f32 v201, v210, v211
v_cvt_pk_bf16_f32 v202, v212, v213
v_mfma_f32_16x16x32_bf16 a[68:71], a[76:79], v[28:31], a[68:71]
v_cvt_pk_bf16_f32 v203, v214, v215
v_permlane16_swap_b32 v200, v202
v_mfma_f32_16x16x32_bf16 a[72:75], a[76:79], v[32:35], a[72:75]
v_permlane16_swap_b32 v201, v203
v_mfma_f32_16x16x32_bf16 a[72:75], a[76:79], v[44:47], a[72:75]
ds_write_b64 v228, v[200:201] offset:8192
s_waitcnt lgkmcnt(7)
v_mfma_f32_16x16x32_bf16 v[120:123], a[0:3], v[24:27], v[120:123]
ds_read_b64_tr_b16 v[248:249], v218 offset:16384
v_mfma_f32_16x16x32_bf16 v[120:123], a[4:7], v[36:39], v[120:123]
ds_read_b64_tr_b16 v[250:251], v218 offset:18432
ds_write_b64 v228, v[202:203] offset:8200
v_mfma_f32_16x16x32_bf16 v[128:131], a[4:7], v[40:43], v[128:131]
ds_read_b64_tr_b16 v[252:253], v218 offset:24576
v_mfma_f32_16x16x32_bf16 v[128:131], a[0:3], v[28:31], v[128:131]
ds_read_b64_tr_b16 v[254:255], v218 offset:26624
v_mfma_f32_16x16x32_bf16 v[136:139], a[0:3], v[32:35], v[136:139]
v_mfma_f32_16x16x32_bf16 v[136:139], a[4:7], v[44:47], v[136:139]
s_waitcnt lgkmcnt(2)
s_barrier
ds_read_b128 a[16:19], v230 offset:6144
v_mfma_f32_16x16x32_bf16 v[124:127], a[8:11], v[24:27], v[124:127]
ds_read_b64_tr_b16 a[0:1], v219 offset:16384
ds_read_b128 a[28:31], v230 offset:16384
v_mfma_f32_16x16x32_bf16 v[124:127], a[12:15], v[36:39], v[124:127]
ds_read_b64_tr_b16 a[2:3], v219 offset:18432
ds_read_b128 a[32:35], v230 offset:17408
v_mfma_f32_16x16x32_bf16 v[132:135], a[12:15], v[40:43], v[132:135]
ds_read_b64_tr_b16 a[4:5], v219 offset:24576
ds_read_b128 a[20:23], v230 offset:7168
v_mfma_f32_16x16x32_bf16 v[132:135], a[8:11], v[28:31], v[132:135]
ds_read_b64_tr_b16 a[6:7], v219 offset:26624
ds_read_b128 a[24:27], v230 offset:8192
v_mfma_f32_16x16x32_bf16 v[140:143], a[8:11], v[32:35], v[140:143]
ds_read_b128 a[36:39], v230 offset:18432
v_mfma_f32_16x16x32_bf16 v[140:143], a[12:15], v[44:47], v[140:143]
s_waitcnt vmcnt(12)
s_barrier
v_mfma_f32_16x16x32_bf16 a[64:67], a[76:79], v[48:51], a[64:67]
s_add_u32 m0, s67, 32768
s_add_u32 s69, s73, 2097664
v_mfma_f32_16x16x32_bf16 a[64:67], a[76:79], v[60:63], a[64:67]
buffer_load_dwordx4 v226, s[32:35], s69 offen offset:0 lds
buffer_load_dwordx4 v227, s[32:35], s69 offen offset:1024 lds
v_mfma_f32_16x16x32_bf16 a[68:71], a[76:79], v[64:67], a[68:71]
s_add_u32 m0, s67, 57344
s_add_u32 s69, s73, 0
v_mfma_f32_16x16x32_bf16 a[68:71], a[76:79], v[52:55], a[68:71]
buffer_load_dwordx4 v224, s[28:31], s69 offen offset:0 nt lds
buffer_load_dwordx4 v225, s[28:31], s69 offen offset:1024 nt lds
v_mfma_f32_16x16x32_bf16 a[72:75], a[76:79], v[56:59], a[72:75]
v_mfma_f32_16x16x32_bf16 a[72:75], a[76:79], v[68:71], a[72:75]
s_waitcnt lgkmcnt(10)
v_mfma_f32_16x16x32_bf16 v[96:99], v[248:251], v[24:27], v[96:99]
ds_read_b64_tr_b16 a[8:9], v216 offset:0
v_mfma_f32_16x16x32_bf16 v[96:99], v[252:255], v[36:39], v[96:99]
ds_read_b64_tr_b16 a[10:11], v216 offset:2048
v_mfma_f32_16x16x32_bf16 v[104:107], v[252:255], v[40:43], v[104:107]
ds_read_b64_tr_b16 a[12:13], v216 offset:4096
v_mfma_f32_16x16x32_bf16 v[104:107], v[248:251], v[28:31], v[104:107]
ds_read_b64_tr_b16 a[14:15], v216 offset:6144
v_mfma_f32_16x16x32_bf16 v[112:115], v[248:251], v[32:35], v[112:115]
v_mfma_f32_16x16x32_bf16 v[112:115], v[252:255], v[44:47], v[112:115]
s_waitcnt lgkmcnt(6)
v_mfma_f32_16x16x32_bf16 v[100:103], a[0:3], v[24:27], v[100:103]
ds_read_b64_tr_b16 v[248:249], v217 offset:0
v_mfma_f32_16x16x32_bf16 v[100:103], a[4:7], v[36:39], v[100:103]
ds_read_b64_tr_b16 v[250:251], v217 offset:2048
v_mfma_f32_16x16x32_bf16 v[108:111], a[4:7], v[40:43], v[108:111]
ds_read_b64_tr_b16 v[252:253], v217 offset:4096
v_mfma_f32_16x16x32_bf16 v[108:111], a[0:3], v[28:31], v[108:111]
ds_read_b64_tr_b16 v[254:255], v217 offset:6144
v_mfma_f32_16x16x32_bf16 v[116:119], a[0:3], v[32:35], v[116:119]
v_mfma_f32_16x16x32_bf16 v[116:119], a[4:7], v[44:47], v[116:119]
v_mfma_f32_16x16x32_bf16 a[64:67], a[76:79], v[72:75], a[64:67]
v_mfma_f32_16x16x32_bf16 a[64:67], a[76:79], v[84:87], a[64:67]
v_mfma_f32_16x16x32_bf16 a[68:71], a[76:79], v[88:91], a[68:71]
v_mfma_f32_16x16x32_bf16 a[68:71], a[76:79], v[76:79], a[68:71]
v_mfma_f32_16x16x32_bf16 a[72:75], a[76:79], v[80:83], a[72:75]
s_nop 4
v_accvgpr_read_b32 v235, a64
v_mfma_f32_16x16x32_bf16 a[72:75], a[76:79], v[92:95], a[72:75]
ds_write_b64 v246, v[234:235] offset:9224
s_waitcnt lgkmcnt(5)
v_mfma_f32_16x16x32_bf16 v[192:195], a[8:11], a[88:91], 0
ds_read_b64_tr_b16 a[0:1], v217 offset:8192
v_accvgpr_read_b32 v236, a68
v_mfma_f32_16x16x32_bf16 v[192:195], a[12:15], a[100:103], v[192:195]
ds_read_b64_tr_b16 a[2:3], v217 offset:10240
v_mfma_f32_16x16x32_bf16 v[200:203], a[12:15], a[104:107], 0
ds_read_b64_tr_b16 a[4:5], v217 offset:12288
v_accvgpr_read_b32 v237, a72
v_mfma_f32_16x16x32_bf16 v[200:203], a[8:11], a[92:95], v[200:203]
ds_read_b64_tr_b16 a[6:7], v217 offset:14336
ds_write_b64 v246, v[236:237] offset:9232
v_and_b32 v246, 0xfffffc00, v229
v_mfma_f32_16x16x32_bf16 v[208:211], a[8:11], a[96:99], 0
v_add_u32 v246, v246, v247
v_mfma_f32_16x16x32_bf16 v[208:211], a[12:15], a[108:111], v[208:211]
s_waitcnt lgkmcnt(6)
v_mfma_f32_16x16x32_bf16 v[196:199], v[248:251], a[88:91], 0
ds_read_b64_tr_b16 a[8:9], v216 offset:8192
v_mfma_f32_16x16x32_bf16 v[196:199], v[252:255], a[100:103], v[196:199]
ds_read_b64_tr_b16 a[10:11], v216 offset:10240
v_mfma_f32_16x16x32_bf16 v[204:207], v[252:255], a[104:107], 0
ds_read_b64_tr_b16 a[12:13], v216 offset:12288
v_mfma_f32_16x16x32_bf16 v[204:207], v[248:251], a[92:95], v[204:207]
ds_read_b64_tr_b16 a[14:15], v216 offset:14336
v_mfma_f32_16x16x32_bf16 v[212:215], v[248:251], a[96:99], 0
v_mfma_f32_16x16x32_bf16 v[212:215], v[252:255], a[108:111], v[212:215]
s_waitcnt vmcnt(12) lgkmcnt(4)
s_barrier
v_mfma_f32_16x16x32_bf16 v[212:215], a[0:3], a[120:123], v[212:215]
ds_read_b64_tr_b16 v[248:249], v220 offset:32768
s_add_u32 m0, s67, 65536
v_mfma_f32_16x16x32_bf16 v[212:215], a[4:7], a[132:135], v[212:215]
ds_read_b64_tr_b16 v[250:251], v220 offset:34816
s_add_u32 s69, s73, 32768
v_mfma_f32_16x16x32_bf16 v[204:207], a[4:7], a[128:131], v[204:207]
ds_read_b64_tr_b16 v[252:253], v220 offset:40960
buffer_load_dwordx4 v224, s[28:31], s69 offen offset:0 nt lds
v_mfma_f32_16x16x32_bf16 v[204:207], a[0:3], a[116:119], v[204:207]
ds_read_b64_tr_b16 v[254:255], v220 offset:43008
buffer_load_dwordx4 v225, s[28:31], s69 offen offset:1024 nt lds
v_mfma_f32_16x16x32_bf16 v[196:199], a[0:3], a[112:115], v[196:199]
s_add_u32 m0, s67, 73728
s_add_u32 s69, s73, 65536
v_mfma_f32_16x16x32_bf16 v[196:199], a[4:7], a[124:127], v[196:199]
buffer_load_dwordx4 v224, s[28:31], s69 offen offset:0 nt lds
s_waitcnt lgkmcnt(4)
v_mfma_f32_16x16x32_bf16 v[208:211], a[8:11], a[120:123], v[208:211]
ds_read_b64_tr_b16 a[0:1], v221 offset:32768
buffer_load_dwordx4 v225, s[28:31], s69 offen offset:1024 nt lds
v_mfma_f32_16x16x32_bf16 v[208:211], a[12:15], a[132:135], v[208:211]
ds_read_b64_tr_b16 a[2:3], v221 offset:34816
ds_read_b128 v[238:241], v246 offset:9216
v_mfma_f32_16x16x32_bf16 v[200:203], a[12:15], a[128:131], v[200:203]
ds_read_b64_tr_b16 a[4:5], v221 offset:40960
ds_read_b64 v[242:243], v246 offset:9232
v_mfma_f32_16x16x32_bf16 v[200:203], a[8:11], a[116:119], v[200:203]
ds_read_b64_tr_b16 a[6:7], v221 offset:43008
v_mfma_f32_16x16x32_bf16 v[192:195], a[8:11], a[112:115], v[192:195]
v_mfma_f32_16x16x32_bf16 v[192:195], a[12:15], a[124:127], v[192:195]
s_waitcnt lgkmcnt(6)
v_mfma_f32_16x16x32_bf16 v[120:123], v[248:251], v[48:51], v[120:123]
ds_read_b64_tr_b16 a[8:9], v218 offset:32768
v_mfma_f32_16x16x32_bf16 v[120:123], v[252:255], v[60:63], v[120:123]
ds_read_b64_tr_b16 a[10:11], v218 offset:34816
s_waitcnt lgkmcnt(5)
v_max_f32 v244, v232, v238
v_mfma_f32_16x16x32_bf16 v[128:131], v[252:255], v[64:67], v[128:131]
ds_read_b64_tr_b16 a[12:13], v218 offset:40960
v_sub_f32 v245, v238, v244
v_mfma_f32_16x16x32_bf16 v[128:131], v[248:251], v[52:55], v[128:131]
ds_read_b64_tr_b16 a[14:15], v218 offset:43008
v_sub_f32 v244, v232, v244
v_mfma_f32_16x16x32_bf16 v[136:139], v[248:251], v[56:59], v[136:139]
v_max_f32 v231, v233, v239
v_max_f32 v246, v234, v240
v_mfma_f32_16x16x32_bf16 v[136:139], v[252:255], v[68:71], v[136:139]
v_sub_f32 v247, v239, v231
s_waitcnt lgkmcnt(4)
v_mfma_f32_16x16x32_bf16 v[124:127], a[0:3], v[48:51], v[124:127]
ds_read_b64_tr_b16 v[248:249], v219 offset:32768
v_sub_f32 v232, v240, v246
v_mfma_f32_16x16x32_bf16 v[124:127], a[4:7], v[60:63], v[124:127]
ds_read_b64_tr_b16 v[250:251], v219 offset:34816
v_sub_f32 v231, v233, v231
v_mfma_f32_16x16x32_bf16 v[132:135], a[4:7], v[64:67], v[132:135]
ds_read_b64_tr_b16 v[252:253], v219 offset:40960
v_sub_f32 v246, v234, v246
v_mfma_f32_16x16x32_bf16 v[132:135], a[0:3], v[52:55], v[132:135]
ds_read_b64_tr_b16 v[254:255], v219 offset:43008
v_mfma_f32_16x16x32_bf16 v[140:143], a[0:3], v[56:59], v[140:143]
v_exp_f32 v245, v245
v_mfma_f32_16x16x32_bf16 v[140:143], a[4:7], v[68:71], v[140:143]
v_mul_f32 v241, v245, v241
s_waitcnt vmcnt(12) lgkmcnt(4)
s_barrier
v_mfma_f32_16x16x32_bf16 v[96:99], a[8:11], v[48:51], v[96:99]
ds_read_b64_tr_b16 a[0:1], v220 offset:49152
s_add_u32 m0, s67, 81920
v_mfma_f32_16x16x32_bf16 v[96:99], a[12:15], v[60:63], v[96:99]
ds_read_b64_tr_b16 a[2:3], v220 offset:51200
s_add_u32 s69, s73, 98304
v_exp_f32 v247, v247
v_mfma_f32_16x16x32_bf16 v[104:107], a[12:15], v[64:67], v[104:107]
ds_read_b64_tr_b16 a[4:5], v220 offset:57344
buffer_load_dwordx4 v224, s[28:31], s69 offen offset:0 nt lds
v_mul_f32 v242, v247, v242
v_mfma_f32_16x16x32_bf16 v[104:107], a[8:11], v[52:55], v[104:107]
ds_read_b64_tr_b16 a[6:7], v220 offset:59392
buffer_load_dwordx4 v225, s[28:31], s69 offen offset:1024 nt lds
v_mfma_f32_16x16x32_bf16 v[112:115], a[8:11], v[56:59], v[112:115]
s_add_u32 m0, s67, 40960
s_add_u32 s69, s73, 2621952
v_exp_f32 v232, v232
v_mfma_f32_16x16x32_bf16 v[112:115], a[12:15], v[68:71], v[112:115]
buffer_load_dwordx4 v226, s[32:35], s69 offen offset:0 lds
v_mul_f32 v243, v232, v243
s_waitcnt lgkmcnt(4)
v_mfma_f32_16x16x32_bf16 v[100:103], v[248:251], v[48:51], v[100:103]
ds_read_b64_tr_b16 a[8:9], v221 offset:49152
buffer_load_dwordx4 v227, s[32:35], s69 offen offset:1024 lds
v_exp_f32 v244, v244
v_mfma_f32_16x16x32_bf16 v[100:103], v[252:255], v[60:63], v[100:103]
ds_read_b64_tr_b16 a[10:11], v221 offset:51200
v_fmac_f32 v241, v244, v235
v_mfma_f32_16x16x32_bf16 v[108:111], v[252:255], v[64:67], v[108:111]
ds_read_b64_tr_b16 a[12:13], v221 offset:57344
v_mfma_f32_16x16x32_bf16 v[108:111], v[248:251], v[52:55], v[108:111]
ds_read_b64_tr_b16 a[14:15], v221 offset:59392
v_exp_f32 v231, v231
v_mfma_f32_16x16x32_bf16 v[116:119], v[248:251], v[56:59], v[116:119]
v_exp_f32 v246, v246
v_mfma_f32_16x16x32_bf16 v[116:119], v[252:255], v[68:71], v[116:119]
v_fmac_f32 v242, v231, v236
s_waitcnt lgkmcnt(4)
v_mfma_f32_16x16x32_bf16 v[120:123], a[0:3], v[72:75], v[120:123]
ds_read_b64_tr_b16 v[248:249], v218 offset:49152
v_fmac_f32 v243, v246, v237
v_mfma_f32_16x16x32_bf16 v[120:123], a[4:7], v[84:87], v[120:123]
ds_read_b64_tr_b16 v[250:251], v218 offset:51200
v_mfma_f32_16x16x32_bf16 v[128:131], a[4:7], v[88:91], v[128:131]
ds_read_b64_tr_b16 v[252:253], v218 offset:57344
v_rcp_f32 v241, v241
v_mfma_f32_16x16x32_bf16 v[128:131], a[0:3], v[76:79], v[128:131]
ds_read_b64_tr_b16 v[254:255], v218 offset:59392
v_mul_f32 v238, v244, v241
v_mfma_f32_16x16x32_bf16 v[136:139], a[0:3], v[80:83], v[136:139]
ds_write_b64 v228, v[120:121] offset:0
v_mul_f32 v241, v245, v241
v_mfma_f32_16x16x32_bf16 v[136:139], a[4:7], v[92:95], v[136:139]
s_waitcnt lgkmcnt(5)
v_mfma_f32_16x16x32_bf16 v[124:127], a[8:11], v[72:75], v[124:127]
ds_read_b64_tr_b16 a[0:1], v219 offset:49152
ds_write_b64 v228, v[122:123] offset:8
v_rcp_f32 v242, v242
v_mfma_f32_16x16x32_bf16 v[124:127], a[12:15], v[84:87], v[124:127]
ds_read_b64_tr_b16 a[2:3], v219 offset:51200
v_mul_f32 v239, v231, v242
v_mfma_f32_16x16x32_bf16 v[132:135], a[12:15], v[88:91], v[132:135]
ds_read_b64_tr_b16 a[4:5], v219 offset:57344
ds_write_b64 v228, v[128:129] offset:2048
v_rcp_f32 v243, v243
v_mfma_f32_16x16x32_bf16 v[132:135], a[8:11], v[76:79], v[132:135]
ds_read_b64_tr_b16 a[6:7], v219 offset:59392
v_mul_f32 v240, v246, v243
v_mfma_f32_16x16x32_bf16 v[140:143], a[8:11], v[80:83], v[140:143]
ds_write_b64 v228, v[130:131] offset:2056
v_mul_f32 v242, v247, v242
v_mfma_f32_16x16x32_bf16 v[140:143], a[12:15], v[92:95], v[140:143]
s_waitcnt vmcnt(10) lgkmcnt(8)
s_barrier
v_mfma_f32_16x16x32_bf16 v[96:99], v[248:251], v[72:75], v[96:99]
ds_read_b64_tr_b16 a[8:9], v216 offset:16384
s_add_u32 m0, s67, 49152
ds_write_b64 v228, v[136:137] offset:4096
v_mul_f32 v243, v232, v243
v_mfma_f32_16x16x32_bf16 v[96:99], v[252:255], v[84:87], v[96:99]
ds_read_b64_tr_b16 a[10:11], v216 offset:18432
s_add_u32 s69, s73, 3146240
v_mfma_f32_16x16x32_bf16 v[104:107], v[252:255], v[88:91], v[104:107]
ds_read_b64_tr_b16 a[12:13], v216 offset:20480
buffer_load_dwordx4 v226, s[32:35], s69 offen offset:0 lds
ds_write_b64 v228, v[138:139] offset:4104
v_mfma_f32_16x16x32_bf16 v[104:107], v[248:251], v[76:79], v[104:107]
ds_read_b64_tr_b16 a[14:15], v216 offset:22528
buffer_load_dwordx4 v227, s[32:35], s69 offen offset:1024 lds
v_mfma_f32_16x16x32_bf16 v[112:115], v[248:251], v[80:83], v[112:115]
s_add_u32 m0, s67, 90112
s_add_u32 s69, s73, 131072
ds_write_b64 v228, v[124:125] offset:1024
v_mul_f32 v96, v238, v96
v_mfma_f32_16x16x32_bf16 v[112:115], v[252:255], v[92:95], v[112:115]
buffer_load_dwordx4 v224, s[28:31], s69 offen offset:0 nt lds
v_mul_f32 v97, v238, v97
s_waitcnt lgkmcnt(8)
v_mfma_f32_16x16x32_bf16 v[100:103], a[0:3], v[72:75], v[100:103]
ds_read_b64_tr_b16 v[248:249], v217 offset:16384
buffer_load_dwordx4 v225, s[28:31], s69 offen offset:1024 nt lds
ds_write_b64 v228, v[126:127] offset:1032
v_mul_f32 v98, v238, v98
v_mfma_f32_16x16x32_bf16 v[100:103], a[4:7], v[84:87], v[100:103]
ds_read_b64_tr_b16 v[250:251], v217 offset:18432
s_add_u32 m0, s67, 98304
v_mul_f32 v99, v238, v99
v_mfma_f32_16x16x32_bf16 v[108:111], a[4:7], v[88:91], v[108:111]
ds_read_b64_tr_b16 v[252:253], v217 offset:20480
s_add_u32 s69, s73, 163840
ds_write_b64 v228, v[132:133] offset:3072
v_mul_f32 v104, v239, v104
v_mfma_f32_16x16x32_bf16 v[108:111], a[0:3], v[76:79], v[108:111]
ds_read_b64_tr_b16 v[254:255], v217 offset:22528
buffer_load_dwordx4 v224, s[28:31], s69 offen offset:0 nt lds
v_mul_f32 v105, v239, v105
v_mfma_f32_16x16x32_bf16 v[116:119], a[0:3], v[80:83], v[116:119]
buffer_load_dwordx4 v225, s[28:31], s69 offen offset:1024 nt lds
ds_write_b64 v228, v[134:135] offset:3080
v_mul_f32 v106, v239, v106
v_mfma_f32_16x16x32_bf16 v[116:119], a[4:7], v[92:95], v[116:119]
v_mul_f32 v107, v239, v107
s_waitcnt lgkmcnt(8)
v_mfma_f32_16x16x32_bf16 v[192:195], a[8:11], a[136:139], v[192:195]
ds_read_b64_tr_b16 a[0:1], v217 offset:24576
ds_write_b64 v228, v[140:141] offset:5120
v_mul_f32 v112, v240, v112
v_mfma_f32_16x16x32_bf16 v[192:195], a[12:15], a[148:151], v[192:195]
ds_read_b64_tr_b16 a[2:3], v217 offset:26624
v_mul_f32 v113, v240, v113
v_mfma_f32_16x16x32_bf16 v[200:203], a[12:15], a[152:155], v[200:203]
ds_read_b64_tr_b16 a[4:5], v217 offset:28672
ds_write_b64 v228, v[142:143] offset:5128
v_mfma_f32_16x16x32_bf16 v[200:203], a[8:11], a[140:143], v[200:203]
ds_read_b64_tr_b16 a[6:7], v217 offset:30720
v_mul_f32 v114, v240, v114
v_mfma_f32_16x16x32_bf16 v[208:211], a[8:11], a[144:147], v[208:211]
v_mul_f32 v115, v240, v115
v_mul_f32 v100, v238, v100
v_mfma_f32_16x16x32_bf16 v[208:211], a[12:15], a[156:159], v[208:211]
v_mul_f32 v101, v238, v101
s_waitcnt lgkmcnt(7)
v_mfma_f32_16x16x32_bf16 v[196:199], v[248:251], a[136:139], v[196:199]
ds_read_b64_tr_b16 a[8:9], v216 offset:24576
s_waitcnt lgkmcnt(2)
s_barrier
ds_read_b128 v[120:123], v229 offset:0
v_mfma_f32_16x16x32_bf16 v[196:199], v[252:255], a[148:151], v[196:199]
ds_read_b64_tr_b16 a[10:11], v216 offset:26624
ds_read_b128 v[124:127], v229 offset:1024
v_mul_f32 v102, v238, v102
v_mfma_f32_16x16x32_bf16 v[204:207], v[252:255], a[152:155], v[204:207]
ds_read_b64_tr_b16 a[12:13], v216 offset:28672
ds_read_b128 v[128:131], v229 offset:2048
v_mul_f32 v103, v238, v103
v_mfma_f32_16x16x32_bf16 v[204:207], v[248:251], a[140:143], v[204:207]
ds_read_b64_tr_b16 a[14:15], v216 offset:30720
ds_read_b128 v[132:135], v229 offset:3072
v_mul_f32 v108, v239, v108
v_mfma_f32_16x16x32_bf16 v[212:215], v[248:251], a[144:147], v[212:215]
ds_read_b128 v[136:139], v229 offset:4096
v_mul_f32 v109, v239, v109
v_mfma_f32_16x16x32_bf16 v[212:215], v[252:255], a[156:159], v[212:215]
ds_read_b128 v[140:143], v229 offset:5120
s_waitcnt lgkmcnt(10)
v_mfma_f32_16x16x32_bf16 v[212:215], a[0:3], a[168:171], v[212:215]
ds_read_b64_tr_b16 v[248:249], v216 offset:32768
s_waitcnt lgkmcnt(9)
v_fmac_f32 v96, v241, v120
v_mfma_f32_16x16x32_bf16 v[212:215], a[4:7], a[180:183], v[212:215]
ds_read_b64_tr_b16 v[250:251], v216 offset:34816
v_fmac_f32 v97, v241, v121
v_mfma_f32_16x16x32_bf16 v[204:207], a[4:7], a[176:179], v[204:207]
ds_read_b64_tr_b16 v[252:253], v216 offset:36864
v_fmac_f32 v98, v241, v122
v_mfma_f32_16x16x32_bf16 v[204:207], a[0:3], a[164:167], v[204:207]
ds_read_b64_tr_b16 v[254:255], v216 offset:38912
v_fmac_f32 v99, v241, v123
v_mfma_f32_16x16x32_bf16 v[196:199], a[0:3], a[160:163], v[196:199]
s_waitcnt lgkmcnt(8)
v_fmac_f32 v104, v242, v128
v_mfma_f32_16x16x32_bf16 v[196:199], a[4:7], a[172:175], v[196:199]
v_fmac_f32 v105, v242, v129
s_waitcnt lgkmcnt(7)
v_mfma_f32_16x16x32_bf16 v[208:211], a[8:11], a[168:171], v[208:211]
ds_read_b64_tr_b16 a[0:1], v217 offset:32768
v_fmac_f32 v106, v242, v130
v_mfma_f32_16x16x32_bf16 v[208:211], a[12:15], a[180:183], v[208:211]
ds_read_b64_tr_b16 a[2:3], v217 offset:34816
v_fmac_f32 v107, v242, v131
v_mfma_f32_16x16x32_bf16 v[200:203], a[12:15], a[176:179], v[200:203]
ds_read_b64_tr_b16 a[4:5], v217 offset:36864
s_waitcnt lgkmcnt(8)
v_fmac_f32 v112, v243, v136
v_mfma_f32_16x16x32_bf16 v[200:203], a[8:11], a[164:167], v[200:203]
ds_read_b64_tr_b16 a[6:7], v217 offset:38912
v_fmac_f32 v113, v243, v137
v_mfma_f32_16x16x32_bf16 v[192:195], a[8:11], a[160:163], v[192:195]
v_fmac_f32 v114, v243, v138
v_fmac_f32 v115, v243, v139
v_mfma_f32_16x16x32_bf16 v[192:195], a[12:15], a[172:175], v[192:195]
s_waitcnt vmcnt(12) lgkmcnt(4)
s_barrier
v_mfma_f32_16x16x32_bf16 v[192:195], v[248:251], a[184:187], v[192:195]
ds_read_b64_tr_b16 a[8:9], v220 offset:0
v_fmac_f32 v100, v241, v124
v_mfma_f32_16x16x32_bf16 v[192:195], v[252:255], a[196:199], v[192:195]
ds_read_b64_tr_b16 a[10:11], v220 offset:2048
v_fmac_f32 v101, v241, v125
v_mfma_f32_16x16x32_bf16 v[200:203], v[252:255], a[200:203], v[200:203]
ds_read_b64_tr_b16 a[12:13], v220 offset:8192
v_fmac_f32 v102, v241, v126
v_mfma_f32_16x16x32_bf16 v[200:203], v[248:251], a[188:191], v[200:203]
ds_read_b64_tr_b16 a[14:15], v220 offset:10240
v_fmac_f32 v103, v241, v127
v_mfma_f32_16x16x32_bf16 v[208:211], v[248:251], a[192:195], v[208:211]
v_mul_f32 v110, v239, v110
v_mul_f32 v111, v239, v111
v_mfma_f32_16x16x32_bf16 v[208:211], v[252:255], a[204:207], v[208:211]
v_fmac_f32 v108, v242, v132
s_waitcnt lgkmcnt(4)
v_mfma_f32_16x16x32_bf16 v[196:199], a[0:3], a[184:187], v[196:199]
ds_read_b64_tr_b16 v[248:249], v221 offset:0
v_fmac_f32 v109, v242, v133
v_mfma_f32_16x16x32_bf16 v[196:199], a[4:7], a[196:199], v[196:199]
ds_read_b64_tr_b16 v[250:251], v221 offset:2048
v_fmac_f32 v110, v242, v134
v_mfma_f32_16x16x32_bf16 v[204:207], a[4:7], a[200:203], v[204:207]
ds_read_b64_tr_b16 v[252:253], v221 offset:8192
v_fmac_f32 v111, v242, v135
v_mfma_f32_16x16x32_bf16 v[204:207], a[0:3], a[188:191], v[204:207]
ds_read_b64_tr_b16 v[254:255], v221 offset:10240
v_mul_f32 v116, v240, v116
v_mfma_f32_16x16x32_bf16 v[212:215], a[0:3], a[192:195], v[212:215]
v_mul_f32 v117, v240, v117
v_mul_f32 v118, v240, v118
v_mfma_f32_16x16x32_bf16 v[212:215], a[4:7], a[204:207], v[212:215]
v_mul_f32 v119, v240, v119
s_waitcnt lgkmcnt(4)
v_mfma_f32_16x16x32_bf16 v[120:123], a[8:11], v[0:3], 0
ds_read_b64_tr_b16 a[0:1], v218 offset:0
v_fmac_f32 v116, v243, v140
v_mfma_f32_16x16x32_bf16 v[120:123], a[12:15], v[12:15], v[120:123]
ds_read_b64_tr_b16 a[2:3], v218 offset:2048
v_fmac_f32 v117, v243, v141
v_mfma_f32_16x16x32_bf16 v[128:131], a[12:15], v[16:19], 0
ds_read_b64_tr_b16 a[4:5], v218 offset:8192
v_fmac_f32 v118, v243, v142
v_mfma_f32_16x16x32_bf16 v[128:131], a[8:11], v[4:7], v[128:131]
ds_read_b64_tr_b16 a[6:7], v218 offset:10240
v_fmac_f32 v119, v243, v143
v_mfma_f32_16x16x32_bf16 v[136:139], a[8:11], v[8:11], 0
v_cvt_pk_bf16_f32 v144, v96, v97
v_cvt_pk_bf16_f32 v145, v98, v99
v_mfma_f32_16x16x32_bf16 v[136:139], a[12:15], v[20:23], v[136:139]
ds_write_b64 v228, v[144:145] offset:6144
s_waitcnt lgkmcnt(5)
v_mfma_f32_16x16x32_bf16 v[124:127], v[248:251], v[0:3], 0
ds_read_b64_tr_b16 a[8:9], v219 offset:0
v_cvt_pk_bf16_f32 v148, v104, v105
v_mfma_f32_16x16x32_bf16 v[124:127], v[252:255], v[12:15], v[124:127]
ds_read_b64_tr_b16 a[10:11], v219 offset:2048
v_cvt_pk_bf16_f32 v149, v106, v107
v_mfma_f32_16x16x32_bf16 v[132:135], v[252:255], v[16:19], 0
ds_read_b64_tr_b16 a[12:13], v219 offset:8192
v_cvt_pk_bf16_f32 v152, v112, v113
v_mfma_f32_16x16x32_bf16 v[132:135], v[248:251], v[4:7], v[132:135]
ds_read_b64_tr_b16 a[14:15], v219 offset:10240
v_cvt_pk_bf16_f32 v153, v114, v115
v_mfma_f32_16x16x32_bf16 v[140:143], v[248:251], v[8:11], 0
v_cvt_pk_bf16_f32 v146, v100, v101
v_cvt_pk_bf16_f32 v147, v102, v103
v_mfma_f32_16x16x32_bf16 v[140:143], v[252:255], v[20:23], v[140:143]
s_waitcnt vmcnt(8) lgkmcnt(5)
s_barrier
v_mfma_f32_16x16x32_bf16 v[96:99], a[0:3], v[0:3], 0
ds_read_b64_tr_b16 v[248:249], v220 offset:16384
s_add_u32 m0, s67, 106496
v_mfma_f32_16x16x32_bf16 v[96:99], a[4:7], v[12:15], v[96:99]
ds_read_b64_tr_b16 v[250:251], v220 offset:18432
s_add_u32 s69, s73, 196608
v_mfma_f32_16x16x32_bf16 v[104:107], a[4:7], v[16:19], 0
ds_read_b64_tr_b16 v[252:253], v220 offset:24576
buffer_load_dwordx4 v224, s[28:31], s69 offen offset:0 nt lds
v_mfma_f32_16x16x32_bf16 v[104:107], a[0:3], v[4:7], v[104:107]
ds_read_b64_tr_b16 v[254:255], v220 offset:26624
buffer_load_dwordx4 v225, s[28:31], s69 offen offset:1024 nt lds
v_mfma_f32_16x16x32_bf16 v[112:115], a[0:3], v[8:11], 0
s_add_u32 m0, s67, 114688
s_add_u32 s69, s73, 229376
v_mfma_f32_16x16x32_bf16 v[112:115], a[4:7], v[20:23], v[112:115]
buffer_load_dwordx4 v224, s[28:31], s69 offen offset:0 nt lds
s_waitcnt lgkmcnt(4)
v_mfma_f32_16x16x32_bf16 v[100:103], a[8:11], v[0:3], 0
ds_read_b64_tr_b16 a[0:1], v221 offset:16384
buffer_load_dwordx4 v225, s[28:31], s69 offen offset:1024 nt lds
v_mfma_f32_16x16x32_bf16 v[100:103], a[12:15], v[12:15], v[100:103]
ds_read_b64_tr_b16 a[2:3], v221 offset:18432
ds_write_b64 v228, v[146:147] offset:6152
v_cvt_pk_bf16_f32 v150, v108, v109
v_cvt_pk_bf16_f32 v151, v110, v111
v_mfma_f32_16x16x32_bf16 v[108:111], a[12:15], v[16:19], 0
ds_read_b64_tr_b16 a[4:5], v221 offset:24576
v_cvt_pk_bf16_f32 v154, v116, v117
v_mfma_f32_16x16x32_bf16 v[108:111], a[8:11], v[4:7], v[108:111]
ds_read_b64_tr_b16 a[6:7], v221 offset:26624
ds_write_b64 v228, v[148:149] offset:7168
v_cvt_pk_bf16_f32 v155, v118, v119
v_mfma_f32_16x16x32_bf16 v[116:119], a[8:11], v[8:11], 0
v_mfma_f32_16x16x32_bf16 v[116:119], a[12:15], v[20:23], v[116:119]
ds_write_b64 v228, v[150:151] offset:7176
s_waitcnt lgkmcnt(7)
v_mfma_f32_16x16x32_bf16 v[120:123], v[248:251], v[24:27], v[120:123]
ds_read_b64_tr_b16 a[8:9], v218 offset:16384
v_mfma_f32_16x16x32_bf16 v[120:123], v[252:255], v[36:39], v[120:123]
ds_read_b64_tr_b16 a[10:11], v218 offset:18432
ds_write_b64 v228, v[152:153] offset:8192
v_mfma_f32_16x16x32_bf16 v[128:131], v[252:255], v[40:43], v[128:131]
ds_read_b64_tr_b16 a[12:13], v218 offset:24576
v_mfma_f32_16x16x32_bf16 v[128:131], v[248:251], v[28:31], v[128:131]
ds_read_b64_tr_b16 a[14:15], v218 offset:26624
ds_write_b64 v228, v[154:155] offset:8200
v_mfma_f32_16x16x32_bf16 v[136:139], v[248:251], v[32:35], v[136:139]
v_mfma_f32_16x16x32_bf16 v[136:139], v[252:255], v[44:47], v[136:139]
s_waitcnt lgkmcnt(8)
v_mfma_f32_16x16x32_bf16 v[124:127], a[0:3], v[24:27], v[124:127]
ds_read_b64_tr_b16 v[248:249], v219 offset:16384
v_mfma_f32_16x16x32_bf16 v[124:127], a[4:7], v[36:39], v[124:127]
ds_read_b64_tr_b16 v[250:251], v219 offset:18432
v_mfma_f32_16x16x32_bf16 v[132:135], a[4:7], v[40:43], v[132:135]
ds_read_b64_tr_b16 v[252:253], v219 offset:24576
v_mfma_f32_16x16x32_bf16 v[132:135], a[0:3], v[28:31], v[132:135]
ds_read_b64_tr_b16 v[254:255], v219 offset:26624
v_mfma_f32_16x16x32_bf16 v[140:143], a[0:3], v[32:35], v[140:143]
v_mfma_f32_16x16x32_bf16 v[140:143], a[4:7], v[44:47], v[140:143]
s_waitcnt vmcnt(8) lgkmcnt(4)
s_barrier
v_mfma_f32_16x16x32_bf16 v[96:99], a[8:11], v[24:27], v[96:99]
ds_read_b64_tr_b16 a[0:1], v217 offset:40960
s_add_u32 m0, s67, 0
v_mfma_f32_16x16x32_bf16 v[96:99], a[12:15], v[36:39], v[96:99]
ds_read_b64_tr_b16 a[2:3], v217 offset:43008
s_add_u32 s69, s74, 512
v_mfma_f32_16x16x32_bf16 v[104:107], a[12:15], v[40:43], v[104:107]
ds_read_b64_tr_b16 a[4:5], v217 offset:45056
buffer_load_dwordx4 v226, s[32:35], s69 offen offset:0 lds
v_mfma_f32_16x16x32_bf16 v[104:107], a[8:11], v[28:31], v[104:107]
ds_read_b64_tr_b16 a[6:7], v217 offset:47104
buffer_load_dwordx4 v227, s[32:35], s69 offen offset:1024 lds
v_mfma_f32_16x16x32_bf16 v[112:115], a[8:11], v[32:35], v[112:115]
s_add_u32 m0, s67, 8192
s_add_u32 s69, s74, 524800
v_mfma_f32_16x16x32_bf16 v[112:115], a[12:15], v[44:47], v[112:115]
buffer_load_dwordx4 v226, s[32:35], s69 offen offset:0 lds
s_waitcnt lgkmcnt(4)
v_mfma_f32_16x16x32_bf16 v[100:103], v[248:251], v[24:27], v[100:103]
ds_read_b64_tr_b16 a[8:9], v216 offset:40960
buffer_load_dwordx4 v227, s[32:35], s69 offen offset:1024 lds
v_mfma_f32_16x16x32_bf16 v[100:103], v[252:255], v[36:39], v[100:103]
ds_read_b64_tr_b16 a[10:11], v216 offset:43008
ds_read_b128 v[180:183], v230 offset:6144
v_mfma_f32_16x16x32_bf16 v[108:111], v[252:255], v[40:43], v[108:111]
ds_read_b64_tr_b16 a[12:13], v216 offset:45056
ds_read_b128 v[144:147], v230 offset:16384
v_mfma_f32_16x16x32_bf16 v[108:111], v[248:251], v[28:31], v[108:111]
ds_read_b64_tr_b16 a[14:15], v216 offset:47104
ds_read_b128 v[148:151], v230 offset:17408
v_mfma_f32_16x16x32_bf16 v[116:119], v[248:251], v[32:35], v[116:119]
ds_read_b128 v[184:187], v230 offset:7168
v_mfma_f32_16x16x32_bf16 v[116:119], v[252:255], v[44:47], v[116:119]
ds_read_b128 v[188:191], v230 offset:8192
s_waitcnt lgkmcnt(9)
v_mfma_f32_16x16x32_bf16 v[212:215], a[0:3], a[216:219], v[212:215]
ds_read_b64_tr_b16 v[248:249], v216 offset:49152
ds_read_b128 v[152:155], v230 offset:18432
v_mfma_f32_16x16x32_bf16 v[212:215], a[4:7], a[228:231], v[212:215]
ds_read_b64_tr_b16 v[250:251], v216 offset:51200
v_mfma_f32_16x16x32_bf16 v[204:207], a[4:7], a[224:227], v[204:207]
ds_read_b64_tr_b16 v[252:253], v216 offset:53248
v_mfma_f32_16x16x32_bf16 v[204:207], a[0:3], a[212:215], v[204:207]
ds_read_b64_tr_b16 v[254:255], v216 offset:55296
v_mfma_f32_16x16x32_bf16 v[196:199], a[0:3], a[208:211], v[196:199]
v_mfma_f32_16x16x32_bf16 v[196:199], a[4:7], a[220:223], v[196:199]
s_waitcnt lgkmcnt(8)
v_mfma_f32_16x16x32_bf16 v[208:211], a[8:11], a[216:219], v[208:211]
ds_read_b64_tr_b16 a[0:1], v217 offset:49152
v_mfma_f32_16x16x32_bf16 v[208:211], a[12:15], a[228:231], v[208:211]
ds_read_b64_tr_b16 a[2:3], v217 offset:51200
v_mfma_f32_16x16x32_bf16 v[200:203], a[12:15], a[224:227], v[200:203]
ds_read_b64_tr_b16 a[4:5], v217 offset:53248
v_mfma_f32_16x16x32_bf16 v[200:203], a[8:11], a[212:215], v[200:203]
ds_read_b64_tr_b16 a[6:7], v217 offset:55296
v_mfma_f32_16x16x32_bf16 v[192:195], a[8:11], a[208:211], v[192:195]
v_mfma_f32_16x16x32_bf16 v[192:195], a[12:15], a[220:223], v[192:195]
s_waitcnt vmcnt(8) lgkmcnt(4)
s_barrier
v_mfma_f32_16x16x32_bf16 v[192:195], v[248:251], a[232:235], v[192:195]
ds_read_b64_tr_b16 a[8:9], v220 offset:32768
s_add_u32 m0, s67, 16384
v_mfma_f32_16x16x32_bf16 v[192:195], v[252:255], a[244:247], v[192:195]
ds_read_b64_tr_b16 a[10:11], v220 offset:34816
s_add_u32 s69, s74, 1049088
v_mfma_f32_16x16x32_bf16 v[200:203], v[252:255], a[248:251], v[200:203]
ds_read_b64_tr_b16 a[12:13], v220 offset:40960
buffer_load_dwordx4 v226, s[32:35], s69 offen offset:0 lds
v_mfma_f32_16x16x32_bf16 v[200:203], v[248:251], a[236:239], v[200:203]
ds_read_b64_tr_b16 a[14:15], v220 offset:43008
buffer_load_dwordx4 v227, s[32:35], s69 offen offset:1024 lds
v_mfma_f32_16x16x32_bf16 v[208:211], v[248:251], a[240:243], v[208:211]
s_add_u32 m0, s67, 24576
s_add_u32 s69, s74, 1573376
v_mul_f32 v192, s64, v192
v_mul_f32 v193, s64, v193
v_mfma_f32_16x16x32_bf16 v[208:211], v[252:255], a[252:255], v[208:211]
buffer_load_dwordx4 v226, s[32:35], s69 offen offset:0 lds
v_mul_f32 v194, s64, v194
s_waitcnt lgkmcnt(4)
v_mfma_f32_16x16x32_bf16 v[196:199], a[0:3], a[232:235], v[196:199]
ds_read_b64_tr_b16 v[248:249], v221 offset:32768
buffer_load_dwordx4 v227, s[32:35], s69 offen offset:1024 lds
v_mul_f32 v195, s64, v195
v_mfma_f32_16x16x32_bf16 v[196:199], a[4:7], a[244:247], v[196:199]
ds_read_b64_tr_b16 v[250:251], v221 offset:34816
v_cvt_pk_bf16_f32 v192, v192, v193
v_mfma_f32_16x16x32_bf16 v[204:207], a[4:7], a[248:251], v[204:207]
ds_read_b64_tr_b16 v[252:253], v221 offset:40960
v_cvt_pk_bf16_f32 v193, v194, v195
v_mfma_f32_16x16x32_bf16 v[204:207], a[0:3], a[236:239], v[204:207]
ds_read_b64_tr_b16 v[254:255], v221 offset:43008
v_mul_f32 v200, s64, v200
v_mfma_f32_16x16x32_bf16 v[212:215], a[0:3], a[240:243], v[212:215]
v_mul_f32 v196, s64, v196
v_mul_f32 v197, s64, v197
v_mfma_f32_16x16x32_bf16 v[212:215], a[4:7], a[252:255], v[212:215]
v_mul_f32 v198, s64, v198
s_waitcnt lgkmcnt(4)
v_mfma_f32_16x16x32_bf16 v[120:123], a[8:11], v[48:51], v[120:123]
ds_read_b64_tr_b16 a[0:1], v218 offset:32768
v_mul_f32 v199, s64, v199
v_mfma_f32_16x16x32_bf16 v[120:123], a[12:15], v[60:63], v[120:123]
ds_read_b64_tr_b16 a[2:3], v218 offset:34816
v_cvt_pk_bf16_f32 v194, v196, v197
v_mfma_f32_16x16x32_bf16 v[128:131], a[12:15], v[64:67], v[128:131]
ds_read_b64_tr_b16 a[4:5], v218 offset:40960
v_cvt_pk_bf16_f32 v195, v198, v199
v_mfma_f32_16x16x32_bf16 v[128:131], a[8:11], v[52:55], v[128:131]
ds_read_b64_tr_b16 a[6:7], v218 offset:43008
v_mul_f32 v201, s64, v201
v_mfma_f32_16x16x32_bf16 v[136:139], a[8:11], v[56:59], v[136:139]
v_permlane16_swap_b32 v192, v194
v_mfma_f32_16x16x32_bf16 v[136:139], a[12:15], v[68:71], v[136:139]
v_mul_f32 v202, s64, v202
s_waitcnt lgkmcnt(4)
v_mfma_f32_16x16x32_bf16 v[124:127], v[248:251], v[48:51], v[124:127]
ds_read_b64_tr_b16 a[8:9], v219 offset:32768
v_mul_f32 v203, s64, v203
v_mfma_f32_16x16x32_bf16 v[124:127], v[252:255], v[60:63], v[124:127]
ds_read_b64_tr_b16 a[10:11], v219 offset:34816
v_mul_f32 v204, s64, v204
v_mfma_f32_16x16x32_bf16 v[132:135], v[252:255], v[64:67], v[132:135]
ds_read_b64_tr_b16 a[12:13], v219 offset:40960
v_mul_f32 v205, s64, v205
v_mfma_f32_16x16x32_bf16 v[132:135], v[248:251], v[52:55], v[132:135]
ds_read_b64_tr_b16 a[14:15], v219 offset:43008
v_mul_f32 v206, s64, v206
v_mfma_f32_16x16x32_bf16 v[140:143], v[248:251], v[56:59], v[140:143]
v_permlane16_swap_b32 v193, v195
v_mfma_f32_16x16x32_bf16 v[140:143], v[252:255], v[68:71], v[140:143]
s_waitcnt vmcnt(8) lgkmcnt(4)
s_barrier
v_mfma_f32_16x16x32_bf16 v[96:99], a[0:3], v[48:51], v[96:99]
ds_read_b64_tr_b16 v[248:249], v220 offset:49152
s_add_u32 m0, s67, 57344
v_mfma_f32_16x16x32_bf16 v[96:99], a[4:7], v[60:63], v[96:99]
ds_read_b64_tr_b16 v[250:251], v220 offset:51200
s_add_u32 s69, s74, 0
v_mul_f32 v207, s64, v207
v_mfma_f32_16x16x32_bf16 v[104:107], a[4:7], v[64:67], v[104:107]
ds_read_b64_tr_b16 v[252:253], v220 offset:57344
buffer_load_dwordx4 v224, s[28:31], s69 offen offset:0 nt lds
v_cvt_pk_bf16_f32 v196, v200, v201
v_mfma_f32_16x16x32_bf16 v[104:107], a[0:3], v[52:55], v[104:107]
ds_read_b64_tr_b16 v[254:255], v220 offset:59392
buffer_load_dwordx4 v225, s[28:31], s69 offen offset:1024 nt lds
v_cvt_pk_bf16_f32 v197, v202, v203
v_mfma_f32_16x16x32_bf16 v[112:115], a[0:3], v[56:59], v[112:115]
s_add_u32 m0, s67, 65536
s_add_u32 s69, s74, 32768
v_cvt_pk_bf16_f32 v198, v204, v205
v_mfma_f32_16x16x32_bf16 v[112:115], a[4:7], v[68:71], v[112:115]
buffer_load_dwordx4 v224, s[28:31], s69 offen offset:0 nt lds
v_cvt_pk_bf16_f32 v199, v206, v207
s_waitcnt lgkmcnt(4)
v_mfma_f32_16x16x32_bf16 v[100:103], a[8:11], v[48:51], v[100:103]
ds_read_b64_tr_b16 a[0:1], v221 offset:49152
buffer_load_dwordx4 v225, s[28:31], s69 offen offset:1024 nt lds
v_permlane16_swap_b32 v196, v198
v_mfma_f32_16x16x32_bf16 v[100:103], a[12:15], v[60:63], v[100:103]
ds_read_b64_tr_b16 a[2:3], v221 offset:51200
ds_write_b64 v228, v[192:193] offset:6144
v_mul_f32 v208, s64, v208
v_mfma_f32_16x16x32_bf16 v[108:111], a[12:15], v[64:67], v[108:111]
ds_read_b64_tr_b16 a[4:5], v221 offset:57344
v_mul_f32 v209, s64, v209
v_mfma_f32_16x16x32_bf16 v[108:111], a[8:11], v[52:55], v[108:111]
ds_read_b64_tr_b16 a[6:7], v221 offset:59392
ds_write_b64 v228, v[194:195] offset:6152
v_mul_f32 v210, s64, v210
v_mfma_f32_16x16x32_bf16 v[116:119], a[8:11], v[56:59], v[116:119]
v_permlane16_swap_b32 v197, v199
v_mfma_f32_16x16x32_bf16 v[116:119], a[12:15], v[68:71], v[116:119]
ds_write_b64 v228, v[196:197] offset:7168
s_waitcnt lgkmcnt(7)
v_mfma_f32_16x16x32_bf16 v[120:123], v[248:251], v[72:75], v[120:123]
ds_read_b64_tr_b16 a[8:9], v218 offset:49152
v_mul_f32 v211, s64, v211
v_mfma_f32_16x16x32_bf16 v[120:123], v[252:255], v[84:87], v[120:123]
ds_read_b64_tr_b16 a[10:11], v218 offset:51200
ds_write_b64 v228, v[198:199] offset:7176
v_mul_f32 v212, s64, v212
v_mfma_f32_16x16x32_bf16 v[128:131], v[252:255], v[88:91], v[128:131]
ds_read_b64_tr_b16 a[12:13], v218 offset:57344
v_mul_f32 v213, s64, v213
v_mfma_f32_16x16x32_bf16 v[128:131], v[248:251], v[76:79], v[128:131]
ds_read_b64_tr_b16 a[14:15], v218 offset:59392
v_mul_f32 v214, s64, v214
v_mfma_f32_16x16x32_bf16 v[136:139], v[248:251], v[80:83], v[136:139]
ds_write_b64 v228, v[120:121] offset:0
v_mul_f32 v215, s64, v215
v_cvt_pk_bf16_f32 v200, v208, v209
v_mfma_f32_16x16x32_bf16 v[136:139], v[252:255], v[92:95], v[136:139]
v_cvt_pk_bf16_f32 v201, v210, v211
s_waitcnt lgkmcnt(8)
v_mfma_f32_16x16x32_bf16 v[124:127], a[0:3], v[72:75], v[124:127]
ds_read_b64_tr_b16 v[248:249], v219 offset:49152
ds_write_b64 v228, v[122:123] offset:8
v_cvt_pk_bf16_f32 v202, v212, v213
v_mfma_f32_16x16x32_bf16 v[124:127], a[4:7], v[84:87], v[124:127]
ds_read_b64_tr_b16 v[250:251], v219 offset:51200
v_cvt_pk_bf16_f32 v203, v214, v215
v_mfma_f32_16x16x32_bf16 v[132:135], a[4:7], v[88:91], v[132:135]
ds_read_b64_tr_b16 v[252:253], v219 offset:57344
ds_write_b64 v228, v[128:129] offset:2048
v_mfma_f32_16x16x32_bf16 v[132:135], a[0:3], v[76:79], v[132:135]
ds_read_b64_tr_b16 v[254:255], v219 offset:59392
v_permlane16_swap_b32 v200, v202
v_mfma_f32_16x16x32_bf16 v[140:143], a[0:3], v[80:83], v[140:143]
ds_write_b64 v228, v[130:131] offset:2056
v_permlane16_swap_b32 v201, v203
v_mfma_f32_16x16x32_bf16 v[140:143], a[4:7], v[92:95], v[140:143]
s_waitcnt vmcnt(8) lgkmcnt(8)
s_barrier
v_mfma_f32_16x16x32_bf16 v[96:99], a[8:11], v[72:75], v[96:99]
ds_read_b64_tr_b16 a[0:1], v216 offset:0
s_add_u32 m0, s67, 73728
ds_write_b64 v228, v[200:201] offset:8192
v_mfma_f32_16x16x32_bf16 v[96:99], a[12:15], v[84:87], v[96:99]
ds_read_b64_tr_b16 a[2:3], v216 offset:2048
s_add_u32 s69, s74, 65536
v_mfma_f32_16x16x32_bf16 v[104:107], a[12:15], v[88:91], v[104:107]
ds_read_b64_tr_b16 a[4:5], v216 offset:4096
buffer_load_dwordx4 v224, s[28:31], s69 offen offset:0 nt lds
ds_write_b64 v228, v[136:137] offset:4096
v_mfma_f32_16x16x32_bf16 v[104:107], a[8:11], v[76:79], v[104:107]
ds_read_b64_tr_b16 a[6:7], v216 offset:6144
buffer_load_dwordx4 v225, s[28:31], s69 offen offset:1024 nt lds
v_mfma_f32_16x16x32_bf16 v[112:115], a[8:11], v[80:83], v[112:115]
s_add_u32 m0, s67, 81920
s_add_u32 s69, s74, 98304
ds_write_b64 v228, v[202:203] offset:8200
v_mul_f32 v96, v238, v96
v_mfma_f32_16x16x32_bf16 v[112:115], a[12:15], v[92:95], v[112:115]
buffer_load_dwordx4 v224, s[28:31], s69 offen offset:0 nt lds
v_mul_f32 v97, v238, v97
s_waitcnt lgkmcnt(8)
v_mfma_f32_16x16x32_bf16 v[100:103], v[248:251], v[72:75], v[100:103]
ds_read_b64_tr_b16 a[8:9], v217 offset:0
buffer_load_dwordx4 v225, s[28:31], s69 offen offset:1024 nt lds
ds_write_b64 v228, v[138:139] offset:4104
v_mul_f32 v98, v238, v98
v_mfma_f32_16x16x32_bf16 v[100:103], v[252:255], v[84:87], v[100:103]
ds_read_b64_tr_b16 a[10:11], v217 offset:2048
v_mul_f32 v99, v238, v99
v_mfma_f32_16x16x32_bf16 v[108:111], v[252:255], v[88:91], v[108:111]
ds_read_b64_tr_b16 a[12:13], v217 offset:4096
ds_write_b64 v228, v[124:125] offset:1024
s_waitcnt lgkmcnt(5)
s_barrier
v_mfma_f32_16x16x32_bf16 v[108:111], v[248:251], v[76:79], v[108:111]
ds_read_b64_tr_b16 a[14:15], v217 offset:6144
ds_read_b128 a[40:43], v230 offset:6144
v_mul_f32 v104, v239, v104
v_mfma_f32_16x16x32_bf16 v[116:119], v[248:251], v[80:83], v[116:119]
ds_read_b128 a[52:55], v230 offset:16384
v_mul_f32 v105, v239, v105
v_mfma_f32_16x16x32_bf16 v[116:119], v[252:255], v[92:95], v[116:119]
ds_read_b128 a[56:59], v230 offset:17408
v_mul_f32 v106, v239, v106
v_mfma_f32_16x16x32_bf16 v[192:195], a[0:3], a[88:91], 0
ds_read_b64_tr_b16 v[248:249], v217 offset:8192
ds_read_b128 a[44:47], v230 offset:7168
v_mfma_f32_16x16x32_bf16 v[192:195], a[4:7], a[100:103], v[192:195]
ds_read_b64_tr_b16 v[250:251], v217 offset:10240
ds_read_b128 a[48:51], v230 offset:8192
v_mul_f32 v107, v239, v107
v_mfma_f32_16x16x32_bf16 v[200:203], a[4:7], a[104:107], 0
ds_read_b64_tr_b16 v[252:253], v217 offset:12288
ds_read_b128 a[60:63], v230 offset:18432
v_mul_f32 v112, v240, v112
v_mfma_f32_16x16x32_bf16 v[200:203], a[0:3], a[92:95], v[200:203]
ds_read_b64_tr_b16 v[254:255], v217 offset:14336
v_mul_f32 v113, v240, v113
v_mfma_f32_16x16x32_bf16 v[208:211], a[0:3], a[96:99], 0
ds_write_b64 v228, v[126:127] offset:1032
v_mul_f32 v114, v240, v114
v_mfma_f32_16x16x32_bf16 v[208:211], a[4:7], a[108:111], v[208:211]
v_mul_f32 v115, v240, v115
s_waitcnt lgkmcnt(11)
v_mfma_f32_16x16x32_bf16 v[196:199], a[8:11], a[88:91], 0
ds_read_b64_tr_b16 a[0:1], v216 offset:8192
ds_write_b64 v228, v[132:133] offset:3072
v_mfma_f32_16x16x32_bf16 v[196:199], a[12:15], a[100:103], v[196:199]
ds_read_b64_tr_b16 a[2:3], v216 offset:10240
v_mul_f32 v100, v238, v100
v_mfma_f32_16x16x32_bf16 v[204:207], a[12:15], a[104:107], 0
ds_read_b64_tr_b16 a[4:5], v216 offset:12288
ds_write_b64 v228, v[134:135] offset:3080
v_mfma_f32_16x16x32_bf16 v[204:207], a[8:11], a[92:95], v[204:207]
ds_read_b64_tr_b16 a[6:7], v216 offset:14336
v_mul_f32 v101, v238, v101
v_mfma_f32_16x16x32_bf16 v[212:215], a[8:11], a[96:99], 0
ds_write_b64 v228, v[140:141] offset:5120
v_mul_f32 v102, v238, v102
v_mfma_f32_16x16x32_bf16 v[212:215], a[12:15], a[108:111], v[212:215]
v_mul_f32 v103, v238, v103
s_waitcnt vmcnt(8) lgkmcnt(8)
s_barrier
v_mfma_f32_16x16x32_bf16 v[212:215], v[248:251], a[120:123], v[212:215]
ds_read_b64_tr_b16 a[8:9], v216 offset:16384
s_add_u32 m0, s67, 32768
ds_write_b64 v228, v[142:143] offset:5128
v_mfma_f32_16x16x32_bf16 v[212:215], v[252:255], a[132:135], v[212:215]
ds_read_b64_tr_b16 a[10:11], v216 offset:18432
s_add_u32 s69, s74, 2097664
v_mul_f32 v108, v239, v108
v_mfma_f32_16x16x32_bf16 v[204:207], v[252:255], a[128:131], v[204:207]
ds_read_b64_tr_b16 a[12:13], v216 offset:20480
buffer_load_dwordx4 v226, s[32:35], s69 offen offset:0 lds
v_mul_f32 v109, v239, v109
v_mfma_f32_16x16x32_bf16 v[204:207], v[248:251], a[116:119], v[204:207]
ds_read_b64_tr_b16 a[14:15], v216 offset:22528
buffer_load_dwordx4 v227, s[32:35], s69 offen offset:1024 lds
v_mul_f32 v110, v239, v110
v_mfma_f32_16x16x32_bf16 v[196:199], v[248:251], a[112:115], v[196:199]
s_add_u32 m0, s67, 40960
s_add_u32 s69, s74, 2621952
s_waitcnt lgkmcnt(3)
s_barrier
ds_read_b128 v[120:123], v229 offset:0
v_mul_f32 v111, v239, v111
v_mfma_f32_16x16x32_bf16 v[196:199], v[252:255], a[124:127], v[196:199]
buffer_load_dwordx4 v226, s[32:35], s69 offen offset:0 lds
buffer_load_dwordx4 v227, s[32:35], s69 offen offset:1024 lds
ds_read_b128 v[124:127], v229 offset:1024
v_mfma_f32_16x16x32_bf16 v[208:211], a[0:3], a[120:123], v[208:211]
ds_read_b64_tr_b16 v[248:249], v217 offset:16384
ds_read_b128 v[128:131], v229 offset:2048
v_mul_f32 v116, v240, v116
v_mfma_f32_16x16x32_bf16 v[208:211], a[4:7], a[132:135], v[208:211]
ds_read_b64_tr_b16 v[250:251], v217 offset:18432
ds_read_b128 v[132:135], v229 offset:3072
v_mul_f32 v117, v240, v117
v_mfma_f32_16x16x32_bf16 v[200:203], a[4:7], a[128:131], v[200:203]
ds_read_b64_tr_b16 v[252:253], v217 offset:20480
ds_read_b128 v[136:139], v229 offset:4096
v_mul_f32 v118, v240, v118
v_mfma_f32_16x16x32_bf16 v[200:203], a[0:3], a[116:119], v[200:203]
ds_read_b64_tr_b16 v[254:255], v217 offset:22528
ds_read_b128 v[140:143], v229 offset:5120
v_mfma_f32_16x16x32_bf16 v[192:195], a[0:3], a[112:115], v[192:195]
s_waitcnt lgkmcnt(9)
v_fmac_f32 v96, v241, v120
v_mfma_f32_16x16x32_bf16 v[192:195], a[4:7], a[124:127], v[192:195]
v_fmac_f32 v97, v241, v121
v_fmac_f32 v98, v241, v122
v_mfma_f32_16x16x32_bf16 v[192:195], a[8:11], a[136:139], v[192:195]
ds_read_b64_tr_b16 a[0:1], v217 offset:24576
v_fmac_f32 v99, v241, v123
v_mfma_f32_16x16x32_bf16 v[192:195], a[12:15], a[148:151], v[192:195]
ds_read_b64_tr_b16 a[2:3], v217 offset:26624
s_waitcnt lgkmcnt(8)
v_fmac_f32 v104, v242, v128
v_mfma_f32_16x16x32_bf16 v[200:203], a[12:15], a[152:155], v[200:203]
ds_read_b64_tr_b16 a[4:5], v217 offset:28672
v_fmac_f32 v105, v242, v129
v_mfma_f32_16x16x32_bf16 v[200:203], a[8:11], a[140:143], v[200:203]
ds_read_b64_tr_b16 a[6:7], v217 offset:30720
v_fmac_f32 v106, v242, v130
v_mfma_f32_16x16x32_bf16 v[208:211], a[8:11], a[144:147], v[208:211]
v_fmac_f32 v107, v242, v131
s_waitcnt lgkmcnt(6)
v_fmac_f32 v112, v243, v136
v_mfma_f32_16x16x32_bf16 v[208:211], a[12:15], a[156:159], v[208:211]
v_fmac_f32 v113, v243, v137
s_waitcnt lgkmcnt(5)
v_mfma_f32_16x16x32_bf16 v[196:199], v[248:251], a[136:139], v[196:199]
ds_read_b64_tr_b16 a[8:9], v216 offset:24576
v_fmac_f32 v114, v243, v138
v_mfma_f32_16x16x32_bf16 v[196:199], v[252:255], a[148:151], v[196:199]
ds_read_b64_tr_b16 a[10:11], v216 offset:26624
v_fmac_f32 v115, v243, v139
v_mfma_f32_16x16x32_bf16 v[204:207], v[252:255], a[152:155], v[204:207]
ds_read_b64_tr_b16 a[12:13], v216 offset:28672
v_fmac_f32 v100, v241, v124
v_mfma_f32_16x16x32_bf16 v[204:207], v[248:251], a[140:143], v[204:207]
ds_read_b64_tr_b16 a[14:15], v216 offset:30720
v_fmac_f32 v101, v241, v125
v_mfma_f32_16x16x32_bf16 v[212:215], v[248:251], a[144:147], v[212:215]
v_fmac_f32 v102, v241, v126
v_fmac_f32 v103, v241, v127
v_mfma_f32_16x16x32_bf16 v[212:215], v[252:255], a[156:159], v[212:215]
s_waitcnt vmcnt(8) lgkmcnt(4)
s_barrier
v_mfma_f32_16x16x32_bf16 v[212:215], a[0:3], a[168:171], v[212:215]
ds_read_b64_tr_b16 v[248:249], v220 offset:0
s_add_u32 m0, s67, 90112
v_mfma_f32_16x16x32_bf16 v[212:215], a[4:7], a[180:183], v[212:215]
ds_read_b64_tr_b16 v[250:251], v220 offset:2048
s_add_u32 s69, s74, 131072
v_mfma_f32_16x16x32_bf16 v[204:207], a[4:7], a[176:179], v[204:207]
ds_read_b64_tr_b16 v[252:253], v220 offset:8192
buffer_load_dwordx4 v224, s[28:31], s69 offen offset:0 nt lds
v_mfma_f32_16x16x32_bf16 v[204:207], a[0:3], a[164:167], v[204:207]
ds_read_b64_tr_b16 v[254:255], v220 offset:10240
buffer_load_dwordx4 v225, s[28:31], s69 offen offset:1024 nt lds
v_mfma_f32_16x16x32_bf16 v[196:199], a[0:3], a[160:163], v[196:199]
s_add_u32 m0, s67, 98304
s_add_u32 s69, s74, 163840
v_mfma_f32_16x16x32_bf16 v[196:199], a[4:7], a[172:175], v[196:199]
buffer_load_dwordx4 v224, s[28:31], s69 offen offset:0 nt lds
s_waitcnt lgkmcnt(4)
v_mfma_f32_16x16x32_bf16 v[208:211], a[8:11], a[168:171], v[208:211]
ds_read_b64_tr_b16 a[0:1], v221 offset:0
buffer_load_dwordx4 v225, s[28:31], s69 offen offset:1024 nt lds
v_fmac_f32 v108, v242, v132
v_mfma_f32_16x16x32_bf16 v[208:211], a[12:15], a[180:183], v[208:211]
ds_read_b64_tr_b16 a[2:3], v221 offset:2048
v_fmac_f32 v109, v242, v133
v_mfma_f32_16x16x32_bf16 v[200:203], a[12:15], a[176:179], v[200:203]
ds_read_b64_tr_b16 a[4:5], v221 offset:8192
v_fmac_f32 v110, v242, v134
v_mfma_f32_16x16x32_bf16 v[200:203], a[8:11], a[164:167], v[200:203]
ds_read_b64_tr_b16 a[6:7], v221 offset:10240
v_fmac_f32 v111, v242, v135
v_mfma_f32_16x16x32_bf16 v[192:195], a[8:11], a[160:163], v[192:195]
v_mul_f32 v119, v240, v119
v_fmac_f32 v116, v243, v140
v_mfma_f32_16x16x32_bf16 v[192:195], a[12:15], a[172:175], v[192:195]
v_fmac_f32 v117, v243, v141
s_waitcnt lgkmcnt(4)
v_mfma_f32_16x16x32_bf16 v[120:123], v[248:251], v[0:3], 0
ds_read_b64_tr_b16 a[8:9], v218 offset:0
v_fmac_f32 v118, v243, v142
v_mfma_f32_16x16x32_bf16 v[120:123], v[252:255], v[12:15], v[120:123]
ds_read_b64_tr_b16 a[10:11], v218 offset:2048
v_fmac_f32 v119, v243, v143
v_mfma_f32_16x16x32_bf16 v[128:131], v[252:255], v[16:19], 0
ds_read_b64_tr_b16 a[12:13], v218 offset:8192
v_cvt_pk_bf16_f32 v156, v96, v97
v_mfma_f32_16x16x32_bf16 v[128:131], v[248:251], v[4:7], v[128:131]
ds_read_b64_tr_b16 a[14:15], v218 offset:10240
v_cvt_pk_bf16_f32 v157, v98, v99
v_mfma_f32_16x16x32_bf16 v[136:139], v[248:251], v[8:11], 0
v_cvt_pk_bf16_f32 v160, v104, v105
v_cvt_pk_bf16_f32 v161, v106, v107
v_mfma_f32_16x16x32_bf16 v[136:139], v[252:255], v[20:23], v[136:139]
v_cvt_pk_bf16_f32 v164, v112, v113
s_waitcnt lgkmcnt(4)
v_mfma_f32_16x16x32_bf16 v[124:127], a[0:3], v[0:3], 0
ds_read_b64_tr_b16 v[248:249], v219 offset:0
v_cvt_pk_bf16_f32 v165, v114, v115
v_mfma_f32_16x16x32_bf16 v[124:127], a[4:7], v[12:15], v[124:127]
ds_read_b64_tr_b16 v[250:251], v219 offset:2048
v_cvt_pk_bf16_f32 v158, v100, v101
v_mfma_f32_16x16x32_bf16 v[132:135], a[4:7], v[16:19], 0
ds_read_b64_tr_b16 v[252:253], v219 offset:8192
v_cvt_pk_bf16_f32 v159, v102, v103
v_mfma_f32_16x16x32_bf16 v[132:135], a[0:3], v[4:7], v[132:135]
ds_read_b64_tr_b16 v[254:255], v219 offset:10240
v_cvt_pk_bf16_f32 v162, v108, v109
v_mfma_f32_16x16x32_bf16 v[140:143], a[0:3], v[8:11], 0
v_cvt_pk_bf16_f32 v163, v110, v111
v_cvt_pk_bf16_f32 v166, v116, v117
v_mfma_f32_16x16x32_bf16 v[140:143], a[4:7], v[20:23], v[140:143]
s_waitcnt vmcnt(8) lgkmcnt(4)
s_barrier
v_mfma_f32_16x16x32_bf16 v[96:99], a[8:11], v[0:3], 0
ds_read_b64_tr_b16 a[0:1], v220 offset:16384
s_add_u32 m0, s67, 106496
v_mfma_f32_16x16x32_bf16 v[96:99], a[12:15], v[12:15], v[96:99]
ds_read_b64_tr_b16 a[2:3], v220 offset:18432
s_add_u32 s69, s74, 196608
v_mfma_f32_16x16x32_bf16 v[104:107], a[12:15], v[16:19], 0
ds_read_b64_tr_b16 a[4:5], v220 offset:24576
buffer_load_dwordx4 v224, s[28:31], s69 offen offset:0 nt lds
v_mfma_f32_16x16x32_bf16 v[104:107], a[8:11], v[4:7], v[104:107]
ds_read_b64_tr_b16 a[6:7], v220 offset:26624
buffer_load_dwordx4 v225, s[28:31], s69 offen offset:1024 nt lds
v_mfma_f32_16x16x32_bf16 v[112:115], a[8:11], v[8:11], 0
s_add_u32 m0, s67, 114688
s_add_u32 s69, s74, 229376
v_mfma_f32_16x16x32_bf16 v[112:115], a[12:15], v[20:23], v[112:115]
buffer_load_dwordx4 v224, s[28:31], s69 offen offset:0 nt lds
s_waitcnt lgkmcnt(4)
v_mfma_f32_16x16x32_bf16 v[100:103], v[248:251], v[0:3], 0
ds_read_b64_tr_b16 a[8:9], v221 offset:16384
buffer_load_dwordx4 v225, s[28:31], s69 offen offset:1024 nt lds
v_mfma_f32_16x16x32_bf16 v[100:103], v[252:255], v[12:15], v[100:103]
ds_read_b64_tr_b16 a[10:11], v221 offset:18432
v_cvt_pk_bf16_f32 v167, v118, v119
v_mfma_f32_16x16x32_bf16 v[108:111], v[252:255], v[16:19], 0
ds_read_b64_tr_b16 a[12:13], v221 offset:24576
s_mov_b32 s65, 0x42000000
v_mfma_f32_16x16x32_bf16 v[108:111], v[248:251], v[4:7], v[108:111]
ds_read_b64_tr_b16 a[14:15], v221 offset:26624
v_mov_b32 v232, 0
v_mfma_f32_16x16x32_bf16 v[116:119], v[248:251], v[8:11], 0
v_mov_b32 v233, 0
v_mov_b32 v234, 0
v_mfma_f32_16x16x32_bf16 v[116:119], v[252:255], v[20:23], v[116:119]
s_waitcnt lgkmcnt(4)
v_mfma_f32_16x16x32_bf16 v[120:123], a[0:3], v[24:27], v[120:123]
ds_read_b64_tr_b16 v[248:249], v218 offset:16384
v_mfma_f32_16x16x32_bf16 v[120:123], a[4:7], v[36:39], v[120:123]
ds_read_b64_tr_b16 v[250:251], v218 offset:18432
v_mfma_f32_16x16x32_bf16 v[128:131], a[4:7], v[40:43], v[128:131]
ds_read_b64_tr_b16 v[252:253], v218 offset:24576
v_mfma_f32_16x16x32_bf16 v[128:131], a[0:3], v[28:31], v[128:131]
ds_read_b64_tr_b16 v[254:255], v218 offset:26624
v_mfma_f32_16x16x32_bf16 v[136:139], a[0:3], v[32:35], v[136:139]
v_mfma_f32_16x16x32_bf16 v[136:139], a[4:7], v[44:47], v[136:139]
s_waitcnt lgkmcnt(4)
v_mfma_f32_16x16x32_bf16 v[124:127], a[8:11], v[24:27], v[124:127]
ds_read_b64_tr_b16 a[0:1], v219 offset:16384
v_mfma_f32_16x16x32_bf16 v[124:127], a[12:15], v[36:39], v[124:127]
ds_read_b64_tr_b16 a[2:3], v219 offset:18432
v_mfma_f32_16x16x32_bf16 v[132:135], a[12:15], v[40:43], v[132:135]
ds_read_b64_tr_b16 a[4:5], v219 offset:24576
v_mfma_f32_16x16x32_bf16 v[132:135], a[8:11], v[28:31], v[132:135]
ds_read_b64_tr_b16 a[6:7], v219 offset:26624
v_mfma_f32_16x16x32_bf16 v[140:143], a[8:11], v[32:35], v[140:143]
v_mfma_f32_16x16x32_bf16 v[140:143], a[12:15], v[44:47], v[140:143]
s_waitcnt vmcnt(8) lgkmcnt(4)
s_barrier
v_mfma_f32_16x16x32_bf16 v[96:99], v[248:251], v[24:27], v[96:99]
ds_read_b64_tr_b16 a[8:9], v216 offset:32768
s_add_u32 m0, s67, 49152
v_mfma_f32_16x16x32_bf16 v[96:99], v[252:255], v[36:39], v[96:99]
ds_read_b64_tr_b16 a[10:11], v216 offset:34816
s_add_u32 s69, s74, 3146240
v_mfma_f32_16x16x32_bf16 v[104:107], v[252:255], v[40:43], v[104:107]
ds_read_b64_tr_b16 a[12:13], v216 offset:36864
buffer_load_dwordx4 v226, s[32:35], s69 offen offset:0 lds
v_mfma_f32_16x16x32_bf16 v[104:107], v[248:251], v[28:31], v[104:107]
ds_read_b64_tr_b16 a[14:15], v216 offset:38912
buffer_load_dwordx4 v227, s[32:35], s69 offen offset:1024 lds
v_mfma_f32_16x16x32_bf16 v[112:115], v[248:251], v[32:35], v[112:115]
s_add_u32 m0, s67, 0
s_add_u32 s69, s75, 512
v_mfma_f32_16x16x32_bf16 v[112:115], v[252:255], v[44:47], v[112:115]
buffer_load_dwordx4 v226, s[32:35], s69 offen offset:0 lds
s_waitcnt lgkmcnt(4)
v_mfma_f32_16x16x32_bf16 v[100:103], a[0:3], v[24:27], v[100:103]
ds_read_b64_tr_b16 v[248:249], v217 offset:32768
buffer_load_dwordx4 v227, s[32:35], s69 offen offset:1024 lds
v_mfma_f32_16x16x32_bf16 v[100:103], a[4:7], v[36:39], v[100:103]
ds_read_b64_tr_b16 v[250:251], v217 offset:34816
v_mfma_f32_16x16x32_bf16 v[108:111], a[4:7], v[40:43], v[108:111]
ds_read_b64_tr_b16 v[252:253], v217 offset:36864
v_mfma_f32_16x16x32_bf16 v[108:111], a[0:3], v[28:31], v[108:111]
ds_read_b64_tr_b16 v[254:255], v217 offset:38912
v_mfma_f32_16x16x32_bf16 v[116:119], a[0:3], v[32:35], v[116:119]
v_mfma_f32_16x16x32_bf16 v[116:119], a[4:7], v[44:47], v[116:119]
s_waitcnt lgkmcnt(4)
v_mfma_f32_16x16x32_bf16 v[192:195], a[8:11], a[184:187], v[192:195]
ds_read_b64_tr_b16 a[0:1], v217 offset:40960
v_mfma_f32_16x16x32_bf16 v[192:195], a[12:15], a[196:199], v[192:195]
ds_read_b64_tr_b16 a[2:3], v217 offset:43008
v_mfma_f32_16x16x32_bf16 v[200:203], a[12:15], a[200:203], v[200:203]
ds_read_b64_tr_b16 a[4:5], v217 offset:45056
v_mfma_f32_16x16x32_bf16 v[200:203], a[8:11], a[188:191], v[200:203]
ds_read_b64_tr_b16 a[6:7], v217 offset:47104
v_mfma_f32_16x16x32_bf16 v[208:211], a[8:11], a[192:195], v[208:211]
v_mfma_f32_16x16x32_bf16 v[208:211], a[12:15], a[204:207], v[208:211]
s_waitcnt lgkmcnt(4)
v_mfma_f32_16x16x32_bf16 v[196:199], v[248:251], a[184:187], v[196:199]
ds_read_b64_tr_b16 a[8:9], v216 offset:40960
v_mfma_f32_16x16x32_bf16 v[196:199], v[252:255], a[196:199], v[196:199]
ds_read_b64_tr_b16 a[10:11], v216 offset:43008
v_mfma_f32_16x16x32_bf16 v[204:207], v[252:255], a[200:203], v[204:207]
ds_read_b64_tr_b16 a[12:13], v216 offset:45056
v_mfma_f32_16x16x32_bf16 v[204:207], v[248:251], a[188:191], v[204:207]
ds_read_b64_tr_b16 a[14:15], v216 offset:47104
v_mfma_f32_16x16x32_bf16 v[212:215], v[248:251], a[192:195], v[212:215]
v_mfma_f32_16x16x32_bf16 v[212:215], v[252:255], a[204:207], v[212:215]
s_waitcnt vmcnt(8) lgkmcnt(4)
s_barrier
v_mfma_f32_16x16x32_bf16 v[212:215], a[0:3], a[216:219], v[212:215]
ds_read_b64_tr_b16 v[248:249], v220 offset:32768
s_add_u32 m0, s67, 8192
v_mfma_f32_16x16x32_bf16 v[212:215], a[4:7], a[228:231], v[212:215]
ds_read_b64_tr_b16 v[250:251], v220 offset:34816
s_add_u32 s69, s75, 524800
v_mfma_f32_16x16x32_bf16 v[204:207], a[4:7], a[224:227], v[204:207]
ds_read_b64_tr_b16 v[252:253], v220 offset:40960
buffer_load_dwordx4 v226, s[32:35], s69 offen offset:0 lds
v_mfma_f32_16x16x32_bf16 v[204:207], a[0:3], a[212:215], v[204:207]
ds_read_b64_tr_b16 v[254:255], v220 offset:43008
buffer_load_dwordx4 v227, s[32:35], s69 offen offset:1024 lds
v_mfma_f32_16x16x32_bf16 v[196:199], a[0:3], a[208:211], v[196:199]
s_add_u32 m0, s67, 16384
s_add_u32 s69, s75, 1049088
v_mfma_f32_16x16x32_bf16 v[196:199], a[4:7], a[220:223], v[196:199]
buffer_load_dwordx4 v226, s[32:35], s69 offen offset:0 lds
s_waitcnt lgkmcnt(4)
v_mfma_f32_16x16x32_bf16 v[208:211], a[8:11], a[216:219], v[208:211]
ds_read_b64_tr_b16 a[0:1], v221 offset:32768
buffer_load_dwordx4 v227, s[32:35], s69 offen offset:1024 lds
v_mfma_f32_16x16x32_bf16 v[208:211], a[12:15], a[228:231], v[208:211]
ds_read_b64_tr_b16 a[2:3], v221 offset:34816
v_mfma_f32_16x16x32_bf16 v[200:203], a[12:15], a[224:227], v[200:203]
ds_read_b64_tr_b16 a[4:5], v221 offset:40960
v_mfma_f32_16x16x32_bf16 v[200:203], a[8:11], a[212:215], v[200:203]
ds_read_b64_tr_b16 a[6:7], v221 offset:43008
v_mfma_f32_16x16x32_bf16 v[192:195], a[8:11], a[208:211], v[192:195]
v_mfma_f32_16x16x32_bf16 v[192:195], a[12:15], a[220:223], v[192:195]
s_waitcnt lgkmcnt(4)
v_mfma_f32_16x16x32_bf16 v[120:123], v[248:251], v[48:51], v[120:123]
ds_read_b64_tr_b16 a[8:9], v218 offset:32768
v_mfma_f32_16x16x32_bf16 v[120:123], v[252:255], v[60:63], v[120:123]
ds_read_b64_tr_b16 a[10:11], v218 offset:34816
v_mfma_f32_16x16x32_bf16 v[128:131], v[252:255], v[64:67], v[128:131]
ds_read_b64_tr_b16 a[12:13], v218 offset:40960
v_mfma_f32_16x16x32_bf16 v[128:131], v[248:251], v[52:55], v[128:131]
ds_read_b64_tr_b16 a[14:15], v218 offset:43008
v_mfma_f32_16x16x32_bf16 v[136:139], v[248:251], v[56:59], v[136:139]
v_mfma_f32_16x16x32_bf16 v[136:139], v[252:255], v[68:71], v[136:139]
s_waitcnt lgkmcnt(4)
v_mfma_f32_16x16x32_bf16 v[124:127], a[0:3], v[48:51], v[124:127]
ds_read_b64_tr_b16 v[248:249], v219 offset:32768
v_mfma_f32_16x16x32_bf16 v[124:127], a[4:7], v[60:63], v[124:127]
ds_read_b64_tr_b16 v[250:251], v219 offset:34816
v_mfma_f32_16x16x32_bf16 v[132:135], a[4:7], v[64:67], v[132:135]
ds_read_b64_tr_b16 v[252:253], v219 offset:40960
v_mfma_f32_16x16x32_bf16 v[132:135], a[0:3], v[52:55], v[132:135]
ds_read_b64_tr_b16 v[254:255], v219 offset:43008
v_mfma_f32_16x16x32_bf16 v[140:143], a[0:3], v[56:59], v[140:143]
v_mfma_f32_16x16x32_bf16 v[140:143], a[4:7], v[68:71], v[140:143]
s_waitcnt vmcnt(8) lgkmcnt(4)
s_barrier
v_mfma_f32_16x16x32_bf16 v[96:99], a[8:11], v[48:51], v[96:99]
ds_read_b64_tr_b16 a[0:1], v220 offset:49152
s_add_u32 m0, s67, 57344
v_mfma_f32_16x16x32_bf16 v[96:99], a[12:15], v[60:63], v[96:99]
ds_read_b64_tr_b16 a[2:3], v220 offset:51200
s_add_u32 s69, s75, 0
v_mfma_f32_16x16x32_bf16 v[104:107], a[12:15], v[64:67], v[104:107]
ds_read_b64_tr_b16 a[4:5], v220 offset:57344
buffer_load_dwordx4 v224, s[28:31], s69 offen offset:0 nt lds
v_mfma_f32_16x16x32_bf16 v[104:107], a[8:11], v[52:55], v[104:107]
ds_read_b64_tr_b16 a[6:7], v220 offset:59392
buffer_load_dwordx4 v225, s[28:31], s69 offen offset:1024 nt lds
v_mfma_f32_16x16x32_bf16 v[112:115], a[8:11], v[56:59], v[112:115]
s_add_u32 m0, s67, 65536
s_add_u32 s69, s75, 32768
v_mfma_f32_16x16x32_bf16 v[112:115], a[12:15], v[68:71], v[112:115]
buffer_load_dwordx4 v224, s[28:31], s69 offen offset:0 nt lds
s_waitcnt lgkmcnt(4)
v_mfma_f32_16x16x32_bf16 v[100:103], v[248:251], v[48:51], v[100:103]
ds_read_b64_tr_b16 a[8:9], v221 offset:49152
buffer_load_dwordx4 v225, s[28:31], s69 offen offset:1024 nt lds
v_mfma_f32_16x16x32_bf16 v[100:103], v[252:255], v[60:63], v[100:103]
ds_read_b64_tr_b16 a[10:11], v221 offset:51200
v_mfma_f32_16x16x32_bf16 v[108:111], v[252:255], v[64:67], v[108:111]
ds_read_b64_tr_b16 a[12:13], v221 offset:57344
v_mfma_f32_16x16x32_bf16 v[108:111], v[248:251], v[52:55], v[108:111]
ds_read_b64_tr_b16 a[14:15], v221 offset:59392
v_mfma_f32_16x16x32_bf16 v[116:119], v[248:251], v[56:59], v[116:119]
v_mfma_f32_16x16x32_bf16 v[116:119], v[252:255], v[68:71], v[116:119]
s_waitcnt lgkmcnt(4)
v_mfma_f32_16x16x32_bf16 v[120:123], a[0:3], v[72:75], v[120:123]
ds_read_b64_tr_b16 v[248:249], v218 offset:49152
v_mfma_f32_16x16x32_bf16 v[120:123], a[4:7], v[84:87], v[120:123]
ds_read_b64_tr_b16 v[250:251], v218 offset:51200
v_mfma_f32_16x16x32_bf16 v[128:131], a[4:7], v[88:91], v[128:131]
ds_read_b64_tr_b16 v[252:253], v218 offset:57344
v_mfma_f32_16x16x32_bf16 v[128:131], a[0:3], v[76:79], v[128:131]
ds_read_b64_tr_b16 v[254:255], v218 offset:59392
v_mfma_f32_16x16x32_bf16 v[136:139], a[0:3], v[80:83], v[136:139]
s_nop 1
ds_write_b64 v228, v[120:121] offset:0
v_mfma_f32_16x16x32_bf16 v[136:139], a[4:7], v[92:95], v[136:139]
s_waitcnt lgkmcnt(5)
v_mfma_f32_16x16x32_bf16 v[124:127], a[8:11], v[72:75], v[124:127]
ds_read_b64_tr_b16 a[0:1], v219 offset:49152
ds_write_b64 v228, v[122:123] offset:8
v_mfma_f32_16x16x32_bf16 v[124:127], a[12:15], v[84:87], v[124:127]
ds_read_b64_tr_b16 a[2:3], v219 offset:51200
v_mfma_f32_16x16x32_bf16 v[132:135], a[12:15], v[88:91], v[132:135]
ds_read_b64_tr_b16 a[4:5], v219 offset:57344
ds_write_b64 v228, v[128:129] offset:2048
v_mfma_f32_16x16x32_bf16 v[132:135], a[8:11], v[76:79], v[132:135]
ds_read_b64_tr_b16 a[6:7], v219 offset:59392
v_mfma_f32_16x16x32_bf16 v[140:143], a[8:11], v[80:83], v[140:143]
ds_write_b64 v228, v[130:131] offset:2056
v_mfma_f32_16x16x32_bf16 v[140:143], a[12:15], v[92:95], v[140:143]
s_waitcnt vmcnt(8) lgkmcnt(8)
s_barrier
v_mfma_f32_16x16x32_bf16 v[96:99], v[248:251], v[72:75], v[96:99]
ds_read_b64_tr_b16 a[8:9], v216 offset:49152
s_add_u32 m0, s67, 73728
ds_write_b64 v228, v[136:137] offset:4096
v_mfma_f32_16x16x32_bf16 v[96:99], v[252:255], v[84:87], v[96:99]
ds_read_b64_tr_b16 a[10:11], v216 offset:51200
s_add_u32 s69, s75, 65536
v_mfma_f32_16x16x32_bf16 v[104:107], v[252:255], v[88:91], v[104:107]
ds_read_b64_tr_b16 a[12:13], v216 offset:53248
buffer_load_dwordx4 v224, s[28:31], s69 offen offset:0 nt lds
ds_write_b64 v228, v[138:139] offset:4104
v_mfma_f32_16x16x32_bf16 v[104:107], v[248:251], v[76:79], v[104:107]
ds_read_b64_tr_b16 a[14:15], v216 offset:55296
buffer_load_dwordx4 v225, s[28:31], s69 offen offset:1024 nt lds
v_mfma_f32_16x16x32_bf16 v[112:115], v[248:251], v[80:83], v[112:115]
s_add_u32 m0, s67, 81920
s_add_u32 s69, s75, 98304
ds_write_b64 v228, v[124:125] offset:1024
v_mul_f32 v96, v238, v96
v_mul_f32 v97, v238, v97
v_mul_f32 v98, v238, v98
v_mfma_f32_16x16x32_bf16 v[112:115], v[252:255], v[92:95], v[112:115]
buffer_load_dwordx4 v224, s[28:31], s69 offen offset:0 nt lds
v_mul_f32 v99, v238, v99
s_waitcnt lgkmcnt(8)
v_mfma_f32_16x16x32_bf16 v[100:103], a[0:3], v[72:75], v[100:103]
ds_read_b64_tr_b16 v[248:249], v217 offset:49152
buffer_load_dwordx4 v225, s[28:31], s69 offen offset:1024 nt lds
ds_write_b64 v228, v[126:127] offset:1032
v_mul_f32 v104, v239, v104
v_mul_f32 v105, v239, v105
v_mul_f32 v106, v239, v106
v_mfma_f32_16x16x32_bf16 v[100:103], a[4:7], v[84:87], v[100:103]
ds_read_b64_tr_b16 v[250:251], v217 offset:51200
v_mul_f32 v107, v239, v107
v_mfma_f32_16x16x32_bf16 v[108:111], a[4:7], v[88:91], v[108:111]
ds_read_b64_tr_b16 v[252:253], v217 offset:53248
ds_write_b64 v228, v[132:133] offset:3072
v_mul_f32 v112, v240, v112
v_mul_f32 v113, v240, v113
v_mul_f32 v114, v240, v114
v_mul_f32 v115, v240, v115
v_mfma_f32_16x16x32_bf16 v[108:111], a[0:3], v[76:79], v[108:111]
ds_read_b64_tr_b16 v[254:255], v217 offset:55296
v_mfma_f32_16x16x32_bf16 v[116:119], a[0:3], v[80:83], v[116:119]
ds_write_b64 v228, v[134:135] offset:3080
v_mul_f32 v100, v238, v100
v_mul_f32 v101, v238, v101
v_mul_f32 v102, v238, v102
v_mul_f32 v103, v238, v103
v_mfma_f32_16x16x32_bf16 v[116:119], a[4:7], v[92:95], v[116:119]
s_waitcnt lgkmcnt(8)
v_mfma_f32_16x16x32_bf16 v[192:195], a[8:11], a[232:235], v[192:195]
ds_read_b64_tr_b16 a[0:1], v216 offset:0
ds_write_b64 v228, v[140:141] offset:5120
v_mul_f32 v108, v239, v108
v_mul_f32 v109, v239, v109
v_mul_f32 v110, v239, v110
v_mul_f32 v111, v239, v111
v_mfma_f32_16x16x32_bf16 v[192:195], a[12:15], a[244:247], v[192:195]
ds_read_b64_tr_b16 a[2:3], v216 offset:2048
v_mfma_f32_16x16x32_bf16 v[200:203], a[12:15], a[248:251], v[200:203]
ds_read_b64_tr_b16 a[4:5], v216 offset:4096
ds_write_b64 v228, v[142:143] offset:5128
v_mul_f32 v116, v240, v116
v_mul_f32 v117, v240, v117
v_mul_f32 v118, v240, v118
v_mul_f32 v119, v240, v119
v_mfma_f32_16x16x32_bf16 v[200:203], a[8:11], a[236:239], v[200:203]
ds_read_b64_tr_b16 a[6:7], v216 offset:6144
v_mfma_f32_16x16x32_bf16 v[208:211], a[8:11], a[240:243], v[208:211]
v_mul_f32 v192, s64, v192
v_mul_f32 v193, s64, v193
v_mul_f32 v194, s64, v194
v_mul_f32 v195, s64, v195
v_cvt_pk_bf16_f32 v192, v192, v193
v_cvt_pk_bf16_f32 v193, v194, v195
v_mfma_f32_16x16x32_bf16 v[208:211], a[12:15], a[252:255], v[208:211]
s_waitcnt lgkmcnt(7)
v_mfma_f32_16x16x32_bf16 v[196:199], v[248:251], a[232:235], v[196:199]
ds_read_b64_tr_b16 a[8:9], v217 offset:0
v_mul_f32 v200, s64, v200
v_mul_f32 v201, s64, v201
v_mul_f32 v202, s64, v202
v_mul_f32 v203, s64, v203
v_mfma_f32_16x16x32_bf16 v[196:199], v[252:255], a[244:247], v[196:199]
ds_read_b64_tr_b16 a[10:11], v217 offset:2048
v_mfma_f32_16x16x32_bf16 v[204:207], v[252:255], a[248:251], v[204:207]
ds_read_b64_tr_b16 a[12:13], v217 offset:4096
v_mul_f32 v208, s64, v208
v_mul_f32 v209, s64, v209
v_mul_f32 v210, s64, v210
v_mul_f32 v211, s64, v211
v_mfma_f32_16x16x32_bf16 v[204:207], v[248:251], a[236:239], v[204:207]
ds_read_b64_tr_b16 a[14:15], v217 offset:6144
v_mfma_f32_16x16x32_bf16 v[212:215], v[248:251], a[240:243], v[212:215]
v_mul_f32 v196, s64, v196
v_mul_f32 v197, s64, v197
v_mul_f32 v198, s64, v198
v_mul_f32 v199, s64, v199
v_cvt_pk_bf16_f32 v194, v196, v197
v_cvt_pk_bf16_f32 v195, v198, v199
v_cvt_pk_bf16_f32 v196, v200, v201
v_permlane16_swap_b32 v192, v194
v_permlane16_swap_b32 v193, v195
v_cvt_pk_bf16_f32 v197, v202, v203
v_cvt_pk_bf16_f32 v200, v208, v209
v_cvt_pk_bf16_f32 v201, v210, v211
v_mfma_f32_16x16x32_bf16 v[212:215], v[252:255], a[252:255], v[212:215]
ds_write_b64 v228, v[192:193] offset:6144
s_waitcnt vmcnt(8) lgkmcnt(5)
s_barrier
ds_write_b64 v228, v[194:195] offset:6152
v_mfma_f32_16x16x32_bf16 v[192:195], a[0:3], a[88:91], 0
ds_read_b64_tr_b16 v[248:249], v217 offset:8192
s_add_u32 m0, s67, 24576
ds_read_b128 v[120:123], v229 offset:0
v_mul_f32 v204, s64, v204
v_mul_f32 v205, s64, v205
v_mul_f32 v206, s64, v206
v_mul_f32 v207, s64, v207
v_cvt_pk_bf16_f32 v198, v204, v205
v_cvt_pk_bf16_f32 v199, v206, v207
v_mfma_f32_16x16x32_bf16 v[192:195], a[4:7], a[100:103], v[192:195]
ds_read_b64_tr_b16 v[250:251], v217 offset:10240
s_add_u32 s69, s75, 1573376
ds_read_b128 v[124:127], v229 offset:1024
v_permlane16_swap_b32 v196, v198
v_permlane16_swap_b32 v197, v199
v_mul_f32 v212, s64, v212
v_mul_f32 v213, s64, v213
v_mul_f32 v214, s64, v214
v_mul_f32 v215, s64, v215
v_cvt_pk_bf16_f32 v202, v212, v213
v_cvt_pk_bf16_f32 v203, v214, v215
s_nop 0
v_permlane16_swap_b32 v200, v202
v_permlane16_swap_b32 v201, v203
ds_write_b64 v228, v[196:197] offset:7168
ds_write_b64 v228, v[198:199] offset:7176
ds_write_b64 v228, v[200:201] offset:8192
ds_write_b64 v228, v[202:203] offset:8200
v_mfma_f32_16x16x32_bf16 v[200:203], a[4:7], a[104:107], 0
ds_read_b64_tr_b16 v[252:253], v217 offset:12288
buffer_load_dwordx4 v226, s[32:35], s69 offen offset:0 lds
ds_read_b128 v[128:131], v229 offset:2048
v_mfma_f32_16x16x32_bf16 v[200:203], a[0:3], a[92:95], v[200:203]
ds_read_b64_tr_b16 v[254:255], v217 offset:14336
buffer_load_dwordx4 v227, s[32:35], s69 offen offset:1024 lds
ds_read_b128 v[132:135], v229 offset:3072
v_mfma_f32_16x16x32_bf16 v[208:211], a[0:3], a[96:99], 0
s_add_u32 m0, s67, 32768
s_add_u32 s69, s75, 2097664
ds_read_b128 v[136:139], v229 offset:4096
v_mfma_f32_16x16x32_bf16 v[208:211], a[4:7], a[108:111], v[208:211]
buffer_load_dwordx4 v226, s[32:35], s69 offen offset:0 lds
ds_read_b128 v[140:143], v229 offset:5120
s_waitcnt lgkmcnt(15)
v_mfma_f32_16x16x32_bf16 v[196:199], a[8:11], a[88:91], 0
ds_read_b64_tr_b16 a[0:1], v216 offset:8192
buffer_load_dwordx4 v227, s[32:35], s69 offen offset:1024 lds
s_waitcnt lgkmcnt(13)
v_fmac_f32 v96, v241, v120
v_mfma_f32_16x16x32_bf16 v[196:199], a[12:15], a[100:103], v[196:199]
ds_read_b64_tr_b16 a[2:3], v216 offset:10240
v_fmac_f32 v97, v241, v121
v_mfma_f32_16x16x32_bf16 v[204:207], a[12:15], a[104:107], 0
ds_read_b64_tr_b16 a[4:5], v216 offset:12288
v_fmac_f32 v98, v241, v122
v_mfma_f32_16x16x32_bf16 v[204:207], a[8:11], a[92:95], v[204:207]
ds_read_b64_tr_b16 a[6:7], v216 offset:14336
v_fmac_f32 v99, v241, v123
v_mfma_f32_16x16x32_bf16 v[212:215], a[8:11], a[96:99], 0
s_waitcnt lgkmcnt(8)
v_fmac_f32 v104, v242, v128
v_mfma_f32_16x16x32_bf16 v[212:215], a[12:15], a[108:111], v[212:215]
v_fmac_f32 v105, v242, v129
s_waitcnt lgkmcnt(7)
v_mfma_f32_16x16x32_bf16 v[212:215], v[248:251], a[120:123], v[212:215]
ds_read_b64_tr_b16 a[8:9], v216 offset:16384
v_fmac_f32 v106, v242, v130
v_mfma_f32_16x16x32_bf16 v[212:215], v[252:255], a[132:135], v[212:215]
ds_read_b64_tr_b16 a[10:11], v216 offset:18432
v_fmac_f32 v107, v242, v131
v_mfma_f32_16x16x32_bf16 v[204:207], v[252:255], a[128:131], v[204:207]
ds_read_b64_tr_b16 a[12:13], v216 offset:20480
s_waitcnt lgkmcnt(8)
v_fmac_f32 v112, v243, v136
v_mfma_f32_16x16x32_bf16 v[204:207], v[248:251], a[116:119], v[204:207]
ds_read_b64_tr_b16 a[14:15], v216 offset:22528
v_fmac_f32 v113, v243, v137
v_mfma_f32_16x16x32_bf16 v[196:199], v[248:251], a[112:115], v[196:199]
v_fmac_f32 v114, v243, v138
v_fmac_f32 v115, v243, v139
v_mfma_f32_16x16x32_bf16 v[196:199], v[252:255], a[124:127], v[196:199]
v_fmac_f32 v100, v241, v124
s_waitcnt lgkmcnt(4)
v_mfma_f32_16x16x32_bf16 v[208:211], a[0:3], a[120:123], v[208:211]
ds_read_b64_tr_b16 v[248:249], v217 offset:16384
v_fmac_f32 v101, v241, v125
v_mfma_f32_16x16x32_bf16 v[208:211], a[4:7], a[132:135], v[208:211]
ds_read_b64_tr_b16 v[250:251], v217 offset:18432
v_fmac_f32 v102, v241, v126
v_mfma_f32_16x16x32_bf16 v[200:203], a[4:7], a[128:131], v[200:203]
ds_read_b64_tr_b16 v[252:253], v217 offset:20480
v_fmac_f32 v103, v241, v127
v_mfma_f32_16x16x32_bf16 v[200:203], a[0:3], a[116:119], v[200:203]
ds_read_b64_tr_b16 v[254:255], v217 offset:22528
v_fmac_f32 v108, v242, v132
v_mfma_f32_16x16x32_bf16 v[192:195], a[0:3], a[112:115], v[192:195]
v_fmac_f32 v109, v242, v133
v_fmac_f32 v110, v242, v134
v_mfma_f32_16x16x32_bf16 v[192:195], a[4:7], a[124:127], v[192:195]
s_waitcnt vmcnt(8) lgkmcnt(4)
s_barrier
v_mfma_f32_16x16x32_bf16 v[192:195], a[8:11], a[136:139], v[192:195]
ds_read_b64_tr_b16 a[0:1], v220 offset:0
s_add_u32 m0, s67, 40960
v_mfma_f32_16x16x32_bf16 v[192:195], a[12:15], a[148:151], v[192:195]
ds_read_b64_tr_b16 a[2:3], v220 offset:2048
s_add_u32 s69, s75, 2621952
v_mfma_f32_16x16x32_bf16 v[200:203], a[12:15], a[152:155], v[200:203]
ds_read_b64_tr_b16 a[4:5], v220 offset:8192
buffer_load_dwordx4 v226, s[32:35], s69 offen offset:0 lds
v_mfma_f32_16x16x32_bf16 v[200:203], a[8:11], a[140:143], v[200:203]
ds_read_b64_tr_b16 a[6:7], v220 offset:10240
buffer_load_dwordx4 v227, s[32:35], s69 offen offset:1024 lds
v_mfma_f32_16x16x32_bf16 v[208:211], a[8:11], a[144:147], v[208:211]
s_add_u32 m0, s67, 90112
s_add_u32 s69, s75, 131072
v_mfma_f32_16x16x32_bf16 v[208:211], a[12:15], a[156:159], v[208:211]
buffer_load_dwordx4 v224, s[28:31], s69 offen offset:0 nt lds
s_waitcnt lgkmcnt(4)
v_mfma_f32_16x16x32_bf16 v[196:199], v[248:251], a[136:139], v[196:199]
ds_read_b64_tr_b16 a[8:9], v221 offset:0
buffer_load_dwordx4 v225, s[28:31], s69 offen offset:1024 nt lds
v_mfma_f32_16x16x32_bf16 v[196:199], v[252:255], a[148:151], v[196:199]
ds_read_b64_tr_b16 a[10:11], v221 offset:2048
ds_read_b128 a[64:67], v230 offset:6144
v_mfma_f32_16x16x32_bf16 v[204:207], v[252:255], a[152:155], v[204:207]
ds_read_b64_tr_b16 a[12:13], v221 offset:8192
ds_read_b128 a[76:79], v230 offset:16384
v_fmac_f32 v111, v242, v135
v_mfma_f32_16x16x32_bf16 v[204:207], v[248:251], a[140:143], v[204:207]
ds_read_b64_tr_b16 a[14:15], v221 offset:10240
ds_read_b128 a[80:83], v230 offset:17408
v_fmac_f32 v116, v243, v140
v_mfma_f32_16x16x32_bf16 v[212:215], v[248:251], a[144:147], v[212:215]
ds_read_b128 a[68:71], v230 offset:7168
v_fmac_f32 v117, v243, v141
v_mfma_f32_16x16x32_bf16 v[212:215], v[252:255], a[156:159], v[212:215]
ds_read_b128 a[72:75], v230 offset:8192
s_waitcnt lgkmcnt(9)
v_mfma_f32_16x16x32_bf16 v[120:123], a[0:3], v[0:3], 0
ds_read_b64_tr_b16 v[248:249], v218 offset:0
ds_read_b128 a[84:87], v230 offset:18432
v_fmac_f32 v118, v243, v142
v_mfma_f32_16x16x32_bf16 v[120:123], a[4:7], v[12:15], v[120:123]
ds_read_b64_tr_b16 v[250:251], v218 offset:2048
v_fmac_f32 v119, v243, v143
v_mfma_f32_16x16x32_bf16 v[128:131], a[4:7], v[16:19], 0
ds_read_b64_tr_b16 v[252:253], v218 offset:8192
v_cvt_pk_bf16_f32 v168, v96, v97
v_mfma_f32_16x16x32_bf16 v[128:131], a[0:3], v[4:7], v[128:131]
ds_read_b64_tr_b16 v[254:255], v218 offset:10240
v_cvt_pk_bf16_f32 v169, v98, v99
v_mfma_f32_16x16x32_bf16 v[136:139], a[0:3], v[8:11], 0
v_cvt_pk_bf16_f32 v172, v104, v105
v_cvt_pk_bf16_f32 v173, v106, v107
v_mfma_f32_16x16x32_bf16 v[136:139], a[4:7], v[20:23], v[136:139]
v_cvt_pk_bf16_f32 v176, v112, v113
s_waitcnt lgkmcnt(8)
v_mfma_f32_16x16x32_bf16 v[124:127], a[8:11], v[0:3], 0
ds_read_b64_tr_b16 a[0:1], v219 offset:0
v_cvt_pk_bf16_f32 v177, v114, v115
v_mfma_f32_16x16x32_bf16 v[124:127], a[12:15], v[12:15], v[124:127]
ds_read_b64_tr_b16 a[2:3], v219 offset:2048
v_cvt_pk_bf16_f32 v170, v100, v101
v_mfma_f32_16x16x32_bf16 v[132:135], a[12:15], v[16:19], 0
ds_read_b64_tr_b16 a[4:5], v219 offset:8192
v_cvt_pk_bf16_f32 v171, v102, v103
v_mfma_f32_16x16x32_bf16 v[132:135], a[8:11], v[4:7], v[132:135]
ds_read_b64_tr_b16 a[6:7], v219 offset:10240
v_cvt_pk_bf16_f32 v174, v108, v109
v_mfma_f32_16x16x32_bf16 v[140:143], a[8:11], v[8:11], 0
v_cvt_pk_bf16_f32 v175, v110, v111
v_cvt_pk_bf16_f32 v178, v116, v117
v_mfma_f32_16x16x32_bf16 v[140:143], a[12:15], v[20:23], v[140:143]
s_waitcnt vmcnt(8) lgkmcnt(4)
s_barrier
v_mfma_f32_16x16x32_bf16 v[96:99], v[248:251], v[0:3], 0
ds_read_b64_tr_b16 a[8:9], v220 offset:16384
s_add_u32 m0, s67, 98304
v_mfma_f32_16x16x32_bf16 v[96:99], v[252:255], v[12:15], v[96:99]
ds_read_b64_tr_b16 a[10:11], v220 offset:18432
s_add_u32 s69, s75, 163840
v_mfma_f32_16x16x32_bf16 v[104:107], v[252:255], v[16:19], 0
ds_read_b64_tr_b16 a[12:13], v220 offset:24576
buffer_load_dwordx4 v224, s[28:31], s69 offen offset:0 nt lds
v_mfma_f32_16x16x32_bf16 v[104:107], v[248:251], v[4:7], v[104:107]
ds_read_b64_tr_b16 a[14:15], v220 offset:26624
buffer_load_dwordx4 v225, s[28:31], s69 offen offset:1024 nt lds
v_mfma_f32_16x16x32_bf16 v[112:115], v[248:251], v[8:11], 0
s_add_u32 m0, s67, 106496
s_add_u32 s69, s75, 196608
v_mfma_f32_16x16x32_bf16 v[112:115], v[252:255], v[20:23], v[112:115]
buffer_load_dwordx4 v224, s[28:31], s69 offen offset:0 nt lds
s_waitcnt lgkmcnt(4)
v_mfma_f32_16x16x32_bf16 v[100:103], a[0:3], v[0:3], 0
ds_read_b64_tr_b16 v[248:249], v221 offset:16384
buffer_load_dwordx4 v225, s[28:31], s69 offen offset:1024 nt lds
v_mfma_f32_16x16x32_bf16 v[100:103], a[4:7], v[12:15], v[100:103]
ds_read_b64_tr_b16 v[250:251], v221 offset:18432
v_cvt_pk_bf16_f32 v179, v118, v119
v_mfma_f32_16x16x32_bf16 v[108:111], a[4:7], v[16:19], 0
ds_read_b64_tr_b16 v[252:253], v221 offset:24576
v_mfma_f32_16x16x32_bf16 v[108:111], a[0:3], v[4:7], v[108:111]
ds_read_b64_tr_b16 v[254:255], v221 offset:26624
v_mfma_f32_16x16x32_bf16 v[116:119], a[0:3], v[8:11], 0
v_mfma_f32_16x16x32_bf16 v[116:119], a[4:7], v[20:23], v[116:119]
s_waitcnt lgkmcnt(4)
v_mfma_f32_16x16x32_bf16 v[120:123], a[8:11], v[24:27], v[120:123]
ds_read_b64_tr_b16 a[0:1], v218 offset:16384
v_mfma_f32_16x16x32_bf16 v[120:123], a[12:15], v[36:39], v[120:123]
ds_read_b64_tr_b16 a[2:3], v218 offset:18432
v_mfma_f32_16x16x32_bf16 v[128:131], a[12:15], v[40:43], v[128:131]
ds_read_b64_tr_b16 a[4:5], v218 offset:24576
v_mfma_f32_16x16x32_bf16 v[128:131], a[8:11], v[28:31], v[128:131]
ds_read_b64_tr_b16 a[6:7], v218 offset:26624
v_mfma_f32_16x16x32_bf16 v[136:139], a[8:11], v[32:35], v[136:139]
v_mfma_f32_16x16x32_bf16 v[136:139], a[12:15], v[44:47], v[136:139]
s_waitcnt lgkmcnt(4)
v_mfma_f32_16x16x32_bf16 v[124:127], v[248:251], v[24:27], v[124:127]
ds_read_b64_tr_b16 a[8:9], v219 offset:16384
v_mfma_f32_16x16x32_bf16 v[124:127], v[252:255], v[36:39], v[124:127]
ds_read_b64_tr_b16 a[10:11], v219 offset:18432
v_mfma_f32_16x16x32_bf16 v[132:135], v[252:255], v[40:43], v[132:135]
ds_read_b64_tr_b16 a[12:13], v219 offset:24576
v_mfma_f32_16x16x32_bf16 v[132:135], v[248:251], v[28:31], v[132:135]
ds_read_b64_tr_b16 a[14:15], v219 offset:26624
v_mfma_f32_16x16x32_bf16 v[140:143], v[248:251], v[32:35], v[140:143]
v_mfma_f32_16x16x32_bf16 v[140:143], v[252:255], v[44:47], v[140:143]
s_waitcnt vmcnt(6) lgkmcnt(4)
s_barrier
v_mfma_f32_16x16x32_bf16 v[96:99], a[0:3], v[24:27], v[96:99]
ds_read_b64_tr_b16 v[248:249], v217 offset:24576
s_add_u32 m0, s67, 114688
v_mfma_f32_16x16x32_bf16 v[96:99], a[4:7], v[36:39], v[96:99]
ds_read_b64_tr_b16 v[250:251], v217 offset:26624
s_add_u32 s69, s75, 229376
v_mfma_f32_16x16x32_bf16 v[104:107], a[4:7], v[40:43], v[104:107]
ds_read_b64_tr_b16 v[252:253], v217 offset:28672
buffer_load_dwordx4 v224, s[28:31], s69 offen offset:0 nt lds
v_mfma_f32_16x16x32_bf16 v[104:107], a[0:3], v[28:31], v[104:107]
ds_read_b64_tr_b16 v[254:255], v217 offset:30720
buffer_load_dwordx4 v225, s[28:31], s69 offen offset:1024 nt lds
v_mfma_f32_16x16x32_bf16 v[112:115], a[0:3], v[32:35], v[112:115]
s_add_u32 m0, s67, 49152
s_add_u32 s69, s75, 3146240
v_mfma_f32_16x16x32_bf16 v[112:115], a[4:7], v[44:47], v[112:115]
buffer_load_dwordx4 v226, s[32:35], s69 offen offset:0 lds
s_waitcnt lgkmcnt(4)
v_mfma_f32_16x16x32_bf16 v[100:103], a[8:11], v[24:27], v[100:103]
ds_read_b64_tr_b16 a[0:1], v216 offset:24576
buffer_load_dwordx4 v227, s[32:35], s69 offen offset:1024 lds
v_mfma_f32_16x16x32_bf16 v[100:103], a[12:15], v[36:39], v[100:103]
ds_read_b64_tr_b16 a[2:3], v216 offset:26624
v_lshrrev_b32 v227, 13, v226
v_mfma_f32_16x16x32_bf16 v[108:111], a[12:15], v[40:43], v[108:111]
ds_read_b64_tr_b16 a[4:5], v216 offset:28672
v_mul_u32_u24 v227, 7296, v227
v_mfma_f32_16x16x32_bf16 v[108:111], a[8:11], v[28:31], v[108:111]
ds_read_b64_tr_b16 a[6:7], v216 offset:30720
v_sub_u32 v226, v226, v227
v_mfma_f32_16x16x32_bf16 v[116:119], a[8:11], v[32:35], v[116:119]
v_xor_b32 v227, 16, v226
v_add_u32 v227, 6144, v227
v_mfma_f32_16x16x32_bf16 v[116:119], a[12:15], v[44:47], v[116:119]
s_add_u32 m0, s67, 0
s_waitcnt lgkmcnt(4)
v_mfma_f32_16x16x32_bf16 v[212:215], v[248:251], a[168:171], v[212:215]
ds_read_b64_tr_b16 a[8:9], v216 offset:32768
s_add_u32 s69, s76, s80
v_mfma_f32_16x16x32_bf16 v[212:215], v[252:255], a[180:183], v[212:215]
ds_read_b64_tr_b16 a[10:11], v216 offset:34816
buffer_load_dwordx4 v226, s[36:39], s69 offen offset:0 lds
v_mfma_f32_16x16x32_bf16 v[204:207], v[252:255], a[176:179], v[204:207]
ds_read_b64_tr_b16 a[12:13], v216 offset:36864
buffer_load_dwordx4 v227, s[36:39], s69 offen offset:1024 lds
v_mfma_f32_16x16x32_bf16 v[204:207], v[248:251], a[164:167], v[204:207]
ds_read_b64_tr_b16 a[14:15], v216 offset:38912
v_mfma_f32_16x16x32_bf16 v[196:199], v[248:251], a[160:163], v[196:199]
v_mfma_f32_16x16x32_bf16 v[196:199], v[252:255], a[172:175], v[196:199]
s_waitcnt lgkmcnt(4)
v_mfma_f32_16x16x32_bf16 v[208:211], a[0:3], a[168:171], v[208:211]
ds_read_b64_tr_b16 v[248:249], v217 offset:32768
v_mfma_f32_16x16x32_bf16 v[208:211], a[4:7], a[180:183], v[208:211]
ds_read_b64_tr_b16 v[250:251], v217 offset:34816
v_mfma_f32_16x16x32_bf16 v[200:203], a[4:7], a[176:179], v[200:203]
ds_read_b64_tr_b16 v[252:253], v217 offset:36864
v_mfma_f32_16x16x32_bf16 v[200:203], a[0:3], a[164:167], v[200:203]
ds_read_b64_tr_b16 v[254:255], v217 offset:38912
v_mfma_f32_16x16x32_bf16 v[192:195], a[0:3], a[160:163], v[192:195]
v_mfma_f32_16x16x32_bf16 v[192:195], a[4:7], a[172:175], v[192:195]
s_waitcnt lgkmcnt(4)
v_mfma_f32_16x16x32_bf16 v[192:195], a[8:11], a[184:187], v[192:195]
ds_read_b64_tr_b16 a[0:1], v217 offset:40960
v_mfma_f32_16x16x32_bf16 v[192:195], a[12:15], a[196:199], v[192:195]
ds_read_b64_tr_b16 a[2:3], v217 offset:43008
v_mfma_f32_16x16x32_bf16 v[200:203], a[12:15], a[200:203], v[200:203]
ds_read_b64_tr_b16 a[4:5], v217 offset:45056
v_mfma_f32_16x16x32_bf16 v[200:203], a[8:11], a[188:191], v[200:203]
ds_read_b64_tr_b16 a[6:7], v217 offset:47104
v_mfma_f32_16x16x32_bf16 v[208:211], a[8:11], a[192:195], v[208:211]
v_mfma_f32_16x16x32_bf16 v[208:211], a[12:15], a[204:207], v[208:211]
s_waitcnt lgkmcnt(4)
v_mfma_f32_16x16x32_bf16 v[196:199], v[248:251], a[184:187], v[196:199]
ds_read_b64_tr_b16 a[8:9], v216 offset:40960
v_mfma_f32_16x16x32_bf16 v[196:199], v[252:255], a[196:199], v[196:199]
ds_read_b64_tr_b16 a[10:11], v216 offset:43008
v_mfma_f32_16x16x32_bf16 v[204:207], v[252:255], a[200:203], v[204:207]
ds_read_b64_tr_b16 a[12:13], v216 offset:45056
v_mfma_f32_16x16x32_bf16 v[204:207], v[248:251], a[188:191], v[204:207]
ds_read_b64_tr_b16 a[14:15], v216 offset:47104
v_mfma_f32_16x16x32_bf16 v[212:215], v[248:251], a[192:195], v[212:215]
v_mfma_f32_16x16x32_bf16 v[212:215], v[252:255], a[204:207], v[212:215]
s_waitcnt vmcnt(8) lgkmcnt(4)
s_barrier
v_mfma_f32_16x16x32_bf16 v[212:215], a[0:3], a[216:219], v[212:215]
ds_read_b64_tr_b16 v[248:249], v220 offset:32768
s_add_u32 m0, s67, 8192
v_mfma_f32_16x16x32_bf16 v[212:215], a[4:7], a[228:231], v[212:215]
ds_read_b64_tr_b16 v[250:251], v220 offset:34816
s_add_u32 s69, s76, s81
v_mfma_f32_16x16x32_bf16 v[204:207], a[4:7], a[224:227], v[204:207]
ds_read_b64_tr_b16 v[252:253], v220 offset:40960
buffer_load_dwordx4 v226, s[36:39], s69 offen offset:0 lds
v_mfma_f32_16x16x32_bf16 v[204:207], a[0:3], a[212:215], v[204:207]
ds_read_b64_tr_b16 v[254:255], v220 offset:43008
buffer_load_dwordx4 v227, s[36:39], s69 offen offset:1024 lds
v_mfma_f32_16x16x32_bf16 v[196:199], a[0:3], a[208:211], v[196:199]
s_add_u32 m0, s67, 16384
s_add_u32 s69, s76, s82
v_mfma_f32_16x16x32_bf16 v[196:199], a[4:7], a[220:223], v[196:199]
buffer_load_dwordx4 v226, s[36:39], s69 offen offset:0 lds
s_waitcnt lgkmcnt(4)
v_mfma_f32_16x16x32_bf16 v[208:211], a[8:11], a[216:219], v[208:211]
ds_read_b64_tr_b16 a[0:1], v221 offset:32768
buffer_load_dwordx4 v227, s[36:39], s69 offen offset:1024 lds
v_mfma_f32_16x16x32_bf16 v[208:211], a[12:15], a[228:231], v[208:211]
ds_read_b64_tr_b16 a[2:3], v221 offset:34816
v_mfma_f32_16x16x32_bf16 v[200:203], a[12:15], a[224:227], v[200:203]
ds_read_b64_tr_b16 a[4:5], v221 offset:40960
v_mfma_f32_16x16x32_bf16 v[200:203], a[8:11], a[212:215], v[200:203]
ds_read_b64_tr_b16 a[6:7], v221 offset:43008
v_mfma_f32_16x16x32_bf16 v[192:195], a[8:11], a[208:211], v[192:195]
v_mfma_f32_16x16x32_bf16 v[192:195], a[12:15], a[220:223], v[192:195]
s_waitcnt lgkmcnt(4)
v_mfma_f32_16x16x32_bf16 v[120:123], v[248:251], v[48:51], v[120:123]
ds_read_b64_tr_b16 a[8:9], v218 offset:32768
v_mfma_f32_16x16x32_bf16 v[120:123], v[252:255], v[60:63], v[120:123]
ds_read_b64_tr_b16 a[10:11], v218 offset:34816
v_mfma_f32_16x16x32_bf16 v[128:131], v[252:255], v[64:67], v[128:131]
ds_read_b64_tr_b16 a[12:13], v218 offset:40960
v_mfma_f32_16x16x32_bf16 v[128:131], v[248:251], v[52:55], v[128:131]
ds_read_b64_tr_b16 a[14:15], v218 offset:43008
v_mfma_f32_16x16x32_bf16 v[136:139], v[248:251], v[56:59], v[136:139]
v_mfma_f32_16x16x32_bf16 v[136:139], v[252:255], v[68:71], v[136:139]
s_waitcnt lgkmcnt(4)
v_mfma_f32_16x16x32_bf16 v[124:127], a[0:3], v[48:51], v[124:127]
ds_read_b64_tr_b16 v[248:249], v219 offset:32768
v_mfma_f32_16x16x32_bf16 v[124:127], a[4:7], v[60:63], v[124:127]
ds_read_b64_tr_b16 v[250:251], v219 offset:34816
v_mfma_f32_16x16x32_bf16 v[132:135], a[4:7], v[64:67], v[132:135]
ds_read_b64_tr_b16 v[252:253], v219 offset:40960
v_mfma_f32_16x16x32_bf16 v[132:135], a[0:3], v[52:55], v[132:135]
ds_read_b64_tr_b16 v[254:255], v219 offset:43008
v_mfma_f32_16x16x32_bf16 v[140:143], a[0:3], v[56:59], v[140:143]
v_mfma_f32_16x16x32_bf16 v[140:143], a[4:7], v[68:71], v[140:143]
s_waitcnt vmcnt(8) lgkmcnt(4)
s_barrier
v_mfma_f32_16x16x32_bf16 v[96:99], a[8:11], v[48:51], v[96:99]
ds_read_b64_tr_b16 a[0:1], v220 offset:49152
s_add_u32 m0, s67, 57344
v_mfma_f32_16x16x32_bf16 v[96:99], a[12:15], v[60:63], v[96:99]
ds_read_b64_tr_b16 a[2:3], v220 offset:51200
s_add_u32 s69, s72, 262144
v_mfma_f32_16x16x32_bf16 v[104:107], a[12:15], v[64:67], v[104:107]
ds_read_b64_tr_b16 a[4:5], v220 offset:57344
buffer_load_dwordx4 v224, s[24:27], s69 offen offset:0 nt lds
v_mfma_f32_16x16x32_bf16 v[104:107], a[8:11], v[52:55], v[104:107]
ds_read_b64_tr_b16 a[6:7], v220 offset:59392
buffer_load_dwordx4 v225, s[24:27], s69 offen offset:1024 nt lds
v_mfma_f32_16x16x32_bf16 v[112:115], a[8:11], v[56:59], v[112:115]
s_add_u32 m0, s67, 65536
s_add_u32 s69, s73, 262144
v_mfma_f32_16x16x32_bf16 v[112:115], a[12:15], v[68:71], v[112:115]
buffer_load_dwordx4 v224, s[24:27], s69 offen offset:0 nt lds
s_waitcnt lgkmcnt(4)
v_mfma_f32_16x16x32_bf16 v[100:103], v[248:251], v[48:51], v[100:103]
ds_read_b64_tr_b16 a[8:9], v221 offset:49152
buffer_load_dwordx4 v225, s[24:27], s69 offen offset:1024 nt lds
v_mfma_f32_16x16x32_bf16 v[100:103], v[252:255], v[60:63], v[100:103]
ds_read_b64_tr_b16 a[10:11], v221 offset:51200
v_mfma_f32_16x16x32_bf16 v[108:111], v[252:255], v[64:67], v[108:111]
ds_read_b64_tr_b16 a[12:13], v221 offset:57344
v_mfma_f32_16x16x32_bf16 v[108:111], v[248:251], v[52:55], v[108:111]
ds_read_b64_tr_b16 a[14:15], v221 offset:59392
v_mfma_f32_16x16x32_bf16 v[116:119], v[248:251], v[56:59], v[116:119]
v_mfma_f32_16x16x32_bf16 v[116:119], v[252:255], v[68:71], v[116:119]
s_waitcnt lgkmcnt(4)
v_mfma_f32_16x16x32_bf16 v[120:123], a[0:3], v[72:75], v[120:123]
ds_read_b64_tr_b16 v[248:249], v218 offset:49152
v_mfma_f32_16x16x32_bf16 v[120:123], a[4:7], v[84:87], v[120:123]
ds_read_b64_tr_b16 v[250:251], v218 offset:51200
v_mfma_f32_16x16x32_bf16 v[128:131], a[4:7], v[88:91], v[128:131]
ds_read_b64_tr_b16 v[252:253], v218 offset:57344
v_mfma_f32_16x16x32_bf16 v[128:131], a[0:3], v[76:79], v[128:131]
ds_read_b64_tr_b16 v[254:255], v218 offset:59392
v_mfma_f32_16x16x32_bf16 v[136:139], a[0:3], v[80:83], v[136:139]
s_nop 1
ds_write_b64 v228, v[120:121] offset:0
v_mfma_f32_16x16x32_bf16 v[136:139], a[4:7], v[92:95], v[136:139]
s_waitcnt lgkmcnt(5)
v_mfma_f32_16x16x32_bf16 v[124:127], a[8:11], v[72:75], v[124:127]
ds_read_b64_tr_b16 a[0:1], v219 offset:49152
ds_write_b64 v228, v[122:123] offset:8
v_mfma_f32_16x16x32_bf16 v[124:127], a[12:15], v[84:87], v[124:127]
ds_read_b64_tr_b16 a[2:3], v219 offset:51200
v_mfma_f32_16x16x32_bf16 v[132:135], a[12:15], v[88:91], v[132:135]
ds_read_b64_tr_b16 a[4:5], v219 offset:57344
ds_write_b64 v228, v[128:129] offset:2048
v_mfma_f32_16x16x32_bf16 v[132:135], a[8:11], v[76:79], v[132:135]
ds_read_b64_tr_b16 a[6:7], v219 offset:59392
v_mfma_f32_16x16x32_bf16 v[140:143], a[8:11], v[80:83], v[140:143]
ds_write_b64 v228, v[130:131] offset:2056
v_mfma_f32_16x16x32_bf16 v[140:143], a[12:15], v[92:95], v[140:143]
s_waitcnt vmcnt(8) lgkmcnt(8)
s_barrier
v_mfma_f32_16x16x32_bf16 v[96:99], v[248:251], v[72:75], v[96:99]
ds_read_b64_tr_b16 a[8:9], v216 offset:49152
s_add_u32 m0, s67, 73728
ds_write_b64 v228, v[136:137] offset:4096
v_mfma_f32_16x16x32_bf16 v[96:99], v[252:255], v[84:87], v[96:99]
ds_read_b64_tr_b16 a[10:11], v216 offset:51200
s_add_u32 s69, s74, 262144
v_mfma_f32_16x16x32_bf16 v[104:107], v[252:255], v[88:91], v[104:107]
ds_read_b64_tr_b16 a[12:13], v216 offset:53248
buffer_load_dwordx4 v224, s[24:27], s69 offen offset:0 nt lds
ds_write_b64 v228, v[138:139] offset:4104
v_mfma_f32_16x16x32_bf16 v[104:107], v[248:251], v[76:79], v[104:107]
ds_read_b64_tr_b16 a[14:15], v216 offset:55296
buffer_load_dwordx4 v225, s[24:27], s69 offen offset:1024 nt lds
v_mfma_f32_16x16x32_bf16 v[112:115], v[248:251], v[80:83], v[112:115]
s_add_u32 m0, s67, 81920
s_add_u32 s69, s75, 262144
ds_write_b64 v228, v[124:125] offset:1024
v_mul_f32 v96, v238, v96
v_mul_f32 v97, v238, v97
v_mfma_f32_16x16x32_bf16 v[112:115], v[252:255], v[92:95], v[112:115]
buffer_load_dwordx4 v224, s[24:27], s69 offen offset:0 nt lds
v_mul_f32 v98, v238, v98
s_waitcnt lgkmcnt(8)
v_mfma_f32_16x16x32_bf16 v[100:103], a[0:3], v[72:75], v[100:103]
ds_read_b64_tr_b16 v[248:249], v217 offset:49152
buffer_load_dwordx4 v225, s[24:27], s69 offen offset:1024 nt lds
ds_write_b64 v228, v[126:127] offset:1032
v_mul_f32 v104, v239, v104
v_mul_f32 v105, v239, v105
v_mfma_f32_16x16x32_bf16 v[100:103], a[4:7], v[84:87], v[100:103]
ds_read_b64_tr_b16 v[250:251], v217 offset:51200
v_mul_f32 v106, v239, v106
v_mfma_f32_16x16x32_bf16 v[108:111], a[4:7], v[88:91], v[108:111]
ds_read_b64_tr_b16 v[252:253], v217 offset:53248
ds_write_b64 v228, v[132:133] offset:3072
v_mul_f32 v112, v240, v112
v_mul_f32 v113, v240, v113
v_mfma_f32_16x16x32_bf16 v[108:111], a[0:3], v[76:79], v[108:111]
ds_read_b64_tr_b16 v[254:255], v217 offset:55296
v_mul_f32 v114, v240, v114
v_mfma_f32_16x16x32_bf16 v[116:119], a[0:3], v[80:83], v[116:119]
ds_write_b64 v228, v[134:135] offset:3080
v_mul_f32 v100, v238, v100
v_mul_f32 v101, v238, v101
v_mfma_f32_16x16x32_bf16 v[116:119], a[4:7], v[92:95], v[116:119]
v_mul_f32 v102, v238, v102
s_waitcnt lgkmcnt(8)
v_mfma_f32_16x16x32_bf16 v[192:195], a[8:11], a[232:235], v[192:195]
ds_read_b64_tr_b16 a[0:1], v216 offset:0
ds_write_b64 v228, v[140:141] offset:5120
v_mul_f32 v108, v239, v108
v_mul_f32 v109, v239, v109
v_mfma_f32_16x16x32_bf16 v[192:195], a[12:15], a[244:247], v[192:195]
ds_read_b64_tr_b16 a[2:3], v216 offset:2048
v_mul_f32 v110, v239, v110
v_mfma_f32_16x16x32_bf16 v[200:203], a[12:15], a[248:251], v[200:203]
ds_read_b64_tr_b16 a[4:5], v216 offset:4096
ds_write_b64 v228, v[142:143] offset:5128
v_mul_f32 v116, v240, v116
v_mfma_f32_16x16x32_bf16 v[200:203], a[8:11], a[236:239], v[200:203]
ds_read_b64_tr_b16 a[6:7], v216 offset:6144
v_mul_f32 v117, v240, v117
v_mul_f32 v118, v240, v118
v_mfma_f32_16x16x32_bf16 v[208:211], a[8:11], a[240:243], v[208:211]
v_mul_f32 v192, s64, v192
v_mul_f32 v193, s64, v193
v_mfma_f32_16x16x32_bf16 v[208:211], a[12:15], a[252:255], v[208:211]
v_mul_f32 v194, s64, v194
s_waitcnt lgkmcnt(7)
v_mfma_f32_16x16x32_bf16 v[196:199], v[248:251], a[232:235], v[196:199]
ds_read_b64_tr_b16 a[8:9], v217 offset:0
v_mul_f32 v195, s64, v195
v_mfma_f32_16x16x32_bf16 v[196:199], v[252:255], a[244:247], v[196:199]
ds_read_b64_tr_b16 a[10:11], v217 offset:2048
v_cvt_pk_bf16_f32 v192, v192, v193
v_cvt_pk_bf16_f32 v193, v194, v195
v_mfma_f32_16x16x32_bf16 v[204:207], v[252:255], a[248:251], v[204:207]
ds_read_b64_tr_b16 a[12:13], v217 offset:4096
v_mul_f32 v200, s64, v200
v_mfma_f32_16x16x32_bf16 v[204:207], v[248:251], a[236:239], v[204:207]
ds_read_b64_tr_b16 a[14:15], v217 offset:6144
v_mul_f32 v201, s64, v201
v_mul_f32 v202, s64, v202
v_mfma_f32_16x16x32_bf16 v[212:215], v[248:251], a[240:243], v[212:215]
v_mul_f32 v196, s64, v196
v_mul_f32 v197, s64, v197
v_mfma_f32_16x16x32_bf16 v[212:215], v[252:255], a[252:255], v[212:215]
s_waitcnt vmcnt(8) lgkmcnt(4)
s_barrier
v_mfma_f32_16x16x32_bf16 a[208:211], a[0:3], v[180:183], 0
ds_read_b64_tr_b16 v[248:249], v216 offset:8192
s_add_u32 m0, s67, 24576
ds_read_b128 v[120:123], v229 offset:0
v_mul_f32 v198, s64, v198
v_mul_f32 v199, s64, v199
v_mfma_f32_16x16x32_bf16 a[208:211], a[4:7], v[144:147], a[208:211]
ds_read_b64_tr_b16 v[250:251], v216 offset:10240
s_add_u32 s69, s76, s83
ds_read_b128 v[124:127], v229 offset:1024
v_cvt_pk_bf16_f32 v194, v196, v197
v_mfma_f32_16x16x32_bf16 a[216:219], a[4:7], v[148:151], 0
ds_read_b64_tr_b16 v[252:253], v216 offset:12288
buffer_load_dwordx4 v226, s[36:39], s69 offen offset:0 lds
ds_read_b128 v[128:131], v229 offset:2048
v_cvt_pk_bf16_f32 v195, v198, v199
v_mul_f32 v203, s64, v203
v_mfma_f32_16x16x32_bf16 a[216:219], a[0:3], v[184:187], a[216:219]
ds_read_b64_tr_b16 v[254:255], v216 offset:14336
buffer_load_dwordx4 v227, s[36:39], s69 offen offset:1024 lds
ds_read_b128 v[132:135], v229 offset:3072
v_permlane16_swap_b32 v192, v194
v_mfma_f32_16x16x32_bf16 a[224:227], a[0:3], v[188:191], 0
s_add_u32 m0, s67, 32768
s_add_u32 s69, s76, s84
ds_read_b128 v[136:139], v229 offset:4096
v_mul_f32 v204, s64, v204
v_mfma_f32_16x16x32_bf16 a[224:227], a[4:7], v[152:155], a[224:227]
buffer_load_dwordx4 v226, s[36:39], s69 offen offset:0 lds
ds_read_b128 v[140:143], v229 offset:5120
v_permlane16_swap_b32 v193, v195
s_waitcnt lgkmcnt(10)
v_mfma_f32_16x16x32_bf16 a[212:215], a[8:11], v[180:183], 0
ds_read_b64_tr_b16 a[0:1], v217 offset:8192
buffer_load_dwordx4 v227, s[36:39], s69 offen offset:1024 lds
v_mfma_f32_16x16x32_bf16 a[212:215], a[12:15], v[144:147], a[212:215]
ds_read_b64_tr_b16 a[2:3], v217 offset:10240
ds_write_b64 v228, v[192:193] offset:6144
v_mul_f32 v205, s64, v205
v_mul_f32 v206, s64, v206
v_mfma_f32_16x16x32_bf16 a[220:223], a[12:15], v[148:151], 0
ds_read_b64_tr_b16 a[4:5], v217 offset:12288
v_mul_f32 v207, s64, v207
v_mfma_f32_16x16x32_bf16 a[220:223], a[8:11], v[184:187], a[220:223]
ds_read_b64_tr_b16 a[6:7], v217 offset:14336
ds_write_b64 v228, v[194:195] offset:6152
v_cvt_pk_bf16_f32 v196, v200, v201
v_cvt_pk_bf16_f32 v197, v202, v203
v_mfma_f32_16x16x32_bf16 a[228:231], a[8:11], v[188:191], 0
v_cvt_pk_bf16_f32 v198, v204, v205
v_cvt_pk_bf16_f32 v199, v206, v207
v_mfma_f32_16x16x32_bf16 a[228:231], a[12:15], v[152:155], a[228:231]
v_mul_f32 v208, s64, v208
s_waitcnt lgkmcnt(9)
v_mfma_f32_16x16x32_bf16 a[232:235], v[248:251], v[180:183], 0
ds_read_b64_tr_b16 a[8:9], v216 offset:16384
v_mul_f32 v209, s64, v209
v_mfma_f32_16x16x32_bf16 a[232:235], v[252:255], v[144:147], a[232:235]
ds_read_b64_tr_b16 a[10:11], v216 offset:18432
v_mul_f32 v210, s64, v210
v_mul_f32 v211, s64, v211
v_mfma_f32_16x16x32_bf16 a[240:243], v[252:255], v[148:151], 0
ds_read_b64_tr_b16 a[12:13], v216 offset:20480
v_mul_f32 v212, s64, v212
v_mfma_f32_16x16x32_bf16 a[240:243], v[248:251], v[184:187], a[240:243]
ds_read_b64_tr_b16 a[14:15], v216 offset:22528
v_mul_f32 v213, s64, v213
v_mul_f32 v214, s64, v214
v_mfma_f32_16x16x32_bf16 a[248:251], v[248:251], v[188:191], 0
v_permlane16_swap_b32 v196, v198
v_mfma_f32_16x16x32_bf16 a[248:251], v[252:255], v[152:155], a[248:251]
v_mul_f32 v215, s64, v215
s_waitcnt lgkmcnt(5)
v_mfma_f32_16x16x32_bf16 a[236:239], a[0:3], v[180:183], 0
ds_read_b64_tr_b16 v[248:249], v217 offset:16384
v_cvt_pk_bf16_f32 v200, v208, v209
v_mfma_f32_16x16x32_bf16 a[236:239], a[4:7], v[144:147], a[236:239]
ds_read_b64_tr_b16 v[250:251], v217 offset:18432
v_cvt_pk_bf16_f32 v201, v210, v211
v_mfma_f32_16x16x32_bf16 a[244:247], a[4:7], v[148:151], 0
ds_read_b64_tr_b16 v[252:253], v217 offset:20480
v_cvt_pk_bf16_f32 v202, v212, v213
v_cvt_pk_bf16_f32 v203, v214, v215
v_mfma_f32_16x16x32_bf16 a[244:247], a[0:3], v[184:187], a[244:247]
ds_read_b64_tr_b16 v[254:255], v217 offset:22528
v_mul_f32 v119, v240, v119
v_mfma_f32_16x16x32_bf16 a[252:255], a[0:3], v[188:191], 0
v_permlane16_swap_b32 v197, v199
v_mfma_f32_16x16x32_bf16 a[252:255], a[4:7], v[152:155], a[252:255]
v_permlane16_swap_b32 v200, v202
s_waitcnt vmcnt(8) lgkmcnt(4)
s_barrier
v_mfma_f32_16x16x32_bf16 v[0:3], a[8:11], v[180:183], 0
ds_read_b128 a[0:3], v222 offset:2048
s_add_u32 m0, s67, 90112
v_mfma_f32_16x16x32_bf16 v[0:3], a[12:15], v[144:147], v[0:3]
ds_read_b128 a[4:7], v223 offset:2048
s_add_u32 s69, s72, 294912
v_permlane16_swap_b32 v201, v203
v_mfma_f32_16x16x32_bf16 v[8:11], a[12:15], v[148:151], 0
buffer_load_dwordx4 v224, s[24:27], s69 offen offset:0 nt lds
buffer_load_dwordx4 v225, s[24:27], s69 offen offset:1024 nt lds
ds_write_b64 v228, v[196:197] offset:7168
v_fmac_f32 v116, v243, v140
v_mfma_f32_16x16x32_bf16 v[8:11], a[8:11], v[184:187], v[8:11]
s_add_u32 m0, s67, 98304
s_add_u32 s69, s73, 294912
v_fmac_f32 v117, v243, v141
v_fmac_f32 v118, v243, v142
v_mfma_f32_16x16x32_bf16 v[16:19], a[8:11], v[188:191], 0
buffer_load_dwordx4 v224, s[24:27], s69 offen offset:0 nt lds
buffer_load_dwordx4 v225, s[24:27], s69 offen offset:1024 nt lds
ds_write_b64 v228, v[198:199] offset:7176
v_fmac_f32 v119, v243, v143
v_mfma_f32_16x16x32_bf16 v[16:19], a[12:15], v[152:155], v[16:19]
v_mul_f32 v111, v239, v111
v_fmac_f32 v108, v242, v132
s_waitcnt lgkmcnt(4)
v_mfma_f32_16x16x32_bf16 v[4:7], v[248:251], v[180:183], 0
ds_read_b128 a[8:11], v222 offset:0
ds_write_b64 v228, v[200:201] offset:8192
v_fmac_f32 v109, v242, v133
v_mfma_f32_16x16x32_bf16 v[4:7], v[252:255], v[144:147], v[4:7]
ds_read_b128 a[12:15], v223 offset:0
v_fmac_f32 v110, v242, v134
v_fmac_f32 v111, v242, v135
v_mfma_f32_16x16x32_bf16 v[12:15], v[252:255], v[148:151], 0
ds_write_b64 v228, v[202:203] offset:8200
v_mul_f32 v103, v238, v103
v_mfma_f32_16x16x32_bf16 v[12:15], v[248:251], v[184:187], v[12:15]
v_fmac_f32 v100, v241, v124
v_fmac_f32 v101, v241, v125
v_mfma_f32_16x16x32_bf16 v[20:23], v[248:251], v[188:191], 0
v_fmac_f32 v102, v241, v126
v_fmac_f32 v103, v241, v127
v_mfma_f32_16x16x32_bf16 v[20:23], v[252:255], v[152:155], v[20:23]
v_mul_f32 v115, v240, v115
s_waitcnt lgkmcnt(6)
v_mfma_f32_16x16x32_bf16 v[140:143], a[0:3], a[24:27], 0
ds_read_b128 v[248:251], v222 offset:8192
s_waitcnt lgkmcnt(1)
s_barrier
v_fmac_f32 v112, v243, v136
v_mfma_f32_16x16x32_bf16 v[140:143], a[4:7], a[36:39], v[140:143]
ds_read_b128 v[252:255], v223 offset:8192
ds_read_b128 a[88:91], v230 offset:6144
v_fmac_f32 v113, v243, v137
v_mfma_f32_16x16x32_bf16 v[132:135], a[4:7], a[32:35], 0
ds_read_b128 a[100:103], v230 offset:16384
v_fmac_f32 v114, v243, v138
v_fmac_f32 v115, v243, v139
v_mfma_f32_16x16x32_bf16 v[132:135], a[0:3], a[20:23], v[132:135]
ds_read_b128 a[104:107], v230 offset:17408
v_mul_f32 v107, v239, v107
v_mfma_f32_16x16x32_bf16 v[124:127], a[0:3], a[16:19], 0
ds_read_b128 a[92:95], v230 offset:7168
v_fmac_f32 v104, v242, v128
v_fmac_f32 v105, v242, v129
v_mfma_f32_16x16x32_bf16 v[124:127], a[4:7], a[28:31], v[124:127]
ds_read_b128 a[96:99], v230 offset:8192
v_fmac_f32 v106, v242, v130
v_mfma_f32_16x16x32_bf16 v[136:139], a[8:11], a[24:27], 0
ds_read_b128 a[0:3], v222 offset:10240
ds_read_b128 a[108:111], v230 offset:18432
v_fmac_f32 v107, v242, v131
v_mfma_f32_16x16x32_bf16 v[136:139], a[12:15], a[36:39], v[136:139]
ds_read_b128 a[4:7], v223 offset:10240
v_mul_f32 v99, v238, v99
v_fmac_f32 v96, v241, v120
v_mfma_f32_16x16x32_bf16 v[128:131], a[12:15], a[32:35], 0
v_fmac_f32 v97, v241, v121
v_fmac_f32 v98, v241, v122
v_mfma_f32_16x16x32_bf16 v[128:131], a[8:11], a[20:23], v[128:131]
v_fmac_f32 v99, v241, v123
v_cvt_pk_bf16_f32 v116, v116, v117
v_mfma_f32_16x16x32_bf16 v[120:123], a[8:11], a[16:19], 0
v_cvt_pk_bf16_f32 v118, v118, v119
v_accvgpr_write_b32 a206, v116
v_mfma_f32_16x16x32_bf16 v[120:123], a[12:15], a[28:31], v[120:123]
s_waitcnt vmcnt(8) lgkmcnt(1)
s_barrier
v_mfma_f32_16x16x32_bf16 v[120:123], v[248:251], a[40:43], v[120:123]
ds_read_b128 a[8:11], v222 offset:18432
s_add_u32 m0, s67, 106496
v_mfma_f32_16x16x32_bf16 v[120:123], v[252:255], a[52:55], v[120:123]
ds_read_b128 a[12:15], v223 offset:18432
s_add_u32 s69, s74, 294912
v_mfma_f32_16x16x32_bf16 v[128:131], v[252:255], a[56:59], v[128:131]
buffer_load_dwordx4 v224, s[24:27], s69 offen offset:0 nt lds
buffer_load_dwordx4 v225, s[24:27], s69 offen offset:1024 nt lds
v_mfma_f32_16x16x32_bf16 v[128:131], v[248:251], a[44:47], v[128:131]
s_add_u32 m0, s67, 114688
s_add_u32 s69, s75, 294912
v_mfma_f32_16x16x32_bf16 v[136:139], v[248:251], a[48:51], v[136:139]
buffer_load_dwordx4 v224, s[24:27], s69 offen offset:0 nt lds
buffer_load_dwordx4 v225, s[24:27], s69 offen offset:1024 nt lds
v_mfma_f32_16x16x32_bf16 v[136:139], v[252:255], a[60:63], v[136:139]
ds_write_b64 v228, v[156:157] offset:6144
v_accvgpr_write_b32 a207, v118
s_waitcnt lgkmcnt(3)
v_mfma_f32_16x16x32_bf16 v[124:127], a[0:3], a[40:43], v[124:127]
ds_read_b128 v[248:251], v222 offset:16384
v_cvt_pk_bf16_f32 v108, v108, v109
v_mfma_f32_16x16x32_bf16 v[124:127], a[4:7], a[52:55], v[124:127]
ds_read_b128 v[252:255], v223 offset:16384
ds_write_b64 v228, v[158:159] offset:6152
v_cvt_pk_bf16_f32 v110, v110, v111
v_mfma_f32_16x16x32_bf16 v[132:135], a[4:7], a[56:59], v[132:135]
v_accvgpr_write_b32 a202, v108
v_accvgpr_write_b32 a203, v110
v_mfma_f32_16x16x32_bf16 v[132:135], a[0:3], a[44:47], v[132:135]
ds_write_b64 v228, v[160:161] offset:7168
v_cvt_pk_bf16_f32 v100, v100, v101
v_mfma_f32_16x16x32_bf16 v[140:143], a[0:3], a[48:51], v[140:143]
v_cvt_pk_bf16_f32 v102, v102, v103
v_accvgpr_write_b32 a198, v100
v_mfma_f32_16x16x32_bf16 v[140:143], a[4:7], a[60:63], v[140:143]
ds_write_b64 v228, v[162:163] offset:7176
s_waitcnt lgkmcnt(6)
v_mfma_f32_16x16x32_bf16 v[140:143], a[8:11], a[72:75], v[140:143]
ds_read_b128 a[0:3], v222 offset:24576
v_accvgpr_write_b32 a199, v102
v_mfma_f32_16x16x32_bf16 v[140:143], a[12:15], a[84:87], v[140:143]
ds_read_b128 a[4:7], v223 offset:24576
ds_write_b64 v228, v[164:165] offset:8192
v_mfma_f32_16x16x32_bf16 v[132:135], a[12:15], a[80:83], v[132:135]
v_cvt_pk_bf16_f32 v112, v112, v113
v_cvt_pk_bf16_f32 v114, v114, v115
v_mfma_f32_16x16x32_bf16 v[132:135], a[8:11], a[68:71], v[132:135]
ds_write_b64 v228, v[166:167] offset:8200
v_accvgpr_write_b32 a204, v112
v_mfma_f32_16x16x32_bf16 v[124:127], a[8:11], a[64:67], v[124:127]
v_accvgpr_write_b32 a205, v114
v_cvt_pk_bf16_f32 v104, v104, v105
v_mfma_f32_16x16x32_bf16 v[124:127], a[12:15], a[76:79], v[124:127]
v_cvt_pk_bf16_f32 v106, v106, v107
s_waitcnt lgkmcnt(7)
v_mfma_f32_16x16x32_bf16 v[136:139], v[248:251], a[72:75], v[136:139]
ds_read_b128 a[8:11], v222 offset:26624
v_accvgpr_write_b32 a200, v104
v_mfma_f32_16x16x32_bf16 v[136:139], v[252:255], a[84:87], v[136:139]
ds_read_b128 a[12:15], v223 offset:26624
v_accvgpr_write_b32 a201, v106
v_mfma_f32_16x16x32_bf16 v[128:131], v[252:255], a[80:83], v[128:131]
v_cvt_pk_bf16_f32 v96, v96, v97
v_cvt_pk_bf16_f32 v98, v98, v99
v_mfma_f32_16x16x32_bf16 v[128:131], v[248:251], a[68:71], v[128:131]
v_accvgpr_write_b32 a196, v96
v_accvgpr_write_b32 a197, v98
v_mfma_f32_16x16x32_bf16 v[120:123], v[248:251], a[64:67], v[120:123]
v_mfma_f32_16x16x32_bf16 v[120:123], v[252:255], a[76:79], v[120:123]
s_waitcnt vmcnt(8) lgkmcnt(4)
s_barrier
v_mfma_f32_16x16x32_bf16 v[120:123], a[0:3], a[88:91], v[120:123]
ds_read_b64_tr_b16 v[248:249], v216 offset:24576
s_add_u32 m0, s67, 40960
v_mfma_f32_16x16x32_bf16 v[120:123], a[4:7], a[100:103], v[120:123]
ds_read_b64_tr_b16 v[250:251], v216 offset:26624
s_add_u32 s69, s76, s85
v_mfma_f32_16x16x32_bf16 v[128:131], a[4:7], a[104:107], v[128:131]
ds_read_b64_tr_b16 v[252:253], v216 offset:28672
buffer_load_dwordx4 v226, s[36:39], s69 offen offset:0 lds
v_mfma_f32_16x16x32_bf16 v[128:131], a[0:3], a[92:95], v[128:131]
ds_read_b64_tr_b16 v[254:255], v216 offset:30720
buffer_load_dwordx4 v227, s[36:39], s69 offen offset:1024 lds
v_mfma_f32_16x16x32_bf16 v[136:139], a[0:3], a[96:99], v[136:139]
s_add_u32 m0, s67, 49152
s_add_u32 s69, s76, s86
v_max3_f32 v244, v120, v121, v122
v_mfma_f32_16x16x32_bf16 v[136:139], a[4:7], a[108:111], v[136:139]
buffer_load_dwordx4 v226, s[36:39], s69 offen offset:0 lds
s_waitcnt lgkmcnt(4)
v_mfma_f32_16x16x32_bf16 v[124:127], a[8:11], a[88:91], v[124:127]
ds_read_b64_tr_b16 a[0:1], v217 offset:24576
buffer_load_dwordx4 v227, s[36:39], s69 offen offset:1024 lds
v_max3_f32 v245, v128, v129, v130
v_mfma_f32_16x16x32_bf16 v[124:127], a[12:15], a[100:103], v[124:127]
ds_read_b64_tr_b16 a[2:3], v217 offset:26624
s_add_u32 m0, s67, 57344
v_mfma_f32_16x16x32_bf16 v[132:135], a[12:15], a[104:107], v[132:135]
ds_read_b64_tr_b16 a[4:5], v217 offset:28672
s_add_u32 s69, s72, 327680
v_max3_f32 v231, v136, v137, v138
v_mfma_f32_16x16x32_bf16 v[132:135], a[8:11], a[92:95], v[132:135]
ds_read_b64_tr_b16 a[6:7], v217 offset:30720
buffer_load_dwordx4 v224, s[24:27], s69 offen offset:0 nt lds
v_mfma_f32_16x16x32_bf16 v[140:143], a[8:11], a[96:99], v[140:143]
buffer_load_dwordx4 v225, s[24:27], s69 offen offset:1024 nt lds
v_max3_f32 v244, v123, v124, v244
v_max3_f32 v244, v125, v126, v244
v_mfma_f32_16x16x32_bf16 v[140:143], a[12:15], a[108:111], v[140:143]
v_max_f32 v244, v127, v244
s_waitcnt lgkmcnt(4)
v_mfma_f32_16x16x32_bf16 v[24:27], v[248:251], v[180:183], 0
ds_read_b64_tr_b16 a[8:9], v216 offset:32768
v_max3_f32 v245, v131, v132, v245
v_mfma_f32_16x16x32_bf16 v[24:27], v[252:255], v[144:147], v[24:27]
ds_read_b64_tr_b16 a[10:11], v216 offset:34816
v_max3_f32 v245, v133, v134, v245
v_mfma_f32_16x16x32_bf16 v[32:35], v[252:255], v[148:151], 0
ds_read_b64_tr_b16 a[12:13], v216 offset:36864
v_max3_f32 v231, v139, v140, v231
v_mfma_f32_16x16x32_bf16 v[32:35], v[248:251], v[184:187], v[32:35]
ds_read_b64_tr_b16 a[14:15], v216 offset:38912
v_max3_f32 v231, v141, v142, v231
v_mfma_f32_16x16x32_bf16 v[40:43], v[248:251], v[188:191], 0
v_max_f32 v245, v135, v245
v_max_f32 v231, v143, v231
v_mfma_f32_16x16x32_bf16 v[40:43], v[252:255], v[152:155], v[40:43]
v_max3_f32 v244, abs(v244), abs(v245), abs(v231)
s_waitcnt lgkmcnt(4)
v_mfma_f32_16x16x32_bf16 v[28:31], a[0:3], v[180:183], 0
ds_read_b64_tr_b16 v[248:249], v217 offset:32768
v_mfma_f32_16x16x32_bf16 v[28:31], a[4:7], v[144:147], v[28:31]
ds_read_b64_tr_b16 v[250:251], v217 offset:34816
v_cmp_lt_f32 vcc, s65, v244
s_cbranch_vccnz L_rare1_0
L_back1_0:
v_mfma_f32_16x16x32_bf16 v[36:39], a[4:7], v[148:151], 0
ds_read_b64_tr_b16 v[252:253], v217 offset:36864
v_mfma_f32_16x16x32_bf16 v[36:39], a[0:3], v[184:187], v[36:39]
ds_read_b64_tr_b16 v[254:255], v217 offset:38912
v_exp_f32 v120, v120
v_mfma_f32_16x16x32_bf16 v[44:47], a[0:3], v[188:191], 0
v_exp_f32 v121, v121
v_mfma_f32_16x16x32_bf16 v[44:47], a[4:7], v[152:155], v[44:47]
s_waitcnt vmcnt(10) lgkmcnt(4)
s_barrier
v_mfma_f32_16x16x32_bf16 v[48:51], a[8:11], v[180:183], 0
ds_read_b128 a[0:3], v222 offset:34816
s_add_u32 m0, s67, 65536
v_exp_f32 v122, v122
v_mfma_f32_16x16x32_bf16 v[48:51], a[12:15], v[144:147], v[48:51]
ds_read_b128 a[4:7], v223 offset:34816
s_add_u32 s69, s73, 327680
v_mfma_f32_16x16x32_bf16 v[56:59], a[12:15], v[148:151], 0
buffer_load_dwordx4 v224, s[24:27], s69 offen offset:0 nt lds
buffer_load_dwordx4 v225, s[24:27], s69 offen offset:1024 nt lds
v_exp_f32 v123, v123
v_mfma_f32_16x16x32_bf16 v[56:59], a[8:11], v[184:187], v[56:59]
v_exp_f32 v124, v124
v_mfma_f32_16x16x32_bf16 v[64:67], a[8:11], v[188:191], 0
v_exp_f32 v125, v125
v_mfma_f32_16x16x32_bf16 v[64:67], a[12:15], v[152:155], v[64:67]
v_cvt_pk_bf16_f32 v120, v120, v121
s_waitcnt lgkmcnt(2)
v_mfma_f32_16x16x32_bf16 v[52:55], v[248:251], v[180:183], 0
ds_read_b128 a[8:11], v222 offset:32768
v_cvt_pk_bf16_f32 v122, v122, v123
v_mfma_f32_16x16x32_bf16 v[52:55], v[252:255], v[144:147], v[52:55]
ds_read_b128 a[12:15], v223 offset:32768
v_cvt_pk_bf16_f32 v124, v124, v125
v_mfma_f32_16x16x32_bf16 v[60:63], v[252:255], v[148:151], 0
v_exp_f32 v126, v126
v_mfma_f32_16x16x32_bf16 v[60:63], v[248:251], v[184:187], v[60:63]
v_exp_f32 v127, v127
v_mfma_f32_16x16x32_bf16 v[68:71], v[248:251], v[188:191], 0
v_exp_f32 v128, v128
v_mfma_f32_16x16x32_bf16 v[68:71], v[252:255], v[152:155], v[68:71]
v_cvt_pk_bf16_f32 v126, v126, v127
s_waitcnt lgkmcnt(2)
v_mfma_f32_16x16x32_bf16 v[116:119], a[0:3], a[24:27], 0
ds_read_b128 v[248:251], v222 offset:40960
v_accvgpr_write_b32 a112, v120
v_mfma_f32_16x16x32_bf16 v[116:119], a[4:7], a[36:39], v[116:119]
ds_read_b128 v[252:255], v223 offset:40960
v_accvgpr_write_b32 a113, v122
v_mfma_f32_16x16x32_bf16 v[108:111], a[4:7], a[32:35], 0
v_exp_f32 v129, v129
v_mfma_f32_16x16x32_bf16 v[108:111], a[0:3], a[20:23], v[108:111]
v_exp_f32 v130, v130
v_mfma_f32_16x16x32_bf16 v[100:103], a[0:3], a[16:19], 0
v_exp_f32 v131, v131
v_mfma_f32_16x16x32_bf16 v[100:103], a[4:7], a[28:31], v[100:103]
v_cvt_pk_bf16_f32 v128, v128, v129
s_waitcnt lgkmcnt(2)
v_mfma_f32_16x16x32_bf16 v[112:115], a[8:11], a[24:27], 0
ds_read_b128 a[0:3], v222 offset:43008
v_cvt_pk_bf16_f32 v130, v130, v131
v_mfma_f32_16x16x32_bf16 v[112:115], a[12:15], a[36:39], v[112:115]
ds_read_b128 a[4:7], v223 offset:43008
v_accvgpr_write_b32 a114, v124
v_mfma_f32_16x16x32_bf16 v[104:107], a[12:15], a[32:35], 0
v_exp_f32 v132, v132
v_mfma_f32_16x16x32_bf16 v[104:107], a[8:11], a[20:23], v[104:107]
v_exp_f32 v133, v133
v_mfma_f32_16x16x32_bf16 v[96:99], a[8:11], a[16:19], 0
v_exp_f32 v134, v134
v_mfma_f32_16x16x32_bf16 v[96:99], a[12:15], a[28:31], v[96:99]
s_waitcnt vmcnt(8) lgkmcnt(2)
s_barrier
v_mfma_f32_16x16x32_bf16 v[96:99], v[248:251], a[40:43], v[96:99]
ds_read_b128 a[8:11], v222 offset:51200
s_add_u32 m0, s67, 73728
v_mfma_f32_16x16x32_bf16 v[96:99], v[252:255], a[52:55], v[96:99]
ds_read_b128 a[12:15], v223 offset:51200
s_add_u32 s69, s74, 327680
v_mfma_f32_16x16x32_bf16 v[104:107], v[252:255], a[56:59], v[104:107]
buffer_load_dwordx4 v224, s[24:27], s69 offen offset:0 nt lds
buffer_load_dwordx4 v225, s[24:27], s69 offen offset:1024 nt lds
v_mfma_f32_16x16x32_bf16 v[104:107], v[248:251], a[44:47], v[104:107]
s_add_u32 m0, s67, 81920
s_add_u32 s69, s75, 327680
v_mfma_f32_16x16x32_bf16 v[112:115], v[248:251], a[48:51], v[112:115]
buffer_load_dwordx4 v224, s[24:27], s69 offen offset:0 nt lds
buffer_load_dwordx4 v225, s[24:27], s69 offen offset:1024 nt lds
v_exp_f32 v135, v135
v_mfma_f32_16x16x32_bf16 v[112:115], v[252:255], a[60:63], v[112:115]
v_cvt_pk_bf16_f32 v132, v132, v133
s_waitcnt lgkmcnt(2)
v_mfma_f32_16x16x32_bf16 v[100:103], a[0:3], a[40:43], v[100:103]
ds_read_b128 v[248:251], v222 offset:49152
v_cvt_pk_bf16_f32 v134, v134, v135
v_mfma_f32_16x16x32_bf16 v[100:103], a[4:7], a[52:55], v[100:103]
ds_read_b128 v[252:255], v223 offset:49152
v_accvgpr_write_b32 a115, v126
v_mfma_f32_16x16x32_bf16 v[108:111], a[4:7], a[56:59], v[108:111]
v_exp_f32 v136, v136
v_mfma_f32_16x16x32_bf16 v[108:111], a[0:3], a[44:47], v[108:111]
v_exp_f32 v137, v137
v_mfma_f32_16x16x32_bf16 v[116:119], a[0:3], a[48:51], v[116:119]
v_exp_f32 v138, v138
v_mfma_f32_16x16x32_bf16 v[116:119], a[4:7], a[60:63], v[116:119]
v_cvt_pk_bf16_f32 v136, v136, v137
s_waitcnt lgkmcnt(2)
v_mfma_f32_16x16x32_bf16 v[116:119], a[8:11], a[72:75], v[116:119]
ds_read_b128 a[0:3], v222 offset:57344
v_accvgpr_write_b32 a116, v128
v_mfma_f32_16x16x32_bf16 v[116:119], a[12:15], a[84:87], v[116:119]
ds_read_b128 a[4:7], v223 offset:57344
v_accvgpr_write_b32 a117, v130
v_mfma_f32_16x16x32_bf16 v[108:111], a[12:15], a[80:83], v[108:111]
v_exp_f32 v139, v139
v_mfma_f32_16x16x32_bf16 v[108:111], a[8:11], a[68:71], v[108:111]
v_exp_f32 v140, v140
v_mfma_f32_16x16x32_bf16 v[100:103], a[8:11], a[64:67], v[100:103]
v_exp_f32 v141, v141
v_mfma_f32_16x16x32_bf16 v[100:103], a[12:15], a[76:79], v[100:103]
v_cvt_pk_bf16_f32 v138, v138, v139
s_waitcnt lgkmcnt(2)
v_mfma_f32_16x16x32_bf16 v[112:115], v[248:251], a[72:75], v[112:115]
ds_read_b128 a[8:11], v222 offset:59392
v_cvt_pk_bf16_f32 v140, v140, v141
v_mfma_f32_16x16x32_bf16 v[112:115], v[252:255], a[84:87], v[112:115]
ds_read_b128 a[12:15], v223 offset:59392
v_accvgpr_write_b32 a118, v132
v_mfma_f32_16x16x32_bf16 v[104:107], v[252:255], a[80:83], v[104:107]
v_exp_f32 v142, v142
v_mfma_f32_16x16x32_bf16 v[104:107], v[248:251], a[68:71], v[104:107]
v_exp_f32 v143, v143
v_mfma_f32_16x16x32_bf16 v[96:99], v[248:251], a[64:67], v[96:99]
v_cvt_pk_bf16_f32 v142, v142, v143
v_accvgpr_write_b32 a119, v134
v_mfma_f32_16x16x32_bf16 v[96:99], v[252:255], a[76:79], v[96:99]
s_waitcnt vmcnt(8) lgkmcnt(2)
s_barrier
v_mfma_f32_16x16x32_bf16 v[96:99], a[0:3], a[88:91], v[96:99]
ds_read_b64_tr_b16 v[248:249], v216 offset:40960
s_add_u32 m0, s67, 0
v_mfma_f32_16x16x32_bf16 v[96:99], a[4:7], a[100:103], v[96:99]
ds_read_b64_tr_b16 v[250:251], v216 offset:43008
s_add_u32 s69, s77, s80
v_mfma_f32_16x16x32_bf16 v[104:107], a[4:7], a[104:107], v[104:107]
ds_read_b64_tr_b16 v[252:253], v216 offset:45056
buffer_load_dwordx4 v226, s[36:39], s69 offen offset:0 lds
v_mfma_f32_16x16x32_bf16 v[104:107], a[0:3], a[92:95], v[104:107]
ds_read_b64_tr_b16 v[254:255], v216 offset:47104
buffer_load_dwordx4 v227, s[36:39], s69 offen offset:1024 lds
v_accvgpr_write_b32 a120, v136
v_mfma_f32_16x16x32_bf16 v[112:115], a[0:3], a[96:99], v[112:115]
s_add_u32 m0, s67, 8192
s_add_u32 s69, s77, s81
v_accvgpr_write_b32 a121, v138
v_mfma_f32_16x16x32_bf16 v[112:115], a[4:7], a[108:111], v[112:115]
buffer_load_dwordx4 v226, s[36:39], s69 offen offset:0 lds
v_accvgpr_write_b32 a122, v140
s_waitcnt lgkmcnt(4)
v_mfma_f32_16x16x32_bf16 v[100:103], a[8:11], a[88:91], v[100:103]
ds_read_b64_tr_b16 a[0:1], v217 offset:40960
buffer_load_dwordx4 v227, s[36:39], s69 offen offset:1024 lds
v_accvgpr_write_b32 a123, v142
v_mfma_f32_16x16x32_bf16 v[100:103], a[12:15], a[100:103], v[100:103]
ds_read_b64_tr_b16 a[2:3], v217 offset:43008
s_add_u32 m0, s67, 16384
v_max3_f32 v244, v96, v97, v98
v_mfma_f32_16x16x32_bf16 v[108:111], a[12:15], a[104:107], v[108:111]
ds_read_b64_tr_b16 a[4:5], v217 offset:45056
s_add_u32 s69, s77, s82
v_mfma_f32_16x16x32_bf16 v[108:111], a[8:11], a[92:95], v[108:111]
ds_read_b64_tr_b16 a[6:7], v217 offset:47104
buffer_load_dwordx4 v226, s[36:39], s69 offen offset:0 lds
v_mfma_f32_16x16x32_bf16 v[116:119], a[8:11], a[96:99], v[116:119]
buffer_load_dwordx4 v227, s[36:39], s69 offen offset:1024 lds
v_max3_f32 v244, v99, v100, v244
v_max3_f32 v244, v101, v102, v244
v_mfma_f32_16x16x32_bf16 v[116:119], a[12:15], a[108:111], v[116:119]
v_max3_f32 v244, v103, v104, v244
s_waitcnt lgkmcnt(4)
v_mfma_f32_16x16x32_bf16 v[72:75], v[248:251], v[180:183], 0
ds_read_b64_tr_b16 a[8:9], v216 offset:49152
v_max3_f32 v244, v105, v106, v244
v_mfma_f32_16x16x32_bf16 v[72:75], v[252:255], v[144:147], v[72:75]
ds_read_b64_tr_b16 a[10:11], v216 offset:51200
v_max3_f32 v244, v107, v108, v244
v_mfma_f32_16x16x32_bf16 v[80:83], v[252:255], v[148:151], 0
ds_read_b64_tr_b16 a[12:13], v216 offset:53248
v_max3_f32 v244, v109, v110, v244
v_mfma_f32_16x16x32_bf16 v[80:83], v[248:251], v[184:187], v[80:83]
ds_read_b64_tr_b16 a[14:15], v216 offset:55296
v_max3_f32 v244, v111, v112, v244
v_mfma_f32_16x16x32_bf16 v[88:91], v[248:251], v[188:191], 0
v_max3_f32 v244, v113, v114, v244
v_max3_f32 v244, v115, v116, v244
v_mfma_f32_16x16x32_bf16 v[88:91], v[252:255], v[152:155], v[88:91]
v_max3_f32 v244, v117, v118, v244
s_waitcnt lgkmcnt(4)
v_mfma_f32_16x16x32_bf16 v[76:79], a[0:3], v[180:183], 0
ds_read_b64_tr_b16 v[248:249], v217 offset:49152
v_max_f32 v244, v119, v244
v_mfma_f32_16x16x32_bf16 v[76:79], a[4:7], v[144:147], v[76:79]
ds_read_b64_tr_b16 v[250:251], v217 offset:51200
v_mfma_f32_16x16x32_bf16 v[84:87], a[4:7], v[148:151], 0
ds_read_b64_tr_b16 v[252:253], v217 offset:53248
v_cmp_lt_f32 vcc, s65, v244
s_cbranch_vccnz L_rare1_1
L_back1_1:
v_mfma_f32_16x16x32_bf16 v[84:87], a[0:3], v[184:187], v[84:87]
ds_read_b64_tr_b16 v[254:255], v217 offset:55296
v_mfma_f32_16x16x32_bf16 v[92:95], a[0:3], v[188:191], 0
v_exp_f32 v96, v96
v_mfma_f32_16x16x32_bf16 v[92:95], a[4:7], v[152:155], v[92:95]
s_waitcnt vmcnt(10) lgkmcnt(4)
s_barrier
v_mfma_f32_16x16x32_bf16 v[192:195], a[8:11], v[180:183], 0
ds_read_b128 a[0:3], v222 offset:2048
s_add_u32 m0, s67, 90112
v_exp_f32 v97, v97
v_mfma_f32_16x16x32_bf16 v[192:195], a[12:15], v[144:147], v[192:195]
ds_read_b128 a[4:7], v223 offset:2048
s_add_u32 s69, s72, 360448
v_cvt_pk_bf16_f32 v96, v96, v97
v_mfma_f32_16x16x32_bf16 v[200:203], a[12:15], v[148:151], 0
buffer_load_dwordx4 v224, s[24:27], s69 offen offset:0 nt lds
buffer_load_dwordx4 v225, s[24:27], s69 offen offset:1024 nt lds
v_accvgpr_write_b32 a124, v96
v_mfma_f32_16x16x32_bf16 v[200:203], a[8:11], v[184:187], v[200:203]
s_add_u32 m0, s67, 98304
s_add_u32 s69, s73, 360448
v_exp_f32 v98, v98
v_mfma_f32_16x16x32_bf16 v[208:211], a[8:11], v[188:191], 0
buffer_load_dwordx4 v224, s[24:27], s69 offen offset:0 nt lds
buffer_load_dwordx4 v225, s[24:27], s69 offen offset:1024 nt lds
v_mfma_f32_16x16x32_bf16 v[208:211], a[12:15], v[152:155], v[208:211]
v_exp_f32 v99, v99
s_waitcnt lgkmcnt(2)
v_mfma_f32_16x16x32_bf16 v[196:199], v[248:251], v[180:183], 0
ds_read_b128 a[8:11], v222 offset:0
ds_read_b128 v[180:183], v230 offset:6144
v_cvt_pk_bf16_f32 v98, v98, v99
v_mfma_f32_16x16x32_bf16 v[196:199], v[252:255], v[144:147], v[196:199]
ds_read_b128 a[12:15], v223 offset:0
ds_read_b128 v[144:147], v230 offset:16384
v_accvgpr_write_b32 a125, v98
v_mfma_f32_16x16x32_bf16 v[204:207], v[252:255], v[148:151], 0
ds_read_b128 v[148:151], v230 offset:17408
v_mfma_f32_16x16x32_bf16 v[204:207], v[248:251], v[184:187], v[204:207]
ds_read_b128 v[184:187], v230 offset:7168
v_exp_f32 v100, v100
v_mfma_f32_16x16x32_bf16 v[212:215], v[248:251], v[188:191], 0
ds_read_b128 v[188:191], v230 offset:8192
v_mfma_f32_16x16x32_bf16 v[212:215], v[252:255], v[152:155], v[212:215]
ds_read_b128 v[152:155], v230 offset:18432
v_exp_f32 v101, v101
s_waitcnt lgkmcnt(8)
v_mfma_f32_16x16x32_bf16 v[140:143], a[0:3], a[24:27], 0
ds_read_b128 v[248:251], v222 offset:8192
v_cvt_pk_bf16_f32 v100, v100, v101
v_mfma_f32_16x16x32_bf16 v[140:143], a[4:7], a[36:39], v[140:143]
ds_read_b128 v[252:255], v223 offset:8192
v_accvgpr_write_b32 a126, v100
v_mfma_f32_16x16x32_bf16 v[132:135], a[4:7], a[32:35], 0
v_exp_f32 v102, v102
v_mfma_f32_16x16x32_bf16 v[132:135], a[0:3], a[20:23], v[132:135]
v_exp_f32 v103, v103
v_mfma_f32_16x16x32_bf16 v[124:127], a[0:3], a[16:19], 0
v_exp_f32 v104, v104
v_mfma_f32_16x16x32_bf16 v[124:127], a[4:7], a[28:31], v[124:127]
v_cvt_pk_bf16_f32 v102, v102, v103
s_waitcnt lgkmcnt(7)
v_mfma_f32_16x16x32_bf16 v[136:139], a[8:11], a[24:27], 0
ds_read_b128 a[0:3], v222 offset:10240
v_accvgpr_write_b32 a127, v102
v_mfma_f32_16x16x32_bf16 v[136:139], a[12:15], a[36:39], v[136:139]
ds_read_b128 a[4:7], v223 offset:10240
v_mfma_f32_16x16x32_bf16 v[128:131], a[12:15], a[32:35], 0
v_exp_f32 v105, v105
v_mfma_f32_16x16x32_bf16 v[128:131], a[8:11], a[20:23], v[128:131]
v_exp_f32 v106, v106
v_mfma_f32_16x16x32_bf16 v[120:123], a[8:11], a[16:19], 0
v_exp_f32 v107, v107
v_mfma_f32_16x16x32_bf16 v[120:123], a[12:15], a[28:31], v[120:123]
s_waitcnt vmcnt(10) lgkmcnt(2)
s_barrier
v_mfma_f32_16x16x32_bf16 v[120:123], v[248:251], a[40:43], v[120:123]
ds_read_b128 a[8:11], v222 offset:18432
s_add_u32 m0, s67, 106496
v_mfma_f32_16x16x32_bf16 v[120:123], v[252:255], a[52:55], v[120:123]
ds_read_b128 a[12:15], v223 offset:18432
s_add_u32 s69, s74, 360448
v_mfma_f32_16x16x32_bf16 v[128:131], v[252:255], a[56:59], v[128:131]
buffer_load_dwordx4 v224, s[24:27], s69 offen offset:0 nt lds
buffer_load_dwordx4 v225, s[24:27], s69 offen offset:1024 nt lds
v_cvt_pk_bf16_f32 v104, v104, v105
v_mfma_f32_16x16x32_bf16 v[128:131], v[248:251], a[44:47], v[128:131]
s_add_u32 m0, s67, 114688
s_add_u32 s69, s75, 360448
v_cvt_pk_bf16_f32 v106, v106, v107
v_mfma_f32_16x16x32_bf16 v[136:139], v[248:251], a[48:51], v[136:139]
buffer_load_dwordx4 v224, s[24:27], s69 offen offset:0 nt lds
buffer_load_dwordx4 v225, s[24:27], s69 offen offset:1024 nt lds
v_exp_f32 v108, v108
v_mfma_f32_16x16x32_bf16 v[136:139], v[252:255], a[60:63], v[136:139]
ds_write_b64 v228, v[168:169] offset:6144
s_waitcnt lgkmcnt(3)
v_mfma_f32_16x16x32_bf16 v[124:127], a[0:3], a[40:43], v[124:127]
ds_read_b128 v[248:251], v222 offset:16384
v_accvgpr_write_b32 a128, v104
v_mfma_f32_16x16x32_bf16 v[124:127], a[4:7], a[52:55], v[124:127]
ds_read_b128 v[252:255], v223 offset:16384
ds_write_b64 v228, v[170:171] offset:6152
v_exp_f32 v109, v109
v_mfma_f32_16x16x32_bf16 v[132:135], a[4:7], a[56:59], v[132:135]
v_exp_f32 v110, v110
v_mfma_f32_16x16x32_bf16 v[132:135], a[0:3], a[44:47], v[132:135]
ds_write_b64 v228, v[172:173] offset:7168
v_cvt_pk_bf16_f32 v108, v108, v109
v_mfma_f32_16x16x32_bf16 v[140:143], a[0:3], a[48:51], v[140:143]
v_exp_f32 v111, v111
v_mfma_f32_16x16x32_bf16 v[140:143], a[4:7], a[60:63], v[140:143]
ds_write_b64 v228, v[174:175] offset:7176
s_waitcnt lgkmcnt(6)
v_mfma_f32_16x16x32_bf16 v[140:143], a[8:11], a[72:75], v[140:143]
ds_read_b128 a[0:3], v222 offset:24576
v_cvt_pk_bf16_f32 v110, v110, v111
v_mfma_f32_16x16x32_bf16 v[140:143], a[12:15], a[84:87], v[140:143]
ds_read_b128 a[4:7], v223 offset:24576
ds_write_b64 v228, v[176:177] offset:8192
v_accvgpr_write_b32 a129, v106
v_mfma_f32_16x16x32_bf16 v[132:135], a[12:15], a[80:83], v[132:135]
v_exp_f32 v112, v112
v_mfma_f32_16x16x32_bf16 v[132:135], a[8:11], a[68:71], v[132:135]
ds_write_b64 v228, v[178:179] offset:8200
v_accvgpr_write_b32 a130, v108
v_mfma_f32_16x16x32_bf16 v[124:127], a[8:11], a[64:67], v[124:127]
v_exp_f32 v113, v113
v_mfma_f32_16x16x32_bf16 v[124:127], a[12:15], a[76:79], v[124:127]
v_cvt_pk_bf16_f32 v112, v112, v113
s_waitcnt lgkmcnt(7)
v_mfma_f32_16x16x32_bf16 v[136:139], v[248:251], a[72:75], v[136:139]
ds_read_b128 a[8:11], v222 offset:26624
v_accvgpr_write_b32 a131, v110
v_mfma_f32_16x16x32_bf16 v[136:139], v[252:255], a[84:87], v[136:139]
ds_read_b128 a[12:15], v223 offset:26624
v_accvgpr_write_b32 a132, v112
v_mfma_f32_16x16x32_bf16 v[128:131], v[252:255], a[80:83], v[128:131]
v_exp_f32 v114, v114
v_mfma_f32_16x16x32_bf16 v[128:131], v[248:251], a[68:71], v[128:131]
v_exp_f32 v115, v115
v_mfma_f32_16x16x32_bf16 v[120:123], v[248:251], a[64:67], v[120:123]
v_exp_f32 v116, v116
v_mfma_f32_16x16x32_bf16 v[120:123], v[252:255], a[76:79], v[120:123]
s_waitcnt vmcnt(8) lgkmcnt(4)
s_barrier
v_mfma_f32_16x16x32_bf16 v[120:123], a[0:3], a[88:91], v[120:123]
ds_read_b64_tr_b16 v[248:249], v216 offset:0
s_add_u32 m0, s67, 24576
v_mfma_f32_16x16x32_bf16 v[120:123], a[4:7], a[100:103], v[120:123]
ds_read_b64_tr_b16 v[250:251], v216 offset:2048
s_add_u32 s69, s77, s83
v_mfma_f32_16x16x32_bf16 v[128:131], a[4:7], a[104:107], v[128:131]
ds_read_b64_tr_b16 v[252:253], v216 offset:4096
buffer_load_dwordx4 v226, s[36:39], s69 offen offset:0 lds
v_mfma_f32_16x16x32_bf16 v[128:131], a[0:3], a[92:95], v[128:131]
ds_read_b64_tr_b16 v[254:255], v216 offset:6144
buffer_load_dwordx4 v227, s[36:39], s69 offen offset:1024 lds
v_exp_f32 v117, v117
v_mfma_f32_16x16x32_bf16 v[136:139], a[0:3], a[96:99], v[136:139]
s_add_u32 m0, s67, 32768
s_add_u32 s69, s77, s84
v_cvt_pk_bf16_f32 v114, v114, v115
v_mfma_f32_16x16x32_bf16 v[136:139], a[4:7], a[108:111], v[136:139]
buffer_load_dwordx4 v226, s[36:39], s69 offen offset:0 lds
v_cvt_pk_bf16_f32 v116, v116, v117
s_waitcnt lgkmcnt(4)
v_mfma_f32_16x16x32_bf16 v[124:127], a[8:11], a[88:91], v[124:127]
ds_read_b64_tr_b16 a[0:1], v217 offset:0
buffer_load_dwordx4 v227, s[36:39], s69 offen offset:1024 lds
v_exp_f32 v118, v118
v_mfma_f32_16x16x32_bf16 v[124:127], a[12:15], a[100:103], v[124:127]
ds_read_b64_tr_b16 a[2:3], v217 offset:2048
s_add_u32 m0, s67, 57344
v_mfma_f32_16x16x32_bf16 v[132:135], a[12:15], a[104:107], v[132:135]
ds_read_b64_tr_b16 a[4:5], v217 offset:4096
s_add_u32 s69, s72, 393216
v_exp_f32 v119, v119
v_mfma_f32_16x16x32_bf16 v[132:135], a[8:11], a[92:95], v[132:135]
ds_read_b64_tr_b16 a[6:7], v217 offset:6144
buffer_load_dwordx4 v224, s[24:27], s69 offen offset:0 nt lds
v_cvt_pk_bf16_f32 v118, v118, v119
v_mfma_f32_16x16x32_bf16 v[140:143], a[8:11], a[96:99], v[140:143]
buffer_load_dwordx4 v225, s[24:27], s69 offen offset:1024 nt lds
v_accvgpr_write_b32 a133, v114
v_accvgpr_write_b32 a134, v116
v_mfma_f32_16x16x32_bf16 v[140:143], a[12:15], a[108:111], v[140:143]
v_accvgpr_write_b32 a135, v118
s_waitcnt lgkmcnt(4)
v_mfma_f32_16x16x32_bf16 a[208:211], v[248:251], v[180:183], a[208:211]
ds_read_b64_tr_b16 a[8:9], v216 offset:8192
v_max3_f32 v244, v120, v121, v122
v_mfma_f32_16x16x32_bf16 a[208:211], v[252:255], v[144:147], a[208:211]
ds_read_b64_tr_b16 a[10:11], v216 offset:10240
v_max3_f32 v244, v123, v124, v244
v_mfma_f32_16x16x32_bf16 a[216:219], v[252:255], v[148:151], a[216:219]
ds_read_b64_tr_b16 a[12:13], v216 offset:12288
v_max3_f32 v244, v125, v126, v244
v_mfma_f32_16x16x32_bf16 a[216:219], v[248:251], v[184:187], a[216:219]
ds_read_b64_tr_b16 a[14:15], v216 offset:14336
v_max3_f32 v244, v127, v128, v244
v_mfma_f32_16x16x32_bf16 a[224:227], v[248:251], v[188:191], a[224:227]
v_max3_f32 v244, v129, v130, v244
v_max3_f32 v244, v131, v132, v244
v_mfma_f32_16x16x32_bf16 a[224:227], v[252:255], v[152:155], a[224:227]
v_max3_f32 v244, v133, v134, v244
s_waitcnt lgkmcnt(4)
v_mfma_f32_16x16x32_bf16 a[212:215], a[0:3], v[180:183], a[212:215]
ds_read_b64_tr_b16 v[248:249], v217 offset:8192
v_max3_f32 v244, v135, v136, v244
v_mfma_f32_16x16x32_bf16 a[212:215], a[4:7], v[144:147], a[212:215]
ds_read_b64_tr_b16 v[250:251], v217 offset:10240
v_max3_f32 v244, v137, v138, v244
v_mfma_f32_16x16x32_bf16 a[220:223], a[4:7], v[148:151], a[220:223]
ds_read_b64_tr_b16 v[252:253], v217 offset:12288
v_max3_f32 v244, v139, v140, v244
v_mfma_f32_16x16x32_bf16 a[220:223], a[0:3], v[184:187], a[220:223]
ds_read_b64_tr_b16 v[254:255], v217 offset:14336
v_max3_f32 v244, v141, v142, v244
v_mfma_f32_16x16x32_bf16 a[228:231], a[0:3], v[188:191], a[228:231]
v_max_f32 v244, v143, v244
v_mfma_f32_16x16x32_bf16 a[228:231], a[4:7], v[152:155], a[228:231]
s_waitcnt lgkmcnt(4)
v_mfma_f32_16x16x32_bf16 a[232:235], a[8:11], v[180:183], a[232:235]
ds_read_b64_tr_b16 a[0:1], v216 offset:16384
v_mfma_f32_16x16x32_bf16 a[232:235], a[12:15], v[144:147], a[232:235]
ds_read_b64_tr_b16 a[2:3], v216 offset:18432
v_cmp_lt_f32 vcc, s65, v244
s_cbranch_vccnz L_rare1_2
L_back1_2:
v_mfma_f32_16x16x32_bf16 a[240:243], a[12:15], v[148:151], a[240:243]
ds_read_b64_tr_b16 a[4:5], v216 offset:20480
v_mfma_f32_16x16x32_bf16 a[240:243], a[8:11], v[184:187], a[240:243]
ds_read_b64_tr_b16 a[6:7], v216 offset:22528
v_exp_f32 v120, v120
v_mfma_f32_16x16x32_bf16 a[248:251], a[8:11], v[188:191], a[248:251]
v_exp_f32 v121, v121
v_mfma_f32_16x16x32_bf16 a[248:251], a[12:15], v[152:155], a[248:251]
v_cvt_pk_bf16_f32 v120, v120, v121
s_waitcnt lgkmcnt(4)
v_mfma_f32_16x16x32_bf16 a[236:239], v[248:251], v[180:183], a[236:239]
ds_read_b64_tr_b16 a[8:9], v217 offset:16384
v_accvgpr_write_b32 a136, v120
v_mfma_f32_16x16x32_bf16 a[236:239], v[252:255], v[144:147], a[236:239]
ds_read_b64_tr_b16 a[10:11], v217 offset:18432
v_mfma_f32_16x16x32_bf16 a[244:247], v[252:255], v[148:151], a[244:247]
ds_read_b64_tr_b16 a[12:13], v217 offset:20480
v_mfma_f32_16x16x32_bf16 a[244:247], v[248:251], v[184:187], a[244:247]
ds_read_b64_tr_b16 a[14:15], v217 offset:22528
v_exp_f32 v122, v122
v_mfma_f32_16x16x32_bf16 a[252:255], v[248:251], v[188:191], a[252:255]
v_exp_f32 v123, v123
v_mfma_f32_16x16x32_bf16 a[252:255], v[252:255], v[152:155], a[252:255]
s_waitcnt vmcnt(10) lgkmcnt(4)
s_barrier
v_mfma_f32_16x16x32_bf16 v[0:3], a[0:3], v[180:183], v[0:3]
ds_read_b128 v[248:251], v222 offset:34816
s_add_u32 m0, s67, 65536
v_cvt_pk_bf16_f32 v122, v122, v123
v_mfma_f32_16x16x32_bf16 v[0:3], a[4:7], v[144:147], v[0:3]
ds_read_b128 v[252:255], v223 offset:34816
s_add_u32 s69, s73, 393216
v_accvgpr_write_b32 a137, v122
v_mfma_f32_16x16x32_bf16 v[8:11], a[4:7], v[148:151], v[8:11]
buffer_load_dwordx4 v224, s[24:27], s69 offen offset:0 nt lds
buffer_load_dwordx4 v225, s[24:27], s69 offen offset:1024 nt lds
v_mfma_f32_16x16x32_bf16 v[8:11], a[0:3], v[184:187], v[8:11]
s_add_u32 m0, s67, 73728
s_add_u32 s69, s74, 393216
v_exp_f32 v124, v124
v_mfma_f32_16x16x32_bf16 v[16:19], a[0:3], v[188:191], v[16:19]
buffer_load_dwordx4 v224, s[24:27], s69 offen offset:0 nt lds
buffer_load_dwordx4 v225, s[24:27], s69 offen offset:1024 nt lds
v_mfma_f32_16x16x32_bf16 v[16:19], a[4:7], v[152:155], v[16:19]
v_exp_f32 v125, v125
s_waitcnt lgkmcnt(2)
v_mfma_f32_16x16x32_bf16 v[4:7], a[8:11], v[180:183], v[4:7]
ds_read_b128 a[0:3], v222 offset:32768
v_cvt_pk_bf16_f32 v124, v124, v125
v_mfma_f32_16x16x32_bf16 v[4:7], a[12:15], v[144:147], v[4:7]
ds_read_b128 a[4:7], v223 offset:32768
v_accvgpr_write_b32 a138, v124
v_mfma_f32_16x16x32_bf16 v[12:15], a[12:15], v[148:151], v[12:15]
v_exp_f32 v126, v126
v_mfma_f32_16x16x32_bf16 v[12:15], a[8:11], v[184:187], v[12:15]
v_exp_f32 v127, v127
v_mfma_f32_16x16x32_bf16 v[20:23], a[8:11], v[188:191], v[20:23]
v_exp_f32 v128, v128
v_mfma_f32_16x16x32_bf16 v[20:23], a[12:15], v[152:155], v[20:23]
v_cvt_pk_bf16_f32 v126, v126, v127
s_waitcnt lgkmcnt(2)
v_mfma_f32_16x16x32_bf16 v[116:119], v[248:251], a[24:27], 0
ds_read_b128 a[8:11], v222 offset:40960
v_accvgpr_write_b32 a139, v126
v_mfma_f32_16x16x32_bf16 v[116:119], v[252:255], a[36:39], v[116:119]
ds_read_b128 a[12:15], v223 offset:40960
v_mfma_f32_16x16x32_bf16 v[108:111], v[252:255], a[32:35], 0
v_exp_f32 v129, v129
v_mfma_f32_16x16x32_bf16 v[108:111], v[248:251], a[20:23], v[108:111]
v_exp_f32 v130, v130
v_mfma_f32_16x16x32_bf16 v[100:103], v[248:251], a[16:19], 0
v_exp_f32 v131, v131
v_mfma_f32_16x16x32_bf16 v[100:103], v[252:255], a[28:31], v[100:103]
v_cvt_pk_bf16_f32 v128, v128, v129
s_waitcnt lgkmcnt(2)
v_mfma_f32_16x16x32_bf16 v[112:115], a[0:3], a[24:27], 0
ds_read_b128 v[248:251], v222 offset:43008
v_cvt_pk_bf16_f32 v130, v130, v131
v_mfma_f32_16x16x32_bf16 v[112:115], a[4:7], a[36:39], v[112:115]
ds_read_b128 v[252:255], v223 offset:43008
v_accvgpr_write_b32 a140, v128
v_mfma_f32_16x16x32_bf16 v[104:107], a[4:7], a[32:35], 0
v_exp_f32 v132, v132
v_mfma_f32_16x16x32_bf16 v[104:107], a[0:3], a[20:23], v[104:107]
v_exp_f32 v133, v133
v_mfma_f32_16x16x32_bf16 v[96:99], a[0:3], a[16:19], 0
v_exp_f32 v134, v134
v_mfma_f32_16x16x32_bf16 v[96:99], a[4:7], a[28:31], v[96:99]
s_waitcnt vmcnt(10) lgkmcnt(2)
s_barrier
v_mfma_f32_16x16x32_bf16 v[96:99], a[8:11], a[40:43], v[96:99]
ds_read_b128 a[0:3], v222 offset:51200
s_add_u32 m0, s67, 81920
v_mfma_f32_16x16x32_bf16 v[96:99], a[12:15], a[52:55], v[96:99]
ds_read_b128 a[4:7], v223 offset:51200
s_add_u32 s69, s75, 393216
v_mfma_f32_16x16x32_bf16 v[104:107], a[12:15], a[56:59], v[104:107]
buffer_load_dwordx4 v224, s[24:27], s69 offen offset:0 nt lds
buffer_load_dwordx4 v225, s[24:27], s69 offen offset:1024 nt lds
v_mfma_f32_16x16x32_bf16 v[104:107], a[8:11], a[44:47], v[104:107]
s_add_u32 m0, s67, 40960
s_add_u32 s69, s77, s85
v_mfma_f32_16x16x32_bf16 v[112:115], a[8:11], a[48:51], v[112:115]
buffer_load_dwordx4 v226, s[36:39], s69 offen offset:0 lds
buffer_load_dwordx4 v227, s[36:39], s69 offen offset:1024 lds
v_cvt_pk_bf16_f32 v132, v132, v133
v_mfma_f32_16x16x32_bf16 v[112:115], a[12:15], a[60:63], v[112:115]
v_accvgpr_write_b32 a141, v130
s_waitcnt lgkmcnt(2)
v_mfma_f32_16x16x32_bf16 v[100:103], v[248:251], a[40:43], v[100:103]
ds_read_b128 a[8:11], v222 offset:49152
v_accvgpr_write_b32 a142, v132
v_mfma_f32_16x16x32_bf16 v[100:103], v[252:255], a[52:55], v[100:103]
ds_read_b128 a[12:15], v223 offset:49152
v_mfma_f32_16x16x32_bf16 v[108:111], v[252:255], a[56:59], v[108:111]
v_exp_f32 v135, v135
v_mfma_f32_16x16x32_bf16 v[108:111], v[248:251], a[44:47], v[108:111]
v_exp_f32 v136, v136
v_mfma_f32_16x16x32_bf16 v[116:119], v[248:251], a[48:51], v[116:119]
v_exp_f32 v137, v137
v_mfma_f32_16x16x32_bf16 v[116:119], v[252:255], a[60:63], v[116:119]
v_cvt_pk_bf16_f32 v134, v134, v135
s_waitcnt lgkmcnt(2)
v_mfma_f32_16x16x32_bf16 v[116:119], a[0:3], a[72:75], v[116:119]
ds_read_b128 v[248:251], v222 offset:57344
v_cvt_pk_bf16_f32 v136, v136, v137
v_mfma_f32_16x16x32_bf16 v[116:119], a[4:7], a[84:87], v[116:119]
ds_read_b128 v[252:255], v223 offset:57344
v_accvgpr_write_b32 a143, v134
v_mfma_f32_16x16x32_bf16 v[108:111], a[4:7], a[80:83], v[108:111]
v_exp_f32 v138, v138
v_mfma_f32_16x16x32_bf16 v[108:111], a[0:3], a[68:71], v[108:111]
v_exp_f32 v139, v139
v_mfma_f32_16x16x32_bf16 v[100:103], a[0:3], a[64:67], v[100:103]
v_exp_f32 v140, v140
v_mfma_f32_16x16x32_bf16 v[100:103], a[4:7], a[76:79], v[100:103]
v_cvt_pk_bf16_f32 v138, v138, v139
s_waitcnt lgkmcnt(2)
v_mfma_f32_16x16x32_bf16 v[112:115], a[8:11], a[72:75], v[112:115]
ds_read_b128 a[0:3], v222 offset:59392
v_accvgpr_write_b32 a144, v136
v_mfma_f32_16x16x32_bf16 v[112:115], a[12:15], a[84:87], v[112:115]
ds_read_b128 a[4:7], v223 offset:59392
v_accvgpr_write_b32 a145, v138
v_mfma_f32_16x16x32_bf16 v[104:107], a[12:15], a[80:83], v[104:107]
v_exp_f32 v141, v141
v_mfma_f32_16x16x32_bf16 v[104:107], a[8:11], a[68:71], v[104:107]
v_exp_f32 v142, v142
v_mfma_f32_16x16x32_bf16 v[96:99], a[8:11], a[64:67], v[96:99]
v_exp_f32 v143, v143
v_mfma_f32_16x16x32_bf16 v[96:99], a[12:15], a[76:79], v[96:99]
s_waitcnt vmcnt(10) lgkmcnt(2)
s_barrier
v_mfma_f32_16x16x32_bf16 v[96:99], v[248:251], a[88:91], v[96:99]
ds_read_b64_tr_b16 a[8:9], v216 offset:24576
s_add_u32 m0, s67, 49152
v_mfma_f32_16x16x32_bf16 v[96:99], v[252:255], a[100:103], v[96:99]
ds_read_b64_tr_b16 a[10:11], v216 offset:26624
s_add_u32 s69, s77, s86
v_mfma_f32_16x16x32_bf16 v[104:107], v[252:255], a[104:107], v[104:107]
ds_read_b64_tr_b16 a[12:13], v216 offset:28672
buffer_load_dwordx4 v226, s[36:39], s69 offen offset:0 lds
v_mfma_f32_16x16x32_bf16 v[104:107], v[248:251], a[92:95], v[104:107]
ds_read_b64_tr_b16 a[14:15], v216 offset:30720
buffer_load_dwordx4 v227, s[36:39], s69 offen offset:1024 lds
v_cvt_pk_bf16_f32 v140, v140, v141
v_mfma_f32_16x16x32_bf16 v[112:115], v[248:251], a[96:99], v[112:115]
s_add_u32 m0, s67, 0
s_add_u32 s69, s78, s80
v_cvt_pk_bf16_f32 v142, v142, v143
v_mfma_f32_16x16x32_bf16 v[112:115], v[252:255], a[108:111], v[112:115]
buffer_load_dwordx4 v226, s[36:39], s69 offen offset:0 lds
v_accvgpr_write_b32 a146, v140
s_waitcnt lgkmcnt(4)
v_mfma_f32_16x16x32_bf16 v[100:103], a[0:3], a[88:91], v[100:103]
ds_read_b64_tr_b16 v[248:249], v217 offset:24576
buffer_load_dwordx4 v227, s[36:39], s69 offen offset:1024 lds
v_accvgpr_write_b32 a147, v142
v_mfma_f32_16x16x32_bf16 v[100:103], a[4:7], a[100:103], v[100:103]
ds_read_b64_tr_b16 v[250:251], v217 offset:26624
v_max3_f32 v244, v96, v97, v98
v_mfma_f32_16x16x32_bf16 v[108:111], a[4:7], a[104:107], v[108:111]
ds_read_b64_tr_b16 v[252:253], v217 offset:28672
v_mfma_f32_16x16x32_bf16 v[108:111], a[0:3], a[92:95], v[108:111]
ds_read_b64_tr_b16 v[254:255], v217 offset:30720
v_mfma_f32_16x16x32_bf16 v[116:119], a[0:3], a[96:99], v[116:119]
s_nop 0
v_max3_f32 v244, v99, v100, v244
v_max3_f32 v244, v101, v102, v244
v_mfma_f32_16x16x32_bf16 v[116:119], a[4:7], a[108:111], v[116:119]
v_max3_f32 v244, v103, v104, v244
s_waitcnt lgkmcnt(4)
v_mfma_f32_16x16x32_bf16 v[24:27], a[8:11], v[180:183], v[24:27]
ds_read_b64_tr_b16 a[0:1], v216 offset:32768
v_max3_f32 v244, v105, v106, v244
v_mfma_f32_16x16x32_bf16 v[24:27], a[12:15], v[144:147], v[24:27]
ds_read_b64_tr_b16 a[2:3], v216 offset:34816
v_max3_f32 v244, v107, v108, v244
v_mfma_f32_16x16x32_bf16 v[32:35], a[12:15], v[148:151], v[32:35]
ds_read_b64_tr_b16 a[4:5], v216 offset:36864
v_max3_f32 v244, v109, v110, v244
v_mfma_f32_16x16x32_bf16 v[32:35], a[8:11], v[184:187], v[32:35]
ds_read_b64_tr_b16 a[6:7], v216 offset:38912
v_max3_f32 v244, v111, v112, v244
v_mfma_f32_16x16x32_bf16 v[40:43], a[8:11], v[188:191], v[40:43]
v_max3_f32 v244, v113, v114, v244
v_max3_f32 v244, v115, v116, v244
v_mfma_f32_16x16x32_bf16 v[40:43], a[12:15], v[152:155], v[40:43]
v_max3_f32 v244, v117, v118, v244
s_waitcnt lgkmcnt(4)
v_mfma_f32_16x16x32_bf16 v[28:31], v[248:251], v[180:183], v[28:31]
ds_read_b64_tr_b16 a[8:9], v217 offset:32768
v_max_f32 v244, v119, v244
v_mfma_f32_16x16x32_bf16 v[28:31], v[252:255], v[144:147], v[28:31]
ds_read_b64_tr_b16 a[10:11], v217 offset:34816
v_mfma_f32_16x16x32_bf16 v[36:39], v[252:255], v[148:151], v[36:39]
ds_read_b64_tr_b16 a[12:13], v217 offset:36864
v_cmp_lt_f32 vcc, s65, v244
s_cbranch_vccnz L_rare1_3
L_back1_3:
v_mfma_f32_16x16x32_bf16 v[36:39], v[248:251], v[184:187], v[36:39]
ds_read_b64_tr_b16 a[14:15], v217 offset:38912
v_mfma_f32_16x16x32_bf16 v[44:47], v[248:251], v[188:191], v[44:47]
v_exp_f32 v96, v96
v_mfma_f32_16x16x32_bf16 v[44:47], v[252:255], v[152:155], v[44:47]
s_waitcnt vmcnt(10) lgkmcnt(4)
s_barrier
v_mfma_f32_16x16x32_bf16 v[48:51], a[0:3], v[180:183], v[48:51]
ds_read_b128 v[248:251], v222 offset:2048
s_add_u32 m0, s67, 90112
v_exp_f32 v97, v97
v_mfma_f32_16x16x32_bf16 v[48:51], a[4:7], v[144:147], v[48:51]
ds_read_b128 v[252:255], v223 offset:2048
s_add_u32 s69, s72, 425984
v_cvt_pk_bf16_f32 v96, v96, v97
v_mfma_f32_16x16x32_bf16 v[56:59], a[4:7], v[148:151], v[56:59]
buffer_load_dwordx4 v224, s[24:27], s69 offen offset:0 nt lds
buffer_load_dwordx4 v225, s[24:27], s69 offen offset:1024 nt lds
v_accvgpr_write_b32 a148, v96
v_mfma_f32_16x16x32_bf16 v[56:59], a[0:3], v[184:187], v[56:59]
s_add_u32 m0, s67, 98304
s_add_u32 s69, s73, 425984
v_exp_f32 v98, v98
v_mfma_f32_16x16x32_bf16 v[64:67], a[0:3], v[188:191], v[64:67]
buffer_load_dwordx4 v224, s[24:27], s69 offen offset:0 nt lds
buffer_load_dwordx4 v225, s[24:27], s69 offen offset:1024 nt lds
v_mfma_f32_16x16x32_bf16 v[64:67], a[4:7], v[152:155], v[64:67]
v_exp_f32 v99, v99
s_waitcnt lgkmcnt(2)
v_mfma_f32_16x16x32_bf16 v[52:55], a[8:11], v[180:183], v[52:55]
ds_read_b128 a[0:3], v222 offset:0
v_cvt_pk_bf16_f32 v98, v98, v99
v_mfma_f32_16x16x32_bf16 v[52:55], a[12:15], v[144:147], v[52:55]
ds_read_b128 a[4:7], v223 offset:0
v_accvgpr_write_b32 a149, v98
v_mfma_f32_16x16x32_bf16 v[60:63], a[12:15], v[148:151], v[60:63]
v_exp_f32 v100, v100
v_mfma_f32_16x16x32_bf16 v[60:63], a[8:11], v[184:187], v[60:63]
v_exp_f32 v101, v101
v_mfma_f32_16x16x32_bf16 v[68:71], a[8:11], v[188:191], v[68:71]
v_exp_f32 v102, v102
v_mfma_f32_16x16x32_bf16 v[68:71], a[12:15], v[152:155], v[68:71]
v_cvt_pk_bf16_f32 v100, v100, v101
s_waitcnt lgkmcnt(2)
v_mfma_f32_16x16x32_bf16 v[140:143], v[248:251], a[24:27], 0
ds_read_b128 a[8:11], v222 offset:8192
v_accvgpr_write_b32 a150, v100
v_mfma_f32_16x16x32_bf16 v[140:143], v[252:255], a[36:39], v[140:143]
ds_read_b128 a[12:15], v223 offset:8192
v_mfma_f32_16x16x32_bf16 v[132:135], v[252:255], a[32:35], 0
v_exp_f32 v103, v103
v_mfma_f32_16x16x32_bf16 v[132:135], v[248:251], a[20:23], v[132:135]
v_exp_f32 v104, v104
v_mfma_f32_16x16x32_bf16 v[124:127], v[248:251], a[16:19], 0
v_exp_f32 v105, v105
v_mfma_f32_16x16x32_bf16 v[124:127], v[252:255], a[28:31], v[124:127]
v_cvt_pk_bf16_f32 v102, v102, v103
s_waitcnt lgkmcnt(2)
v_mfma_f32_16x16x32_bf16 v[136:139], a[0:3], a[24:27], 0
ds_read_b128 v[248:251], v222 offset:10240
v_cvt_pk_bf16_f32 v104, v104, v105
v_mfma_f32_16x16x32_bf16 v[136:139], a[4:7], a[36:39], v[136:139]
ds_read_b128 v[252:255], v223 offset:10240
v_accvgpr_write_b32 a151, v102
v_mfma_f32_16x16x32_bf16 v[128:131], a[4:7], a[32:35], 0
v_exp_f32 v106, v106
v_mfma_f32_16x16x32_bf16 v[128:131], a[0:3], a[20:23], v[128:131]
v_exp_f32 v107, v107
v_mfma_f32_16x16x32_bf16 v[120:123], a[0:3], a[16:19], 0
v_exp_f32 v108, v108
v_mfma_f32_16x16x32_bf16 v[120:123], a[4:7], a[28:31], v[120:123]
s_waitcnt vmcnt(10) lgkmcnt(2)
s_barrier
v_mfma_f32_16x16x32_bf16 v[120:123], a[8:11], a[40:43], v[120:123]
ds_read_b128 a[0:3], v222 offset:18432
s_add_u32 m0, s67, 106496
v_mfma_f32_16x16x32_bf16 v[120:123], a[12:15], a[52:55], v[120:123]
ds_read_b128 a[4:7], v223 offset:18432
s_add_u32 s69, s74, 425984
v_mfma_f32_16x16x32_bf16 v[128:131], a[12:15], a[56:59], v[128:131]
buffer_load_dwordx4 v224, s[24:27], s69 offen offset:0 nt lds
buffer_load_dwordx4 v225, s[24:27], s69 offen offset:1024 nt lds
v_mfma_f32_16x16x32_bf16 v[128:131], a[8:11], a[44:47], v[128:131]
s_add_u32 m0, s67, 114688
s_add_u32 s69, s75, 425984
v_cvt_pk_bf16_f32 v106, v106, v107
v_mfma_f32_16x16x32_bf16 v[136:139], a[8:11], a[48:51], v[136:139]
buffer_load_dwordx4 v224, s[24:27], s69 offen offset:0 nt lds
buffer_load_dwordx4 v225, s[24:27], s69 offen offset:1024 nt lds
v_accvgpr_write_b32 a152, v104
v_mfma_f32_16x16x32_bf16 v[136:139], a[12:15], a[60:63], v[136:139]
v_accvgpr_write_b32 a153, v106
s_waitcnt lgkmcnt(2)
v_mfma_f32_16x16x32_bf16 v[124:127], v[248:251], a[40:43], v[124:127]
ds_read_b128 a[8:11], v222 offset:16384
v_exp_f32 v109, v109
v_mfma_f32_16x16x32_bf16 v[124:127], v[252:255], a[52:55], v[124:127]
ds_read_b128 a[12:15], v223 offset:16384
v_cvt_pk_bf16_f32 v108, v108, v109
v_mfma_f32_16x16x32_bf16 v[132:135], v[252:255], a[56:59], v[132:135]
v_exp_f32 v110, v110
v_mfma_f32_16x16x32_bf16 v[132:135], v[248:251], a[44:47], v[132:135]
v_exp_f32 v111, v111
v_mfma_f32_16x16x32_bf16 v[140:143], v[248:251], a[48:51], v[140:143]
v_exp_f32 v112, v112
v_mfma_f32_16x16x32_bf16 v[140:143], v[252:255], a[60:63], v[140:143]
v_cvt_pk_bf16_f32 v110, v110, v111
s_waitcnt lgkmcnt(2)
v_mfma_f32_16x16x32_bf16 v[140:143], a[0:3], a[72:75], v[140:143]
ds_read_b128 v[248:251], v222 offset:24576
v_accvgpr_write_b32 a154, v108
v_mfma_f32_16x16x32_bf16 v[140:143], a[4:7], a[84:87], v[140:143]
ds_read_b128 v[252:255], v223 offset:24576
v_accvgpr_write_b32 a155, v110
v_mfma_f32_16x16x32_bf16 v[132:135], a[4:7], a[80:83], v[132:135]
v_exp_f32 v113, v113
v_mfma_f32_16x16x32_bf16 v[132:135], a[0:3], a[68:71], v[132:135]
v_exp_f32 v114, v114
v_mfma_f32_16x16x32_bf16 v[124:127], a[0:3], a[64:67], v[124:127]
v_exp_f32 v115, v115
v_mfma_f32_16x16x32_bf16 v[124:127], a[4:7], a[76:79], v[124:127]
v_cvt_pk_bf16_f32 v112, v112, v113
s_waitcnt lgkmcnt(2)
v_mfma_f32_16x16x32_bf16 v[136:139], a[8:11], a[72:75], v[136:139]
ds_read_b128 a[0:3], v222 offset:26624
v_cvt_pk_bf16_f32 v114, v114, v115
v_mfma_f32_16x16x32_bf16 v[136:139], a[12:15], a[84:87], v[136:139]
ds_read_b128 a[4:7], v223 offset:26624
v_accvgpr_write_b32 a156, v112
v_mfma_f32_16x16x32_bf16 v[128:131], a[12:15], a[80:83], v[128:131]
v_exp_f32 v116, v116
v_mfma_f32_16x16x32_bf16 v[128:131], a[8:11], a[68:71], v[128:131]
v_exp_f32 v117, v117
v_mfma_f32_16x16x32_bf16 v[120:123], a[8:11], a[64:67], v[120:123]
v_exp_f32 v118, v118
v_mfma_f32_16x16x32_bf16 v[120:123], a[12:15], a[76:79], v[120:123]
s_waitcnt vmcnt(8) lgkmcnt(2)
s_barrier
v_mfma_f32_16x16x32_bf16 v[120:123], v[248:251], a[88:91], v[120:123]
ds_read_b64_tr_b16 a[8:9], v216 offset:40960
s_add_u32 m0, s67, 8192
v_mfma_f32_16x16x32_bf16 v[120:123], v[252:255], a[100:103], v[120:123]
ds_read_b64_tr_b16 a[10:11], v216 offset:43008
s_add_u32 s69, s78, s81
v_mfma_f32_16x16x32_bf16 v[128:131], v[252:255], a[104:107], v[128:131]
ds_read_b64_tr_b16 a[12:13], v216 offset:45056
buffer_load_dwordx4 v226, s[36:39], s69 offen offset:0 lds
v_mfma_f32_16x16x32_bf16 v[128:131], v[248:251], a[92:95], v[128:131]
ds_read_b64_tr_b16 a[14:15], v216 offset:47104
buffer_load_dwordx4 v227, s[36:39], s69 offen offset:1024 lds
v_mfma_f32_16x16x32_bf16 v[136:139], v[248:251], a[96:99], v[136:139]
s_add_u32 m0, s67, 16384
s_add_u32 s69, s78, s82
v_exp_f32 v119, v119
v_mfma_f32_16x16x32_bf16 v[136:139], v[252:255], a[108:111], v[136:139]
buffer_load_dwordx4 v226, s[36:39], s69 offen offset:0 lds
s_waitcnt lgkmcnt(4)
v_mfma_f32_16x16x32_bf16 v[124:127], a[0:3], a[88:91], v[124:127]
ds_read_b64_tr_b16 v[248:249], v217 offset:40960
buffer_load_dwordx4 v227, s[36:39], s69 offen offset:1024 lds
v_cvt_pk_bf16_f32 v116, v116, v117
v_mfma_f32_16x16x32_bf16 v[124:127], a[4:7], a[100:103], v[124:127]
ds_read_b64_tr_b16 v[250:251], v217 offset:43008
s_add_u32 m0, s67, 57344
v_cvt_pk_bf16_f32 v118, v118, v119
v_mfma_f32_16x16x32_bf16 v[132:135], a[4:7], a[104:107], v[132:135]
ds_read_b64_tr_b16 v[252:253], v217 offset:45056
s_add_u32 s69, s72, 458752
v_accvgpr_write_b32 a157, v114
v_mfma_f32_16x16x32_bf16 v[132:135], a[0:3], a[92:95], v[132:135]
ds_read_b64_tr_b16 v[254:255], v217 offset:47104
buffer_load_dwordx4 v224, s[24:27], s69 offen offset:0 nt lds
v_accvgpr_write_b32 a158, v116
v_mfma_f32_16x16x32_bf16 v[140:143], a[0:3], a[96:99], v[140:143]
buffer_load_dwordx4 v225, s[24:27], s69 offen offset:1024 nt lds
v_accvgpr_write_b32 a159, v118
v_mfma_f32_16x16x32_bf16 v[140:143], a[4:7], a[108:111], v[140:143]
v_max3_f32 v244, v120, v121, v122
s_waitcnt lgkmcnt(4)
v_mfma_f32_16x16x32_bf16 v[72:75], a[8:11], v[180:183], v[72:75]
ds_read_b64_tr_b16 a[0:1], v216 offset:49152
v_max3_f32 v244, v123, v124, v244
v_mfma_f32_16x16x32_bf16 v[72:75], a[12:15], v[144:147], v[72:75]
ds_read_b64_tr_b16 a[2:3], v216 offset:51200
v_max3_f32 v244, v125, v126, v244
v_mfma_f32_16x16x32_bf16 v[80:83], a[12:15], v[148:151], v[80:83]
ds_read_b64_tr_b16 a[4:5], v216 offset:53248
v_max3_f32 v244, v127, v128, v244
v_max3_f32 v244, v129, v130, v244
v_mfma_f32_16x16x32_bf16 v[80:83], a[8:11], v[184:187], v[80:83]
ds_read_b64_tr_b16 a[6:7], v216 offset:55296
v_max3_f32 v244, v131, v132, v244
v_mfma_f32_16x16x32_bf16 v[88:91], a[8:11], v[188:191], v[88:91]
v_max3_f32 v244, v133, v134, v244
v_max3_f32 v244, v135, v136, v244
v_mfma_f32_16x16x32_bf16 v[88:91], a[12:15], v[152:155], v[88:91]
v_max3_f32 v244, v137, v138, v244
s_waitcnt lgkmcnt(4)
v_mfma_f32_16x16x32_bf16 v[76:79], v[248:251], v[180:183], v[76:79]
ds_read_b64_tr_b16 a[8:9], v217 offset:49152
v_max3_f32 v244, v139, v140, v244
v_mfma_f32_16x16x32_bf16 v[76:79], v[252:255], v[144:147], v[76:79]
ds_read_b64_tr_b16 a[10:11], v217 offset:51200
v_max3_f32 v244, v141, v142, v244
v_mfma_f32_16x16x32_bf16 v[84:87], v[252:255], v[148:151], v[84:87]
ds_read_b64_tr_b16 a[12:13], v217 offset:53248
v_max_f32 v244, v143, v244
v_mfma_f32_16x16x32_bf16 v[84:87], v[248:251], v[184:187], v[84:87]
ds_read_b64_tr_b16 a[14:15], v217 offset:55296
v_mov_b32 v246, 0x3f803f80
v_mfma_f32_16x16x32_bf16 v[92:95], v[248:251], v[188:191], v[92:95]
v_cmp_lt_f32 vcc, s65, v244
s_cbranch_vccnz L_rare1_4
L_back1_4:
v_mfma_f32_16x16x32_bf16 v[92:95], v[252:255], v[152:155], v[92:95]
s_waitcnt lgkmcnt(4)
v_mfma_f32_16x16x32_bf16 v[192:195], a[0:3], v[180:183], v[192:195]
ds_read_b64_tr_b16 v[248:249], v216 offset:0
v_mfma_f32_16x16x32_bf16 v[192:195], a[4:7], v[144:147], v[192:195]
ds_read_b64_tr_b16 v[250:251], v216 offset:2048
v_mfma_f32_16x16x32_bf16 v[200:203], a[4:7], v[148:151], v[200:203]
ds_read_b64_tr_b16 v[252:253], v216 offset:4096
v_exp_f32 v120, v120
v_mfma_f32_16x16x32_bf16 v[200:203], a[0:3], v[184:187], v[200:203]
ds_read_b64_tr_b16 v[254:255], v216 offset:6144
v_mfma_f32_16x16x32_bf16 v[208:211], a[0:3], v[188:191], v[208:211]
v_exp_f32 v121, v121
v_mfma_f32_16x16x32_bf16 v[208:211], a[4:7], v[152:155], v[208:211]
v_cvt_pk_bf16_f32 v120, v120, v121
s_waitcnt lgkmcnt(4)
v_mfma_f32_16x16x32_bf16 v[196:199], a[8:11], v[180:183], v[196:199]
ds_read_b64_tr_b16 a[0:1], v217 offset:0
ds_read_b128 v[180:183], v230 offset:6144
v_accvgpr_write_b32 a160, v120
v_mfma_f32_16x16x32_bf16 v[196:199], a[12:15], v[144:147], v[196:199]
ds_read_b64_tr_b16 a[2:3], v217 offset:2048
ds_read_b128 v[144:147], v230 offset:16384
v_mfma_f32_16x16x32_bf16 v[204:207], a[12:15], v[148:151], v[204:207]
ds_read_b64_tr_b16 a[4:5], v217 offset:4096
ds_read_b128 v[148:151], v230 offset:17408
v_exp_f32 v122, v122
v_mfma_f32_16x16x32_bf16 v[204:207], a[8:11], v[184:187], v[204:207]
ds_read_b64_tr_b16 a[6:7], v217 offset:6144
ds_read_b128 v[184:187], v230 offset:7168
v_mfma_f32_16x16x32_bf16 v[212:215], a[8:11], v[188:191], v[212:215]
ds_read_b128 v[188:191], v230 offset:8192
v_exp_f32 v123, v123
v_mfma_f32_16x16x32_bf16 v[212:215], a[12:15], v[152:155], v[212:215]
ds_read_b128 v[152:155], v230 offset:18432
v_cvt_pk_bf16_f32 v122, v122, v123
s_waitcnt vmcnt(10) lgkmcnt(10)
s_barrier
s_waitcnt lgkmcnt(8)
v_mfma_f32_16x16x32_bf16 a[208:211], v[248:251], v[180:183], a[208:211]
ds_read_b128 a[8:11], v222 offset:34816
s_add_u32 m0, s67, 65536
v_accvgpr_write_b32 a161, v122
s_waitcnt lgkmcnt(7)
v_mfma_f32_16x16x32_bf16 a[208:211], v[252:255], v[144:147], a[208:211]
ds_read_b128 a[12:15], v223 offset:34816
s_add_u32 s69, s73, 458752
s_waitcnt lgkmcnt(6)
v_mfma_f32_16x16x32_bf16 a[216:219], v[252:255], v[148:151], a[216:219]
buffer_load_dwordx4 v224, s[24:27], s69 offen offset:0 nt lds
buffer_load_dwordx4 v225, s[24:27], s69 offen offset:1024 nt lds
v_exp_f32 v124, v124
s_waitcnt lgkmcnt(4)
v_mfma_f32_16x16x32_bf16 a[216:219], v[248:251], v[184:187], a[216:219]
s_add_u32 m0, s67, 73728
s_add_u32 s69, s74, 458752
s_waitcnt lgkmcnt(3)
v_mfma_f32_16x16x32_bf16 a[224:227], v[248:251], v[188:191], a[224:227]
buffer_load_dwordx4 v224, s[24:27], s69 offen offset:0 nt lds
buffer_load_dwordx4 v225, s[24:27], s69 offen offset:1024 nt lds
v_exp_f32 v125, v125
s_waitcnt lgkmcnt(2)
v_mfma_f32_16x16x32_bf16 a[224:227], v[252:255], v[152:155], a[224:227]
v_exp_f32 v126, v126
v_mfma_f32_16x16x32_bf16 a[212:215], a[0:3], v[180:183], a[212:215]
ds_read_b128 v[248:251], v222 offset:32768
v_cvt_pk_bf16_f32 v124, v124, v125
v_mfma_f32_16x16x32_bf16 a[212:215], a[4:7], v[144:147], a[212:215]
ds_read_b128 v[252:255], v223 offset:32768
v_accvgpr_write_b32 a162, v124
v_mfma_f32_16x16x32_bf16 a[220:223], a[4:7], v[148:151], a[220:223]
v_exp_f32 v127, v127
v_mfma_f32_16x16x32_bf16 a[220:223], a[0:3], v[184:187], a[220:223]
v_exp_f32 v128, v128
v_mfma_f32_16x16x32_bf16 a[228:231], a[0:3], v[188:191], a[228:231]
v_exp_f32 v129, v129
v_mfma_f32_16x16x32_bf16 a[228:231], a[4:7], v[152:155], a[228:231]
v_cvt_pk_bf16_f32 v126, v126, v127
s_waitcnt lgkmcnt(2)
v_mfma_f32_16x16x32_bf16 v[116:119], a[8:11], a[24:27], 0
ds_read_b128 a[0:3], v222 offset:40960
v_cvt_pk_bf16_f32 v128, v128, v129
v_mfma_f32_16x16x32_bf16 v[116:119], a[12:15], a[36:39], v[116:119]
ds_read_b128 a[4:7], v223 offset:40960
v_accvgpr_write_b32 a163, v126
v_mfma_f32_16x16x32_bf16 v[108:111], a[12:15], a[32:35], 0
v_exp_f32 v130, v130
v_mfma_f32_16x16x32_bf16 v[108:111], a[8:11], a[20:23], v[108:111]
v_exp_f32 v131, v131
v_mfma_f32_16x16x32_bf16 v[100:103], a[8:11], a[16:19], 0
v_exp_f32 v132, v132
v_mfma_f32_16x16x32_bf16 v[100:103], a[12:15], a[28:31], v[100:103]
v_cvt_pk_bf16_f32 v130, v130, v131
s_waitcnt lgkmcnt(2)
v_mfma_f32_16x16x32_bf16 v[112:115], v[248:251], a[24:27], 0
ds_read_b128 a[8:11], v222 offset:43008
v_accvgpr_write_b32 a164, v128
v_mfma_f32_16x16x32_bf16 v[112:115], v[252:255], a[36:39], v[112:115]
ds_read_b128 a[12:15], v223 offset:43008
v_accvgpr_write_b32 a165, v130
v_mfma_f32_16x16x32_bf16 v[104:107], v[252:255], a[32:35], 0
v_exp_f32 v133, v133
v_mfma_f32_16x16x32_bf16 v[104:107], v[248:251], a[20:23], v[104:107]
v_exp_f32 v134, v134
v_mfma_f32_16x16x32_bf16 v[96:99], v[248:251], a[16:19], 0
v_exp_f32 v135, v135
v_mfma_f32_16x16x32_bf16 v[96:99], v[252:255], a[28:31], v[96:99]
s_waitcnt vmcnt(10) lgkmcnt(2)
s_barrier
v_mfma_f32_16x16x32_bf16 v[96:99], a[0:3], a[40:43], v[96:99]
ds_read_b128 v[248:251], v222 offset:51200
s_add_u32 m0, s67, 81920
v_mfma_f32_16x16x32_bf16 v[96:99], a[4:7], a[52:55], v[96:99]
ds_read_b128 v[252:255], v223 offset:51200
s_add_u32 s69, s75, 458752
v_mfma_f32_16x16x32_bf16 v[104:107], a[4:7], a[56:59], v[104:107]
buffer_load_dwordx4 v224, s[24:27], s69 offen offset:0 nt lds
buffer_load_dwordx4 v225, s[24:27], s69 offen offset:1024 nt lds
v_mfma_f32_16x16x32_bf16 v[104:107], a[0:3], a[44:47], v[104:107]
s_add_u32 m0, s67, 24576
s_add_u32 s69, s78, s83
v_mfma_f32_16x16x32_bf16 v[112:115], a[0:3], a[48:51], v[112:115]
buffer_load_dwordx4 v226, s[36:39], s69 offen offset:0 lds
buffer_load_dwordx4 v227, s[36:39], s69 offen offset:1024 lds
v_mfma_f32_16x16x32_bf16 v[112:115], a[4:7], a[60:63], v[112:115]
ds_write_b64 v228, a[196:197] offset:6144
v_exp_f32 v136, v136
s_waitcnt lgkmcnt(3)
v_mfma_f32_16x16x32_bf16 v[100:103], a[8:11], a[40:43], v[100:103]
ds_read_b128 a[0:3], v222 offset:49152
v_cvt_pk_bf16_f32 v132, v132, v133
v_mfma_f32_16x16x32_bf16 v[100:103], a[12:15], a[52:55], v[100:103]
ds_read_b128 a[4:7], v223 offset:49152
ds_write_b64 v228, a[198:199] offset:6152
v_mfma_f32_16x16x32_bf16 v[108:111], a[12:15], a[56:59], v[108:111]
v_exp_f32 v137, v137
v_mfma_f32_16x16x32_bf16 v[108:111], a[8:11], a[44:47], v[108:111]
ds_write_b64 v228, a[200:201] offset:7168
v_cvt_pk_bf16_f32 v134, v134, v135
v_mfma_f32_16x16x32_bf16 v[116:119], a[8:11], a[48:51], v[116:119]
v_exp_f32 v138, v138
v_mfma_f32_16x16x32_bf16 v[116:119], a[12:15], a[60:63], v[116:119]
ds_write_b64 v228, a[202:203] offset:7176
s_waitcnt lgkmcnt(6)
v_mfma_f32_16x16x32_bf16 v[116:119], v[248:251], a[72:75], v[116:119]
ds_read_b128 a[8:11], v222 offset:57344
v_cvt_pk_bf16_f32 v136, v136, v137
v_mfma_f32_16x16x32_bf16 v[116:119], v[252:255], a[84:87], v[116:119]
ds_read_b128 a[12:15], v223 offset:57344
ds_write_b64 v228, a[204:205] offset:8192
v_accvgpr_write_b32 a166, v132
v_mfma_f32_16x16x32_bf16 v[108:111], v[252:255], a[80:83], v[108:111]
v_exp_f32 v139, v139
v_mfma_f32_16x16x32_bf16 v[108:111], v[248:251], a[68:71], v[108:111]
ds_write_b64 v228, a[206:207] offset:8200
v_cvt_pk_bf16_f32 v138, v138, v139
v_mfma_f32_16x16x32_bf16 v[100:103], v[248:251], a[64:67], v[100:103]
v_exp_f32 v140, v140
v_mfma_f32_16x16x32_bf16 v[100:103], v[252:255], a[76:79], v[100:103]
v_accvgpr_write_b32 a167, v134
s_waitcnt lgkmcnt(7)
v_mfma_f32_16x16x32_bf16 v[112:115], a[0:3], a[72:75], v[112:115]
ds_read_b128 v[248:251], v222 offset:59392
v_accvgpr_write_b32 a168, v136
v_mfma_f32_16x16x32_bf16 v[112:115], a[4:7], a[84:87], v[112:115]
ds_read_b128 v[252:255], v223 offset:59392
v_accvgpr_write_b32 a169, v138
v_mfma_f32_16x16x32_bf16 v[104:107], a[4:7], a[80:83], v[104:107]
v_exp_f32 v141, v141
v_mfma_f32_16x16x32_bf16 v[104:107], a[0:3], a[68:71], v[104:107]
v_exp_f32 v142, v142
v_mfma_f32_16x16x32_bf16 v[96:99], a[0:3], a[64:67], v[96:99]
v_exp_f32 v143, v143
v_mfma_f32_16x16x32_bf16 v[96:99], a[4:7], a[76:79], v[96:99]
s_waitcnt vmcnt(10) lgkmcnt(4)
s_barrier
v_mfma_f32_16x16x32_bf16 v[96:99], a[8:11], a[88:91], v[96:99]
ds_read_b64_tr_b16 a[0:1], v216 offset:8192
s_add_u32 m0, s67, 32768
v_mfma_f32_16x16x32_bf16 v[96:99], a[12:15], a[100:103], v[96:99]
ds_read_b64_tr_b16 a[2:3], v216 offset:10240
s_add_u32 s69, s78, s84
v_mfma_f32_16x16x32_bf16 v[104:107], a[12:15], a[104:107], v[104:107]
ds_read_b64_tr_b16 a[4:5], v216 offset:12288
buffer_load_dwordx4 v226, s[36:39], s69 offen offset:0 lds
v_mfma_f32_16x16x32_bf16 v[104:107], a[8:11], a[92:95], v[104:107]
ds_read_b64_tr_b16 a[6:7], v216 offset:14336
buffer_load_dwordx4 v227, s[36:39], s69 offen offset:1024 lds
v_cvt_pk_bf16_f32 v140, v140, v141
v_mfma_f32_16x16x32_bf16 v[112:115], a[8:11], a[96:99], v[112:115]
s_add_u32 m0, s67, 90112
s_add_u32 s69, s72, 491520
v_cvt_pk_bf16_f32 v142, v142, v143
v_mfma_f32_16x16x32_bf16 v[112:115], a[12:15], a[108:111], v[112:115]
buffer_load_dwordx4 v224, s[24:27], s69 offen offset:0 nt lds
v_accvgpr_write_b32 a170, v140
s_waitcnt lgkmcnt(4)
v_mfma_f32_16x16x32_bf16 v[100:103], v[248:251], a[88:91], v[100:103]
ds_read_b64_tr_b16 a[8:9], v217 offset:8192
buffer_load_dwordx4 v225, s[24:27], s69 offen offset:1024 nt lds
v_accvgpr_write_b32 a171, v142
v_mfma_f32_16x16x32_bf16 v[100:103], v[252:255], a[100:103], v[100:103]
ds_read_b64_tr_b16 a[10:11], v217 offset:10240
v_max3_f32 v244, v96, v97, v98
v_mfma_f32_16x16x32_bf16 v[108:111], v[252:255], a[104:107], v[108:111]
ds_read_b64_tr_b16 a[12:13], v217 offset:12288
v_mfma_f32_16x16x32_bf16 v[108:111], v[248:251], a[92:95], v[108:111]
ds_read_b64_tr_b16 a[14:15], v217 offset:14336
v_mfma_f32_16x16x32_bf16 v[116:119], v[248:251], a[96:99], v[116:119]
s_nop 0
v_max3_f32 v244, v99, v100, v244
v_max3_f32 v244, v101, v102, v244
v_mfma_f32_16x16x32_bf16 v[116:119], v[252:255], a[108:111], v[116:119]
v_max3_f32 v244, v103, v104, v244
s_waitcnt lgkmcnt(4)
v_mfma_f32_16x16x32_bf16 a[232:235], a[0:3], v[180:183], a[232:235]
ds_read_b64_tr_b16 v[248:249], v216 offset:16384
v_max3_f32 v244, v105, v106, v244
v_mfma_f32_16x16x32_bf16 a[232:235], a[4:7], v[144:147], a[232:235]
ds_read_b64_tr_b16 v[250:251], v216 offset:18432
v_max3_f32 v244, v107, v108, v244
v_mfma_f32_16x16x32_bf16 a[240:243], a[4:7], v[148:151], a[240:243]
ds_read_b64_tr_b16 v[252:253], v216 offset:20480
v_max3_f32 v244, v109, v110, v244
v_mfma_f32_16x16x32_bf16 a[240:243], a[0:3], v[184:187], a[240:243]
ds_read_b64_tr_b16 v[254:255], v216 offset:22528
v_max3_f32 v244, v111, v112, v244
v_mfma_f32_16x16x32_bf16 a[248:251], a[0:3], v[188:191], a[248:251]
v_max3_f32 v244, v113, v114, v244
v_max3_f32 v244, v115, v116, v244
v_mfma_f32_16x16x32_bf16 a[248:251], a[4:7], v[152:155], a[248:251]
v_max3_f32 v244, v117, v118, v244
s_waitcnt lgkmcnt(4)
v_mfma_f32_16x16x32_bf16 a[236:239], a[8:11], v[180:183], a[236:239]
ds_read_b64_tr_b16 a[0:1], v217 offset:16384
v_max_f32 v244, v119, v244
v_mfma_f32_16x16x32_bf16 a[236:239], a[12:15], v[144:147], a[236:239]
ds_read_b64_tr_b16 a[2:3], v217 offset:18432
v_mfma_f32_16x16x32_bf16 a[244:247], a[12:15], v[148:151], a[244:247]
ds_read_b64_tr_b16 a[4:5], v217 offset:20480
v_cmp_lt_f32 vcc, s65, v244
s_cbranch_vccnz L_rare1_5
L_back1_5:
v_mfma_f32_16x16x32_bf16 a[244:247], a[8:11], v[184:187], a[244:247]
ds_read_b64_tr_b16 a[6:7], v217 offset:22528
v_mfma_f32_16x16x32_bf16 a[252:255], a[8:11], v[188:191], a[252:255]
v_exp_f32 v96, v96
v_mfma_f32_16x16x32_bf16 a[252:255], a[12:15], v[152:155], a[252:255]
s_waitcnt vmcnt(10) lgkmcnt(4)
s_barrier
v_mfma_f32_16x16x32_bf16 v[0:3], v[248:251], v[180:183], v[0:3]
ds_read_b128 a[8:11], v222 offset:2048
s_add_u32 m0, s67, 98304
v_exp_f32 v97, v97
v_mfma_f32_16x16x32_bf16 v[0:3], v[252:255], v[144:147], v[0:3]
ds_read_b128 a[12:15], v223 offset:2048
s_add_u32 s69, s73, 491520
v_cvt_pk_bf16_f32 v96, v96, v97
v_mfma_f32_16x16x32_bf16 v[8:11], v[252:255], v[148:151], v[8:11]
buffer_load_dwordx4 v224, s[24:27], s69 offen offset:0 nt lds
buffer_load_dwordx4 v225, s[24:27], s69 offen offset:1024 nt lds
v_accvgpr_write_b32 a172, v96
v_mfma_f32_16x16x32_bf16 v[8:11], v[248:251], v[184:187], v[8:11]
s_add_u32 m0, s67, 106496
s_add_u32 s69, s74, 491520
v_exp_f32 v98, v98
v_mfma_f32_16x16x32_bf16 v[16:19], v[248:251], v[188:191], v[16:19]
buffer_load_dwordx4 v224, s[24:27], s69 offen offset:0 nt lds
buffer_load_dwordx4 v225, s[24:27], s69 offen offset:1024 nt lds
v_mfma_f32_16x16x32_bf16 v[16:19], v[252:255], v[152:155], v[16:19]
v_exp_f32 v99, v99
s_waitcnt lgkmcnt(2)
v_mfma_f32_16x16x32_bf16 v[4:7], a[0:3], v[180:183], v[4:7]
ds_read_b128 v[248:251], v222 offset:0
v_cvt_pk_bf16_f32 v98, v98, v99
v_mfma_f32_16x16x32_bf16 v[4:7], a[4:7], v[144:147], v[4:7]
ds_read_b128 v[252:255], v223 offset:0
v_accvgpr_write_b32 a173, v98
v_mfma_f32_16x16x32_bf16 v[12:15], a[4:7], v[148:151], v[12:15]
v_exp_f32 v100, v100
v_mfma_f32_16x16x32_bf16 v[12:15], a[0:3], v[184:187], v[12:15]
v_exp_f32 v101, v101
v_mfma_f32_16x16x32_bf16 v[20:23], a[0:3], v[188:191], v[20:23]
v_exp_f32 v102, v102
v_mfma_f32_16x16x32_bf16 v[20:23], a[4:7], v[152:155], v[20:23]
v_cvt_pk_bf16_f32 v100, v100, v101
s_waitcnt lgkmcnt(2)
v_mfma_f32_16x16x32_bf16 v[140:143], a[8:11], a[24:27], 0
ds_read_b128 a[0:3], v222 offset:8192
v_accvgpr_write_b32 a174, v100
v_mfma_f32_16x16x32_bf16 v[140:143], a[12:15], a[36:39], v[140:143]
ds_read_b128 a[4:7], v223 offset:8192
v_mfma_f32_16x16x32_bf16 v[132:135], a[12:15], a[32:35], 0
v_exp_f32 v103, v103
v_mfma_f32_16x16x32_bf16 v[132:135], a[8:11], a[20:23], v[132:135]
v_exp_f32 v104, v104
v_mfma_f32_16x16x32_bf16 v[124:127], a[8:11], a[16:19], 0
v_exp_f32 v105, v105
v_mfma_f32_16x16x32_bf16 v[124:127], a[12:15], a[28:31], v[124:127]
v_cvt_pk_bf16_f32 v102, v102, v103
s_waitcnt lgkmcnt(2)
v_mfma_f32_16x16x32_bf16 v[136:139], v[248:251], a[24:27], 0
ds_read_b128 a[8:11], v222 offset:10240
v_cvt_pk_bf16_f32 v104, v104, v105
v_mfma_f32_16x16x32_bf16 v[136:139], v[252:255], a[36:39], v[136:139]
ds_read_b128 a[12:15], v223 offset:10240
v_accvgpr_write_b32 a175, v102
v_mfma_f32_16x16x32_bf16 v[128:131], v[252:255], a[32:35], 0
v_exp_f32 v106, v106
v_mfma_f32_16x16x32_bf16 v[128:131], v[248:251], a[20:23], v[128:131]
v_exp_f32 v107, v107
v_mfma_f32_16x16x32_bf16 v[120:123], v[248:251], a[16:19], 0
v_exp_f32 v108, v108
v_mfma_f32_16x16x32_bf16 v[120:123], v[252:255], a[28:31], v[120:123]
s_waitcnt vmcnt(10) lgkmcnt(2)
s_barrier
v_mfma_f32_16x16x32_bf16 v[120:123], a[0:3], a[40:43], v[120:123]
ds_read_b128 v[248:251], v222 offset:18432
s_add_u32 m0, s67, 114688
v_mfma_f32_16x16x32_bf16 v[120:123], a[4:7], a[52:55], v[120:123]
ds_read_b128 v[252:255], v223 offset:18432
s_add_u32 s69, s75, 491520
v_mfma_f32_16x16x32_bf16 v[128:131], a[4:7], a[56:59], v[128:131]
buffer_load_dwordx4 v224, s[24:27], s69 offen offset:0 nt lds
buffer_load_dwordx4 v225, s[24:27], s69 offen offset:1024 nt lds
v_mfma_f32_16x16x32_bf16 v[128:131], a[0:3], a[44:47], v[128:131]
s_add_u32 m0, s67, 40960
s_add_u32 s69, s78, s85
v_cvt_pk_bf16_f32 v106, v106, v107
v_mfma_f32_16x16x32_bf16 v[136:139], a[0:3], a[48:51], v[136:139]
buffer_load_dwordx4 v226, s[36:39], s69 offen offset:0 lds
buffer_load_dwordx4 v227, s[36:39], s69 offen offset:1024 lds
v_accvgpr_write_b32 a176, v104
v_mfma_f32_16x16x32_bf16 v[136:139], a[4:7], a[60:63], v[136:139]
v_accvgpr_write_b32 a177, v106
s_waitcnt lgkmcnt(2)
v_mfma_f32_16x16x32_bf16 v[124:127], a[8:11], a[40:43], v[124:127]
ds_read_b128 a[0:3], v222 offset:16384
v_exp_f32 v109, v109
v_mfma_f32_16x16x32_bf16 v[124:127], a[12:15], a[52:55], v[124:127]
ds_read_b128 a[4:7], v223 offset:16384
v_cvt_pk_bf16_f32 v108, v108, v109
v_mfma_f32_16x16x32_bf16 v[132:135], a[12:15], a[56:59], v[132:135]
v_exp_f32 v110, v110
v_mfma_f32_16x16x32_bf16 v[132:135], a[8:11], a[44:47], v[132:135]
v_exp_f32 v111, v111
v_mfma_f32_16x16x32_bf16 v[140:143], a[8:11], a[48:51], v[140:143]
v_exp_f32 v112, v112
v_mfma_f32_16x16x32_bf16 v[140:143], a[12:15], a[60:63], v[140:143]
v_cvt_pk_bf16_f32 v110, v110, v111
s_waitcnt lgkmcnt(2)
v_mfma_f32_16x16x32_bf16 v[140:143], v[248:251], a[72:75], v[140:143]
ds_read_b128 a[8:11], v222 offset:24576
v_accvgpr_write_b32 a178, v108
v_mfma_f32_16x16x32_bf16 v[140:143], v[252:255], a[84:87], v[140:143]
ds_read_b128 a[12:15], v223 offset:24576
v_accvgpr_write_b32 a179, v110
v_mfma_f32_16x16x32_bf16 v[132:135], v[252:255], a[80:83], v[132:135]
v_exp_f32 v113, v113
v_mfma_f32_16x16x32_bf16 v[132:135], v[248:251], a[68:71], v[132:135]
v_exp_f32 v114, v114
v_mfma_f32_16x16x32_bf16 v[124:127], v[248:251], a[64:67], v[124:127]
v_exp_f32 v115, v115
v_mfma_f32_16x16x32_bf16 v[124:127], v[252:255], a[76:79], v[124:127]
v_cvt_pk_bf16_f32 v112, v112, v113
s_waitcnt lgkmcnt(2)
v_mfma_f32_16x16x32_bf16 v[136:139], a[0:3], a[72:75], v[136:139]
ds_read_b128 v[248:251], v222 offset:26624
v_cvt_pk_bf16_f32 v114, v114, v115
v_mfma_f32_16x16x32_bf16 v[136:139], a[4:7], a[84:87], v[136:139]
ds_read_b128 v[252:255], v223 offset:26624
v_accvgpr_write_b32 a180, v112
v_mfma_f32_16x16x32_bf16 v[128:131], a[4:7], a[80:83], v[128:131]
v_exp_f32 v116, v116
v_mfma_f32_16x16x32_bf16 v[128:131], a[0:3], a[68:71], v[128:131]
v_exp_f32 v117, v117
v_mfma_f32_16x16x32_bf16 v[120:123], a[0:3], a[64:67], v[120:123]
v_exp_f32 v118, v118
v_mfma_f32_16x16x32_bf16 v[120:123], a[4:7], a[76:79], v[120:123]
s_waitcnt vmcnt(10) lgkmcnt(2)
s_barrier
v_mfma_f32_16x16x32_bf16 v[120:123], a[8:11], a[88:91], v[120:123]
ds_read_b64_tr_b16 a[0:1], v216 offset:24576
s_add_u32 m0, s67, 49152
v_mfma_f32_16x16x32_bf16 v[120:123], a[12:15], a[100:103], v[120:123]
ds_read_b64_tr_b16 a[2:3], v216 offset:26624
s_add_u32 s69, s78, s86
v_mfma_f32_16x16x32_bf16 v[128:131], a[12:15], a[104:107], v[128:131]
ds_read_b64_tr_b16 a[4:5], v216 offset:28672
buffer_load_dwordx4 v226, s[36:39], s69 offen offset:0 lds
v_mfma_f32_16x16x32_bf16 v[128:131], a[8:11], a[92:95], v[128:131]
ds_read_b64_tr_b16 a[6:7], v216 offset:30720
buffer_load_dwordx4 v227, s[36:39], s69 offen offset:1024 lds
v_exp_f32 v119, v119
v_mfma_f32_16x16x32_bf16 v[136:139], a[8:11], a[96:99], v[136:139]
v_cvt_pk_bf16_f32 v116, v116, v117
v_cvt_pk_bf16_f32 v118, v118, v119
v_mfma_f32_16x16x32_bf16 v[136:139], a[12:15], a[108:111], v[136:139]
v_accvgpr_write_b32 a181, v114
s_waitcnt lgkmcnt(4)
v_mfma_f32_16x16x32_bf16 v[124:127], v[248:251], a[88:91], v[124:127]
ds_read_b64_tr_b16 a[8:9], v217 offset:24576
v_accvgpr_write_b32 a182, v116
v_mfma_f32_16x16x32_bf16 v[124:127], v[252:255], a[100:103], v[124:127]
ds_read_b64_tr_b16 a[10:11], v217 offset:26624
v_accvgpr_write_b32 a183, v118
v_mfma_f32_16x16x32_bf16 v[132:135], v[252:255], a[104:107], v[132:135]
ds_read_b64_tr_b16 a[12:13], v217 offset:28672
v_max3_f32 v244, v120, v121, v122
v_mfma_f32_16x16x32_bf16 v[132:135], v[248:251], a[92:95], v[132:135]
ds_read_b64_tr_b16 a[14:15], v217 offset:30720
v_mfma_f32_16x16x32_bf16 v[140:143], v[248:251], a[96:99], v[140:143]
v_max3_f32 v244, v123, v124, v244
v_max3_f32 v244, v125, v126, v244
v_mfma_f32_16x16x32_bf16 v[140:143], v[252:255], a[108:111], v[140:143]
v_max3_f32 v244, v127, v128, v244
s_waitcnt lgkmcnt(4)
v_mfma_f32_16x16x32_bf16 v[24:27], a[0:3], v[180:183], v[24:27]
ds_read_b64_tr_b16 v[248:249], v216 offset:32768
v_max3_f32 v244, v129, v130, v244
v_mfma_f32_16x16x32_bf16 v[24:27], a[4:7], v[144:147], v[24:27]
ds_read_b64_tr_b16 v[250:251], v216 offset:34816
v_max3_f32 v244, v131, v132, v244
v_mfma_f32_16x16x32_bf16 v[32:35], a[4:7], v[148:151], v[32:35]
ds_read_b64_tr_b16 v[252:253], v216 offset:36864
v_max3_f32 v244, v133, v134, v244
v_mfma_f32_16x16x32_bf16 v[32:35], a[0:3], v[184:187], v[32:35]
ds_read_b64_tr_b16 v[254:255], v216 offset:38912
v_max3_f32 v244, v135, v136, v244
v_mfma_f32_16x16x32_bf16 v[40:43], a[0:3], v[188:191], v[40:43]
v_max3_f32 v244, v137, v138, v244
v_max3_f32 v244, v139, v140, v244
v_mfma_f32_16x16x32_bf16 v[40:43], a[4:7], v[152:155], v[40:43]
v_max3_f32 v244, v141, v142, v244
s_waitcnt lgkmcnt(4)
v_mfma_f32_16x16x32_bf16 v[28:31], a[8:11], v[180:183], v[28:31]
ds_read_b64_tr_b16 a[0:1], v217 offset:32768
v_max_f32 v244, v143, v244
v_mfma_f32_16x16x32_bf16 v[28:31], a[12:15], v[144:147], v[28:31]
ds_read_b64_tr_b16 a[2:3], v217 offset:34816
v_mfma_f32_16x16x32_bf16 v[36:39], a[12:15], v[148:151], v[36:39]
ds_read_b64_tr_b16 a[4:5], v217 offset:36864
v_cmp_lt_f32 vcc, s65, v244
s_cbranch_vccnz L_rare1_6
L_back1_6:
v_mfma_f32_16x16x32_bf16 v[36:39], a[8:11], v[184:187], v[36:39]
ds_read_b64_tr_b16 a[6:7], v217 offset:38912
v_mfma_f32_16x16x32_bf16 v[44:47], a[8:11], v[188:191], v[44:47]
v_exp_f32 v120, v120
v_mfma_f32_16x16x32_bf16 v[44:47], a[12:15], v[152:155], v[44:47]
s_waitcnt vmcnt(8) lgkmcnt(4)
s_barrier
v_mfma_f32_16x16x32_bf16 v[48:51], v[248:251], v[180:183], v[48:51]
ds_read_b128 a[8:11], v222 offset:34816
s_add_u32 m0, s67, 57344
v_exp_f32 v121, v121
v_mfma_f32_16x16x32_bf16 v[48:51], v[252:255], v[144:147], v[48:51]
ds_read_b128 a[12:15], v223 offset:34816
s_add_u32 s69, s72, 262144
v_cvt_pk_bf16_f32 v120, v120, v121
v_mfma_f32_16x16x32_bf16 v[56:59], v[252:255], v[148:151], v[56:59]
buffer_load_dwordx4 v224, s[28:31], s69 offen offset:0 nt lds
buffer_load_dwordx4 v225, s[28:31], s69 offen offset:1024 nt lds
v_accvgpr_write_b32 a184, v120
v_mfma_f32_16x16x32_bf16 v[56:59], v[248:251], v[184:187], v[56:59]
s_add_u32 m0, s67, 65536
s_add_u32 s69, s72, 294912
v_exp_f32 v122, v122
v_mfma_f32_16x16x32_bf16 v[64:67], v[248:251], v[188:191], v[64:67]
buffer_load_dwordx4 v224, s[28:31], s69 offen offset:0 nt lds
buffer_load_dwordx4 v225, s[28:31], s69 offen offset:1024 nt lds
v_mfma_f32_16x16x32_bf16 v[64:67], v[252:255], v[152:155], v[64:67]
s_add_u32 m0, s67, 73728
v_exp_f32 v123, v123
s_waitcnt lgkmcnt(2)
v_mfma_f32_16x16x32_bf16 v[52:55], a[0:3], v[180:183], v[52:55]
ds_read_b128 v[248:251], v222 offset:32768
s_add_u32 s69, s72, 327680
v_cvt_pk_bf16_f32 v122, v122, v123
v_mfma_f32_16x16x32_bf16 v[52:55], a[4:7], v[144:147], v[52:55]
ds_read_b128 v[252:255], v223 offset:32768
buffer_load_dwordx4 v224, s[28:31], s69 offen offset:0 nt lds
v_accvgpr_write_b32 a185, v122
v_mfma_f32_16x16x32_bf16 v[60:63], a[4:7], v[148:151], v[60:63]
buffer_load_dwordx4 v225, s[28:31], s69 offen offset:1024 nt lds
v_mfma_f32_16x16x32_bf16 v[60:63], a[0:3], v[184:187], v[60:63]
v_exp_f32 v124, v124
v_mfma_f32_16x16x32_bf16 v[68:71], a[0:3], v[188:191], v[68:71]
v_exp_f32 v125, v125
v_mfma_f32_16x16x32_bf16 v[68:71], a[4:7], v[152:155], v[68:71]
v_cvt_pk_bf16_f32 v124, v124, v125
s_waitcnt lgkmcnt(2)
v_mfma_f32_16x16x32_bf16 v[116:119], a[8:11], a[24:27], 0
ds_read_b128 a[0:3], v222 offset:40960
v_accvgpr_write_b32 a186, v124
v_mfma_f32_16x16x32_bf16 v[116:119], a[12:15], a[36:39], v[116:119]
ds_read_b128 a[4:7], v223 offset:40960
v_mfma_f32_16x16x32_bf16 v[108:111], a[12:15], a[32:35], 0
v_exp_f32 v126, v126
v_mfma_f32_16x16x32_bf16 v[108:111], a[8:11], a[20:23], v[108:111]
v_exp_f32 v127, v127
v_mfma_f32_16x16x32_bf16 v[100:103], a[8:11], a[16:19], 0
v_exp_f32 v128, v128
v_mfma_f32_16x16x32_bf16 v[100:103], a[12:15], a[28:31], v[100:103]
v_cvt_pk_bf16_f32 v126, v126, v127
s_waitcnt lgkmcnt(2)
v_mfma_f32_16x16x32_bf16 v[112:115], v[248:251], a[24:27], 0
ds_read_b128 a[8:11], v222 offset:43008
v_accvgpr_write_b32 a187, v126
v_mfma_f32_16x16x32_bf16 v[112:115], v[252:255], a[36:39], v[112:115]
ds_read_b128 a[12:15], v223 offset:43008
v_mfma_f32_16x16x32_bf16 v[104:107], v[252:255], a[32:35], 0
v_exp_f32 v129, v129
v_mfma_f32_16x16x32_bf16 v[104:107], v[248:251], a[20:23], v[104:107]
v_exp_f32 v130, v130
v_mfma_f32_16x16x32_bf16 v[96:99], v[248:251], a[16:19], 0
v_exp_f32 v131, v131
v_mfma_f32_16x16x32_bf16 v[96:99], v[252:255], a[28:31], v[96:99]
s_waitcnt vmcnt(10) lgkmcnt(2)
s_barrier
v_mfma_f32_16x16x32_bf16 v[96:99], a[0:3], a[40:43], v[96:99]
ds_read_b128 v[248:251], v222 offset:51200
s_add_u32 m0, s67, 81920
v_mfma_f32_16x16x32_bf16 v[96:99], a[4:7], a[52:55], v[96:99]
ds_read_b128 v[252:255], v223 offset:51200
s_add_u32 s69, s72, 360448
v_mfma_f32_16x16x32_bf16 v[104:107], a[4:7], a[56:59], v[104:107]
buffer_load_dwordx4 v224, s[28:31], s69 offen offset:0 nt lds
buffer_load_dwordx4 v225, s[28:31], s69 offen offset:1024 nt lds
v_exp_f32 v132, v132
v_mfma_f32_16x16x32_bf16 v[104:107], a[0:3], a[44:47], v[104:107]
s_add_u32 m0, s67, 0
s_add_u32 s69, s79, s80
v_cvt_pk_bf16_f32 v128, v128, v129
v_mfma_f32_16x16x32_bf16 v[112:115], a[0:3], a[48:51], v[112:115]
buffer_load_dwordx4 v226, s[36:39], s69 offen offset:0 lds
buffer_load_dwordx4 v227, s[36:39], s69 offen offset:1024 lds
v_exp_f32 v133, v133
v_mfma_f32_16x16x32_bf16 v[112:115], a[4:7], a[60:63], v[112:115]
v_cvt_pk_bf16_f32 v130, v130, v131
s_waitcnt lgkmcnt(2)
v_mfma_f32_16x16x32_bf16 v[100:103], a[8:11], a[40:43], v[100:103]
ds_read_b128 a[0:3], v222 offset:49152
v_cvt_pk_bf16_f32 v132, v132, v133
v_accvgpr_write_b32 a188, v128
v_mfma_f32_16x16x32_bf16 v[100:103], a[12:15], a[52:55], v[100:103]
ds_read_b128 a[4:7], v223 offset:49152
v_accvgpr_write_b32 a189, v130
v_accvgpr_write_b32 a190, v132
v_mfma_f32_16x16x32_bf16 v[108:111], a[12:15], a[56:59], v[108:111]
v_exp_f32 v134, v134
v_mfma_f32_16x16x32_bf16 v[108:111], a[8:11], a[44:47], v[108:111]
v_exp_f32 v135, v135
v_mfma_f32_16x16x32_bf16 v[116:119], a[8:11], a[48:51], v[116:119]
v_exp_f32 v136, v136
v_mfma_f32_16x16x32_bf16 v[116:119], a[12:15], a[60:63], v[116:119]
v_cvt_pk_bf16_f32 v134, v134, v135
v_exp_f32 v137, v137
s_waitcnt lgkmcnt(2)
v_mfma_f32_16x16x32_bf16 v[116:119], v[248:251], a[72:75], v[116:119]
ds_read_b128 a[8:11], v222 offset:57344
v_cvt_pk_bf16_f32 v136, v136, v137
v_accvgpr_write_b32 a191, v134
v_mfma_f32_16x16x32_bf16 v[116:119], v[252:255], a[84:87], v[116:119]
ds_read_b128 a[12:15], v223 offset:57344
v_accvgpr_write_b32 a192, v136
v_mfma_f32_16x16x32_bf16 v[108:111], v[252:255], a[80:83], v[108:111]
v_exp_f32 v138, v138
v_mfma_f32_16x16x32_bf16 v[108:111], v[248:251], a[68:71], v[108:111]
v_exp_f32 v139, v139
v_mfma_f32_16x16x32_bf16 v[100:103], v[248:251], a[64:67], v[100:103]
v_exp_f32 v140, v140
v_cvt_pk_bf16_f32 v138, v138, v139
v_mfma_f32_16x16x32_bf16 v[100:103], v[252:255], a[76:79], v[100:103]
v_accvgpr_write_b32 a193, v138
v_exp_f32 v141, v141
s_waitcnt lgkmcnt(2)
v_mfma_f32_16x16x32_bf16 v[112:115], a[0:3], a[72:75], v[112:115]
ds_read_b128 v[248:251], v222 offset:59392
v_cvt_pk_bf16_f32 v140, v140, v141
v_mfma_f32_16x16x32_bf16 v[112:115], a[4:7], a[84:87], v[112:115]
ds_read_b128 v[252:255], v223 offset:59392
v_accvgpr_write_b32 a194, v140
v_exp_f32 v142, v142
v_mfma_f32_16x16x32_bf16 v[104:107], a[4:7], a[80:83], v[104:107]
v_exp_f32 v143, v143
v_mfma_f32_16x16x32_bf16 v[104:107], a[0:3], a[68:71], v[104:107]
v_cvt_pk_bf16_f32 v142, v142, v143
v_accvgpr_write_b32 a195, v142
v_mfma_f32_16x16x32_bf16 v[96:99], a[0:3], a[64:67], v[96:99]
v_mfma_f32_16x16x32_bf16 v[96:99], a[4:7], a[76:79], v[96:99]
v_accvgpr_write_b32 a76, v246
v_accvgpr_write_b32 a77, v246
v_accvgpr_write_b32 a78, v246
s_waitcnt vmcnt(10) lgkmcnt(2)
s_barrier
v_mfma_f32_16x16x32_bf16 v[96:99], a[8:11], a[88:91], v[96:99]
ds_read_b64_tr_b16 a[0:1], v216 offset:40960
s_add_u32 m0, s67, 8192
v_accvgpr_write_b32 a79, v246
v_and_b32 v246, 0xf0, v228
v_mfma_f32_16x16x32_bf16 v[96:99], a[12:15], a[100:103], v[96:99]
ds_read_b64_tr_b16 a[2:3], v216 offset:43008
s_add_u32 s69, s79, s81
v_lshlrev_b32 v247, 1, v246
v_and_b32 v246, 0xfffffc00, v228
v_add_u32 v246, v246, v247
v_mfma_f32_16x16x32_bf16 v[104:107], a[12:15], a[104:107], v[104:107]
ds_read_b64_tr_b16 a[4:5], v216 offset:45056
buffer_load_dwordx4 v226, s[36:39], s69 offen offset:0 lds
v_mfma_f32_16x16x32_bf16 v[104:107], a[8:11], a[92:95], v[104:107]
ds_read_b64_tr_b16 a[6:7], v216 offset:47104
buffer_load_dwordx4 v227, s[36:39], s69 offen offset:1024 lds
v_mfma_f32_16x16x32_bf16 v[112:115], a[8:11], a[96:99], v[112:115]
v_and_b32 v222, 0x3f0, v228
v_mov_b32 v223, 1
v_max3_f32 v244, v96, v97, v98
v_mfma_f32_16x16x32_bf16 v[112:115], a[12:15], a[108:111], v[112:115]
s_waitcnt lgkmcnt(4)
v_mfma_f32_16x16x32_bf16 v[100:103], v[248:251], a[88:91], v[100:103]
ds_read_b64_tr_b16 a[8:9], v217 offset:40960
v_mfma_f32_16x16x32_bf16 v[100:103], v[252:255], a[100:103], v[100:103]
ds_read_b64_tr_b16 a[10:11], v217 offset:43008
v_mfma_f32_16x16x32_bf16 v[108:111], v[252:255], a[104:107], v[108:111]
ds_read_b64_tr_b16 a[12:13], v217 offset:45056
v_mfma_f32_16x16x32_bf16 v[108:111], v[248:251], a[92:95], v[108:111]
ds_read_b64_tr_b16 a[14:15], v217 offset:47104
v_mfma_f32_16x16x32_bf16 v[116:119], v[248:251], a[96:99], v[116:119]
s_nop 1
v_max3_f32 v244, v99, v100, v244
v_max3_f32 v244, v101, v102, v244
v_max3_f32 v244, v103, v104, v244
v_max3_f32 v244, v105, v106, v244
v_mfma_f32_16x16x32_bf16 v[116:119], v[252:255], a[108:111], v[116:119]
s_waitcnt lgkmcnt(4)
v_mfma_f32_16x16x32_bf16 v[72:75], a[0:3], v[180:183], v[72:75]
ds_read_b64_tr_b16 v[248:249], v216 offset:49152
v_max3_f32 v244, v107, v108, v244
v_max3_f32 v244, v109, v110, v244
v_max3_f32 v244, v111, v112, v244
v_max3_f32 v244, v113, v114, v244
v_mfma_f32_16x16x32_bf16 v[72:75], a[4:7], v[144:147], v[72:75]
ds_read_b64_tr_b16 v[250:251], v216 offset:51200
v_mfma_f32_16x16x32_bf16 v[80:83], a[4:7], v[148:151], v[80:83]
ds_read_b64_tr_b16 v[252:253], v216 offset:53248
v_max3_f32 v244, v115, v116, v244
v_max3_f32 v244, v117, v118, v244
v_max_f32 v244, v119, v244
v_cmp_lt_f32 vcc, s65, v244
s_cbranch_vccnz L_rare1_7
L_back1_7:
v_mfma_f32_16x16x32_bf16 v[80:83], a[0:3], v[184:187], v[80:83]
ds_read_b64_tr_b16 v[254:255], v216 offset:55296
ds_write_b64 v246, v[232:233] offset:9216
v_exp_f32 v96, v96
v_mfma_f32_16x16x32_bf16 v[88:91], a[0:3], v[188:191], v[88:91]
v_exp_f32 v97, v97
v_exp_f32 v98, v98
v_mfma_f32_16x16x32_bf16 v[88:91], a[4:7], v[152:155], v[88:91]
v_cvt_pk_bf16_f32 v96, v96, v97
v_exp_f32 v99, v99
s_waitcnt lgkmcnt(5)
v_mfma_f32_16x16x32_bf16 v[76:79], a[8:11], v[180:183], v[76:79]
ds_read_b64_tr_b16 a[0:1], v217 offset:49152
v_cvt_pk_bf16_f32 v98, v98, v99
v_exp_f32 v100, v100
v_accvgpr_write_b32 a196, v96
v_mfma_f32_16x16x32_bf16 v[76:79], a[12:15], v[144:147], v[76:79]
ds_read_b64_tr_b16 a[2:3], v217 offset:51200
v_accvgpr_write_b32 a197, v98
v_exp_f32 v101, v101
v_mfma_f32_16x16x32_bf16 v[84:87], a[12:15], v[148:151], v[84:87]
ds_read_b64_tr_b16 a[4:5], v217 offset:53248
v_cvt_pk_bf16_f32 v100, v100, v101
v_exp_f32 v102, v102
v_accvgpr_write_b32 a198, v100
v_mfma_f32_16x16x32_bf16 v[84:87], a[8:11], v[184:187], v[84:87]
ds_read_b64_tr_b16 a[6:7], v217 offset:55296
v_exp_f32 v103, v103
v_exp_f32 v104, v104
v_mfma_f32_16x16x32_bf16 v[92:95], a[8:11], v[188:191], v[92:95]
v_exp_f32 v105, v105
v_cvt_pk_bf16_f32 v102, v102, v103
v_mfma_f32_16x16x32_bf16 v[92:95], a[12:15], v[152:155], v[92:95]
v_exp_f32 v106, v106
v_exp_f32 v107, v107
s_waitcnt vmcnt(8) lgkmcnt(5)
s_barrier
v_mfma_f32_16x16x32_bf16 v[192:195], v[248:251], v[180:183], v[192:195]
ds_read_b64_tr_b16 a[8:9], v220 offset:0
s_add_u32 m0, s67, 90112
v_exp_f32 v108, v108
v_cvt_pk_bf16_f32 v104, v104, v105
v_mfma_f32_16x16x32_bf16 v[192:195], v[252:255], v[144:147], v[192:195]
ds_read_b64_tr_b16 a[10:11], v220 offset:2048
s_add_u32 s69, s72, 393216
v_exp_f32 v109, v109
v_exp_f32 v110, v110
v_mfma_f32_16x16x32_bf16 v[200:203], v[252:255], v[148:151], v[200:203]
ds_read_b64_tr_b16 a[12:13], v220 offset:8192
buffer_load_dwordx4 v224, s[28:31], s69 offen offset:0 nt lds
v_exp_f32 v111, v111
v_cvt_pk_bf16_f32 v106, v106, v107
v_mfma_f32_16x16x32_bf16 v[200:203], v[248:251], v[184:187], v[200:203]
ds_read_b64_tr_b16 a[14:15], v220 offset:10240
buffer_load_dwordx4 v225, s[28:31], s69 offen offset:1024 nt lds
v_exp_f32 v112, v112
v_cvt_pk_bf16_f32 v108, v108, v109
v_mfma_f32_16x16x32_bf16 v[208:211], v[248:251], v[188:191], v[208:211]
v_exp_f32 v113, v113
v_exp_f32 v114, v114
v_mfma_f32_16x16x32_bf16 v[208:211], v[252:255], v[152:155], v[208:211]
v_cvt_pk_bf16_f32 v110, v110, v111
v_exp_f32 v115, v115
s_waitcnt lgkmcnt(4)
v_mfma_f32_16x16x32_bf16 v[196:199], a[0:3], v[180:183], v[196:199]
ds_read_b64_tr_b16 v[248:249], v221 offset:0
ds_read_b128 v[180:183], v230 offset:6144
v_exp_f32 v116, v116
v_exp_f32 v117, v117
v_mfma_f32_16x16x32_bf16 v[196:199], a[4:7], v[144:147], v[196:199]
ds_read_b64_tr_b16 v[250:251], v221 offset:2048
ds_read_b128 v[144:147], v230 offset:16384
v_exp_f32 v118, v118
v_cvt_pk_bf16_f32 v112, v112, v113
v_mfma_f32_16x16x32_bf16 v[204:207], a[4:7], v[148:151], v[204:207]
ds_read_b64_tr_b16 v[252:253], v221 offset:8192
ds_read_b128 v[148:151], v230 offset:17408
v_exp_f32 v119, v119
v_cvt_pk_bf16_f32 v114, v114, v115
v_mfma_f32_16x16x32_bf16 v[204:207], a[0:3], v[184:187], v[204:207]
ds_read_b64_tr_b16 v[254:255], v221 offset:10240
ds_read_b128 v[184:187], v230 offset:7168
v_cvt_pk_bf16_f32 v116, v116, v117
v_cvt_pk_bf16_f32 v118, v118, v119
v_accvgpr_write_b32 a199, v102
v_accvgpr_write_b32 a200, v104
v_mfma_f32_16x16x32_bf16 v[212:215], a[0:3], v[188:191], v[212:215]
ds_read_b128 v[188:191], v230 offset:8192
v_accvgpr_write_b32 a201, v106
v_accvgpr_write_b32 a202, v108
v_accvgpr_write_b32 a203, v110
v_mfma_f32_16x16x32_bf16 v[212:215], a[4:7], v[152:155], v[212:215]
ds_read_b128 v[152:155], v230 offset:18432
v_accvgpr_write_b32 a204, v112
v_accvgpr_write_b32 a205, v114
v_accvgpr_write_b32 a206, v116
v_accvgpr_write_b32 a207, v118
s_waitcnt lgkmcnt(10)
v_mfma_f32_16x16x32_bf16 v[120:123], a[8:11], a[112:115], 0
ds_read_b64_tr_b16 a[0:1], v218 offset:0
v_mfma_f32_16x16x32_bf16 v[120:123], a[12:15], a[124:127], v[120:123]
ds_read_b64_tr_b16 a[2:3], v218 offset:2048
v_mfma_f32_16x16x32_bf16 v[128:131], a[12:15], a[128:131], 0
ds_read_b64_tr_b16 a[4:5], v218 offset:8192
v_mfma_f32_16x16x32_bf16 v[128:131], a[8:11], a[116:119], v[128:131]
ds_read_b64_tr_b16 a[6:7], v218 offset:10240
v_mfma_f32_16x16x32_bf16 v[136:139], a[8:11], a[120:123], 0
v_mfma_f32_16x16x32_bf16 v[136:139], a[12:15], a[132:135], v[136:139]
s_waitcnt lgkmcnt(7)
v_mfma_f32_16x16x32_bf16 v[124:127], v[248:251], a[112:115], 0
ds_read_b64_tr_b16 a[8:9], v219 offset:0
v_mfma_f32_16x16x32_bf16 v[124:127], v[252:255], a[124:127], v[124:127]
ds_read_b64_tr_b16 a[10:11], v219 offset:2048
v_mfma_f32_16x16x32_bf16 v[132:135], v[252:255], a[128:131], 0
ds_read_b64_tr_b16 a[12:13], v219 offset:8192
v_mfma_f32_16x16x32_bf16 v[132:135], v[248:251], a[116:119], v[132:135]
ds_read_b64_tr_b16 a[14:15], v219 offset:10240
v_mfma_f32_16x16x32_bf16 v[140:143], v[248:251], a[120:123], 0
v_mfma_f32_16x16x32_bf16 v[140:143], v[252:255], a[132:135], v[140:143]
s_waitcnt vmcnt(6)
s_barrier
v_mfma_f32_16x16x32_bf16 a[64:67], a[76:79], a[112:115], 0
s_add_u32 m0, s67, 98304
s_add_u32 s69, s72, 425984
v_mfma_f32_16x16x32_bf16 a[64:67], a[76:79], a[124:127], a[64:67]
buffer_load_dwordx4 v224, s[28:31], s69 offen offset:0 nt lds
buffer_load_dwordx4 v225, s[28:31], s69 offen offset:1024 nt lds
v_mfma_f32_16x16x32_bf16 a[68:71], a[76:79], a[128:131], 0
s_add_u32 m0, s67, 106496
s_add_u32 s69, s72, 458752
v_mfma_f32_16x16x32_bf16 a[68:71], a[76:79], a[116:119], a[68:71]
buffer_load_dwordx4 v224, s[28:31], s69 offen offset:0 nt lds
buffer_load_dwordx4 v225, s[28:31], s69 offen offset:1024 nt lds
v_mfma_f32_16x16x32_bf16 a[72:75], a[76:79], a[120:123], 0
v_mfma_f32_16x16x32_bf16 a[72:75], a[76:79], a[132:135], a[72:75]
s_waitcnt lgkmcnt(4)
v_mfma_f32_16x16x32_bf16 v[96:99], a[0:3], a[112:115], 0
ds_read_b64_tr_b16 v[248:249], v220 offset:16384
v_mfma_f32_16x16x32_bf16 v[96:99], a[4:7], a[124:127], v[96:99]
ds_read_b64_tr_b16 v[250:251], v220 offset:18432
v_mfma_f32_16x16x32_bf16 v[104:107], a[4:7], a[128:131], 0
ds_read_b64_tr_b16 v[252:253], v220 offset:24576
v_mfma_f32_16x16x32_bf16 v[104:107], a[0:3], a[116:119], v[104:107]
ds_read_b64_tr_b16 v[254:255], v220 offset:26624
v_mfma_f32_16x16x32_bf16 v[112:115], a[0:3], a[120:123], 0
v_mfma_f32_16x16x32_bf16 v[112:115], a[4:7], a[132:135], v[112:115]
s_waitcnt lgkmcnt(4)
v_mfma_f32_16x16x32_bf16 v[100:103], a[8:11], a[112:115], 0
ds_read_b64_tr_b16 a[0:1], v221 offset:16384
v_mfma_f32_16x16x32_bf16 v[100:103], a[12:15], a[124:127], v[100:103]
ds_read_b64_tr_b16 a[2:3], v221 offset:18432
v_mfma_f32_16x16x32_bf16 v[108:111], a[12:15], a[128:131], 0
ds_read_b64_tr_b16 a[4:5], v221 offset:24576
v_mfma_f32_16x16x32_bf16 v[108:111], a[8:11], a[116:119], v[108:111]
ds_read_b64_tr_b16 a[6:7], v221 offset:26624
v_mfma_f32_16x16x32_bf16 v[116:119], a[8:11], a[120:123], 0
v_mfma_f32_16x16x32_bf16 v[116:119], a[12:15], a[132:135], v[116:119]
v_mfma_f32_16x16x32_bf16 a[64:67], a[76:79], a[136:139], a[64:67]
v_mfma_f32_16x16x32_bf16 a[64:67], a[76:79], a[148:151], a[64:67]
v_mfma_f32_16x16x32_bf16 a[68:71], a[76:79], a[152:155], a[68:71]
v_mfma_f32_16x16x32_bf16 a[68:71], a[76:79], a[140:143], a[68:71]
v_mfma_f32_16x16x32_bf16 a[72:75], a[76:79], a[144:147], a[72:75]
v_mfma_f32_16x16x32_bf16 a[72:75], a[76:79], a[156:159], a[72:75]
s_waitcnt lgkmcnt(4)
v_mfma_f32_16x16x32_bf16 v[120:123], v[248:251], a[136:139], v[120:123]
ds_read_b64_tr_b16 a[8:9], v218 offset:16384
v_mfma_f32_16x16x32_bf16 v[120:123], v[252:255], a[148:151], v[120:123]
ds_read_b64_tr_b16 a[10:11], v218 offset:18432
v_mfma_f32_16x16x32_bf16 v[128:131], v[252:255], a[152:155], v[128:131]
ds_read_b64_tr_b16 a[12:13], v218 offset:24576
v_mfma_f32_16x16x32_bf16 v[128:131], v[248:251], a[140:143], v[128:131]
ds_read_b64_tr_b16 a[14:15], v218 offset:26624
v_mfma_f32_16x16x32_bf16 v[136:139], v[248:251], a[144:147], v[136:139]
v_mfma_f32_16x16x32_bf16 v[136:139], v[252:255], a[156:159], v[136:139]
s_waitcnt lgkmcnt(4)
v_mfma_f32_16x16x32_bf16 v[124:127], a[0:3], a[136:139], v[124:127]
ds_read_b64_tr_b16 v[248:249], v219 offset:16384
v_mfma_f32_16x16x32_bf16 v[124:127], a[4:7], a[148:151], v[124:127]
ds_read_b64_tr_b16 v[250:251], v219 offset:18432
v_mfma_f32_16x16x32_bf16 v[132:135], a[4:7], a[152:155], v[132:135]
ds_read_b64_tr_b16 v[252:253], v219 offset:24576
v_mfma_f32_16x16x32_bf16 v[132:135], a[0:3], a[140:143], v[132:135]
ds_read_b64_tr_b16 v[254:255], v219 offset:26624
v_mfma_f32_16x16x32_bf16 v[140:143], a[0:3], a[144:147], v[140:143]
v_mfma_f32_16x16x32_bf16 v[140:143], a[4:7], a[156:159], v[140:143]
s_waitcnt vmcnt(6)
s_barrier
v_mfma_f32_16x16x32_bf16 a[64:67], a[76:79], a[160:163], a[64:67]
s_add_u32 m0, s67, 114688
s_add_u32 s69, s72, 491520
v_mfma_f32_16x16x32_bf16 a[64:67], a[76:79], a[172:175], a[64:67]
buffer_load_dwordx4 v224, s[28:31], s69 offen offset:0 nt lds
buffer_load_dwordx4 v225, s[28:31], s69 offen offset:1024 nt lds
v_mfma_f32_16x16x32_bf16 a[68:71], a[76:79], a[176:179], a[68:71]
s_add_u32 m0, s67, 16384
s_add_u32 s69, s79, s82
v_mfma_f32_16x16x32_bf16 a[68:71], a[76:79], a[164:167], a[68:71]
buffer_load_dwordx4 v226, s[36:39], s69 offen offset:0 lds
buffer_load_dwordx4 v227, s[36:39], s69 offen offset:1024 lds
v_mfma_f32_16x16x32_bf16 a[72:75], a[76:79], a[168:171], a[72:75]
s_add_u32 m0, s67, 24576
s_add_u32 s69, s79, s83
v_mfma_f32_16x16x32_bf16 a[72:75], a[76:79], a[180:183], a[72:75]
buffer_load_dwordx4 v226, s[36:39], s69 offen offset:0 lds
s_waitcnt lgkmcnt(4)
v_mfma_f32_16x16x32_bf16 v[96:99], a[8:11], a[136:139], v[96:99]
ds_read_b64_tr_b16 a[0:1], v216 offset:0
buffer_load_dwordx4 v227, s[36:39], s69 offen offset:1024 lds
v_mfma_f32_16x16x32_bf16 v[96:99], a[12:15], a[148:151], v[96:99]
ds_read_b64_tr_b16 a[2:3], v216 offset:2048
v_mfma_f32_16x16x32_bf16 v[104:107], a[12:15], a[152:155], v[104:107]
ds_read_b64_tr_b16 a[4:5], v216 offset:4096
v_mfma_f32_16x16x32_bf16 v[104:107], a[8:11], a[140:143], v[104:107]
ds_read_b64_tr_b16 a[6:7], v216 offset:6144
v_mfma_f32_16x16x32_bf16 v[112:115], a[8:11], a[144:147], v[112:115]
v_mfma_f32_16x16x32_bf16 v[112:115], a[12:15], a[156:159], v[112:115]
s_waitcnt lgkmcnt(4)
v_mfma_f32_16x16x32_bf16 v[100:103], v[248:251], a[136:139], v[100:103]
ds_read_b64_tr_b16 a[8:9], v217 offset:0
v_mfma_f32_16x16x32_bf16 v[100:103], v[252:255], a[148:151], v[100:103]
ds_read_b64_tr_b16 a[10:11], v217 offset:2048
v_mfma_f32_16x16x32_bf16 v[108:111], v[252:255], a[152:155], v[108:111]
ds_read_b64_tr_b16 a[12:13], v217 offset:4096
v_mfma_f32_16x16x32_bf16 v[108:111], v[248:251], a[140:143], v[108:111]
ds_read_b64_tr_b16 a[14:15], v217 offset:6144
v_mfma_f32_16x16x32_bf16 v[116:119], v[248:251], a[144:147], v[116:119]
v_mfma_f32_16x16x32_bf16 v[116:119], v[252:255], a[156:159], v[116:119]
v_mfma_f32_16x16x32_bf16 a[64:67], a[76:79], a[184:187], a[64:67]
v_mfma_f32_16x16x32_bf16 a[64:67], a[76:79], a[196:199], a[64:67]
v_mfma_f32_16x16x32_bf16 a[68:71], a[76:79], a[200:203], a[68:71]
v_mfma_f32_16x16x32_bf16 a[68:71], a[76:79], a[188:191], a[68:71]
v_mfma_f32_16x16x32_bf16 a[72:75], a[76:79], a[192:195], a[72:75]
s_nop 4
v_accvgpr_read_b32 v235, a64
v_mfma_f32_16x16x32_bf16 a[72:75], a[76:79], a[204:207], a[72:75]
ds_write_b64 v246, v[234:235] offset:9224
s_waitcnt lgkmcnt(5)
v_mfma_f32_16x16x32_bf16 a[208:211], a[0:3], v[180:183], a[208:211]
ds_read_b64_tr_b16 v[248:249], v216 offset:8192
v_accvgpr_read_b32 v236, a68
v_mfma_f32_16x16x32_bf16 a[208:211], a[4:7], v[144:147], a[208:211]
ds_read_b64_tr_b16 v[250:251], v216 offset:10240
v_mfma_f32_16x16x32_bf16 a[216:219], a[4:7], v[148:151], a[216:219]
ds_read_b64_tr_b16 v[252:253], v216 offset:12288
v_accvgpr_read_b32 v237, a72
v_mfma_f32_16x16x32_bf16 a[216:219], a[0:3], v[184:187], a[216:219]
ds_read_b64_tr_b16 v[254:255], v216 offset:14336
ds_write_b64 v246, v[236:237] offset:9232
v_and_b32 v246, 0xfffffc00, v229
v_mfma_f32_16x16x32_bf16 a[224:227], a[0:3], v[188:191], a[224:227]
v_add_u32 v246, v246, v247
v_mfma_f32_16x16x32_bf16 a[224:227], a[4:7], v[152:155], a[224:227]
s_waitcnt lgkmcnt(6)
v_mfma_f32_16x16x32_bf16 a[212:215], a[8:11], v[180:183], a[212:215]
ds_read_b64_tr_b16 a[0:1], v217 offset:8192
v_mfma_f32_16x16x32_bf16 a[212:215], a[12:15], v[144:147], a[212:215]
ds_read_b64_tr_b16 a[2:3], v217 offset:10240
v_mfma_f32_16x16x32_bf16 a[220:223], a[12:15], v[148:151], a[220:223]
ds_read_b64_tr_b16 a[4:5], v217 offset:12288
v_mfma_f32_16x16x32_bf16 a[220:223], a[8:11], v[184:187], a[220:223]
ds_read_b64_tr_b16 a[6:7], v217 offset:14336
v_mfma_f32_16x16x32_bf16 a[228:231], a[8:11], v[188:191], a[228:231]
v_mfma_f32_16x16x32_bf16 a[228:231], a[12:15], v[152:155], a[228:231]
s_waitcnt vmcnt(8) lgkmcnt(4)
s_barrier
v_mfma_f32_16x16x32_bf16 a[232:235], v[248:251], v[180:183], a[232:235]
ds_read_b64_tr_b16 a[8:9], v220 offset:32768
s_add_u32 m0, s67, 32768
v_mfma_f32_16x16x32_bf16 a[232:235], v[252:255], v[144:147], a[232:235]
ds_read_b64_tr_b16 a[10:11], v220 offset:34816
s_add_u32 s69, s79, s84
v_mfma_f32_16x16x32_bf16 a[240:243], v[252:255], v[148:151], a[240:243]
ds_read_b64_tr_b16 a[12:13], v220 offset:40960
buffer_load_dwordx4 v226, s[36:39], s69 offen offset:0 lds
v_mfma_f32_16x16x32_bf16 a[240:243], v[248:251], v[184:187], a[240:243]
ds_read_b64_tr_b16 a[14:15], v220 offset:43008
buffer_load_dwordx4 v227, s[36:39], s69 offen offset:1024 lds
v_mfma_f32_16x16x32_bf16 a[248:251], v[248:251], v[188:191], a[248:251]
ds_read_b128 v[238:241], v246 offset:9216
v_mfma_f32_16x16x32_bf16 a[248:251], v[252:255], v[152:155], a[248:251]
ds_read_b64 v[242:243], v246 offset:9232
s_waitcnt lgkmcnt(6)
v_mfma_f32_16x16x32_bf16 a[236:239], a[0:3], v[180:183], a[236:239]
ds_read_b64_tr_b16 v[248:249], v221 offset:32768
v_mfma_f32_16x16x32_bf16 a[236:239], a[4:7], v[144:147], a[236:239]
ds_read_b64_tr_b16 v[250:251], v221 offset:34816
v_mfma_f32_16x16x32_bf16 a[244:247], a[4:7], v[148:151], a[244:247]
ds_read_b64_tr_b16 v[252:253], v221 offset:40960
v_mfma_f32_16x16x32_bf16 a[244:247], a[0:3], v[184:187], a[244:247]
ds_read_b64_tr_b16 v[254:255], v221 offset:43008
v_mfma_f32_16x16x32_bf16 a[252:255], a[0:3], v[188:191], a[252:255]
s_waitcnt lgkmcnt(5)
v_max_f32 v244, v232, v238
v_mfma_f32_16x16x32_bf16 a[252:255], a[4:7], v[152:155], a[252:255]
v_sub_f32 v245, v238, v244
v_sub_f32 v244, v232, v244
v_mfma_f32_16x16x32_bf16 v[120:123], a[8:11], a[160:163], v[120:123]
ds_read_b64_tr_b16 a[0:1], v218 offset:32768
v_max_f32 v231, v233, v239
v_mfma_f32_16x16x32_bf16 v[120:123], a[12:15], a[172:175], v[120:123]
ds_read_b64_tr_b16 a[2:3], v218 offset:34816
v_max_f32 v246, v234, v240
v_mfma_f32_16x16x32_bf16 v[128:131], a[12:15], a[176:179], v[128:131]
ds_read_b64_tr_b16 a[4:5], v218 offset:40960
v_sub_f32 v247, v239, v231
v_mfma_f32_16x16x32_bf16 v[128:131], a[8:11], a[164:167], v[128:131]
ds_read_b64_tr_b16 a[6:7], v218 offset:43008
v_sub_f32 v232, v240, v246
v_mfma_f32_16x16x32_bf16 v[136:139], a[8:11], a[168:171], v[136:139]
v_exp_f32 v245, v245
v_mfma_f32_16x16x32_bf16 v[136:139], a[12:15], a[180:183], v[136:139]
v_sub_f32 v231, v233, v231
s_waitcnt lgkmcnt(4)
v_mfma_f32_16x16x32_bf16 v[124:127], v[248:251], a[160:163], v[124:127]
ds_read_b64_tr_b16 a[8:9], v219 offset:32768
v_sub_f32 v246, v234, v246
v_mfma_f32_16x16x32_bf16 v[124:127], v[252:255], a[172:175], v[124:127]
ds_read_b64_tr_b16 a[10:11], v219 offset:34816
v_mul_f32 v241, v245, v241
v_mfma_f32_16x16x32_bf16 v[132:135], v[252:255], a[176:179], v[132:135]
ds_read_b64_tr_b16 a[12:13], v219 offset:40960
v_mfma_f32_16x16x32_bf16 v[132:135], v[248:251], a[164:167], v[132:135]
ds_read_b64_tr_b16 a[14:15], v219 offset:43008
v_mfma_f32_16x16x32_bf16 v[140:143], v[248:251], a[168:171], v[140:143]
v_exp_f32 v247, v247
v_mfma_f32_16x16x32_bf16 v[140:143], v[252:255], a[180:183], v[140:143]
s_waitcnt vmcnt(6) lgkmcnt(4)
s_barrier
v_mfma_f32_16x16x32_bf16 v[96:99], a[0:3], a[160:163], v[96:99]
ds_read_b64_tr_b16 v[248:249], v220 offset:49152
s_add_u32 m0, s67, 57344
v_mfma_f32_16x16x32_bf16 v[96:99], a[4:7], a[172:175], v[96:99]
ds_read_b64_tr_b16 v[250:251], v220 offset:51200
s_add_u32 s69, s73, 262144
v_exp_f32 v232, v232
v_mfma_f32_16x16x32_bf16 v[104:107], a[4:7], a[176:179], v[104:107]
ds_read_b64_tr_b16 v[252:253], v220 offset:57344
buffer_load_dwordx4 v224, s[28:31], s69 offen offset:0 nt lds
v_mul_f32 v242, v247, v242
v_mfma_f32_16x16x32_bf16 v[104:107], a[0:3], a[164:167], v[104:107]
ds_read_b64_tr_b16 v[254:255], v220 offset:59392
buffer_load_dwordx4 v225, s[28:31], s69 offen offset:1024 nt lds
v_mul_f32 v243, v232, v243
v_mfma_f32_16x16x32_bf16 v[112:115], a[0:3], a[168:171], v[112:115]
s_add_u32 m0, s67, 65536
s_add_u32 s69, s73, 294912
v_mfma_f32_16x16x32_bf16 v[112:115], a[4:7], a[180:183], v[112:115]
buffer_load_dwordx4 v224, s[28:31], s69 offen offset:0 nt lds
v_exp_f32 v244, v244
s_waitcnt lgkmcnt(4)
v_mfma_f32_16x16x32_bf16 v[100:103], a[8:11], a[160:163], v[100:103]
ds_read_b64_tr_b16 a[0:1], v221 offset:49152
buffer_load_dwordx4 v225, s[28:31], s69 offen offset:1024 nt lds
v_fmac_f32 v241, v244, v235
v_mfma_f32_16x16x32_bf16 v[100:103], a[12:15], a[172:175], v[100:103]
ds_read_b64_tr_b16 a[2:3], v221 offset:51200
v_mfma_f32_16x16x32_bf16 v[108:111], a[12:15], a[176:179], v[108:111]
ds_read_b64_tr_b16 a[4:5], v221 offset:57344
v_exp_f32 v231, v231
v_mfma_f32_16x16x32_bf16 v[108:111], a[8:11], a[164:167], v[108:111]
ds_read_b64_tr_b16 a[6:7], v221 offset:59392
v_fmac_f32 v242, v231, v236
v_mfma_f32_16x16x32_bf16 v[116:119], a[8:11], a[168:171], v[116:119]
v_exp_f32 v246, v246
v_mfma_f32_16x16x32_bf16 v[116:119], a[12:15], a[180:183], v[116:119]
v_fmac_f32 v243, v246, v237
s_waitcnt lgkmcnt(4)
v_mfma_f32_16x16x32_bf16 v[120:123], v[248:251], a[184:187], v[120:123]
ds_read_b64_tr_b16 a[8:9], v218 offset:49152
v_mfma_f32_16x16x32_bf16 v[120:123], v[252:255], a[196:199], v[120:123]
ds_read_b64_tr_b16 a[10:11], v218 offset:51200
v_mfma_f32_16x16x32_bf16 v[128:131], v[252:255], a[200:203], v[128:131]
ds_read_b64_tr_b16 a[12:13], v218 offset:57344
v_rcp_f32 v241, v241
v_mfma_f32_16x16x32_bf16 v[128:131], v[248:251], a[188:191], v[128:131]
ds_read_b64_tr_b16 a[14:15], v218 offset:59392
v_mul_f32 v238, v244, v241
v_mfma_f32_16x16x32_bf16 v[136:139], v[248:251], a[192:195], v[136:139]
ds_write_b64 v228, v[120:121] offset:0
v_mul_f32 v241, v245, v241
v_mfma_f32_16x16x32_bf16 v[136:139], v[252:255], a[204:207], v[136:139]
v_rcp_f32 v242, v242
s_waitcnt lgkmcnt(5)
v_mfma_f32_16x16x32_bf16 v[124:127], a[0:3], a[184:187], v[124:127]
ds_read_b64_tr_b16 v[248:249], v219 offset:49152
ds_write_b64 v228, v[122:123] offset:8
v_mfma_f32_16x16x32_bf16 v[124:127], a[4:7], a[196:199], v[124:127]
ds_read_b64_tr_b16 v[250:251], v219 offset:51200
v_mul_f32 v239, v231, v242
v_mfma_f32_16x16x32_bf16 v[132:135], a[4:7], a[200:203], v[132:135]
ds_read_b64_tr_b16 v[252:253], v219 offset:57344
ds_write_b64 v228, v[128:129] offset:2048
v_rcp_f32 v243, v243
v_mfma_f32_16x16x32_bf16 v[132:135], a[0:3], a[188:191], v[132:135]
ds_read_b64_tr_b16 v[254:255], v219 offset:59392
v_mul_f32 v240, v246, v243
v_mfma_f32_16x16x32_bf16 v[140:143], a[0:3], a[192:195], v[140:143]
ds_write_b64 v228, v[130:131] offset:2056
v_mul_f32 v242, v247, v242
v_mfma_f32_16x16x32_bf16 v[140:143], a[4:7], a[204:207], v[140:143]
v_mul_f32 v243, v232, v243
s_waitcnt vmcnt(4) lgkmcnt(8)
s_barrier
v_mfma_f32_16x16x32_bf16 v[96:99], a[8:11], a[184:187], v[96:99]
ds_read_b64_tr_b16 a[0:1], v216 offset:16384
s_add_u32 m0, s67, 73728
ds_write_b64 v228, v[136:137] offset:4096
v_mfma_f32_16x16x32_bf16 v[96:99], a[12:15], a[196:199], v[96:99]
ds_read_b64_tr_b16 a[2:3], v216 offset:18432
s_add_u32 s69, s73, 327680
v_mfma_f32_16x16x32_bf16 v[104:107], a[12:15], a[200:203], v[104:107]
ds_read_b64_tr_b16 a[4:5], v216 offset:20480
buffer_load_dwordx4 v224, s[28:31], s69 offen offset:0 nt lds
ds_write_b64 v228, v[138:139] offset:4104
v_mfma_f32_16x16x32_bf16 v[104:107], a[8:11], a[188:191], v[104:107]
ds_read_b64_tr_b16 a[6:7], v216 offset:22528
buffer_load_dwordx4 v225, s[28:31], s69 offen offset:1024 nt lds
v_mfma_f32_16x16x32_bf16 v[112:115], a[8:11], a[192:195], v[112:115]
s_add_u32 m0, s67, 81920
s_add_u32 s69, s73, 360448
ds_write_b64 v228, v[124:125] offset:1024
v_mul_f32 v96, v238, v96
v_mfma_f32_16x16x32_bf16 v[112:115], a[12:15], a[204:207], v[112:115]
buffer_load_dwordx4 v224, s[28:31], s69 offen offset:0 nt lds
v_mul_f32 v97, v238, v97
s_waitcnt lgkmcnt(8)
v_mfma_f32_16x16x32_bf16 v[100:103], v[248:251], a[184:187], v[100:103]
ds_read_b64_tr_b16 a[8:9], v217 offset:16384
buffer_load_dwordx4 v225, s[28:31], s69 offen offset:1024 nt lds
ds_write_b64 v228, v[126:127] offset:1032
v_mul_f32 v98, v238, v98
v_mfma_f32_16x16x32_bf16 v[100:103], v[252:255], a[196:199], v[100:103]
ds_read_b64_tr_b16 a[10:11], v217 offset:18432
s_add_u32 m0, s67, 40960
v_mul_f32 v99, v238, v99
v_mfma_f32_16x16x32_bf16 v[108:111], v[252:255], a[200:203], v[108:111]
ds_read_b64_tr_b16 a[12:13], v217 offset:20480
s_add_u32 s69, s79, s85
ds_write_b64 v228, v[132:133] offset:3072
v_mul_f32 v104, v239, v104
v_mfma_f32_16x16x32_bf16 v[108:111], v[248:251], a[188:191], v[108:111]
ds_read_b64_tr_b16 a[14:15], v217 offset:22528
buffer_load_dwordx4 v226, s[36:39], s69 offen offset:0 lds
v_mul_f32 v105, v239, v105
v_mfma_f32_16x16x32_bf16 v[116:119], v[248:251], a[192:195], v[116:119]
buffer_load_dwordx4 v227, s[36:39], s69 offen offset:1024 lds
s_add_u32 m0, s67, 49152
ds_write_b64 v228, v[134:135] offset:3080
v_mul_f32 v106, v239, v106
v_mfma_f32_16x16x32_bf16 v[116:119], v[252:255], a[204:207], v[116:119]
s_add_u32 s69, s79, s86
v_mul_f32 v107, v239, v107
s_waitcnt lgkmcnt(8)
v_mfma_f32_16x16x32_bf16 v[0:3], a[0:3], v[180:183], v[0:3]
ds_read_b64_tr_b16 v[248:249], v216 offset:24576
buffer_load_dwordx4 v226, s[36:39], s69 offen offset:0 lds
ds_write_b64 v228, v[140:141] offset:5120
v_mul_f32 v112, v240, v112
v_mfma_f32_16x16x32_bf16 v[0:3], a[4:7], v[144:147], v[0:3]
ds_read_b64_tr_b16 v[250:251], v216 offset:26624
buffer_load_dwordx4 v227, s[36:39], s69 offen offset:1024 lds
v_mul_f32 v113, v240, v113
v_mfma_f32_16x16x32_bf16 v[8:11], a[4:7], v[148:151], v[8:11]
ds_read_b64_tr_b16 v[252:253], v216 offset:28672
ds_write_b64 v228, v[142:143] offset:5128
v_mfma_f32_16x16x32_bf16 v[8:11], a[0:3], v[184:187], v[8:11]
ds_read_b64_tr_b16 v[254:255], v216 offset:30720
v_mul_f32 v114, v240, v114
v_mfma_f32_16x16x32_bf16 v[16:19], a[0:3], v[188:191], v[16:19]
v_mul_f32 v115, v240, v115
v_mul_f32 v100, v238, v100
v_mfma_f32_16x16x32_bf16 v[16:19], a[4:7], v[152:155], v[16:19]
v_mul_f32 v101, v238, v101
s_waitcnt lgkmcnt(7)
v_mfma_f32_16x16x32_bf16 v[4:7], a[8:11], v[180:183], v[4:7]
ds_read_b64_tr_b16 a[0:1], v217 offset:24576
s_waitcnt lgkmcnt(2)
s_barrier
ds_read_b128 v[120:123], v229 offset:0
v_mfma_f32_16x16x32_bf16 v[4:7], a[12:15], v[144:147], v[4:7]
ds_read_b64_tr_b16 a[2:3], v217 offset:26624
ds_read_b128 v[124:127], v229 offset:1024
v_mul_f32 v102, v238, v102
v_mfma_f32_16x16x32_bf16 v[12:15], a[12:15], v[148:151], v[12:15]
ds_read_b64_tr_b16 a[4:5], v217 offset:28672
ds_read_b128 v[128:131], v229 offset:2048
v_mul_f32 v103, v238, v103
v_mfma_f32_16x16x32_bf16 v[12:15], a[8:11], v[184:187], v[12:15]
ds_read_b64_tr_b16 a[6:7], v217 offset:30720
ds_read_b128 v[132:135], v229 offset:3072
v_mul_f32 v108, v239, v108
v_mfma_f32_16x16x32_bf16 v[20:23], a[8:11], v[188:191], v[20:23]
ds_read_b128 v[136:139], v229 offset:4096
v_mul_f32 v109, v239, v109
v_mfma_f32_16x16x32_bf16 v[20:23], a[12:15], v[152:155], v[20:23]
ds_read_b128 v[140:143], v229 offset:5120
s_waitcnt lgkmcnt(10)
v_mfma_f32_16x16x32_bf16 v[24:27], v[248:251], v[180:183], v[24:27]
ds_read_b64_tr_b16 a[8:9], v216 offset:32768
s_waitcnt lgkmcnt(9)
v_fmac_f32 v96, v241, v120
v_mfma_f32_16x16x32_bf16 v[24:27], v[252:255], v[144:147], v[24:27]
ds_read_b64_tr_b16 a[10:11], v216 offset:34816
v_fmac_f32 v97, v241, v121
v_mfma_f32_16x16x32_bf16 v[32:35], v[252:255], v[148:151], v[32:35]
ds_read_b64_tr_b16 a[12:13], v216 offset:36864
v_fmac_f32 v98, v241, v122
v_mfma_f32_16x16x32_bf16 v[32:35], v[248:251], v[184:187], v[32:35]
ds_read_b64_tr_b16 a[14:15], v216 offset:38912
v_fmac_f32 v99, v241, v123
v_mfma_f32_16x16x32_bf16 v[40:43], v[248:251], v[188:191], v[40:43]
s_waitcnt lgkmcnt(8)
v_fmac_f32 v104, v242, v128
v_mfma_f32_16x16x32_bf16 v[40:43], v[252:255], v[152:155], v[40:43]
v_fmac_f32 v105, v242, v129
s_waitcnt lgkmcnt(7)
v_mfma_f32_16x16x32_bf16 v[28:31], a[0:3], v[180:183], v[28:31]
ds_read_b64_tr_b16 v[248:249], v217 offset:32768
v_fmac_f32 v106, v242, v130
v_mfma_f32_16x16x32_bf16 v[28:31], a[4:7], v[144:147], v[28:31]
ds_read_b64_tr_b16 v[250:251], v217 offset:34816
v_fmac_f32 v107, v242, v131
v_mfma_f32_16x16x32_bf16 v[36:39], a[4:7], v[148:151], v[36:39]
ds_read_b64_tr_b16 v[252:253], v217 offset:36864
s_waitcnt lgkmcnt(8)
v_fmac_f32 v112, v243, v136
v_mfma_f32_16x16x32_bf16 v[36:39], a[0:3], v[184:187], v[36:39]
ds_read_b64_tr_b16 v[254:255], v217 offset:38912
v_fmac_f32 v113, v243, v137
v_mfma_f32_16x16x32_bf16 v[44:47], a[0:3], v[188:191], v[44:47]
v_fmac_f32 v114, v243, v138
v_fmac_f32 v115, v243, v139
v_mfma_f32_16x16x32_bf16 v[44:47], a[4:7], v[152:155], v[44:47]
s_waitcnt vmcnt(8) lgkmcnt(4)
s_barrier
v_mfma_f32_16x16x32_bf16 v[48:51], a[8:11], v[180:183], v[48:51]
ds_read_b64_tr_b16 a[0:1], v220 offset:0
s_add_u32 m0, s67, 90112
v_mfma_f32_16x16x32_bf16 v[48:51], a[12:15], v[144:147], v[48:51]
ds_read_b64_tr_b16 a[2:3], v220 offset:2048
s_add_u32 s69, s73, 393216
v_mfma_f32_16x16x32_bf16 v[56:59], a[12:15], v[148:151], v[56:59]
ds_read_b64_tr_b16 a[4:5], v220 offset:8192
buffer_load_dwordx4 v224, s[28:31], s69 offen offset:0 nt lds
v_mfma_f32_16x16x32_bf16 v[56:59], a[8:11], v[184:187], v[56:59]
ds_read_b64_tr_b16 a[6:7], v220 offset:10240
buffer_load_dwordx4 v225, s[28:31], s69 offen offset:1024 nt lds
v_mfma_f32_16x16x32_bf16 v[64:67], a[8:11], v[188:191], v[64:67]
s_add_u32 m0, s67, 98304
s_add_u32 s69, s73, 425984
v_fmac_f32 v100, v241, v124
v_mfma_f32_16x16x32_bf16 v[64:67], a[12:15], v[152:155], v[64:67]
buffer_load_dwordx4 v224, s[28:31], s69 offen offset:0 nt lds
v_fmac_f32 v101, v241, v125
s_waitcnt lgkmcnt(4)
v_mfma_f32_16x16x32_bf16 v[52:55], v[248:251], v[180:183], v[52:55]
ds_read_b64_tr_b16 a[8:9], v221 offset:0
buffer_load_dwordx4 v225, s[28:31], s69 offen offset:1024 nt lds
v_fmac_f32 v102, v241, v126
v_mfma_f32_16x16x32_bf16 v[52:55], v[252:255], v[144:147], v[52:55]
ds_read_b64_tr_b16 a[10:11], v221 offset:2048
v_fmac_f32 v103, v241, v127
v_mfma_f32_16x16x32_bf16 v[60:63], v[252:255], v[148:151], v[60:63]
ds_read_b64_tr_b16 a[12:13], v221 offset:8192
v_mul_f32 v110, v239, v110
v_mfma_f32_16x16x32_bf16 v[60:63], v[248:251], v[184:187], v[60:63]
ds_read_b64_tr_b16 a[14:15], v221 offset:10240
v_mul_f32 v111, v239, v111
v_mfma_f32_16x16x32_bf16 v[68:71], v[248:251], v[188:191], v[68:71]
v_fmac_f32 v108, v242, v132
v_fmac_f32 v109, v242, v133
v_mfma_f32_16x16x32_bf16 v[68:71], v[252:255], v[152:155], v[68:71]
v_fmac_f32 v110, v242, v134
s_waitcnt lgkmcnt(4)
v_mfma_f32_16x16x32_bf16 v[120:123], a[0:3], a[112:115], 0
ds_read_b64_tr_b16 v[248:249], v218 offset:0
v_fmac_f32 v111, v242, v135
v_mfma_f32_16x16x32_bf16 v[120:123], a[4:7], a[124:127], v[120:123]
ds_read_b64_tr_b16 v[250:251], v218 offset:2048
v_mul_f32 v116, v240, v116
v_mfma_f32_16x16x32_bf16 v[128:131], a[4:7], a[128:131], 0
ds_read_b64_tr_b16 v[252:253], v218 offset:8192
v_mul_f32 v117, v240, v117
v_mfma_f32_16x16x32_bf16 v[128:131], a[0:3], a[116:119], v[128:131]
ds_read_b64_tr_b16 v[254:255], v218 offset:10240
v_mul_f32 v118, v240, v118
v_mfma_f32_16x16x32_bf16 v[136:139], a[0:3], a[120:123], 0
v_mul_f32 v119, v240, v119
v_fmac_f32 v116, v243, v140
v_mfma_f32_16x16x32_bf16 v[136:139], a[4:7], a[132:135], v[136:139]
v_fmac_f32 v117, v243, v141
s_waitcnt lgkmcnt(4)
v_mfma_f32_16x16x32_bf16 v[124:127], a[8:11], a[112:115], 0
ds_read_b64_tr_b16 a[0:1], v219 offset:0
v_fmac_f32 v118, v243, v142
v_mfma_f32_16x16x32_bf16 v[124:127], a[12:15], a[124:127], v[124:127]
ds_read_b64_tr_b16 a[2:3], v219 offset:2048
v_fmac_f32 v119, v243, v143
v_mfma_f32_16x16x32_bf16 v[132:135], a[12:15], a[128:131], 0
ds_read_b64_tr_b16 a[4:5], v219 offset:8192
v_cvt_pk_bf16_f32 v156, v96, v97
v_mfma_f32_16x16x32_bf16 v[132:135], a[8:11], a[116:119], v[132:135]
ds_read_b64_tr_b16 a[6:7], v219 offset:10240
v_cvt_pk_bf16_f32 v157, v98, v99
v_mfma_f32_16x16x32_bf16 v[140:143], a[8:11], a[120:123], 0
ds_write_b64 v228, v[156:157] offset:6144
v_cvt_pk_bf16_f32 v160, v104, v105
v_mfma_f32_16x16x32_bf16 v[140:143], a[12:15], a[132:135], v[140:143]
s_waitcnt vmcnt(8) lgkmcnt(5)
s_barrier
v_mfma_f32_16x16x32_bf16 v[96:99], v[248:251], a[112:115], 0
ds_read_b64_tr_b16 a[8:9], v220 offset:16384
s_add_u32 m0, s67, 106496
v_mfma_f32_16x16x32_bf16 v[96:99], v[252:255], a[124:127], v[96:99]
ds_read_b64_tr_b16 a[10:11], v220 offset:18432
s_add_u32 s69, s73, 458752
v_cvt_pk_bf16_f32 v161, v106, v107
v_mfma_f32_16x16x32_bf16 v[104:107], v[252:255], a[128:131], 0
ds_read_b64_tr_b16 a[12:13], v220 offset:24576
buffer_load_dwordx4 v224, s[28:31], s69 offen offset:0 nt lds
v_cvt_pk_bf16_f32 v164, v112, v113
v_mfma_f32_16x16x32_bf16 v[104:107], v[248:251], a[116:119], v[104:107]
ds_read_b64_tr_b16 a[14:15], v220 offset:26624
buffer_load_dwordx4 v225, s[28:31], s69 offen offset:1024 nt lds
v_cvt_pk_bf16_f32 v165, v114, v115
v_mfma_f32_16x16x32_bf16 v[112:115], v[248:251], a[120:123], 0
s_add_u32 m0, s67, 114688
s_add_u32 s69, s73, 491520
v_cvt_pk_bf16_f32 v158, v100, v101
v_mfma_f32_16x16x32_bf16 v[112:115], v[252:255], a[132:135], v[112:115]
buffer_load_dwordx4 v224, s[28:31], s69 offen offset:0 nt lds
v_cvt_pk_bf16_f32 v159, v102, v103
s_waitcnt lgkmcnt(5)
v_mfma_f32_16x16x32_bf16 v[100:103], a[0:3], a[112:115], 0
ds_read_b64_tr_b16 v[248:249], v221 offset:16384
buffer_load_dwordx4 v225, s[28:31], s69 offen offset:1024 nt lds
v_cvt_pk_bf16_f32 v162, v108, v109
v_mfma_f32_16x16x32_bf16 v[100:103], a[4:7], a[124:127], v[100:103]
ds_read_b64_tr_b16 v[250:251], v221 offset:18432
ds_write_b64 v228, v[158:159] offset:6152
v_cvt_pk_bf16_f32 v163, v110, v111
v_mfma_f32_16x16x32_bf16 v[108:111], a[4:7], a[128:131], 0
ds_read_b64_tr_b16 v[252:253], v221 offset:24576
v_cvt_pk_bf16_f32 v166, v116, v117
v_mfma_f32_16x16x32_bf16 v[108:111], a[0:3], a[116:119], v[108:111]
ds_read_b64_tr_b16 v[254:255], v221 offset:26624
ds_write_b64 v228, v[160:161] offset:7168
v_cvt_pk_bf16_f32 v167, v118, v119
v_mfma_f32_16x16x32_bf16 v[116:119], a[0:3], a[120:123], 0
v_mfma_f32_16x16x32_bf16 v[116:119], a[4:7], a[132:135], v[116:119]
ds_write_b64 v228, v[162:163] offset:7176
s_waitcnt lgkmcnt(7)
v_mfma_f32_16x16x32_bf16 v[120:123], a[8:11], a[136:139], v[120:123]
ds_read_b64_tr_b16 a[0:1], v218 offset:16384
v_mfma_f32_16x16x32_bf16 v[120:123], a[12:15], a[148:151], v[120:123]
ds_read_b64_tr_b16 a[2:3], v218 offset:18432
ds_write_b64 v228, v[164:165] offset:8192
v_mfma_f32_16x16x32_bf16 v[128:131], a[12:15], a[152:155], v[128:131]
ds_read_b64_tr_b16 a[4:5], v218 offset:24576
v_mfma_f32_16x16x32_bf16 v[128:131], a[8:11], a[140:143], v[128:131]
ds_read_b64_tr_b16 a[6:7], v218 offset:26624
ds_write_b64 v228, v[166:167] offset:8200
v_mfma_f32_16x16x32_bf16 v[136:139], a[8:11], a[144:147], v[136:139]
v_mfma_f32_16x16x32_bf16 v[136:139], a[12:15], a[156:159], v[136:139]
s_waitcnt lgkmcnt(8)
v_mfma_f32_16x16x32_bf16 v[124:127], v[248:251], a[136:139], v[124:127]
ds_read_b64_tr_b16 a[8:9], v219 offset:16384
v_mfma_f32_16x16x32_bf16 v[124:127], v[252:255], a[148:151], v[124:127]
ds_read_b64_tr_b16 a[10:11], v219 offset:18432
v_mfma_f32_16x16x32_bf16 v[132:135], v[252:255], a[152:155], v[132:135]
ds_read_b64_tr_b16 a[12:13], v219 offset:24576
v_mfma_f32_16x16x32_bf16 v[132:135], v[248:251], a[140:143], v[132:135]
ds_read_b64_tr_b16 a[14:15], v219 offset:26624
v_mfma_f32_16x16x32_bf16 v[140:143], v[248:251], a[144:147], v[140:143]
v_mfma_f32_16x16x32_bf16 v[140:143], v[252:255], a[156:159], v[140:143]
s_waitcnt vmcnt(8) lgkmcnt(4)
s_barrier
v_mfma_f32_16x16x32_bf16 v[96:99], a[0:3], a[136:139], v[96:99]
ds_read_b64_tr_b16 v[248:249], v216 offset:40960
s_add_u32 s76, s76, 229376
v_mfma_f32_16x16x32_bf16 v[96:99], a[4:7], a[148:151], v[96:99]
ds_read_b64_tr_b16 v[250:251], v216 offset:43008
s_add_u32 s77, s77, 229376
v_mfma_f32_16x16x32_bf16 v[104:107], a[4:7], a[152:155], v[104:107]
ds_read_b64_tr_b16 v[252:253], v216 offset:45056
s_add_u32 s78, s78, 229376
v_mfma_f32_16x16x32_bf16 v[104:107], a[0:3], a[140:143], v[104:107]
ds_read_b64_tr_b16 v[254:255], v216 offset:47104
s_add_u32 s79, s79, 229376
v_mfma_f32_16x16x32_bf16 v[112:115], a[0:3], a[144:147], v[112:115]
s_add_u32 m0, s67, 0
s_add_u32 s69, s76, s80
v_mfma_f32_16x16x32_bf16 v[112:115], a[4:7], a[156:159], v[112:115]
buffer_load_dwordx4 v226, s[36:39], s69 offen offset:0 lds
s_waitcnt lgkmcnt(4)
v_mfma_f32_16x16x32_bf16 v[100:103], a[8:11], a[136:139], v[100:103]
ds_read_b64_tr_b16 a[0:1], v217 offset:40960
buffer_load_dwordx4 v227, s[36:39], s69 offen offset:1024 lds
v_mfma_f32_16x16x32_bf16 v[100:103], a[12:15], a[148:151], v[100:103]
ds_read_b64_tr_b16 a[2:3], v217 offset:43008
s_add_u32 m0, s67, 8192
v_mfma_f32_16x16x32_bf16 v[108:111], a[12:15], a[152:155], v[108:111]
ds_read_b64_tr_b16 a[4:5], v217 offset:45056
s_add_u32 s69, s76, s81
v_mfma_f32_16x16x32_bf16 v[108:111], a[8:11], a[140:143], v[108:111]
ds_read_b64_tr_b16 a[6:7], v217 offset:47104
buffer_load_dwordx4 v226, s[36:39], s69 offen offset:0 lds
v_mfma_f32_16x16x32_bf16 v[116:119], a[8:11], a[144:147], v[116:119]
buffer_load_dwordx4 v227, s[36:39], s69 offen offset:1024 lds
s_add_u32 m0, s67, 16384
v_mfma_f32_16x16x32_bf16 v[116:119], a[12:15], a[156:159], v[116:119]
s_add_u32 s69, s76, s82
s_waitcnt lgkmcnt(4)
v_mfma_f32_16x16x32_bf16 v[72:75], v[248:251], v[180:183], v[72:75]
ds_read_b64_tr_b16 a[8:9], v216 offset:49152
buffer_load_dwordx4 v226, s[36:39], s69 offen offset:0 lds
v_mfma_f32_16x16x32_bf16 v[72:75], v[252:255], v[144:147], v[72:75]
ds_read_b64_tr_b16 a[10:11], v216 offset:51200
buffer_load_dwordx4 v227, s[36:39], s69 offen offset:1024 lds
v_mfma_f32_16x16x32_bf16 v[80:83], v[252:255], v[148:151], v[80:83]
ds_read_b64_tr_b16 a[12:13], v216 offset:53248
ds_read_b128 a[16:19], v230 offset:6144
v_mfma_f32_16x16x32_bf16 v[80:83], v[248:251], v[184:187], v[80:83]
ds_read_b64_tr_b16 a[14:15], v216 offset:55296
ds_read_b128 a[28:31], v230 offset:16384
v_mfma_f32_16x16x32_bf16 v[88:91], v[248:251], v[188:191], v[88:91]
ds_read_b128 a[32:35], v230 offset:17408
v_mfma_f32_16x16x32_bf16 v[88:91], v[252:255], v[152:155], v[88:91]
ds_read_b128 a[20:23], v230 offset:7168
s_waitcnt lgkmcnt(8)
v_mfma_f32_16x16x32_bf16 v[76:79], a[0:3], v[180:183], v[76:79]
ds_read_b64_tr_b16 v[248:249], v217 offset:49152
ds_read_b128 a[24:27], v230 offset:8192
v_mfma_f32_16x16x32_bf16 v[76:79], a[4:7], v[144:147], v[76:79]
ds_read_b64_tr_b16 v[250:251], v217 offset:51200
ds_read_b128 a[36:39], v230 offset:18432
v_mfma_f32_16x16x32_bf16 v[84:87], a[4:7], v[148:151], v[84:87]
ds_read_b64_tr_b16 v[252:253], v217 offset:53248
v_mfma_f32_16x16x32_bf16 v[84:87], a[0:3], v[184:187], v[84:87]
ds_read_b64_tr_b16 v[254:255], v217 offset:55296
v_mfma_f32_16x16x32_bf16 v[92:95], a[0:3], v[188:191], v[92:95]
v_mfma_f32_16x16x32_bf16 v[92:95], a[4:7], v[152:155], v[92:95]
s_waitcnt vmcnt(10) lgkmcnt(9)
s_barrier
v_mfma_f32_16x16x32_bf16 v[192:195], a[8:11], v[180:183], v[192:195]
ds_read_b64_tr_b16 a[0:1], v220 offset:32768
s_add_u32 m0, s67, 24576
v_mfma_f32_16x16x32_bf16 v[192:195], a[12:15], v[144:147], v[192:195]
ds_read_b64_tr_b16 a[2:3], v220 offset:34816
s_add_u32 s69, s76, s83
v_mfma_f32_16x16x32_bf16 v[200:203], a[12:15], v[148:151], v[200:203]
ds_read_b64_tr_b16 a[4:5], v220 offset:40960
buffer_load_dwordx4 v226, s[36:39], s69 offen offset:0 lds
v_mfma_f32_16x16x32_bf16 v[200:203], a[8:11], v[184:187], v[200:203]
ds_read_b64_tr_b16 a[6:7], v220 offset:43008
buffer_load_dwordx4 v227, s[36:39], s69 offen offset:1024 lds
v_mfma_f32_16x16x32_bf16 v[208:211], a[8:11], v[188:191], v[208:211]
v_mfma_f32_16x16x32_bf16 v[208:211], a[12:15], v[152:155], v[208:211]
s_waitcnt lgkmcnt(4)
v_mfma_f32_16x16x32_bf16 v[196:199], v[248:251], v[180:183], v[196:199]
ds_read_b64_tr_b16 a[8:9], v221 offset:32768
v_mfma_f32_16x16x32_bf16 v[196:199], v[252:255], v[144:147], v[196:199]
ds_read_b64_tr_b16 a[10:11], v221 offset:34816
v_mfma_f32_16x16x32_bf16 v[204:207], v[252:255], v[148:151], v[204:207]
ds_read_b64_tr_b16 a[12:13], v221 offset:40960
v_mfma_f32_16x16x32_bf16 v[204:207], v[248:251], v[184:187], v[204:207]
ds_read_b64_tr_b16 a[14:15], v221 offset:43008
v_mfma_f32_16x16x32_bf16 v[212:215], v[248:251], v[188:191], v[212:215]
v_mfma_f32_16x16x32_bf16 v[212:215], v[252:255], v[152:155], v[212:215]
s_waitcnt lgkmcnt(4)
v_mfma_f32_16x16x32_bf16 v[120:123], a[0:3], a[160:163], v[120:123]
ds_read_b64_tr_b16 v[248:249], v218 offset:32768
v_mfma_f32_16x16x32_bf16 v[120:123], a[4:7], a[172:175], v[120:123]
ds_read_b64_tr_b16 v[250:251], v218 offset:34816
v_mfma_f32_16x16x32_bf16 v[128:131], a[4:7], a[176:179], v[128:131]
ds_read_b64_tr_b16 v[252:253], v218 offset:40960
v_mfma_f32_16x16x32_bf16 v[128:131], a[0:3], a[164:167], v[128:131]
ds_read_b64_tr_b16 v[254:255], v218 offset:43008
v_mfma_f32_16x16x32_bf16 v[136:139], a[0:3], a[168:171], v[136:139]
v_mfma_f32_16x16x32_bf16 v[136:139], a[4:7], a[180:183], v[136:139]
s_waitcnt lgkmcnt(4)
v_mfma_f32_16x16x32_bf16 v[124:127], a[8:11], a[160:163], v[124:127]
ds_read_b64_tr_b16 a[0:1], v219 offset:32768
v_mfma_f32_16x16x32_bf16 v[124:127], a[12:15], a[172:175], v[124:127]
ds_read_b64_tr_b16 a[2:3], v219 offset:34816
v_mfma_f32_16x16x32_bf16 v[132:135], a[12:15], a[176:179], v[132:135]
ds_read_b64_tr_b16 a[4:5], v219 offset:40960
v_mfma_f32_16x16x32_bf16 v[132:135], a[8:11], a[164:167], v[132:135]
ds_read_b64_tr_b16 a[6:7], v219 offset:43008
v_mfma_f32_16x16x32_bf16 v[140:143], a[8:11], a[168:171], v[140:143]
v_mfma_f32_16x16x32_bf16 v[140:143], a[12:15], a[180:183], v[140:143]
s_waitcnt vmcnt(8) lgkmcnt(4)
s_barrier
v_mfma_f32_16x16x32_bf16 v[96:99], v[248:251], a[160:163], v[96:99]
ds_read_b64_tr_b16 a[8:9], v220 offset:49152
s_add_u32 m0, s67, 57344
v_mfma_f32_16x16x32_bf16 v[96:99], v[252:255], a[172:175], v[96:99]
ds_read_b64_tr_b16 a[10:11], v220 offset:51200
s_add_u32 s69, s74, 262144
v_mfma_f32_16x16x32_bf16 v[104:107], v[252:255], a[176:179], v[104:107]
ds_read_b64_tr_b16 a[12:13], v220 offset:57344
buffer_load_dwordx4 v224, s[28:31], s69 offen offset:0 nt lds
v_mfma_f32_16x16x32_bf16 v[104:107], v[248:251], a[164:167], v[104:107]
ds_read_b64_tr_b16 a[14:15], v220 offset:59392
buffer_load_dwordx4 v225, s[28:31], s69 offen offset:1024 nt lds
v_mfma_f32_16x16x32_bf16 v[112:115], v[248:251], a[168:171], v[112:115]
s_add_u32 m0, s67, 65536
s_add_u32 s69, s74, 294912
v_mfma_f32_16x16x32_bf16 v[112:115], v[252:255], a[180:183], v[112:115]
buffer_load_dwordx4 v224, s[28:31], s69 offen offset:0 nt lds
s_waitcnt lgkmcnt(4)
v_mfma_f32_16x16x32_bf16 v[100:103], a[0:3], a[160:163], v[100:103]
ds_read_b64_tr_b16 v[248:249], v221 offset:49152
buffer_load_dwordx4 v225, s[28:31], s69 offen offset:1024 nt lds
v_mfma_f32_16x16x32_bf16 v[100:103], a[4:7], a[172:175], v[100:103]
ds_read_b64_tr_b16 v[250:251], v221 offset:51200
v_mfma_f32_16x16x32_bf16 v[108:111], a[4:7], a[176:179], v[108:111]
ds_read_b64_tr_b16 v[252:253], v221 offset:57344
v_mfma_f32_16x16x32_bf16 v[108:111], a[0:3], a[164:167], v[108:111]
ds_read_b64_tr_b16 v[254:255], v221 offset:59392
v_mfma_f32_16x16x32_bf16 v[116:119], a[0:3], a[168:171], v[116:119]
v_mfma_f32_16x16x32_bf16 v[116:119], a[4:7], a[180:183], v[116:119]
s_waitcnt lgkmcnt(4)
v_mfma_f32_16x16x32_bf16 v[120:123], a[8:11], a[184:187], v[120:123]
ds_read_b64_tr_b16 a[0:1], v218 offset:49152
v_mfma_f32_16x16x32_bf16 v[120:123], a[12:15], a[196:199], v[120:123]
ds_read_b64_tr_b16 a[2:3], v218 offset:51200
v_mfma_f32_16x16x32_bf16 v[128:131], a[12:15], a[200:203], v[128:131]
ds_read_b64_tr_b16 a[4:5], v218 offset:57344
v_mfma_f32_16x16x32_bf16 v[128:131], a[8:11], a[188:191], v[128:131]
ds_read_b64_tr_b16 a[6:7], v218 offset:59392
v_mfma_f32_16x16x32_bf16 v[136:139], a[8:11], a[192:195], v[136:139]
s_nop 1
ds_write_b64 v228, v[120:121] offset:0
v_mfma_f32_16x16x32_bf16 v[136:139], a[12:15], a[204:207], v[136:139]
s_waitcnt lgkmcnt(5)
v_mfma_f32_16x16x32_bf16 v[124:127], v[248:251], a[184:187], v[124:127]
ds_read_b64_tr_b16 a[8:9], v219 offset:49152
ds_write_b64 v228, v[122:123] offset:8
v_mfma_f32_16x16x32_bf16 v[124:127], v[252:255], a[196:199], v[124:127]
ds_read_b64_tr_b16 a[10:11], v219 offset:51200
v_mfma_f32_16x16x32_bf16 v[132:135], v[252:255], a[200:203], v[132:135]
ds_read_b64_tr_b16 a[12:13], v219 offset:57344
ds_write_b64 v228, v[128:129] offset:2048
v_mfma_f32_16x16x32_bf16 v[132:135], v[248:251], a[188:191], v[132:135]
ds_read_b64_tr_b16 a[14:15], v219 offset:59392
v_mfma_f32_16x16x32_bf16 v[140:143], v[248:251], a[192:195], v[140:143]
ds_write_b64 v228, v[130:131] offset:2056
v_mfma_f32_16x16x32_bf16 v[140:143], v[252:255], a[204:207], v[140:143]
s_waitcnt vmcnt(8) lgkmcnt(8)
s_barrier
v_mfma_f32_16x16x32_bf16 v[96:99], a[0:3], a[184:187], v[96:99]
ds_read_b64_tr_b16 v[248:249], v216 offset:0
s_add_u32 m0, s67, 73728
ds_write_b64 v228, v[136:137] offset:4096
v_mfma_f32_16x16x32_bf16 v[96:99], a[4:7], a[196:199], v[96:99]
ds_read_b64_tr_b16 v[250:251], v216 offset:2048
s_add_u32 s69, s74, 327680
v_mfma_f32_16x16x32_bf16 v[104:107], a[4:7], a[200:203], v[104:107]
ds_read_b64_tr_b16 v[252:253], v216 offset:4096
buffer_load_dwordx4 v224, s[28:31], s69 offen offset:0 nt lds
ds_write_b64 v228, v[138:139] offset:4104
v_mfma_f32_16x16x32_bf16 v[104:107], a[0:3], a[188:191], v[104:107]
ds_read_b64_tr_b16 v[254:255], v216 offset:6144
buffer_load_dwordx4 v225, s[28:31], s69 offen offset:1024 nt lds
v_mfma_f32_16x16x32_bf16 v[112:115], a[0:3], a[192:195], v[112:115]
s_add_u32 m0, s67, 81920
s_add_u32 s69, s74, 360448
ds_write_b64 v228, v[124:125] offset:1024
v_mul_f32 v96, v238, v96
v_mfma_f32_16x16x32_bf16 v[112:115], a[4:7], a[204:207], v[112:115]
buffer_load_dwordx4 v224, s[28:31], s69 offen offset:0 nt lds
v_mul_f32 v97, v238, v97
s_waitcnt lgkmcnt(8)
v_mfma_f32_16x16x32_bf16 v[100:103], a[8:11], a[184:187], v[100:103]
ds_read_b64_tr_b16 a[0:1], v217 offset:0
buffer_load_dwordx4 v225, s[28:31], s69 offen offset:1024 nt lds
ds_write_b64 v228, v[126:127] offset:1032
v_mul_f32 v98, v238, v98
v_mfma_f32_16x16x32_bf16 v[100:103], a[12:15], a[196:199], v[100:103]
ds_read_b64_tr_b16 a[2:3], v217 offset:2048
s_add_u32 m0, s67, 32768
v_mul_f32 v99, v238, v99
v_mfma_f32_16x16x32_bf16 v[108:111], a[12:15], a[200:203], v[108:111]
ds_read_b64_tr_b16 a[4:5], v217 offset:4096
s_add_u32 s69, s76, s84
ds_write_b64 v228, v[132:133] offset:3072
v_mfma_f32_16x16x32_bf16 v[108:111], a[8:11], a[188:191], v[108:111]
ds_read_b64_tr_b16 a[6:7], v217 offset:6144
buffer_load_dwordx4 v226, s[36:39], s69 offen offset:0 lds
v_mul_f32 v104, v239, v104
v_mfma_f32_16x16x32_bf16 v[116:119], a[8:11], a[192:195], v[116:119]
buffer_load_dwordx4 v227, s[36:39], s69 offen offset:1024 lds
ds_write_b64 v228, v[134:135] offset:3080
v_mul_f32 v105, v239, v105
v_mfma_f32_16x16x32_bf16 v[116:119], a[12:15], a[204:207], v[116:119]
v_mul_f32 v106, v239, v106
s_waitcnt lgkmcnt(8)
v_mfma_f32_16x16x32_bf16 a[208:211], v[248:251], a[16:19], a[208:211]
ds_read_b64_tr_b16 a[8:9], v216 offset:8192
ds_write_b64 v228, v[140:141] offset:5120
v_mfma_f32_16x16x32_bf16 a[208:211], v[252:255], a[28:31], a[208:211]
ds_read_b64_tr_b16 a[10:11], v216 offset:10240
v_mul_f32 v107, v239, v107
v_mfma_f32_16x16x32_bf16 a[216:219], v[252:255], a[32:35], a[216:219]
ds_read_b64_tr_b16 a[12:13], v216 offset:12288
ds_write_b64 v228, v[142:143] offset:5128
v_mul_f32 v112, v240, v112
v_mfma_f32_16x16x32_bf16 a[216:219], v[248:251], a[20:23], a[216:219]
ds_read_b64_tr_b16 a[14:15], v216 offset:14336
v_mul_f32 v113, v240, v113
v_mfma_f32_16x16x32_bf16 a[224:227], v[248:251], a[24:27], a[224:227]
v_mul_f32 v114, v240, v114
v_mul_f32 v115, v240, v115
v_mfma_f32_16x16x32_bf16 a[224:227], v[252:255], a[36:39], a[224:227]
v_mul_f32 v100, v238, v100
s_waitcnt lgkmcnt(7)
v_mfma_f32_16x16x32_bf16 a[212:215], a[0:3], a[16:19], a[212:215]
ds_read_b64_tr_b16 v[248:249], v217 offset:8192
v_mul_f32 v101, v238, v101
v_mfma_f32_16x16x32_bf16 a[212:215], a[4:7], a[28:31], a[212:215]
ds_read_b64_tr_b16 v[250:251], v217 offset:10240
v_mul_f32 v102, v238, v102
v_mfma_f32_16x16x32_bf16 a[220:223], a[4:7], a[32:35], a[220:223]
ds_read_b64_tr_b16 v[252:253], v217 offset:12288
v_mul_f32 v103, v238, v103
v_mfma_f32_16x16x32_bf16 a[220:223], a[0:3], a[20:23], a[220:223]
ds_read_b64_tr_b16 v[254:255], v217 offset:14336
v_mul_f32 v108, v239, v108
v_mfma_f32_16x16x32_bf16 a[228:231], a[0:3], a[24:27], a[228:231]
v_mul_f32 v109, v239, v109
v_mul_f32 v110, v239, v110
v_mfma_f32_16x16x32_bf16 a[228:231], a[4:7], a[36:39], a[228:231]
s_waitcnt vmcnt(10) lgkmcnt(4)
s_barrier
v_mfma_f32_16x16x32_bf16 a[232:235], a[8:11], a[16:19], a[232:235]
ds_read_b64_tr_b16 a[0:1], v216 offset:16384
s_add_u32 m0, s67, 40960
ds_read_b128 v[120:123], v229 offset:0
v_mfma_f32_16x16x32_bf16 a[232:235], a[12:15], a[28:31], a[232:235]
ds_read_b64_tr_b16 a[2:3], v216 offset:18432
s_add_u32 s69, s76, s85
ds_read_b128 v[124:127], v229 offset:1024
v_mfma_f32_16x16x32_bf16 a[240:243], a[12:15], a[32:35], a[240:243]
ds_read_b64_tr_b16 a[4:5], v216 offset:20480
buffer_load_dwordx4 v226, s[36:39], s69 offen offset:0 lds
ds_read_b128 v[128:131], v229 offset:2048
v_mfma_f32_16x16x32_bf16 a[240:243], a[8:11], a[20:23], a[240:243]
ds_read_b64_tr_b16 a[6:7], v216 offset:22528
buffer_load_dwordx4 v227, s[36:39], s69 offen offset:1024 lds
ds_read_b128 v[132:135], v229 offset:3072
v_mfma_f32_16x16x32_bf16 a[248:251], a[8:11], a[24:27], a[248:251]
s_add_u32 m0, s67, 90112
s_add_u32 s69, s74, 393216
ds_read_b128 v[136:139], v229 offset:4096
v_mfma_f32_16x16x32_bf16 a[248:251], a[12:15], a[36:39], a[248:251]
buffer_load_dwordx4 v224, s[28:31], s69 offen offset:0 nt lds
ds_read_b128 v[140:143], v229 offset:5120
v_mul_f32 v111, v239, v111
s_waitcnt lgkmcnt(10)
v_mfma_f32_16x16x32_bf16 a[236:239], v[248:251], a[16:19], a[236:239]
ds_read_b64_tr_b16 a[8:9], v217 offset:16384
buffer_load_dwordx4 v225, s[28:31], s69 offen offset:1024 nt lds
s_waitcnt lgkmcnt(9)
v_fmac_f32 v96, v241, v120
v_mfma_f32_16x16x32_bf16 a[236:239], v[252:255], a[28:31], a[236:239]
ds_read_b64_tr_b16 a[10:11], v217 offset:18432
v_fmac_f32 v97, v241, v121
v_mfma_f32_16x16x32_bf16 a[244:247], v[252:255], a[32:35], a[244:247]
ds_read_b64_tr_b16 a[12:13], v217 offset:20480
v_fmac_f32 v98, v241, v122
v_mfma_f32_16x16x32_bf16 a[244:247], v[248:251], a[20:23], a[244:247]
ds_read_b64_tr_b16 a[14:15], v217 offset:22528
v_fmac_f32 v99, v241, v123
v_mfma_f32_16x16x32_bf16 a[252:255], v[248:251], a[24:27], a[252:255]
s_waitcnt lgkmcnt(8)
v_fmac_f32 v104, v242, v128
v_mfma_f32_16x16x32_bf16 a[252:255], v[252:255], a[36:39], a[252:255]
v_fmac_f32 v105, v242, v129
s_waitcnt lgkmcnt(7)
v_mfma_f32_16x16x32_bf16 v[0:3], a[0:3], a[16:19], v[0:3]
ds_read_b64_tr_b16 v[248:249], v216 offset:24576
v_fmac_f32 v106, v242, v130
v_mfma_f32_16x16x32_bf16 v[0:3], a[4:7], a[28:31], v[0:3]
ds_read_b64_tr_b16 v[250:251], v216 offset:26624
v_fmac_f32 v107, v242, v131
v_mfma_f32_16x16x32_bf16 v[8:11], a[4:7], a[32:35], v[8:11]
ds_read_b64_tr_b16 v[252:253], v216 offset:28672
s_waitcnt lgkmcnt(8)
v_fmac_f32 v112, v243, v136
v_mfma_f32_16x16x32_bf16 v[8:11], a[0:3], a[20:23], v[8:11]
ds_read_b64_tr_b16 v[254:255], v216 offset:30720
v_fmac_f32 v113, v243, v137
v_mfma_f32_16x16x32_bf16 v[16:19], a[0:3], a[24:27], v[16:19]
v_fmac_f32 v114, v243, v138
v_fmac_f32 v115, v243, v139
v_mfma_f32_16x16x32_bf16 v[16:19], a[4:7], a[36:39], v[16:19]
v_fmac_f32 v100, v241, v124
s_waitcnt lgkmcnt(4)
v_mfma_f32_16x16x32_bf16 v[4:7], a[8:11], a[16:19], v[4:7]
ds_read_b64_tr_b16 a[0:1], v217 offset:24576
v_fmac_f32 v101, v241, v125
v_mfma_f32_16x16x32_bf16 v[4:7], a[12:15], a[28:31], v[4:7]
ds_read_b64_tr_b16 a[2:3], v217 offset:26624
v_fmac_f32 v102, v241, v126
v_mfma_f32_16x16x32_bf16 v[12:15], a[12:15], a[32:35], v[12:15]
ds_read_b64_tr_b16 a[4:5], v217 offset:28672
v_fmac_f32 v103, v241, v127
v_mfma_f32_16x16x32_bf16 v[12:15], a[8:11], a[20:23], v[12:15]
ds_read_b64_tr_b16 a[6:7], v217 offset:30720
v_fmac_f32 v108, v242, v132
v_mfma_f32_16x16x32_bf16 v[20:23], a[8:11], a[24:27], v[20:23]
v_fmac_f32 v109, v242, v133
v_fmac_f32 v110, v242, v134
v_mfma_f32_16x16x32_bf16 v[20:23], a[12:15], a[36:39], v[20:23]
s_waitcnt vmcnt(10) lgkmcnt(4)
s_barrier
v_mfma_f32_16x16x32_bf16 v[24:27], v[248:251], a[16:19], v[24:27]
ds_read_b64_tr_b16 a[8:9], v220 offset:0
s_add_u32 m0, s67, 98304
v_mfma_f32_16x16x32_bf16 v[24:27], v[252:255], a[28:31], v[24:27]
ds_read_b64_tr_b16 a[10:11], v220 offset:2048
s_add_u32 s69, s74, 425984
v_mfma_f32_16x16x32_bf16 v[32:35], v[252:255], a[32:35], v[32:35]
ds_read_b64_tr_b16 a[12:13], v220 offset:8192
buffer_load_dwordx4 v224, s[28:31], s69 offen offset:0 nt lds
v_mfma_f32_16x16x32_bf16 v[32:35], v[248:251], a[20:23], v[32:35]
ds_read_b64_tr_b16 a[14:15], v220 offset:10240
buffer_load_dwordx4 v225, s[28:31], s69 offen offset:1024 nt lds
v_mfma_f32_16x16x32_bf16 v[40:43], v[248:251], a[24:27], v[40:43]
v_fmac_f32 v111, v242, v135
v_mul_f32 v116, v240, v116
v_mfma_f32_16x16x32_bf16 v[40:43], v[252:255], a[36:39], v[40:43]
v_mul_f32 v117, v240, v117
s_waitcnt lgkmcnt(4)
v_mfma_f32_16x16x32_bf16 v[28:31], a[0:3], a[16:19], v[28:31]
ds_read_b64_tr_b16 v[248:249], v221 offset:0
v_mul_f32 v118, v240, v118
v_mfma_f32_16x16x32_bf16 v[28:31], a[4:7], a[28:31], v[28:31]
ds_read_b64_tr_b16 v[250:251], v221 offset:2048
v_mul_f32 v119, v240, v119
v_mfma_f32_16x16x32_bf16 v[36:39], a[4:7], a[32:35], v[36:39]
ds_read_b64_tr_b16 v[252:253], v221 offset:8192
v_fmac_f32 v116, v243, v140
v_mfma_f32_16x16x32_bf16 v[36:39], a[0:3], a[20:23], v[36:39]
ds_read_b64_tr_b16 v[254:255], v221 offset:10240
v_fmac_f32 v117, v243, v141
v_mfma_f32_16x16x32_bf16 v[44:47], a[0:3], a[24:27], v[44:47]
v_fmac_f32 v118, v243, v142
v_fmac_f32 v119, v243, v143
v_mfma_f32_16x16x32_bf16 v[44:47], a[4:7], a[36:39], v[44:47]
v_cvt_pk_bf16_f32 v156, v96, v97
s_waitcnt lgkmcnt(4)
v_mfma_f32_16x16x32_bf16 v[120:123], a[8:11], a[112:115], 0
ds_read_b64_tr_b16 a[0:1], v218 offset:0
v_cvt_pk_bf16_f32 v157, v98, v99
v_mfma_f32_16x16x32_bf16 v[120:123], a[12:15], a[124:127], v[120:123]
ds_read_b64_tr_b16 a[2:3], v218 offset:2048
ds_write_b64 v228, v[156:157] offset:6144
v_mfma_f32_16x16x32_bf16 v[128:131], a[12:15], a[128:131], 0
ds_read_b64_tr_b16 a[4:5], v218 offset:8192
v_cvt_pk_bf16_f32 v160, v104, v105
v_mfma_f32_16x16x32_bf16 v[128:131], a[8:11], a[116:119], v[128:131]
ds_read_b64_tr_b16 a[6:7], v218 offset:10240
v_cvt_pk_bf16_f32 v161, v106, v107
v_mfma_f32_16x16x32_bf16 v[136:139], a[8:11], a[120:123], 0
v_cvt_pk_bf16_f32 v164, v112, v113
v_cvt_pk_bf16_f32 v165, v114, v115
v_mfma_f32_16x16x32_bf16 v[136:139], a[12:15], a[132:135], v[136:139]
v_cvt_pk_bf16_f32 v158, v100, v101
s_waitcnt lgkmcnt(5)
v_mfma_f32_16x16x32_bf16 v[124:127], v[248:251], a[112:115], 0
ds_read_b64_tr_b16 a[8:9], v219 offset:0
v_cvt_pk_bf16_f32 v159, v102, v103
v_mfma_f32_16x16x32_bf16 v[124:127], v[252:255], a[124:127], v[124:127]
ds_read_b64_tr_b16 a[10:11], v219 offset:2048
ds_write_b64 v228, v[158:159] offset:6152
v_mfma_f32_16x16x32_bf16 v[132:135], v[252:255], a[128:131], 0
ds_read_b64_tr_b16 a[12:13], v219 offset:8192
v_cvt_pk_bf16_f32 v162, v108, v109
v_mfma_f32_16x16x32_bf16 v[132:135], v[248:251], a[116:119], v[132:135]
ds_read_b64_tr_b16 a[14:15], v219 offset:10240
ds_write_b64 v228, v[160:161] offset:7168
v_mfma_f32_16x16x32_bf16 v[140:143], v[248:251], a[120:123], 0
v_cvt_pk_bf16_f32 v163, v110, v111
v_cvt_pk_bf16_f32 v166, v116, v117
v_mfma_f32_16x16x32_bf16 v[140:143], v[252:255], a[132:135], v[140:143]
s_waitcnt vmcnt(8) lgkmcnt(6)
s_barrier
v_mfma_f32_16x16x32_bf16 v[96:99], a[0:3], a[112:115], 0
ds_read_b64_tr_b16 v[248:249], v220 offset:16384
s_add_u32 m0, s67, 106496
v_mfma_f32_16x16x32_bf16 v[96:99], a[4:7], a[124:127], v[96:99]
ds_read_b64_tr_b16 v[250:251], v220 offset:18432
s_add_u32 s69, s74, 458752
v_mfma_f32_16x16x32_bf16 v[104:107], a[4:7], a[128:131], 0
ds_read_b64_tr_b16 v[252:253], v220 offset:24576
buffer_load_dwordx4 v224, s[28:31], s69 offen offset:0 nt lds
v_mfma_f32_16x16x32_bf16 v[104:107], a[0:3], a[116:119], v[104:107]
ds_read_b64_tr_b16 v[254:255], v220 offset:26624
buffer_load_dwordx4 v225, s[28:31], s69 offen offset:1024 nt lds
v_mfma_f32_16x16x32_bf16 v[112:115], a[0:3], a[120:123], 0
s_add_u32 m0, s67, 114688
s_add_u32 s69, s74, 491520
v_mfma_f32_16x16x32_bf16 v[112:115], a[4:7], a[132:135], v[112:115]
buffer_load_dwordx4 v224, s[28:31], s69 offen offset:0 nt lds
s_waitcnt lgkmcnt(5)
v_mfma_f32_16x16x32_bf16 v[100:103], a[8:11], a[112:115], 0
ds_read_b64_tr_b16 a[0:1], v221 offset:16384
buffer_load_dwordx4 v225, s[28:31], s69 offen offset:1024 nt lds
v_mfma_f32_16x16x32_bf16 v[100:103], a[12:15], a[124:127], v[100:103]
ds_read_b64_tr_b16 a[2:3], v221 offset:18432
ds_write_b64 v228, v[162:163] offset:7176
v_mfma_f32_16x16x32_bf16 v[108:111], a[12:15], a[128:131], 0
ds_read_b64_tr_b16 a[4:5], v221 offset:24576
v_cvt_pk_bf16_f32 v167, v118, v119
v_mfma_f32_16x16x32_bf16 v[108:111], a[8:11], a[116:119], v[108:111]
ds_read_b64_tr_b16 a[6:7], v221 offset:26624
ds_write_b64 v228, v[164:165] offset:8192
v_mfma_f32_16x16x32_bf16 v[116:119], a[8:11], a[120:123], 0
v_mfma_f32_16x16x32_bf16 v[116:119], a[12:15], a[132:135], v[116:119]
ds_write_b64 v228, v[166:167] offset:8200
s_waitcnt lgkmcnt(7)
v_mfma_f32_16x16x32_bf16 v[120:123], v[248:251], a[136:139], v[120:123]
ds_read_b64_tr_b16 a[8:9], v218 offset:16384
v_mfma_f32_16x16x32_bf16 v[120:123], v[252:255], a[148:151], v[120:123]
ds_read_b64_tr_b16 a[10:11], v218 offset:18432
v_mfma_f32_16x16x32_bf16 v[128:131], v[252:255], a[152:155], v[128:131]
ds_read_b64_tr_b16 a[12:13], v218 offset:24576
v_mfma_f32_16x16x32_bf16 v[128:131], v[248:251], a[140:143], v[128:131]
ds_read_b64_tr_b16 a[14:15], v218 offset:26624
v_mfma_f32_16x16x32_bf16 v[136:139], v[248:251], a[144:147], v[136:139]
v_mfma_f32_16x16x32_bf16 v[136:139], v[252:255], a[156:159], v[136:139]
s_waitcnt lgkmcnt(6)
v_mfma_f32_16x16x32_bf16 v[124:127], a[0:3], a[136:139], v[124:127]
ds_read_b64_tr_b16 v[248:249], v219 offset:16384
v_mfma_f32_16x16x32_bf16 v[124:127], a[4:7], a[148:151], v[124:127]
ds_read_b64_tr_b16 v[250:251], v219 offset:18432
v_mfma_f32_16x16x32_bf16 v[132:135], a[4:7], a[152:155], v[132:135]
ds_read_b64_tr_b16 v[252:253], v219 offset:24576
v_mfma_f32_16x16x32_bf16 v[132:135], a[0:3], a[140:143], v[132:135]
ds_read_b64_tr_b16 v[254:255], v219 offset:26624
v_mfma_f32_16x16x32_bf16 v[140:143], a[0:3], a[144:147], v[140:143]
v_mfma_f32_16x16x32_bf16 v[140:143], a[4:7], a[156:159], v[140:143]
s_waitcnt vmcnt(8) lgkmcnt(4)
s_barrier
v_mfma_f32_16x16x32_bf16 v[96:99], a[8:11], a[136:139], v[96:99]
ds_read_b64_tr_b16 a[0:1], v216 offset:32768
s_add_u32 m0, s67, 49152
v_mfma_f32_16x16x32_bf16 v[96:99], a[12:15], a[148:151], v[96:99]
ds_read_b64_tr_b16 a[2:3], v216 offset:34816
s_add_u32 s69, s77, s80
v_mfma_f32_16x16x32_bf16 v[104:107], a[12:15], a[152:155], v[104:107]
ds_read_b64_tr_b16 a[4:5], v216 offset:36864
buffer_load_dwordx4 v226, s[36:39], s69 offen offset:0 lds
v_mfma_f32_16x16x32_bf16 v[104:107], a[8:11], a[140:143], v[104:107]
ds_read_b64_tr_b16 a[6:7], v216 offset:38912
buffer_load_dwordx4 v227, s[36:39], s69 offen offset:1024 lds
v_mfma_f32_16x16x32_bf16 v[112:115], a[8:11], a[144:147], v[112:115]
s_add_u32 m0, s67, 0
s_add_u32 s69, s77, s81
v_mfma_f32_16x16x32_bf16 v[112:115], a[12:15], a[156:159], v[112:115]
buffer_load_dwordx4 v226, s[36:39], s69 offen offset:0 lds
s_waitcnt lgkmcnt(4)
v_mfma_f32_16x16x32_bf16 v[100:103], v[248:251], a[136:139], v[100:103]
ds_read_b64_tr_b16 a[8:9], v217 offset:32768
buffer_load_dwordx4 v227, s[36:39], s69 offen offset:1024 lds
v_mfma_f32_16x16x32_bf16 v[100:103], v[252:255], a[148:151], v[100:103]
ds_read_b64_tr_b16 a[10:11], v217 offset:34816
s_add_u32 m0, s67, 8192
v_mfma_f32_16x16x32_bf16 v[108:111], v[252:255], a[152:155], v[108:111]
ds_read_b64_tr_b16 a[12:13], v217 offset:36864
s_add_u32 s69, s77, s82
v_mfma_f32_16x16x32_bf16 v[108:111], v[248:251], a[140:143], v[108:111]
ds_read_b64_tr_b16 a[14:15], v217 offset:38912
buffer_load_dwordx4 v226, s[36:39], s69 offen offset:0 lds
v_mfma_f32_16x16x32_bf16 v[116:119], v[248:251], a[144:147], v[116:119]
buffer_load_dwordx4 v227, s[36:39], s69 offen offset:1024 lds
ds_read_b128 a[40:43], v230 offset:6144
v_mfma_f32_16x16x32_bf16 v[116:119], v[252:255], a[156:159], v[116:119]
ds_read_b128 a[52:55], v230 offset:16384
s_waitcnt lgkmcnt(6)
v_mfma_f32_16x16x32_bf16 v[48:51], a[0:3], a[16:19], v[48:51]
ds_read_b64_tr_b16 v[248:249], v216 offset:40960
ds_read_b128 a[56:59], v230 offset:17408
v_mfma_f32_16x16x32_bf16 v[48:51], a[4:7], a[28:31], v[48:51]
ds_read_b64_tr_b16 v[250:251], v216 offset:43008
ds_read_b128 a[44:47], v230 offset:7168
v_mfma_f32_16x16x32_bf16 v[56:59], a[4:7], a[32:35], v[56:59]
ds_read_b64_tr_b16 v[252:253], v216 offset:45056
ds_read_b128 a[48:51], v230 offset:8192
v_mfma_f32_16x16x32_bf16 v[56:59], a[0:3], a[20:23], v[56:59]
ds_read_b64_tr_b16 v[254:255], v216 offset:47104
ds_read_b128 a[60:63], v230 offset:18432
v_mfma_f32_16x16x32_bf16 v[64:67], a[0:3], a[24:27], v[64:67]
v_mfma_f32_16x16x32_bf16 v[64:67], a[4:7], a[36:39], v[64:67]
s_waitcnt lgkmcnt(10)
v_mfma_f32_16x16x32_bf16 v[52:55], a[8:11], a[16:19], v[52:55]
ds_read_b64_tr_b16 a[0:1], v217 offset:40960
v_mfma_f32_16x16x32_bf16 v[52:55], a[12:15], a[28:31], v[52:55]
ds_read_b64_tr_b16 a[2:3], v217 offset:43008
v_mfma_f32_16x16x32_bf16 v[60:63], a[12:15], a[32:35], v[60:63]
ds_read_b64_tr_b16 a[4:5], v217 offset:45056
v_mfma_f32_16x16x32_bf16 v[60:63], a[8:11], a[20:23], v[60:63]
ds_read_b64_tr_b16 a[6:7], v217 offset:47104
v_mfma_f32_16x16x32_bf16 v[68:71], a[8:11], a[24:27], v[68:71]
v_mfma_f32_16x16x32_bf16 v[68:71], a[12:15], a[36:39], v[68:71]
s_waitcnt vmcnt(10) lgkmcnt(5)
s_barrier
v_mfma_f32_16x16x32_bf16 v[72:75], v[248:251], a[16:19], v[72:75]
ds_read_b64_tr_b16 a[8:9], v220 offset:32768
s_add_u32 m0, s67, 16384
v_mfma_f32_16x16x32_bf16 v[72:75], v[252:255], a[28:31], v[72:75]
ds_read_b64_tr_b16 a[10:11], v220 offset:34816
s_add_u32 s69, s77, s83
v_mfma_f32_16x16x32_bf16 v[80:83], v[252:255], a[32:35], v[80:83]
ds_read_b64_tr_b16 a[12:13], v220 offset:40960
buffer_load_dwordx4 v226, s[36:39], s69 offen offset:0 lds
v_mfma_f32_16x16x32_bf16 v[80:83], v[248:251], a[20:23], v[80:83]
ds_read_b64_tr_b16 a[14:15], v220 offset:43008
buffer_load_dwordx4 v227, s[36:39], s69 offen offset:1024 lds
v_mfma_f32_16x16x32_bf16 v[88:91], v[248:251], a[24:27], v[88:91]
v_mfma_f32_16x16x32_bf16 v[88:91], v[252:255], a[36:39], v[88:91]
s_waitcnt lgkmcnt(4)
v_mfma_f32_16x16x32_bf16 v[76:79], a[0:3], a[16:19], v[76:79]
ds_read_b64_tr_b16 v[248:249], v221 offset:32768
v_mfma_f32_16x16x32_bf16 v[76:79], a[4:7], a[28:31], v[76:79]
ds_read_b64_tr_b16 v[250:251], v221 offset:34816
v_mfma_f32_16x16x32_bf16 v[84:87], a[4:7], a[32:35], v[84:87]
ds_read_b64_tr_b16 v[252:253], v221 offset:40960
v_mfma_f32_16x16x32_bf16 v[84:87], a[0:3], a[20:23], v[84:87]
ds_read_b64_tr_b16 v[254:255], v221 offset:43008
v_mfma_f32_16x16x32_bf16 v[92:95], a[0:3], a[24:27], v[92:95]
v_mfma_f32_16x16x32_bf16 v[92:95], a[4:7], a[36:39], v[92:95]
s_waitcnt lgkmcnt(4)
v_mfma_f32_16x16x32_bf16 v[120:123], a[8:11], a[160:163], v[120:123]
ds_read_b64_tr_b16 a[0:1], v218 offset:32768
v_mfma_f32_16x16x32_bf16 v[120:123], a[12:15], a[172:175], v[120:123]
ds_read_b64_tr_b16 a[2:3], v218 offset:34816
v_mfma_f32_16x16x32_bf16 v[128:131], a[12:15], a[176:179], v[128:131]
ds_read_b64_tr_b16 a[4:5], v218 offset:40960
v_mfma_f32_16x16x32_bf16 v[128:131], a[8:11], a[164:167], v[128:131]
ds_read_b64_tr_b16 a[6:7], v218 offset:43008
v_mfma_f32_16x16x32_bf16 v[136:139], a[8:11], a[168:171], v[136:139]
v_mfma_f32_16x16x32_bf16 v[136:139], a[12:15], a[180:183], v[136:139]
s_waitcnt lgkmcnt(4)
v_mfma_f32_16x16x32_bf16 v[124:127], v[248:251], a[160:163], v[124:127]
ds_read_b64_tr_b16 a[8:9], v219 offset:32768
v_mfma_f32_16x16x32_bf16 v[124:127], v[252:255], a[172:175], v[124:127]
ds_read_b64_tr_b16 a[10:11], v219 offset:34816
v_mfma_f32_16x16x32_bf16 v[132:135], v[252:255], a[176:179], v[132:135]
ds_read_b64_tr_b16 a[12:13], v219 offset:40960
v_mfma_f32_16x16x32_bf16 v[132:135], v[248:251], a[164:167], v[132:135]
ds_read_b64_tr_b16 a[14:15], v219 offset:43008
v_mfma_f32_16x16x32_bf16 v[140:143], v[248:251], a[168:171], v[140:143]
v_mfma_f32_16x16x32_bf16 v[140:143], v[252:255], a[180:183], v[140:143]
s_waitcnt vmcnt(8) lgkmcnt(4)
s_barrier
v_mfma_f32_16x16x32_bf16 v[96:99], a[0:3], a[160:163], v[96:99]
ds_read_b64_tr_b16 v[248:249], v220 offset:49152
s_add_u32 m0, s67, 57344
v_mfma_f32_16x16x32_bf16 v[96:99], a[4:7], a[172:175], v[96:99]
ds_read_b64_tr_b16 v[250:251], v220 offset:51200
s_add_u32 s69, s75, 262144
v_mfma_f32_16x16x32_bf16 v[104:107], a[4:7], a[176:179], v[104:107]
ds_read_b64_tr_b16 v[252:253], v220 offset:57344
buffer_load_dwordx4 v224, s[28:31], s69 offen offset:0 nt lds
v_mfma_f32_16x16x32_bf16 v[104:107], a[0:3], a[164:167], v[104:107]
ds_read_b64_tr_b16 v[254:255], v220 offset:59392
buffer_load_dwordx4 v225, s[28:31], s69 offen offset:1024 nt lds
v_mfma_f32_16x16x32_bf16 v[112:115], a[0:3], a[168:171], v[112:115]
s_add_u32 m0, s67, 65536
s_add_u32 s69, s75, 294912
v_mfma_f32_16x16x32_bf16 v[112:115], a[4:7], a[180:183], v[112:115]
buffer_load_dwordx4 v224, s[28:31], s69 offen offset:0 nt lds
s_waitcnt lgkmcnt(4)
v_mfma_f32_16x16x32_bf16 v[100:103], a[8:11], a[160:163], v[100:103]
ds_read_b64_tr_b16 a[0:1], v221 offset:49152
buffer_load_dwordx4 v225, s[28:31], s69 offen offset:1024 nt lds
v_mfma_f32_16x16x32_bf16 v[100:103], a[12:15], a[172:175], v[100:103]
ds_read_b64_tr_b16 a[2:3], v221 offset:51200
v_mfma_f32_16x16x32_bf16 v[108:111], a[12:15], a[176:179], v[108:111]
ds_read_b64_tr_b16 a[4:5], v221 offset:57344
v_mfma_f32_16x16x32_bf16 v[108:111], a[8:11], a[164:167], v[108:111]
ds_read_b64_tr_b16 a[6:7], v221 offset:59392
v_mfma_f32_16x16x32_bf16 v[116:119], a[8:11], a[168:171], v[116:119]
v_mfma_f32_16x16x32_bf16 v[116:119], a[12:15], a[180:183], v[116:119]
s_waitcnt lgkmcnt(4)
v_mfma_f32_16x16x32_bf16 v[120:123], v[248:251], a[184:187], v[120:123]
ds_read_b64_tr_b16 a[8:9], v218 offset:49152
v_mfma_f32_16x16x32_bf16 v[120:123], v[252:255], a[196:199], v[120:123]
ds_read_b64_tr_b16 a[10:11], v218 offset:51200
v_mfma_f32_16x16x32_bf16 v[128:131], v[252:255], a[200:203], v[128:131]
ds_read_b64_tr_b16 a[12:13], v218 offset:57344
v_mfma_f32_16x16x32_bf16 v[128:131], v[248:251], a[188:191], v[128:131]
ds_read_b64_tr_b16 a[14:15], v218 offset:59392
v_mfma_f32_16x16x32_bf16 v[136:139], v[248:251], a[192:195], v[136:139]
s_nop 1
ds_write_b64 v228, v[120:121] offset:0
v_mfma_f32_16x16x32_bf16 v[136:139], v[252:255], a[204:207], v[136:139]
s_waitcnt lgkmcnt(5)
v_mfma_f32_16x16x32_bf16 v[124:127], a[0:3], a[184:187], v[124:127]
ds_read_b64_tr_b16 v[248:249], v219 offset:49152
ds_write_b64 v228, v[122:123] offset:8
v_mfma_f32_16x16x32_bf16 v[124:127], a[4:7], a[196:199], v[124:127]
ds_read_b64_tr_b16 v[250:251], v219 offset:51200
v_mfma_f32_16x16x32_bf16 v[132:135], a[4:7], a[200:203], v[132:135]
ds_read_b64_tr_b16 v[252:253], v219 offset:57344
ds_write_b64 v228, v[128:129] offset:2048
v_mfma_f32_16x16x32_bf16 v[132:135], a[0:3], a[188:191], v[132:135]
ds_read_b64_tr_b16 v[254:255], v219 offset:59392
v_mfma_f32_16x16x32_bf16 v[140:143], a[0:3], a[192:195], v[140:143]
ds_write_b64 v228, v[130:131] offset:2056
v_mfma_f32_16x16x32_bf16 v[140:143], a[4:7], a[204:207], v[140:143]
s_waitcnt vmcnt(8) lgkmcnt(8)
s_barrier
v_mfma_f32_16x16x32_bf16 v[96:99], a[8:11], a[184:187], v[96:99]
ds_read_b64_tr_b16 a[0:1], v216 offset:49152
s_add_u32 m0, s67, 73728
ds_write_b64 v228, v[136:137] offset:4096
v_mfma_f32_16x16x32_bf16 v[96:99], a[12:15], a[196:199], v[96:99]
ds_read_b64_tr_b16 a[2:3], v216 offset:51200
s_add_u32 s69, s75, 327680
v_mfma_f32_16x16x32_bf16 v[104:107], a[12:15], a[200:203], v[104:107]
ds_read_b64_tr_b16 a[4:5], v216 offset:53248
buffer_load_dwordx4 v224, s[28:31], s69 offen offset:0 nt lds
ds_write_b64 v228, v[138:139] offset:4104
v_mfma_f32_16x16x32_bf16 v[104:107], a[8:11], a[188:191], v[104:107]
ds_read_b64_tr_b16 a[6:7], v216 offset:55296
buffer_load_dwordx4 v225, s[28:31], s69 offen offset:1024 nt lds
v_mfma_f32_16x16x32_bf16 v[112:115], a[8:11], a[192:195], v[112:115]
s_add_u32 m0, s67, 81920
s_add_u32 s69, s75, 360448
ds_write_b64 v228, v[124:125] offset:1024
v_mul_f32 v96, v238, v96
v_mfma_f32_16x16x32_bf16 v[112:115], a[12:15], a[204:207], v[112:115]
buffer_load_dwordx4 v224, s[28:31], s69 offen offset:0 nt lds
v_mul_f32 v97, v238, v97
s_waitcnt lgkmcnt(8)
v_mfma_f32_16x16x32_bf16 v[100:103], v[248:251], a[184:187], v[100:103]
ds_read_b64_tr_b16 a[8:9], v217 offset:49152
buffer_load_dwordx4 v225, s[28:31], s69 offen offset:1024 nt lds
ds_write_b64 v228, v[126:127] offset:1032
v_mul_f32 v98, v238, v98
v_mfma_f32_16x16x32_bf16 v[100:103], v[252:255], a[196:199], v[100:103]
ds_read_b64_tr_b16 a[10:11], v217 offset:51200
s_add_u32 m0, s67, 24576
v_mul_f32 v99, v238, v99
v_mfma_f32_16x16x32_bf16 v[108:111], v[252:255], a[200:203], v[108:111]
ds_read_b64_tr_b16 a[12:13], v217 offset:53248
s_add_u32 s69, s77, s84
ds_write_b64 v228, v[132:133] offset:3072
v_mfma_f32_16x16x32_bf16 v[108:111], v[248:251], a[188:191], v[108:111]
ds_read_b64_tr_b16 a[14:15], v217 offset:55296
buffer_load_dwordx4 v226, s[36:39], s69 offen offset:0 lds
v_mul_f32 v104, v239, v104
v_mfma_f32_16x16x32_bf16 v[116:119], v[248:251], a[192:195], v[116:119]
buffer_load_dwordx4 v227, s[36:39], s69 offen offset:1024 lds
ds_write_b64 v228, v[134:135] offset:3080
v_mul_f32 v105, v239, v105
v_mfma_f32_16x16x32_bf16 v[116:119], v[252:255], a[204:207], v[116:119]
v_mul_f32 v106, v239, v106
s_waitcnt lgkmcnt(8)
v_mfma_f32_16x16x32_bf16 a[208:211], a[0:3], a[40:43], a[208:211]
ds_read_b64_tr_b16 v[248:249], v216 offset:0
ds_write_b64 v228, v[140:141] offset:5120
v_mfma_f32_16x16x32_bf16 a[208:211], a[4:7], a[52:55], a[208:211]
ds_read_b64_tr_b16 v[250:251], v216 offset:2048
v_mul_f32 v107, v239, v107
v_mfma_f32_16x16x32_bf16 a[216:219], a[4:7], a[56:59], a[216:219]
ds_read_b64_tr_b16 v[252:253], v216 offset:4096
ds_write_b64 v228, v[142:143] offset:5128
v_mul_f32 v112, v240, v112
v_mfma_f32_16x16x32_bf16 a[216:219], a[0:3], a[44:47], a[216:219]
ds_read_b64_tr_b16 v[254:255], v216 offset:6144
v_mul_f32 v113, v240, v113
v_mfma_f32_16x16x32_bf16 a[224:227], a[0:3], a[48:51], a[224:227]
v_mul_f32 v114, v240, v114
v_mul_f32 v115, v240, v115
v_mfma_f32_16x16x32_bf16 a[224:227], a[4:7], a[60:63], a[224:227]
v_mul_f32 v100, v238, v100
s_waitcnt lgkmcnt(7)
v_mfma_f32_16x16x32_bf16 a[212:215], a[8:11], a[40:43], a[212:215]
ds_read_b64_tr_b16 a[0:1], v217 offset:0
v_mul_f32 v101, v238, v101
v_mfma_f32_16x16x32_bf16 a[212:215], a[12:15], a[52:55], a[212:215]
ds_read_b64_tr_b16 a[2:3], v217 offset:2048
v_mul_f32 v102, v238, v102
v_mfma_f32_16x16x32_bf16 a[220:223], a[12:15], a[56:59], a[220:223]
ds_read_b64_tr_b16 a[4:5], v217 offset:4096
v_mul_f32 v103, v238, v103
v_mfma_f32_16x16x32_bf16 a[220:223], a[8:11], a[44:47], a[220:223]
ds_read_b64_tr_b16 a[6:7], v217 offset:6144
v_mul_f32 v108, v239, v108
v_mfma_f32_16x16x32_bf16 a[228:231], a[8:11], a[48:51], a[228:231]
v_mul_f32 v109, v239, v109
v_mul_f32 v110, v239, v110
v_mfma_f32_16x16x32_bf16 a[228:231], a[12:15], a[60:63], a[228:231]
s_waitcnt vmcnt(10) lgkmcnt(4)
s_barrier
v_mfma_f32_16x16x32_bf16 a[232:235], v[248:251], a[40:43], a[232:235]
ds_read_b64_tr_b16 a[8:9], v216 offset:8192
s_add_u32 m0, s67, 32768
ds_read_b128 v[120:123], v229 offset:0
v_mfma_f32_16x16x32_bf16 a[232:235], v[252:255], a[52:55], a[232:235]
ds_read_b64_tr_b16 a[10:11], v216 offset:10240
s_add_u32 s69, s78, s80
ds_read_b128 v[124:127], v229 offset:1024
v_mfma_f32_16x16x32_bf16 a[240:243], v[252:255], a[56:59], a[240:243]
ds_read_b64_tr_b16 a[12:13], v216 offset:12288
buffer_load_dwordx4 v226, s[36:39], s69 offen offset:0 lds
ds_read_b128 v[128:131], v229 offset:2048
v_mfma_f32_16x16x32_bf16 a[240:243], v[248:251], a[44:47], a[240:243]
ds_read_b64_tr_b16 a[14:15], v216 offset:14336
buffer_load_dwordx4 v227, s[36:39], s69 offen offset:1024 lds
ds_read_b128 v[132:135], v229 offset:3072
v_mfma_f32_16x16x32_bf16 a[248:251], v[248:251], a[48:51], a[248:251]
s_add_u32 m0, s67, 90112
s_add_u32 s69, s75, 393216
ds_read_b128 v[136:139], v229 offset:4096
v_mfma_f32_16x16x32_bf16 a[248:251], v[252:255], a[60:63], a[248:251]
buffer_load_dwordx4 v224, s[28:31], s69 offen offset:0 nt lds
ds_read_b128 v[140:143], v229 offset:5120
v_mul_f32 v111, v239, v111
s_waitcnt lgkmcnt(10)
v_mfma_f32_16x16x32_bf16 a[236:239], a[0:3], a[40:43], a[236:239]
ds_read_b64_tr_b16 v[248:249], v217 offset:8192
buffer_load_dwordx4 v225, s[28:31], s69 offen offset:1024 nt lds
s_waitcnt lgkmcnt(9)
v_fmac_f32 v96, v241, v120
v_mfma_f32_16x16x32_bf16 a[236:239], a[4:7], a[52:55], a[236:239]
ds_read_b64_tr_b16 v[250:251], v217 offset:10240
v_fmac_f32 v97, v241, v121
v_mfma_f32_16x16x32_bf16 a[244:247], a[4:7], a[56:59], a[244:247]
ds_read_b64_tr_b16 v[252:253], v217 offset:12288
v_fmac_f32 v98, v241, v122
v_mfma_f32_16x16x32_bf16 a[244:247], a[0:3], a[44:47], a[244:247]
ds_read_b64_tr_b16 v[254:255], v217 offset:14336
v_fmac_f32 v99, v241, v123
v_mfma_f32_16x16x32_bf16 a[252:255], a[0:3], a[48:51], a[252:255]
s_waitcnt lgkmcnt(8)
v_fmac_f32 v104, v242, v128
v_mfma_f32_16x16x32_bf16 a[252:255], a[4:7], a[60:63], a[252:255]
v_fmac_f32 v105, v242, v129
s_waitcnt lgkmcnt(7)
v_mfma_f32_16x16x32_bf16 v[0:3], a[8:11], a[40:43], v[0:3]
ds_read_b64_tr_b16 a[0:1], v216 offset:16384
v_fmac_f32 v106, v242, v130
v_mfma_f32_16x16x32_bf16 v[0:3], a[12:15], a[52:55], v[0:3]
ds_read_b64_tr_b16 a[2:3], v216 offset:18432
v_fmac_f32 v107, v242, v131
v_mfma_f32_16x16x32_bf16 v[8:11], a[12:15], a[56:59], v[8:11]
ds_read_b64_tr_b16 a[4:5], v216 offset:20480
s_waitcnt lgkmcnt(8)
v_fmac_f32 v112, v243, v136
v_mfma_f32_16x16x32_bf16 v[8:11], a[8:11], a[44:47], v[8:11]
ds_read_b64_tr_b16 a[6:7], v216 offset:22528
v_fmac_f32 v113, v243, v137
v_mfma_f32_16x16x32_bf16 v[16:19], a[8:11], a[48:51], v[16:19]
v_fmac_f32 v114, v243, v138
v_fmac_f32 v115, v243, v139
v_mfma_f32_16x16x32_bf16 v[16:19], a[12:15], a[60:63], v[16:19]
v_fmac_f32 v100, v241, v124
s_waitcnt lgkmcnt(4)
v_mfma_f32_16x16x32_bf16 v[4:7], v[248:251], a[40:43], v[4:7]
ds_read_b64_tr_b16 a[8:9], v217 offset:16384
v_fmac_f32 v101, v241, v125
v_mfma_f32_16x16x32_bf16 v[4:7], v[252:255], a[52:55], v[4:7]
ds_read_b64_tr_b16 a[10:11], v217 offset:18432
v_fmac_f32 v102, v241, v126
v_mfma_f32_16x16x32_bf16 v[12:15], v[252:255], a[56:59], v[12:15]
ds_read_b64_tr_b16 a[12:13], v217 offset:20480
v_fmac_f32 v103, v241, v127
v_mfma_f32_16x16x32_bf16 v[12:15], v[248:251], a[44:47], v[12:15]
ds_read_b64_tr_b16 a[14:15], v217 offset:22528
v_fmac_f32 v108, v242, v132
v_mfma_f32_16x16x32_bf16 v[20:23], v[248:251], a[48:51], v[20:23]
v_fmac_f32 v109, v242, v133
v_fmac_f32 v110, v242, v134
v_mfma_f32_16x16x32_bf16 v[20:23], v[252:255], a[60:63], v[20:23]
s_waitcnt vmcnt(10) lgkmcnt(4)
s_barrier
v_mfma_f32_16x16x32_bf16 v[24:27], a[0:3], a[40:43], v[24:27]
ds_read_b64_tr_b16 v[248:249], v220 offset:0
s_add_u32 m0, s67, 98304
v_mfma_f32_16x16x32_bf16 v[24:27], a[4:7], a[52:55], v[24:27]
ds_read_b64_tr_b16 v[250:251], v220 offset:2048
s_add_u32 s69, s75, 425984
v_mfma_f32_16x16x32_bf16 v[32:35], a[4:7], a[56:59], v[32:35]
ds_read_b64_tr_b16 v[252:253], v220 offset:8192
buffer_load_dwordx4 v224, s[28:31], s69 offen offset:0 nt lds
v_mfma_f32_16x16x32_bf16 v[32:35], a[0:3], a[44:47], v[32:35]
ds_read_b64_tr_b16 v[254:255], v220 offset:10240
buffer_load_dwordx4 v225, s[28:31], s69 offen offset:1024 nt lds
v_mfma_f32_16x16x32_bf16 v[40:43], a[0:3], a[48:51], v[40:43]
s_add_u32 m0, s67, 106496
s_add_u32 s69, s75, 458752
v_mfma_f32_16x16x32_bf16 v[40:43], a[4:7], a[60:63], v[40:43]
buffer_load_dwordx4 v224, s[28:31], s69 offen offset:0 nt lds
s_waitcnt lgkmcnt(4)
v_mfma_f32_16x16x32_bf16 v[28:31], a[8:11], a[40:43], v[28:31]
ds_read_b64_tr_b16 a[0:1], v221 offset:0
buffer_load_dwordx4 v225, s[28:31], s69 offen offset:1024 nt lds
v_fmac_f32 v111, v242, v135
v_mfma_f32_16x16x32_bf16 v[28:31], a[12:15], a[52:55], v[28:31]
ds_read_b64_tr_b16 a[2:3], v221 offset:2048
s_add_u32 m0, s67, 114688
v_mul_f32 v116, v240, v116
v_mfma_f32_16x16x32_bf16 v[36:39], a[12:15], a[56:59], v[36:39]
ds_read_b64_tr_b16 a[4:5], v221 offset:8192
s_add_u32 s69, s75, 491520
v_mfma_f32_16x16x32_bf16 v[36:39], a[8:11], a[44:47], v[36:39]
ds_read_b64_tr_b16 a[6:7], v221 offset:10240
buffer_load_dwordx4 v224, s[28:31], s69 offen offset:0 nt lds
v_mul_f32 v117, v240, v117
v_mfma_f32_16x16x32_bf16 v[44:47], a[8:11], a[48:51], v[44:47]
buffer_load_dwordx4 v225, s[28:31], s69 offen offset:1024 nt lds
v_mul_f32 v118, v240, v118
v_mfma_f32_16x16x32_bf16 v[44:47], a[12:15], a[60:63], v[44:47]
v_mul_f32 v119, v240, v119
s_waitcnt lgkmcnt(4)
v_mfma_f32_16x16x32_bf16 v[120:123], v[248:251], a[112:115], 0
ds_read_b64_tr_b16 a[8:9], v218 offset:0
v_fmac_f32 v116, v243, v140
v_mfma_f32_16x16x32_bf16 v[120:123], v[252:255], a[124:127], v[120:123]
ds_read_b64_tr_b16 a[10:11], v218 offset:2048
v_fmac_f32 v117, v243, v141
v_mfma_f32_16x16x32_bf16 v[128:131], v[252:255], a[128:131], 0
ds_read_b64_tr_b16 a[12:13], v218 offset:8192
v_fmac_f32 v118, v243, v142
v_mfma_f32_16x16x32_bf16 v[128:131], v[248:251], a[116:119], v[128:131]
ds_read_b64_tr_b16 a[14:15], v218 offset:10240
v_fmac_f32 v119, v243, v143
v_mfma_f32_16x16x32_bf16 v[136:139], v[248:251], a[120:123], 0
v_cvt_pk_bf16_f32 v156, v96, v97
v_cvt_pk_bf16_f32 v157, v98, v99
v_mfma_f32_16x16x32_bf16 v[136:139], v[252:255], a[132:135], v[136:139]
ds_write_b64 v228, v[156:157] offset:6144
s_waitcnt lgkmcnt(5)
v_mfma_f32_16x16x32_bf16 v[124:127], a[0:3], a[112:115], 0
ds_read_b64_tr_b16 v[248:249], v219 offset:0
v_cvt_pk_bf16_f32 v160, v104, v105
v_mfma_f32_16x16x32_bf16 v[124:127], a[4:7], a[124:127], v[124:127]
ds_read_b64_tr_b16 v[250:251], v219 offset:2048
v_cvt_pk_bf16_f32 v161, v106, v107
v_mfma_f32_16x16x32_bf16 v[132:135], a[4:7], a[128:131], 0
ds_read_b64_tr_b16 v[252:253], v219 offset:8192
v_cvt_pk_bf16_f32 v164, v112, v113
v_mfma_f32_16x16x32_bf16 v[132:135], a[0:3], a[116:119], v[132:135]
ds_read_b64_tr_b16 v[254:255], v219 offset:10240
v_cvt_pk_bf16_f32 v165, v114, v115
v_mfma_f32_16x16x32_bf16 v[140:143], a[0:3], a[120:123], 0
v_cvt_pk_bf16_f32 v158, v100, v101
v_cvt_pk_bf16_f32 v159, v102, v103
v_mfma_f32_16x16x32_bf16 v[140:143], a[4:7], a[132:135], v[140:143]
s_waitcnt vmcnt(12) lgkmcnt(5)
s_barrier
v_mfma_f32_16x16x32_bf16 v[96:99], a[8:11], a[112:115], 0
ds_read_b64_tr_b16 a[0:1], v220 offset:16384
s_add_u32 m0, s67, 40960
v_mfma_f32_16x16x32_bf16 v[96:99], a[12:15], a[124:127], v[96:99]
ds_read_b64_tr_b16 a[2:3], v220 offset:18432
s_add_u32 s69, s78, s81
v_mfma_f32_16x16x32_bf16 v[104:107], a[12:15], a[128:131], 0
ds_read_b64_tr_b16 a[4:5], v220 offset:24576
buffer_load_dwordx4 v226, s[36:39], s69 offen offset:0 lds
v_mfma_f32_16x16x32_bf16 v[104:107], a[8:11], a[116:119], v[104:107]
ds_read_b64_tr_b16 a[6:7], v220 offset:26624
buffer_load_dwordx4 v227, s[36:39], s69 offen offset:1024 lds
v_mfma_f32_16x16x32_bf16 v[112:115], a[8:11], a[120:123], 0
s_add_u32 m0, s67, 49152
s_add_u32 s69, s78, s82
v_mfma_f32_16x16x32_bf16 v[112:115], a[12:15], a[132:135], v[112:115]
buffer_load_dwordx4 v226, s[36:39], s69 offen offset:0 lds
s_waitcnt lgkmcnt(4)
v_mfma_f32_16x16x32_bf16 v[100:103], v[248:251], a[112:115], 0
ds_read_b64_tr_b16 a[8:9], v221 offset:16384
buffer_load_dwordx4 v227, s[36:39], s69 offen offset:1024 lds
v_mfma_f32_16x16x32_bf16 v[100:103], v[252:255], a[124:127], v[100:103]
ds_read_b64_tr_b16 a[10:11], v221 offset:18432
ds_write_b64 v228, v[158:159] offset:6152
v_cvt_pk_bf16_f32 v162, v108, v109
v_cvt_pk_bf16_f32 v163, v110, v111
v_mfma_f32_16x16x32_bf16 v[108:111], v[252:255], a[128:131], 0
ds_read_b64_tr_b16 a[12:13], v221 offset:24576
v_cvt_pk_bf16_f32 v166, v116, v117
v_mfma_f32_16x16x32_bf16 v[108:111], v[248:251], a[116:119], v[108:111]
ds_read_b64_tr_b16 a[14:15], v221 offset:26624
ds_write_b64 v228, v[160:161] offset:7168
v_cvt_pk_bf16_f32 v167, v118, v119
v_mfma_f32_16x16x32_bf16 v[116:119], v[248:251], a[120:123], 0
v_mfma_f32_16x16x32_bf16 v[116:119], v[252:255], a[132:135], v[116:119]
ds_write_b64 v228, v[162:163] offset:7176
s_waitcnt lgkmcnt(7)
v_mfma_f32_16x16x32_bf16 v[120:123], a[0:3], a[136:139], v[120:123]
ds_read_b64_tr_b16 v[248:249], v218 offset:16384
v_mfma_f32_16x16x32_bf16 v[120:123], a[4:7], a[148:151], v[120:123]
ds_read_b64_tr_b16 v[250:251], v218 offset:18432
ds_write_b64 v228, v[164:165] offset:8192
v_mfma_f32_16x16x32_bf16 v[128:131], a[4:7], a[152:155], v[128:131]
ds_read_b64_tr_b16 v[252:253], v218 offset:24576
v_mfma_f32_16x16x32_bf16 v[128:131], a[0:3], a[140:143], v[128:131]
ds_read_b64_tr_b16 v[254:255], v218 offset:26624
ds_write_b64 v228, v[166:167] offset:8200
v_mfma_f32_16x16x32_bf16 v[136:139], a[0:3], a[144:147], v[136:139]
v_mfma_f32_16x16x32_bf16 v[136:139], a[4:7], a[156:159], v[136:139]
s_waitcnt lgkmcnt(8)
v_mfma_f32_16x16x32_bf16 v[124:127], a[8:11], a[136:139], v[124:127]
ds_read_b64_tr_b16 a[0:1], v219 offset:16384
v_mfma_f32_16x16x32_bf16 v[124:127], a[12:15], a[148:151], v[124:127]
ds_read_b64_tr_b16 a[2:3], v219 offset:18432
v_mfma_f32_16x16x32_bf16 v[132:135], a[12:15], a[152:155], v[132:135]
ds_read_b64_tr_b16 a[4:5], v219 offset:24576
v_mfma_f32_16x16x32_bf16 v[132:135], a[8:11], a[140:143], v[132:135]
ds_read_b64_tr_b16 a[6:7], v219 offset:26624
v_mfma_f32_16x16x32_bf16 v[140:143], a[8:11], a[144:147], v[140:143]
v_mfma_f32_16x16x32_bf16 v[140:143], a[12:15], a[156:159], v[140:143]
s_waitcnt vmcnt(12) lgkmcnt(4)
s_barrier
v_mfma_f32_16x16x32_bf16 v[96:99], v[248:251], a[136:139], v[96:99]
ds_read_b64_tr_b16 a[8:9], v216 offset:24576
s_add_u32 m0, s67, 0
v_mfma_f32_16x16x32_bf16 v[96:99], v[252:255], a[148:151], v[96:99]
ds_read_b64_tr_b16 a[10:11], v216 offset:26624
s_add_u32 s69, s78, s83
v_mfma_f32_16x16x32_bf16 v[104:107], v[252:255], a[152:155], v[104:107]
ds_read_b64_tr_b16 a[12:13], v216 offset:28672
buffer_load_dwordx4 v226, s[36:39], s69 offen offset:0 lds
v_mfma_f32_16x16x32_bf16 v[104:107], v[248:251], a[140:143], v[104:107]
ds_read_b64_tr_b16 a[14:15], v216 offset:30720
buffer_load_dwordx4 v227, s[36:39], s69 offen offset:1024 lds
v_mfma_f32_16x16x32_bf16 v[112:115], v[248:251], a[144:147], v[112:115]
s_add_u32 m0, s67, 8192
s_add_u32 s69, s78, s84
v_mfma_f32_16x16x32_bf16 v[112:115], v[252:255], a[156:159], v[112:115]
buffer_load_dwordx4 v226, s[36:39], s69 offen offset:0 lds
s_waitcnt lgkmcnt(4)
v_mfma_f32_16x16x32_bf16 v[100:103], a[0:3], a[136:139], v[100:103]
ds_read_b64_tr_b16 v[248:249], v217 offset:24576
buffer_load_dwordx4 v227, s[36:39], s69 offen offset:1024 lds
v_mfma_f32_16x16x32_bf16 v[100:103], a[4:7], a[148:151], v[100:103]
ds_read_b64_tr_b16 v[250:251], v217 offset:26624
ds_read_b128 a[88:91], v230 offset:6144
v_mfma_f32_16x16x32_bf16 v[108:111], a[4:7], a[152:155], v[108:111]
ds_read_b64_tr_b16 v[252:253], v217 offset:28672
ds_read_b128 a[100:103], v230 offset:16384
v_mfma_f32_16x16x32_bf16 v[108:111], a[0:3], a[140:143], v[108:111]
ds_read_b64_tr_b16 v[254:255], v217 offset:30720
ds_read_b128 a[104:107], v230 offset:17408
v_mfma_f32_16x16x32_bf16 v[116:119], a[0:3], a[144:147], v[116:119]
ds_read_b128 a[92:95], v230 offset:7168
v_mfma_f32_16x16x32_bf16 v[116:119], a[4:7], a[156:159], v[116:119]
ds_read_b128 a[96:99], v230 offset:8192
s_waitcnt lgkmcnt(9)
v_mfma_f32_16x16x32_bf16 v[48:51], a[8:11], a[40:43], v[48:51]
ds_read_b64_tr_b16 a[0:1], v216 offset:32768
ds_read_b128 a[108:111], v230 offset:18432
v_mfma_f32_16x16x32_bf16 v[48:51], a[12:15], a[52:55], v[48:51]
ds_read_b64_tr_b16 a[2:3], v216 offset:34816
v_mfma_f32_16x16x32_bf16 v[56:59], a[12:15], a[56:59], v[56:59]
ds_read_b64_tr_b16 a[4:5], v216 offset:36864
v_mfma_f32_16x16x32_bf16 v[56:59], a[8:11], a[44:47], v[56:59]
ds_read_b64_tr_b16 a[6:7], v216 offset:38912
v_mfma_f32_16x16x32_bf16 v[64:67], a[8:11], a[48:51], v[64:67]
v_mfma_f32_16x16x32_bf16 v[64:67], a[12:15], a[60:63], v[64:67]
s_waitcnt lgkmcnt(8)
v_mfma_f32_16x16x32_bf16 v[52:55], v[248:251], a[40:43], v[52:55]
ds_read_b64_tr_b16 a[8:9], v217 offset:32768
v_mfma_f32_16x16x32_bf16 v[52:55], v[252:255], a[52:55], v[52:55]
ds_read_b64_tr_b16 a[10:11], v217 offset:34816
v_mfma_f32_16x16x32_bf16 v[60:63], v[252:255], a[56:59], v[60:63]
ds_read_b64_tr_b16 a[12:13], v217 offset:36864
v_mfma_f32_16x16x32_bf16 v[60:63], v[248:251], a[44:47], v[60:63]
ds_read_b64_tr_b16 a[14:15], v217 offset:38912
v_mfma_f32_16x16x32_bf16 v[68:71], v[248:251], a[48:51], v[68:71]
v_mfma_f32_16x16x32_bf16 v[68:71], v[252:255], a[60:63], v[68:71]
s_waitcnt vmcnt(12) lgkmcnt(4)
s_barrier
v_mfma_f32_16x16x32_bf16 a[208:211], a[0:3], a[88:91], a[208:211]
ds_read_b64_tr_b16 v[248:249], v220 offset:32768
s_add_u32 m0, s67, 16384
v_mfma_f32_16x16x32_bf16 a[208:211], a[4:7], a[100:103], a[208:211]
ds_read_b64_tr_b16 v[250:251], v220 offset:34816
s_add_u32 s69, s79, s80
v_mfma_f32_16x16x32_bf16 a[216:219], a[4:7], a[104:107], a[216:219]
ds_read_b64_tr_b16 v[252:253], v220 offset:40960
buffer_load_dwordx4 v226, s[36:39], s69 offen offset:0 lds
v_mfma_f32_16x16x32_bf16 a[216:219], a[0:3], a[92:95], a[216:219]
ds_read_b64_tr_b16 v[254:255], v220 offset:43008
buffer_load_dwordx4 v227, s[36:39], s69 offen offset:1024 lds
v_mfma_f32_16x16x32_bf16 a[224:227], a[0:3], a[96:99], a[224:227]
s_add_u32 m0, s67, 24576
s_add_u32 s69, s79, s81
v_mfma_f32_16x16x32_bf16 a[224:227], a[4:7], a[108:111], a[224:227]
buffer_load_dwordx4 v226, s[36:39], s69 offen offset:0 lds
s_waitcnt lgkmcnt(4)
v_mfma_f32_16x16x32_bf16 a[212:215], a[8:11], a[88:91], a[212:215]
ds_read_b64_tr_b16 a[0:1], v221 offset:32768
buffer_load_dwordx4 v227, s[36:39], s69 offen offset:1024 lds
v_mfma_f32_16x16x32_bf16 a[212:215], a[12:15], a[100:103], a[212:215]
ds_read_b64_tr_b16 a[2:3], v221 offset:34816
v_mfma_f32_16x16x32_bf16 a[220:223], a[12:15], a[104:107], a[220:223]
ds_read_b64_tr_b16 a[4:5], v221 offset:40960
v_mfma_f32_16x16x32_bf16 a[220:223], a[8:11], a[92:95], a[220:223]
ds_read_b64_tr_b16 a[6:7], v221 offset:43008
v_mfma_f32_16x16x32_bf16 a[228:231], a[8:11], a[96:99], a[228:231]
v_mfma_f32_16x16x32_bf16 a[228:231], a[12:15], a[108:111], a[228:231]
s_waitcnt lgkmcnt(4)
v_mfma_f32_16x16x32_bf16 v[120:123], v[248:251], a[160:163], v[120:123]
ds_read_b64_tr_b16 a[8:9], v218 offset:32768
v_mfma_f32_16x16x32_bf16 v[120:123], v[252:255], a[172:175], v[120:123]
ds_read_b64_tr_b16 a[10:11], v218 offset:34816
v_mfma_f32_16x16x32_bf16 v[128:131], v[252:255], a[176:179], v[128:131]
ds_read_b64_tr_b16 a[12:13], v218 offset:40960
v_mfma_f32_16x16x32_bf16 v[128:131], v[248:251], a[164:167], v[128:131]
ds_read_b64_tr_b16 a[14:15], v218 offset:43008
v_mfma_f32_16x16x32_bf16 v[136:139], v[248:251], a[168:171], v[136:139]
v_mfma_f32_16x16x32_bf16 v[136:139], v[252:255], a[180:183], v[136:139]
s_waitcnt lgkmcnt(4)
v_mfma_f32_16x16x32_bf16 v[124:127], a[0:3], a[160:163], v[124:127]
ds_read_b64_tr_b16 v[248:249], v219 offset:32768
v_mfma_f32_16x16x32_bf16 v[124:127], a[4:7], a[172:175], v[124:127]
ds_read_b64_tr_b16 v[250:251], v219 offset:34816
v_mfma_f32_16x16x32_bf16 v[132:135], a[4:7], a[176:179], v[132:135]
ds_read_b64_tr_b16 v[252:253], v219 offset:40960
v_mfma_f32_16x16x32_bf16 v[132:135], a[0:3], a[164:167], v[132:135]
ds_read_b64_tr_b16 v[254:255], v219 offset:43008
v_mfma_f32_16x16x32_bf16 v[140:143], a[0:3], a[168:171], v[140:143]
v_mfma_f32_16x16x32_bf16 v[140:143], a[4:7], a[180:183], v[140:143]
s_waitcnt vmcnt(12) lgkmcnt(4)
s_barrier
v_mfma_f32_16x16x32_bf16 v[96:99], a[8:11], a[160:163], v[96:99]
ds_read_b64_tr_b16 a[0:1], v220 offset:49152
s_add_u32 m0, s67, 32768
v_mfma_f32_16x16x32_bf16 v[96:99], a[12:15], a[172:175], v[96:99]
ds_read_b64_tr_b16 a[2:3], v220 offset:51200
s_add_u32 s69, s79, s82
v_mfma_f32_16x16x32_bf16 v[104:107], a[12:15], a[176:179], v[104:107]
ds_read_b64_tr_b16 a[4:5], v220 offset:57344
buffer_load_dwordx4 v226, s[36:39], s69 offen offset:0 lds
v_mfma_f32_16x16x32_bf16 v[104:107], a[8:11], a[164:167], v[104:107]
ds_read_b64_tr_b16 a[6:7], v220 offset:59392
buffer_load_dwordx4 v227, s[36:39], s69 offen offset:1024 lds
v_mfma_f32_16x16x32_bf16 v[112:115], a[8:11], a[168:171], v[112:115]
v_mfma_f32_16x16x32_bf16 v[112:115], a[12:15], a[180:183], v[112:115]
s_waitcnt lgkmcnt(4)
v_mfma_f32_16x16x32_bf16 v[100:103], v[248:251], a[160:163], v[100:103]
ds_read_b64_tr_b16 a[8:9], v221 offset:49152
v_mfma_f32_16x16x32_bf16 v[100:103], v[252:255], a[172:175], v[100:103]
ds_read_b64_tr_b16 a[10:11], v221 offset:51200
v_mfma_f32_16x16x32_bf16 v[108:111], v[252:255], a[176:179], v[108:111]
ds_read_b64_tr_b16 a[12:13], v221 offset:57344
v_mfma_f32_16x16x32_bf16 v[108:111], v[248:251], a[164:167], v[108:111]
ds_read_b64_tr_b16 a[14:15], v221 offset:59392
v_mfma_f32_16x16x32_bf16 v[116:119], v[248:251], a[168:171], v[116:119]
v_mfma_f32_16x16x32_bf16 v[116:119], v[252:255], a[180:183], v[116:119]
s_waitcnt lgkmcnt(4)
v_mfma_f32_16x16x32_bf16 v[120:123], a[0:3], a[184:187], v[120:123]
ds_read_b64_tr_b16 v[248:249], v218 offset:49152
v_mfma_f32_16x16x32_bf16 v[120:123], a[4:7], a[196:199], v[120:123]
ds_read_b64_tr_b16 v[250:251], v218 offset:51200
v_mfma_f32_16x16x32_bf16 v[128:131], a[4:7], a[200:203], v[128:131]
ds_read_b64_tr_b16 v[252:253], v218 offset:57344
v_mfma_f32_16x16x32_bf16 v[128:131], a[0:3], a[188:191], v[128:131]
ds_read_b64_tr_b16 v[254:255], v218 offset:59392
v_mfma_f32_16x16x32_bf16 v[136:139], a[0:3], a[192:195], v[136:139]
s_nop 1
ds_write_b64 v228, v[120:121] offset:0
v_mfma_f32_16x16x32_bf16 v[136:139], a[4:7], a[204:207], v[136:139]
s_waitcnt lgkmcnt(5)
v_mfma_f32_16x16x32_bf16 v[124:127], a[8:11], a[184:187], v[124:127]
ds_read_b64_tr_b16 a[0:1], v219 offset:49152
ds_write_b64 v228, v[122:123] offset:8
v_mfma_f32_16x16x32_bf16 v[124:127], a[12:15], a[196:199], v[124:127]
ds_read_b64_tr_b16 a[2:3], v219 offset:51200
v_mfma_f32_16x16x32_bf16 v[132:135], a[12:15], a[200:203], v[132:135]
ds_read_b64_tr_b16 a[4:5], v219 offset:57344
ds_write_b64 v228, v[128:129] offset:2048
v_mfma_f32_16x16x32_bf16 v[132:135], a[8:11], a[188:191], v[132:135]
ds_read_b64_tr_b16 a[6:7], v219 offset:59392
v_mfma_f32_16x16x32_bf16 v[140:143], a[8:11], a[192:195], v[140:143]
ds_write_b64 v228, v[130:131] offset:2056
v_mfma_f32_16x16x32_bf16 v[140:143], a[12:15], a[204:207], v[140:143]
s_waitcnt vmcnt(10) lgkmcnt(8)
s_barrier
v_mfma_f32_16x16x32_bf16 v[96:99], v[248:251], a[184:187], v[96:99]
ds_read_b64_tr_b16 a[8:9], v216 offset:40960
ds_write_b64 v228, v[136:137] offset:4096
v_mfma_f32_16x16x32_bf16 v[96:99], v[252:255], a[196:199], v[96:99]
ds_read_b64_tr_b16 a[10:11], v216 offset:43008
v_mfma_f32_16x16x32_bf16 v[104:107], v[252:255], a[200:203], v[104:107]
ds_read_b64_tr_b16 a[12:13], v216 offset:45056
ds_write_b64 v228, v[138:139] offset:4104
v_mfma_f32_16x16x32_bf16 v[104:107], v[248:251], a[188:191], v[104:107]
ds_read_b64_tr_b16 a[14:15], v216 offset:47104
v_mfma_f32_16x16x32_bf16 v[112:115], v[248:251], a[192:195], v[112:115]
ds_write_b64 v228, v[124:125] offset:1024
v_mul_f32 v96, v238, v96
v_mul_f32 v97, v238, v97
v_mfma_f32_16x16x32_bf16 v[112:115], v[252:255], a[204:207], v[112:115]
v_mul_f32 v98, v238, v98
s_waitcnt lgkmcnt(8)
v_mfma_f32_16x16x32_bf16 v[100:103], a[0:3], a[184:187], v[100:103]
ds_read_b64_tr_b16 v[248:249], v217 offset:40960
ds_write_b64 v228, v[126:127] offset:1032
v_mul_f32 v99, v238, v99
v_mul_f32 v104, v239, v104
v_mfma_f32_16x16x32_bf16 v[100:103], a[4:7], a[196:199], v[100:103]
ds_read_b64_tr_b16 v[250:251], v217 offset:43008
v_mul_f32 v105, v239, v105
v_mfma_f32_16x16x32_bf16 v[108:111], a[4:7], a[200:203], v[108:111]
ds_read_b64_tr_b16 v[252:253], v217 offset:45056
ds_write_b64 v228, v[132:133] offset:3072
v_mul_f32 v106, v239, v106
v_mfma_f32_16x16x32_bf16 v[108:111], a[0:3], a[188:191], v[108:111]
ds_read_b64_tr_b16 v[254:255], v217 offset:47104
v_mul_f32 v107, v239, v107
v_mul_f32 v112, v240, v112
v_mfma_f32_16x16x32_bf16 v[116:119], a[0:3], a[192:195], v[116:119]
ds_write_b64 v228, v[134:135] offset:3080
v_mul_f32 v100, v238, v100
v_mfma_f32_16x16x32_bf16 v[116:119], a[4:7], a[204:207], v[116:119]
v_mul_f32 v101, v238, v101
v_mul_f32 v102, v238, v102
s_waitcnt lgkmcnt(8)
v_mfma_f32_16x16x32_bf16 a[232:235], a[8:11], a[88:91], a[232:235]
ds_read_b64_tr_b16 a[0:1], v216 offset:49152
ds_write_b64 v228, v[140:141] offset:5120
v_mul_f32 v103, v238, v103
v_mfma_f32_16x16x32_bf16 a[232:235], a[12:15], a[100:103], a[232:235]
ds_read_b64_tr_b16 a[2:3], v216 offset:51200
v_mul_f32 v108, v239, v108
v_mfma_f32_16x16x32_bf16 a[240:243], a[12:15], a[104:107], a[240:243]
ds_read_b64_tr_b16 a[4:5], v216 offset:53248
ds_write_b64 v228, v[142:143] offset:5128
v_mul_f32 v109, v239, v109
v_mul_f32 v110, v239, v110
v_mfma_f32_16x16x32_bf16 a[240:243], a[8:11], a[92:95], a[240:243]
ds_read_b64_tr_b16 a[6:7], v216 offset:55296
v_mul_f32 v111, v239, v111
v_mfma_f32_16x16x32_bf16 a[248:251], a[8:11], a[96:99], a[248:251]
v_mul_f32 v113, v240, v113
v_mul_f32 v114, v240, v114
v_mfma_f32_16x16x32_bf16 a[248:251], a[12:15], a[108:111], a[248:251]
v_mul_f32 v115, v240, v115
s_waitcnt lgkmcnt(7)
v_mfma_f32_16x16x32_bf16 a[236:239], v[248:251], a[88:91], a[236:239]
ds_read_b64_tr_b16 a[8:9], v217 offset:49152
v_mul_f32 v116, v240, v116
v_mfma_f32_16x16x32_bf16 a[236:239], v[252:255], a[100:103], a[236:239]
ds_read_b64_tr_b16 a[10:11], v217 offset:51200
v_mul_f32 v117, v240, v117
v_mul_f32 v118, v240, v118
v_mfma_f32_16x16x32_bf16 a[244:247], v[252:255], a[104:107], a[244:247]
ds_read_b64_tr_b16 a[12:13], v217 offset:53248
v_mul_f32 v119, v240, v119
v_mfma_f32_16x16x32_bf16 a[244:247], v[248:251], a[92:95], a[244:247]
ds_read_b64_tr_b16 a[14:15], v217 offset:55296
v_mfma_f32_16x16x32_bf16 a[252:255], v[248:251], a[96:99], a[252:255]
v_mfma_f32_16x16x32_bf16 a[252:255], v[252:255], a[108:111], a[252:255]
v_lshrrev_b32 v145, 4, v222
s_add_u32 s14, s19, 7
v_sub_u32 v144, s14, v145
s_waitcnt vmcnt(6) lgkmcnt(4)
s_barrier
v_mfma_f32_16x16x32_bf16 v[0:3], a[0:3], a[88:91], v[0:3]
ds_read_b64_tr_b16 v[248:249], v216 offset:0
s_add_u32 m0, s67, 40960
ds_read_b128 v[120:123], v229 offset:0
v_and_b32 v144, 7, v144
v_mfma_f32_16x16x32_bf16 v[0:3], a[4:7], a[100:103], v[0:3]
ds_read_b64_tr_b16 v[250:251], v216 offset:2048
s_add_u32 s69, s79, s83
ds_read_b128 v[124:127], v229 offset:1024
v_lshlrev_b32 v144, 2, v144
v_mfma_f32_16x16x32_bf16 v[8:11], a[4:7], a[104:107], v[8:11]
ds_read_b64_tr_b16 v[252:253], v216 offset:4096
buffer_load_dwordx4 v226, s[36:39], s69 offen offset:0 lds
ds_read_b128 v[128:131], v229 offset:2048
v_lshl_add_u32 v144, v145, 7, v144
v_mfma_f32_16x16x32_bf16 v[8:11], a[0:3], a[92:95], v[8:11]
ds_read_b64_tr_b16 v[254:255], v216 offset:6144
buffer_load_dwordx4 v227, s[36:39], s69 offen offset:1024 lds
ds_read_b128 v[132:135], v229 offset:3072
v_mfma_f32_16x16x32_bf16 v[16:19], a[0:3], a[96:99], v[16:19]
s_add_u32 m0, s67, 57344
s_add_u32 s69, s79, s84
ds_read_b128 v[136:139], v229 offset:4096
v_mfma_f32_16x16x32_bf16 v[16:19], a[4:7], a[108:111], v[16:19]
buffer_load_dwordx4 v226, s[36:39], s69 offen offset:0 lds
ds_read_b128 v[140:143], v229 offset:5120
s_waitcnt lgkmcnt(10)
v_mfma_f32_16x16x32_bf16 v[4:7], a[8:11], a[88:91], v[4:7]
ds_read_b64_tr_b16 a[0:1], v217 offset:0
buffer_load_dwordx4 v227, s[36:39], s69 offen offset:1024 lds
s_waitcnt lgkmcnt(9)
v_fmac_f32 v96, v241, v120
v_fmac_f32 v97, v241, v121
v_mfma_f32_16x16x32_bf16 v[4:7], a[12:15], a[100:103], v[4:7]
ds_read_b64_tr_b16 a[2:3], v217 offset:2048
s_add_u32 m0, s67, 65536
v_fmac_f32 v98, v241, v122
v_fmac_f32 v99, v241, v123
v_mfma_f32_16x16x32_bf16 v[12:15], a[12:15], a[104:107], v[12:15]
ds_read_b64_tr_b16 a[4:5], v217 offset:4096
s_add_u32 s69, s77, s85
v_cvt_pk_bf16_f32 v156, v96, v97
v_cvt_pk_bf16_f32 v157, v98, v99
v_mfma_f32_16x16x32_bf16 v[12:15], a[8:11], a[92:95], v[12:15]
ds_read_b64_tr_b16 a[6:7], v217 offset:6144
buffer_load_dwordx4 v226, s[36:39], s69 offen offset:0 lds
ds_write_b64 v228, v[156:157] offset:6144
s_waitcnt lgkmcnt(11)
v_fmac_f32 v100, v241, v124
v_mfma_f32_16x16x32_bf16 v[20:23], a[8:11], a[96:99], v[20:23]
buffer_load_dwordx4 v227, s[36:39], s69 offen offset:1024 lds
s_add_u32 m0, s67, 73728
v_fmac_f32 v101, v241, v125
v_fmac_f32 v102, v241, v126
v_mfma_f32_16x16x32_bf16 v[20:23], a[12:15], a[108:111], v[20:23]
s_add_u32 s69, s78, s85
v_fmac_f32 v103, v241, v127
v_cvt_pk_bf16_f32 v158, v100, v101
v_cvt_pk_bf16_f32 v159, v102, v103
s_waitcnt lgkmcnt(8)
v_mfma_f32_16x16x32_bf16 v[24:27], v[248:251], a[88:91], v[24:27]
ds_read_b64_tr_b16 a[8:9], v216 offset:8192
buffer_load_dwordx4 v226, s[36:39], s69 offen offset:0 lds
ds_write_b64 v228, v[158:159] offset:6152
v_fmac_f32 v104, v242, v128
v_fmac_f32 v105, v242, v129
v_mfma_f32_16x16x32_bf16 v[24:27], v[252:255], a[100:103], v[24:27]
ds_read_b64_tr_b16 a[10:11], v216 offset:10240
buffer_load_dwordx4 v227, s[36:39], s69 offen offset:1024 lds
v_fmac_f32 v106, v242, v130
v_fmac_f32 v107, v242, v131
v_mfma_f32_16x16x32_bf16 v[32:35], v[252:255], a[104:107], v[32:35]
ds_read_b64_tr_b16 a[12:13], v216 offset:12288
v_cvt_pk_bf16_f32 v160, v104, v105
v_cvt_pk_bf16_f32 v161, v106, v107
s_waitcnt lgkmcnt(11)
v_fmac_f32 v108, v242, v132
v_mfma_f32_16x16x32_bf16 v[32:35], v[248:251], a[92:95], v[32:35]
ds_read_b64_tr_b16 a[14:15], v216 offset:14336
ds_write_b64 v228, v[160:161] offset:7168
v_fmac_f32 v109, v242, v133
v_mfma_f32_16x16x32_bf16 v[40:43], v[248:251], a[96:99], v[40:43]
v_fmac_f32 v110, v242, v134
v_fmac_f32 v111, v242, v135
v_mfma_f32_16x16x32_bf16 v[40:43], v[252:255], a[108:111], v[40:43]
v_cvt_pk_bf16_f32 v162, v108, v109
v_cvt_pk_bf16_f32 v163, v110, v111
s_waitcnt lgkmcnt(12)
v_fmac_f32 v112, v243, v136
s_waitcnt lgkmcnt(7)
v_mfma_f32_16x16x32_bf16 v[28:31], a[0:3], a[88:91], v[28:31]
ds_read_b64_tr_b16 v[248:249], v217 offset:8192
ds_write_b64 v228, v[162:163] offset:7176
v_fmac_f32 v113, v243, v137
v_mfma_f32_16x16x32_bf16 v[28:31], a[4:7], a[100:103], v[28:31]
ds_read_b64_tr_b16 v[250:251], v217 offset:10240
v_fmac_f32 v114, v243, v138
v_fmac_f32 v115, v243, v139
v_cvt_pk_bf16_f32 v164, v112, v113
v_mfma_f32_16x16x32_bf16 v[36:39], a[4:7], a[104:107], v[36:39]
ds_read_b64_tr_b16 v[252:253], v217 offset:12288
v_cvt_pk_bf16_f32 v165, v114, v115
v_fmac_f32 v116, v243, v140
v_mfma_f32_16x16x32_bf16 v[36:39], a[0:3], a[92:95], v[36:39]
ds_read_b64_tr_b16 v[254:255], v217 offset:14336
ds_write_b64 v228, v[164:165] offset:8192
v_fmac_f32 v117, v243, v141
v_fmac_f32 v118, v243, v142
v_fmac_f32 v119, v243, v143
v_mfma_f32_16x16x32_bf16 v[44:47], a[0:3], a[96:99], v[44:47]
v_cvt_pk_bf16_f32 v166, v116, v117
v_cvt_pk_bf16_f32 v167, v118, v119
v_mfma_f32_16x16x32_bf16 v[44:47], a[4:7], a[108:111], v[44:47]
ds_write_b64 v228, v[166:167] offset:8200
s_waitcnt vmcnt(10) lgkmcnt(8)
s_barrier
v_mfma_f32_16x16x32_bf16 v[48:51], a[8:11], a[88:91], v[48:51]
ds_read_b64_tr_b16 a[0:1], v216 offset:16384
s_add_u32 m0, s67, 81920
v_mfma_f32_16x16x32_bf16 v[48:51], a[12:15], a[100:103], v[48:51]
ds_read_b64_tr_b16 a[2:3], v216 offset:18432
s_add_u32 s69, s79, s85
v_mfma_f32_16x16x32_bf16 v[56:59], a[12:15], a[104:107], v[56:59]
ds_read_b64_tr_b16 a[4:5], v216 offset:20480
buffer_load_dwordx4 v226, s[36:39], s69 offen offset:0 lds
v_mfma_f32_16x16x32_bf16 v[56:59], a[8:11], a[92:95], v[56:59]
ds_read_b64_tr_b16 a[6:7], v216 offset:22528
buffer_load_dwordx4 v227, s[36:39], s69 offen offset:1024 lds
s_waitcnt lgkmcnt(4)
s_barrier
ds_read_b128 a[64:67], v230 offset:6144
v_mfma_f32_16x16x32_bf16 v[64:67], a[8:11], a[96:99], v[64:67]
s_add_u32 m0, s67, 90112
s_add_u32 s69, s76, s86
ds_read_b128 a[76:79], v230 offset:16384
v_mfma_f32_16x16x32_bf16 v[64:67], a[12:15], a[108:111], v[64:67]
buffer_load_dwordx4 v226, s[36:39], s69 offen offset:0 lds
buffer_load_dwordx4 v227, s[36:39], s69 offen offset:1024 lds
ds_read_b128 a[80:83], v230 offset:17408
v_mfma_f32_16x16x32_bf16 v[52:55], v[248:251], a[88:91], v[52:55]
ds_read_b64_tr_b16 a[8:9], v217 offset:16384
ds_read_b128 a[68:71], v230 offset:7168
v_mfma_f32_16x16x32_bf16 v[52:55], v[252:255], a[100:103], v[52:55]
ds_read_b64_tr_b16 a[10:11], v217 offset:18432
ds_read_b128 a[72:75], v230 offset:8192
v_mfma_f32_16x16x32_bf16 v[60:63], v[252:255], a[104:107], v[60:63]
ds_read_b64_tr_b16 a[12:13], v217 offset:20480
ds_read_b128 a[84:87], v230 offset:18432
v_mfma_f32_16x16x32_bf16 v[60:63], v[248:251], a[92:95], v[60:63]
ds_read_b64_tr_b16 a[14:15], v217 offset:22528
v_mfma_f32_16x16x32_bf16 v[68:71], v[248:251], a[96:99], v[68:71]
v_mfma_f32_16x16x32_bf16 v[68:71], v[252:255], a[108:111], v[68:71]
s_waitcnt lgkmcnt(10)
s_waitcnt lgkmcnt(9)
v_mfma_f32_16x16x32_bf16 a[208:211], a[0:3], a[64:67], a[208:211]
ds_read_b64_tr_b16 v[248:249], v216 offset:24576
s_waitcnt lgkmcnt(9)
v_mfma_f32_16x16x32_bf16 a[208:211], a[4:7], a[76:79], a[208:211]
ds_read_b64_tr_b16 v[250:251], v216 offset:26624
s_waitcnt lgkmcnt(9)
v_mfma_f32_16x16x32_bf16 a[216:219], a[4:7], a[80:83], a[216:219]
ds_read_b64_tr_b16 v[252:253], v216 offset:28672
s_waitcnt lgkmcnt(8)
v_mfma_f32_16x16x32_bf16 a[216:219], a[0:3], a[68:71], a[216:219]
ds_read_b64_tr_b16 v[254:255], v216 offset:30720
s_waitcnt lgkmcnt(7)
v_mfma_f32_16x16x32_bf16 a[224:227], a[0:3], a[72:75], a[224:227]
v_accvgpr_read_b32 v96, a208
v_accvgpr_read_b32 v97, a209
v_accvgpr_read_b32 v98, a210
s_waitcnt lgkmcnt(5)
v_mfma_f32_16x16x32_bf16 a[224:227], a[4:7], a[84:87], a[224:227]
v_accvgpr_read_b32 v99, a211
v_cvt_pk_bf16_f32 v168, v96, v97
s_waitcnt lgkmcnt(4)
v_mfma_f32_16x16x32_bf16 a[212:215], a[8:11], a[64:67], a[212:215]
ds_read_b64_tr_b16 a[0:1], v217 offset:24576
v_cvt_pk_bf16_f32 v169, v98, v99
v_accvgpr_read_b32 v104, a216
v_accvgpr_read_b32 v105, a217
v_mfma_f32_16x16x32_bf16 a[212:215], a[12:15], a[76:79], a[212:215]
ds_read_b64_tr_b16 a[2:3], v217 offset:26624
v_accvgpr_read_b32 v106, a218
v_accvgpr_read_b32 v107, a219
v_mfma_f32_16x16x32_bf16 a[220:223], a[12:15], a[80:83], a[220:223]
ds_read_b64_tr_b16 a[4:5], v217 offset:28672
v_cvt_pk_bf16_f32 v172, v104, v105
v_cvt_pk_bf16_f32 v173, v106, v107
v_accvgpr_read_b32 v96, a224
v_mfma_f32_16x16x32_bf16 a[220:223], a[8:11], a[68:71], a[220:223]
ds_read_b64_tr_b16 a[6:7], v217 offset:30720
v_accvgpr_read_b32 v97, a225
v_accvgpr_read_b32 v98, a226
v_mfma_f32_16x16x32_bf16 a[228:231], a[8:11], a[72:75], a[228:231]
v_accvgpr_read_b32 v100, a212
v_accvgpr_read_b32 v101, a213
v_mfma_f32_16x16x32_bf16 a[228:231], a[12:15], a[84:87], a[228:231]
v_accvgpr_read_b32 v102, a214
v_accvgpr_read_b32 v103, a215
v_cvt_pk_bf16_f32 v170, v100, v101
s_waitcnt vmcnt(10) lgkmcnt(4)
s_barrier
v_mfma_f32_16x16x32_bf16 a[232:235], v[248:251], a[64:67], a[232:235]
ds_read_b64_tr_b16 a[8:9], v216 offset:32768
s_add_u32 m0, s67, 98304
v_cvt_pk_bf16_f32 v171, v102, v103
v_accvgpr_read_b32 v108, a220
v_mfma_f32_16x16x32_bf16 a[232:235], v[252:255], a[76:79], a[232:235]
ds_read_b64_tr_b16 a[10:11], v216 offset:34816
s_add_u32 s69, s77, s86
v_accvgpr_read_b32 v109, a221
v_accvgpr_read_b32 v110, a222
v_accvgpr_read_b32 v111, a223
v_mfma_f32_16x16x32_bf16 a[240:243], v[252:255], a[80:83], a[240:243]
ds_read_b64_tr_b16 a[12:13], v216 offset:36864
buffer_load_dwordx4 v226, s[36:39], s69 offen offset:0 lds
buffer_store_dwordx4 v[168:171], v222, s[40:43], s4 offen offset:0 sc1
v_cvt_pk_bf16_f32 v174, v108, v109
v_mfma_f32_16x16x32_bf16 a[240:243], v[248:251], a[68:71], a[240:243]
ds_read_b64_tr_b16 a[14:15], v216 offset:38912
buffer_load_dwordx4 v227, s[36:39], s69 offen offset:1024 lds
v_cvt_pk_bf16_f32 v175, v110, v111
v_accvgpr_read_b32 v99, a227
v_accvgpr_read_b32 v100, a228
v_mfma_f32_16x16x32_bf16 a[248:251], v[248:251], a[72:75], a[248:251]
s_add_u32 m0, s67, 106496
s_add_u32 s69, s78, s86
v_accvgpr_read_b32 v101, a229
v_accvgpr_read_b32 v102, a230
v_mfma_f32_16x16x32_bf16 a[248:251], v[252:255], a[84:87], a[248:251]
buffer_load_dwordx4 v226, s[36:39], s69 offen offset:0 lds
v_accvgpr_read_b32 v103, a231
buffer_store_dwordx4 v[172:175], v222, s[40:43], s4 offen offset:1024 sc1
s_waitcnt lgkmcnt(4)
v_mfma_f32_16x16x32_bf16 a[236:239], a[0:3], a[64:67], a[236:239]
ds_read_b64_tr_b16 v[248:249], v217 offset:32768
buffer_load_dwordx4 v227, s[36:39], s69 offen offset:1024 lds
v_cvt_pk_bf16_f32 v176, v96, v97
v_cvt_pk_bf16_f32 v177, v98, v99
v_cvt_pk_bf16_f32 v178, v100, v101
v_mfma_f32_16x16x32_bf16 a[236:239], a[4:7], a[76:79], a[236:239]
ds_read_b64_tr_b16 v[250:251], v217 offset:34816
v_cvt_pk_bf16_f32 v179, v102, v103
buffer_store_dwordx4 v[176:179], v222, s[40:43], s4 offen offset:2048 sc1
v_mfma_f32_16x16x32_bf16 a[244:247], a[4:7], a[80:83], a[244:247]
ds_read_b64_tr_b16 v[252:253], v217 offset:36864
v_accvgpr_read_b32 v96, a232
v_accvgpr_read_b32 v97, a233
v_accvgpr_read_b32 v98, a234
v_mfma_f32_16x16x32_bf16 a[244:247], a[0:3], a[68:71], a[244:247]
ds_read_b64_tr_b16 v[254:255], v217 offset:38912
v_accvgpr_read_b32 v99, a235
v_cvt_pk_bf16_f32 v180, v96, v97
v_mfma_f32_16x16x32_bf16 a[252:255], a[0:3], a[72:75], a[252:255]
v_accvgpr_read_b32 v100, a236
v_accvgpr_read_b32 v101, a237
v_accvgpr_read_b32 v102, a238
v_mfma_f32_16x16x32_bf16 a[252:255], a[4:7], a[84:87], a[252:255]
v_accvgpr_read_b32 v103, a239
v_cvt_pk_bf16_f32 v181, v98, v99
s_waitcnt lgkmcnt(4)
v_mfma_f32_16x16x32_bf16 v[0:3], a[8:11], a[64:67], v[0:3]
ds_read_b64_tr_b16 a[0:1], v216 offset:40960
v_cvt_pk_bf16_f32 v182, v100, v101
v_cvt_pk_bf16_f32 v183, v102, v103
v_mfma_f32_16x16x32_bf16 v[0:3], a[12:15], a[76:79], v[0:3]
ds_read_b64_tr_b16 a[2:3], v216 offset:43008
v_accvgpr_read_b32 v104, a240
v_accvgpr_read_b32 v105, a241
v_accvgpr_read_b32 v106, a242
v_mfma_f32_16x16x32_bf16 v[8:11], a[12:15], a[80:83], v[8:11]
ds_read_b64_tr_b16 a[4:5], v216 offset:45056
v_accvgpr_read_b32 v107, a243
v_accvgpr_read_b32 v108, a244
v_mfma_f32_16x16x32_bf16 v[8:11], a[8:11], a[68:71], v[8:11]
ds_read_b64_tr_b16 a[6:7], v216 offset:47104
v_accvgpr_read_b32 v109, a245
v_accvgpr_read_b32 v110, a246
v_accvgpr_read_b32 v111, a247
v_mfma_f32_16x16x32_bf16 v[16:19], a[8:11], a[72:75], v[16:19]
buffer_store_dwordx4 v[180:183], v222, s[40:43], s5 offen offset:0 sc1
v_cvt_pk_bf16_f32 v184, v104, v105
v_mfma_f32_16x16x32_bf16 v[16:19], a[12:15], a[84:87], v[16:19]
v_cvt_pk_bf16_f32 v185, v106, v107
v_cvt_pk_bf16_f32 v186, v108, v109
s_waitcnt lgkmcnt(4)
v_mfma_f32_16x16x32_bf16 v[4:7], v[248:251], a[64:67], v[4:7]
ds_read_b64_tr_b16 a[8:9], v217 offset:40960
v_cvt_pk_bf16_f32 v187, v110, v111
v_accvgpr_read_b32 v96, a248
v_accvgpr_read_b32 v97, a249
v_mfma_f32_16x16x32_bf16 v[4:7], v[252:255], a[76:79], v[4:7]
ds_read_b64_tr_b16 a[10:11], v217 offset:43008
v_accvgpr_read_b32 v98, a250
v_accvgpr_read_b32 v99, a251
v_mfma_f32_16x16x32_bf16 v[12:15], v[252:255], a[80:83], v[12:15]
ds_read_b64_tr_b16 a[12:13], v217 offset:45056
v_accvgpr_read_b32 v100, a252
v_accvgpr_read_b32 v101, a253
v_accvgpr_read_b32 v102, a254
v_mfma_f32_16x16x32_bf16 v[12:15], v[248:251], a[68:71], v[12:15]
ds_read_b64_tr_b16 a[14:15], v217 offset:47104
v_accvgpr_read_b32 v103, a255
buffer_store_dwordx4 v[184:187], v222, s[40:43], s5 offen offset:1024 sc1
v_mfma_f32_16x16x32_bf16 v[20:23], v[248:251], a[72:75], v[20:23]
v_cvt_pk_bf16_f32 v188, v96, v97
v_cvt_pk_bf16_f32 v189, v98, v99
v_cvt_pk_bf16_f32 v190, v100, v101
v_mfma_f32_16x16x32_bf16 v[20:23], v[252:255], a[84:87], v[20:23]
v_cvt_pk_bf16_f32 v191, v102, v103
buffer_store_dwordx4 v[188:191], v222, s[40:43], s5 offen offset:2048 sc1
s_waitcnt vmcnt(16) lgkmcnt(4)
s_barrier
v_mfma_f32_16x16x32_bf16 v[24:27], a[0:3], a[64:67], v[24:27]
v_add_u32 v216, 57344, v216
v_add_u32 v217, 57344, v217
v_cvt_pk_bf16_f32 v0, v0, v1
v_mfma_f32_16x16x32_bf16 v[24:27], a[4:7], a[76:79], v[24:27]
ds_read_b64_tr_b16 v[248:249], v216 offset:0
s_add_u32 m0, s67, 114688
v_cvt_pk_bf16_f32 v1, v2, v3
v_cvt_pk_bf16_f32 v2, v4, v5
v_mfma_f32_16x16x32_bf16 v[32:35], a[4:7], a[80:83], v[32:35]
ds_read_b64_tr_b16 v[250:251], v216 offset:2048
s_add_u32 s69, s79, s86
v_cvt_pk_bf16_f32 v3, v6, v7
buffer_store_dwordx4 v[0:3], v222, s[40:43], s6 offen offset:0 sc1
v_mfma_f32_16x16x32_bf16 v[32:35], a[0:3], a[68:71], v[32:35]
ds_read_b64_tr_b16 v[252:253], v216 offset:4096
buffer_load_dwordx4 v226, s[36:39], s69 offen offset:0 lds
v_cvt_pk_bf16_f32 v4, v8, v9
v_mfma_f32_16x16x32_bf16 v[40:43], a[0:3], a[72:75], v[40:43]
ds_read_b64_tr_b16 v[254:255], v216 offset:6144
buffer_load_dwordx4 v227, s[36:39], s69 offen offset:1024 lds
v_cvt_pk_bf16_f32 v5, v10, v11
v_cvt_pk_bf16_f32 v6, v12, v13
v_mfma_f32_16x16x32_bf16 v[40:43], a[4:7], a[84:87], v[40:43]
v_cvt_pk_bf16_f32 v7, v14, v15
buffer_store_dwordx4 v[4:7], v222, s[40:43], s6 offen offset:1024 sc1
s_waitcnt lgkmcnt(4)
v_mfma_f32_16x16x32_bf16 v[28:31], a[8:11], a[64:67], v[28:31]
ds_read_b64_tr_b16 a[0:1], v217 offset:0
v_cvt_pk_bf16_f32 v8, v16, v17
v_mfma_f32_16x16x32_bf16 v[28:31], a[12:15], a[76:79], v[28:31]
ds_read_b64_tr_b16 a[2:3], v217 offset:2048
v_cvt_pk_bf16_f32 v9, v18, v19
v_cvt_pk_bf16_f32 v10, v20, v21
v_mfma_f32_16x16x32_bf16 v[36:39], a[12:15], a[80:83], v[36:39]
ds_read_b64_tr_b16 a[4:5], v217 offset:4096
v_cvt_pk_bf16_f32 v11, v22, v23
buffer_store_dwordx4 v[8:11], v222, s[40:43], s6 offen offset:2048 sc1
v_mfma_f32_16x16x32_bf16 v[36:39], a[8:11], a[68:71], v[36:39]
ds_read_b64_tr_b16 a[6:7], v217 offset:6144
v_cvt_pk_bf16_f32 v24, v24, v25
v_mfma_f32_16x16x32_bf16 v[44:47], a[8:11], a[72:75], v[44:47]
v_cvt_pk_bf16_f32 v25, v26, v27
v_cvt_pk_bf16_f32 v26, v28, v29
v_mfma_f32_16x16x32_bf16 v[44:47], a[12:15], a[84:87], v[44:47]
v_cvt_pk_bf16_f32 v27, v30, v31
buffer_store_dwordx4 v[24:27], v222, s[40:43], s7 offen offset:0 sc1
s_waitcnt lgkmcnt(4)
v_mfma_f32_16x16x32_bf16 v[48:51], v[248:251], a[64:67], v[48:51]
ds_read_b64_tr_b16 a[8:9], v216 offset:8192
v_cvt_pk_bf16_f32 v28, v32, v33
v_cvt_pk_bf16_f32 v29, v34, v35
v_mfma_f32_16x16x32_bf16 v[48:51], v[252:255], a[76:79], v[48:51]
ds_read_b64_tr_b16 a[10:11], v216 offset:10240
v_cvt_pk_bf16_f32 v30, v36, v37
v_mfma_f32_16x16x32_bf16 v[56:59], v[252:255], a[80:83], v[56:59]
ds_read_b64_tr_b16 a[12:13], v216 offset:12288
v_cvt_pk_bf16_f32 v31, v38, v39
buffer_store_dwordx4 v[28:31], v222, s[40:43], s7 offen offset:1024 sc1
v_mfma_f32_16x16x32_bf16 v[56:59], v[248:251], a[68:71], v[56:59]
ds_read_b64_tr_b16 a[14:15], v216 offset:14336
v_cvt_pk_bf16_f32 v32, v40, v41
v_cvt_pk_bf16_f32 v33, v42, v43
v_mfma_f32_16x16x32_bf16 v[64:67], v[248:251], a[72:75], v[64:67]
v_cvt_pk_bf16_f32 v34, v44, v45
v_cvt_pk_bf16_f32 v35, v46, v47
v_mfma_f32_16x16x32_bf16 v[64:67], v[252:255], a[84:87], v[64:67]
buffer_store_dwordx4 v[32:35], v222, s[40:43], s7 offen offset:2048 sc1
s_waitcnt lgkmcnt(4)
v_mfma_f32_16x16x32_bf16 v[52:55], a[0:3], a[64:67], v[52:55]
ds_read_b64_tr_b16 v[248:249], v217 offset:8192
v_cvt_pk_bf16_f32 v48, v48, v49
v_mfma_f32_16x16x32_bf16 v[52:55], a[4:7], a[76:79], v[52:55]
ds_read_b64_tr_b16 v[250:251], v217 offset:10240
v_cvt_pk_bf16_f32 v49, v50, v51
v_mfma_f32_16x16x32_bf16 v[60:63], a[4:7], a[80:83], v[60:63]
ds_read_b64_tr_b16 v[252:253], v217 offset:12288
v_mfma_f32_16x16x32_bf16 v[60:63], a[0:3], a[68:71], v[60:63]
ds_read_b64_tr_b16 v[254:255], v217 offset:14336
v_mfma_f32_16x16x32_bf16 v[68:71], a[0:3], a[72:75], v[68:71]
s_nop 0
v_cvt_pk_bf16_f32 v50, v52, v53
v_cvt_pk_bf16_f32 v51, v54, v55
buffer_store_dwordx4 v[48:51], v222, s[40:43], s8 offen offset:0 sc1
v_mfma_f32_16x16x32_bf16 v[68:71], a[4:7], a[84:87], v[68:71]
v_cvt_pk_bf16_f32 v52, v56, v57
v_cvt_pk_bf16_f32 v53, v58, v59
s_waitcnt vmcnt(21) lgkmcnt(4)
s_barrier
v_mfma_f32_16x16x32_bf16 v[72:75], a[8:11], a[40:43], v[72:75]
ds_read_b64_tr_b16 a[0:1], v216 offset:16384
v_cvt_pk_bf16_f32 v54, v60, v61
v_cvt_pk_bf16_f32 v55, v62, v63
v_mfma_f32_16x16x32_bf16 v[72:75], a[12:15], a[52:55], v[72:75]
ds_read_b64_tr_b16 a[2:3], v216 offset:18432
buffer_store_dwordx4 v[52:55], v222, s[40:43], s8 offen offset:1024 sc1
v_cvt_pk_bf16_f32 v56, v64, v65
v_mfma_f32_16x16x32_bf16 v[80:83], a[12:15], a[56:59], v[80:83]
ds_read_b64_tr_b16 a[4:5], v216 offset:20480
v_cvt_pk_bf16_f32 v57, v66, v67
v_cvt_pk_bf16_f32 v58, v68, v69
v_cvt_pk_bf16_f32 v59, v70, v71
v_mfma_f32_16x16x32_bf16 v[80:83], a[8:11], a[44:47], v[80:83]
ds_read_b64_tr_b16 a[6:7], v216 offset:22528
buffer_store_dwordx4 v[56:59], v222, s[40:43], s8 offen offset:2048 sc1
v_mfma_f32_16x16x32_bf16 v[88:91], a[8:11], a[48:51], v[88:91]
v_mfma_f32_16x16x32_bf16 v[88:91], a[12:15], a[60:63], v[88:91]
s_lshr_b32 s15, s80, 7
s_waitcnt vmcnt(14)
s_lshl_b64 exec, 1, s15
buffer_store_dword v223, v144, s[40:43], s71 offen sc1
s_mov_b64 exec, -1
s_waitcnt lgkmcnt(4)
v_mfma_f32_16x16x32_bf16 v[76:79], v[248:251], a[40:43], v[76:79]
ds_read_b64_tr_b16 a[8:9], v217 offset:16384
v_mfma_f32_16x16x32_bf16 v[76:79], v[252:255], a[52:55], v[76:79]
ds_read_b64_tr_b16 a[10:11], v217 offset:18432
v_mfma_f32_16x16x32_bf16 v[84:87], v[252:255], a[56:59], v[84:87]
ds_read_b64_tr_b16 a[12:13], v217 offset:20480
v_mfma_f32_16x16x32_bf16 v[84:87], v[248:251], a[44:47], v[84:87]
ds_read_b64_tr_b16 a[14:15], v217 offset:22528
v_mfma_f32_16x16x32_bf16 v[92:95], v[248:251], a[48:51], v[92:95]
v_mfma_f32_16x16x32_bf16 v[92:95], v[252:255], a[60:63], v[92:95]
s_waitcnt lgkmcnt(4)
v_mfma_f32_16x16x32_bf16 v[72:75], a[0:3], a[88:91], v[72:75]
ds_read_b64_tr_b16 v[248:249], v216 offset:24576
v_mfma_f32_16x16x32_bf16 v[72:75], a[4:7], a[100:103], v[72:75]
ds_read_b64_tr_b16 v[250:251], v216 offset:26624
v_mfma_f32_16x16x32_bf16 v[80:83], a[4:7], a[104:107], v[80:83]
ds_read_b64_tr_b16 v[252:253], v216 offset:28672
v_mfma_f32_16x16x32_bf16 v[80:83], a[0:3], a[92:95], v[80:83]
ds_read_b64_tr_b16 v[254:255], v216 offset:30720
v_mfma_f32_16x16x32_bf16 v[88:91], a[0:3], a[96:99], v[88:91]
v_mfma_f32_16x16x32_bf16 v[88:91], a[4:7], a[108:111], v[88:91]
s_lshr_b32 s15, s81, 7
s_waitcnt vmcnt(12)
s_lshl_b64 exec, 1, s15
buffer_store_dword v223, v144, s[40:43], s71 offen sc1
s_mov_b64 exec, -1
s_waitcnt lgkmcnt(4)
v_mfma_f32_16x16x32_bf16 v[76:79], a[8:11], a[88:91], v[76:79]
ds_read_b64_tr_b16 a[0:1], v217 offset:24576
v_mfma_f32_16x16x32_bf16 v[76:79], a[12:15], a[100:103], v[76:79]
ds_read_b64_tr_b16 a[2:3], v217 offset:26624
v_mfma_f32_16x16x32_bf16 v[84:87], a[12:15], a[104:107], v[84:87]
ds_read_b64_tr_b16 a[4:5], v217 offset:28672
v_mfma_f32_16x16x32_bf16 v[84:87], a[8:11], a[92:95], v[84:87]
ds_read_b64_tr_b16 a[6:7], v217 offset:30720
v_mfma_f32_16x16x32_bf16 v[92:95], a[8:11], a[96:99], v[92:95]
v_mfma_f32_16x16x32_bf16 v[92:95], a[12:15], a[108:111], v[92:95]
s_waitcnt vmcnt(10) lgkmcnt(4)
s_barrier
v_mfma_f32_16x16x32_bf16 v[72:75], v[248:251], a[64:67], v[72:75]
ds_read_b64_tr_b16 a[8:9], v216 offset:32768
v_mfma_f32_16x16x32_bf16 v[72:75], v[252:255], a[76:79], v[72:75]
ds_read_b64_tr_b16 a[10:11], v216 offset:34816
v_mfma_f32_16x16x32_bf16 v[80:83], v[252:255], a[80:83], v[80:83]
ds_read_b64_tr_b16 a[12:13], v216 offset:36864
v_mfma_f32_16x16x32_bf16 v[80:83], v[248:251], a[68:71], v[80:83]
ds_read_b64_tr_b16 a[14:15], v216 offset:38912
v_mfma_f32_16x16x32_bf16 v[88:91], v[248:251], a[72:75], v[88:91]
s_nop 1
v_cvt_pk_bf16_f32 v72, v72, v73
v_cvt_pk_bf16_f32 v73, v74, v75
v_mfma_f32_16x16x32_bf16 v[88:91], v[252:255], a[84:87], v[88:91]
s_lshr_b32 s15, s82, 7
s_waitcnt vmcnt(8)
s_lshl_b64 exec, 1, s15
buffer_store_dword v223, v144, s[40:43], s71 offen sc1
s_mov_b64 exec, -1
s_waitcnt lgkmcnt(4)
v_mfma_f32_16x16x32_bf16 v[76:79], a[0:3], a[64:67], v[76:79]
ds_read_b64_tr_b16 v[248:249], v217 offset:32768
v_mfma_f32_16x16x32_bf16 v[76:79], a[4:7], a[76:79], v[76:79]
ds_read_b64_tr_b16 v[250:251], v217 offset:34816
v_mfma_f32_16x16x32_bf16 v[84:87], a[4:7], a[80:83], v[84:87]
ds_read_b64_tr_b16 v[252:253], v217 offset:36864
v_mfma_f32_16x16x32_bf16 v[84:87], a[0:3], a[68:71], v[84:87]
ds_read_b64_tr_b16 v[254:255], v217 offset:38912
v_mfma_f32_16x16x32_bf16 v[92:95], a[0:3], a[72:75], v[92:95]
s_nop 1
v_cvt_pk_bf16_f32 v74, v76, v77
v_cvt_pk_bf16_f32 v75, v78, v79
buffer_store_dwordx4 v[72:75], v222, s[40:43], s9 offen offset:0 sc1
v_mfma_f32_16x16x32_bf16 v[92:95], a[4:7], a[84:87], v[92:95]
v_cvt_pk_bf16_f32 v76, v80, v81
v_cvt_pk_bf16_f32 v77, v82, v83
s_waitcnt lgkmcnt(4)
v_mfma_f32_16x16x32_bf16 v[192:195], a[8:11], a[16:19], v[192:195]
ds_read_b64_tr_b16 a[0:1], v216 offset:40960
v_cvt_pk_bf16_f32 v78, v84, v85
v_cvt_pk_bf16_f32 v79, v86, v87
v_mfma_f32_16x16x32_bf16 v[192:195], a[12:15], a[28:31], v[192:195]
ds_read_b64_tr_b16 a[2:3], v216 offset:43008
buffer_store_dwordx4 v[76:79], v222, s[40:43], s9 offen offset:1024 sc1
v_cvt_pk_bf16_f32 v80, v88, v89
v_mfma_f32_16x16x32_bf16 v[200:203], a[12:15], a[32:35], v[200:203]
ds_read_b64_tr_b16 a[4:5], v216 offset:45056
v_cvt_pk_bf16_f32 v81, v90, v91
v_cvt_pk_bf16_f32 v82, v92, v93
v_cvt_pk_bf16_f32 v83, v94, v95
v_mfma_f32_16x16x32_bf16 v[200:203], a[8:11], a[20:23], v[200:203]
ds_read_b64_tr_b16 a[6:7], v216 offset:47104
buffer_store_dwordx4 v[80:83], v222, s[40:43], s9 offen offset:2048 sc1
v_mfma_f32_16x16x32_bf16 v[208:211], a[8:11], a[24:27], v[208:211]
v_mfma_f32_16x16x32_bf16 v[208:211], a[12:15], a[36:39], v[208:211]
s_lshr_b32 s15, s83, 7
s_waitcnt vmcnt(9)
s_lshl_b64 exec, 1, s15
buffer_store_dword v223, v144, s[40:43], s71 offen sc1
s_mov_b64 exec, -1
s_waitcnt lgkmcnt(4)
v_mfma_f32_16x16x32_bf16 v[196:199], v[248:251], a[16:19], v[196:199]
ds_read_b64_tr_b16 a[8:9], v217 offset:40960
v_mfma_f32_16x16x32_bf16 v[196:199], v[252:255], a[28:31], v[196:199]
ds_read_b64_tr_b16 a[10:11], v217 offset:43008
v_mfma_f32_16x16x32_bf16 v[204:207], v[252:255], a[32:35], v[204:207]
ds_read_b64_tr_b16 a[12:13], v217 offset:45056
v_mfma_f32_16x16x32_bf16 v[204:207], v[248:251], a[20:23], v[204:207]
ds_read_b64_tr_b16 a[14:15], v217 offset:47104
v_mfma_f32_16x16x32_bf16 v[212:215], v[248:251], a[24:27], v[212:215]
v_mfma_f32_16x16x32_bf16 v[212:215], v[252:255], a[36:39], v[212:215]
s_waitcnt lgkmcnt(4)
v_mfma_f32_16x16x32_bf16 v[192:195], a[0:3], a[40:43], v[192:195]
ds_read_b64_tr_b16 v[248:249], v216 offset:49152
v_mfma_f32_16x16x32_bf16 v[192:195], a[4:7], a[52:55], v[192:195]
ds_read_b64_tr_b16 v[250:251], v216 offset:51200
v_mfma_f32_16x16x32_bf16 v[200:203], a[4:7], a[56:59], v[200:203]
ds_read_b64_tr_b16 v[252:253], v216 offset:53248
v_mfma_f32_16x16x32_bf16 v[200:203], a[0:3], a[44:47], v[200:203]
ds_read_b64_tr_b16 v[254:255], v216 offset:55296
v_mfma_f32_16x16x32_bf16 v[208:211], a[0:3], a[48:51], v[208:211]
v_mfma_f32_16x16x32_bf16 v[208:211], a[4:7], a[60:63], v[208:211]
s_lshr_b32 s15, s84, 7
s_waitcnt vmcnt(7)
s_lshl_b64 exec, 1, s15
buffer_store_dword v223, v144, s[40:43], s71 offen sc1
s_mov_b64 exec, -1
s_waitcnt lgkmcnt(4)
v_mfma_f32_16x16x32_bf16 v[196:199], a[8:11], a[40:43], v[196:199]
ds_read_b64_tr_b16 a[0:1], v217 offset:49152
v_mfma_f32_16x16x32_bf16 v[196:199], a[12:15], a[52:55], v[196:199]
ds_read_b64_tr_b16 a[2:3], v217 offset:51200
v_mfma_f32_16x16x32_bf16 v[204:207], a[12:15], a[56:59], v[204:207]
ds_read_b64_tr_b16 a[4:5], v217 offset:53248
v_mfma_f32_16x16x32_bf16 v[204:207], a[8:11], a[44:47], v[204:207]
ds_read_b64_tr_b16 a[6:7], v217 offset:55296
v_mfma_f32_16x16x32_bf16 v[212:215], a[8:11], a[48:51], v[212:215]
v_mfma_f32_16x16x32_bf16 v[212:215], a[12:15], a[60:63], v[212:215]
s_waitcnt lgkmcnt(4)
v_mfma_f32_16x16x32_bf16 v[192:195], v[248:251], a[88:91], v[192:195]
ds_read_b64_tr_b16 a[8:9], v216 offset:57344
v_mfma_f32_16x16x32_bf16 v[192:195], v[252:255], a[100:103], v[192:195]
ds_read_b64_tr_b16 a[10:11], v216 offset:59392
v_mfma_f32_16x16x32_bf16 v[200:203], v[252:255], a[104:107], v[200:203]
ds_read_b64_tr_b16 a[12:13], v216 offset:61440
v_mfma_f32_16x16x32_bf16 v[200:203], v[248:251], a[92:95], v[200:203]
ds_read_b64_tr_b16 a[14:15], v216 offset:63488
v_mfma_f32_16x16x32_bf16 v[208:211], v[248:251], a[96:99], v[208:211]
v_mfma_f32_16x16x32_bf16 v[208:211], v[252:255], a[108:111], v[208:211]
s_waitcnt lgkmcnt(4)
v_mfma_f32_16x16x32_bf16 v[196:199], a[0:3], a[88:91], v[196:199]
ds_read_b64_tr_b16 v[248:249], v217 offset:57344
v_mfma_f32_16x16x32_bf16 v[196:199], a[4:7], a[100:103], v[196:199]
ds_read_b64_tr_b16 v[250:251], v217 offset:59392
v_mfma_f32_16x16x32_bf16 v[204:207], a[4:7], a[104:107], v[204:207]
ds_read_b64_tr_b16 v[252:253], v217 offset:61440
v_mfma_f32_16x16x32_bf16 v[204:207], a[0:3], a[92:95], v[204:207]
ds_read_b64_tr_b16 v[254:255], v217 offset:63488
v_mfma_f32_16x16x32_bf16 v[212:215], a[0:3], a[96:99], v[212:215]
v_mfma_f32_16x16x32_bf16 v[212:215], a[4:7], a[108:111], v[212:215]
s_waitcnt lgkmcnt(4)
v_mfma_f32_16x16x32_bf16 v[192:195], a[8:11], a[64:67], v[192:195]
v_mfma_f32_16x16x32_bf16 v[192:195], a[12:15], a[76:79], v[192:195]
v_mfma_f32_16x16x32_bf16 v[200:203], a[12:15], a[80:83], v[200:203]
v_mfma_f32_16x16x32_bf16 v[200:203], a[8:11], a[68:71], v[200:203]
v_mfma_f32_16x16x32_bf16 v[208:211], a[8:11], a[72:75], v[208:211]
v_mfma_f32_16x16x32_bf16 v[208:211], a[12:15], a[84:87], v[208:211]
s_waitcnt lgkmcnt(0)
v_mfma_f32_16x16x32_bf16 v[196:199], v[248:251], a[64:67], v[196:199]
v_mfma_f32_16x16x32_bf16 v[196:199], v[252:255], a[76:79], v[196:199]
v_mfma_f32_16x16x32_bf16 v[204:207], v[252:255], a[80:83], v[204:207]
v_mfma_f32_16x16x32_bf16 v[204:207], v[248:251], a[68:71], v[204:207]
v_mfma_f32_16x16x32_bf16 v[212:215], v[248:251], a[72:75], v[212:215]
v_mfma_f32_16x16x32_bf16 v[212:215], v[252:255], a[84:87], v[212:215]
v_lshrrev_b32 v97, 2, v222
s_mov_b64 exec, 0x7f
buffer_load_dword v98, v97, s[40:43], s91 offen sc1
s_mov_b64 exec, -1
s_lshr_b32 s15, s85, 7
s_waitcnt vmcnt(3)
s_lshl_b64 exec, 1, s15
buffer_store_dword v223, v144, s[40:43], s71 offen sc1
s_mov_b64 exec, -1
s_mov_b64 exec, 0x80
s_cmp_lg_u32 s19, 7
s_cbranch_scc1 L_not7
s_mov_b64 exec, -1
s_nop 7
v_cvt_pk_bf16_f32 v192, v192, v193
v_cvt_pk_bf16_f32 v193, v194, v195
v_cvt_pk_bf16_f32 v194, v196, v197
v_cvt_pk_bf16_f32 v195, v198, v199
buffer_store_dwordx4 v[192:195], v222, s[40:43], s10 offen offset:0 sc1
v_cvt_pk_bf16_f32 v196, v200, v201
v_cvt_pk_bf16_f32 v197, v202, v203
v_cvt_pk_bf16_f32 v198, v204, v205
v_cvt_pk_bf16_f32 v199, v206, v207
buffer_store_dwordx4 v[196:199], v222, s[40:43], s10 offen offset:1024 sc1
v_cvt_pk_bf16_f32 v200, v208, v209
v_cvt_pk_bf16_f32 v201, v210, v211
v_cvt_pk_bf16_f32 v202, v212, v213
v_cvt_pk_bf16_f32 v203, v214, v215
buffer_store_dwordx4 v[200:203], v222, s[40:43], s10 offen offset:2048 sc1
s_waitcnt vmcnt(0)
s_mov_b64 exec, 1
L_not7:
buffer_store_dword v223, v144, s[40:43], s71 offen sc1
s_mov_b64 exec, -1
v_lshrrev_b32 v101, 4, v222
s_mul_i32 s3, s19, 98304
s_add_u32 s16, s3, s12
s_add_u32 s3, s19, 1
s_and_b32 s3, s3, 7
s_mul_i32 s3, s3, 12288
s_add_u32 s4, s3, s16
s_add_u32 s3, s19, 2
s_and_b32 s3, s3, 7
s_mul_i32 s3, s3, 12288
s_add_u32 s5, s3, s16
s_add_u32 s3, s19, 3
s_and_b32 s3, s3, 7
s_mul_i32 s3, s3, 12288
s_add_u32 s6, s3, s16
s_add_u32 s3, s19, 4
s_and_b32 s3, s3, 7
s_mul_i32 s3, s3, 12288
s_add_u32 s7, s3, s16
s_add_u32 s3, s19, 5
s_and_b32 s3, s3, 7
s_mul_i32 s3, s3, 12288
s_add_u32 s8, s3, s16
s_add_u32 s3, s19, 6
s_and_b32 s3, s3, 7
s_mul_i32 s3, s3, 12288
s_add_u32 s9, s3, s16
s_add_u32 s3, s19, 7
s_and_b32 s3, s3, 7
s_mul_i32 s3, s3, 12288
s_add_u32 s10, s3, s16
v_and_b32 v99, 15, v101
v_lshrrev_b32 v102, 4, v101
v_lshrrev_b32 v103, 2, v99
v_cmp_eq_u32 vcc, v102, v103
v_and_b32 v103, 1, v99
v_lshlrev_b32 v103, 4, v103
s_movk_i32 s3, 0x3f80
v_lshlrev_b32 v103, v103, s3
v_cndmask_b32 v103, 0, v103, vcc
v_and_b32 v104, 2, v99
v_cmp_eq_u32 vcc, 0, v104
v_mov_b32 v108, 0
v_mov_b32 v109, 0
v_cndmask_b32 v110, 0, v103, vcc
v_sub_u32 v111, v103, v110
v_mov_b32 v112, 0
v_mov_b32 v113, 0
v_lshrrev_b32 v103, 1, v102
v_and_b32 v102, 1, v102
v_lshl_or_b32 v102, v102, 1, v103
s_mul_i32 s3, s62, 96
s_mul_i32 s15, s89, 48
s_add_u32 s3, s3, s15
v_add_u32 v99, s3, v99
v_mul_u32_u24 v99, 1792, v99
v_lshl_add_u32 v99, v102, 4, v99
s_mul_i32 s3, s60, 896
s_lshl_b32 s15, s19, 7
s_add_u32 s3, s3, s15
s_lshl_b32 s15, s88, 6
s_add_u32 s17, s3, s15
s_mov_b64 exec, 0x7f
s_waitcnt vmcnt(2)
L_look:
v_cmp_ne_u32 vcc, 1, v98
s_cbranch_vccz L_all
buffer_load_dword v98, v97, s[40:43], s91 offen sc1
s_sub_u32 s66, s66, 16
s_waitcnt vmcnt(0)
s_cbranch_scc0 L_look
L_all:
s_mov_b64 exec, -1
s_cmp_eq_u32 s19, 7
s_cbranch_scc1 L_last
buffer_load_dwordx4 a[112:115], v222, s[40:43], s4 offen offset:0 sc1
buffer_load_dwordx4 a[124:127], v222, s[40:43], s5 offen offset:0 sc1
buffer_load_dwordx4 a[136:139], v222, s[40:43], s6 offen offset:0 sc1
buffer_load_dwordx4 a[148:151], v222, s[40:43], s7 offen offset:0 sc1
buffer_load_dwordx4 a[160:163], v222, s[40:43], s8 offen offset:0 sc1
buffer_load_dwordx4 a[172:175], v222, s[40:43], s9 offen offset:0 sc1
buffer_load_dwordx4 a[184:187], v222, s[40:43], s10 offen offset:0 sc1
buffer_load_dwordx4 a[116:119], v222, s[40:43], s4 offen offset:1024 sc1
buffer_load_dwordx4 a[128:131], v222, s[40:43], s5 offen offset:1024 sc1
buffer_load_dwordx4 a[140:143], v222, s[40:43], s6 offen offset:1024 sc1
buffer_load_dwordx4 a[152:155], v222, s[40:43], s7 offen offset:1024 sc1
buffer_load_dwordx4 a[164:167], v222, s[40:43], s8 offen offset:1024 sc1
buffer_load_dwordx4 a[176:179], v222, s[40:43], s9 offen offset:1024 sc1
s_waitcnt vmcnt(12)
v_mfma_f32_16x16x32_bf16 v[192:195], v[110:113], a[112:115], v[192:195]
v_mfma_f32_16x16x32_bf16 v[196:199], v[108:111], a[112:115], v[196:199]
buffer_load_dwordx4 a[188:191], v222, s[40:43], s10 offen offset:1024 sc1
s_waitcnt vmcnt(12)
v_mfma_f32_16x16x32_bf16 v[192:195], v[110:113], a[124:127], v[192:195]
v_mfma_f32_16x16x32_bf16 v[196:199], v[108:111], a[124:127], v[196:199]
buffer_load_dwordx4 a[120:123], v222, s[40:43], s4 offen offset:2048 sc1
s_waitcnt vmcnt(12)
v_mfma_f32_16x16x32_bf16 v[192:195], v[110:113], a[136:139], v[192:195]
v_mfma_f32_16x16x32_bf16 v[196:199], v[108:111], a[136:139], v[196:199]
buffer_load_dwordx4 a[132:135], v222, s[40:43], s5 offen offset:2048 sc1
s_waitcnt vmcnt(12)
v_mfma_f32_16x16x32_bf16 v[192:195], v[110:113], a[148:151], v[192:195]
v_mfma_f32_16x16x32_bf16 v[196:199], v[108:111], a[148:151], v[196:199]
buffer_load_dwordx4 a[144:147], v222, s[40:43], s6 offen offset:2048 sc1
s_waitcnt vmcnt(12)
v_mfma_f32_16x16x32_bf16 v[192:195], v[110:113], a[160:163], v[192:195]
v_mfma_f32_16x16x32_bf16 v[196:199], v[108:111], a[160:163], v[196:199]
buffer_load_dwordx4 a[156:159], v222, s[40:43], s7 offen offset:2048 sc1
s_waitcnt vmcnt(12)
v_mfma_f32_16x16x32_bf16 v[192:195], v[110:113], a[172:175], v[192:195]
v_mfma_f32_16x16x32_bf16 v[196:199], v[108:111], a[172:175], v[196:199]
buffer_load_dwordx4 a[168:171], v222, s[40:43], s8 offen offset:2048 sc1
s_waitcnt vmcnt(12)
v_mfma_f32_16x16x32_bf16 v[192:195], v[110:113], a[184:187], v[192:195]
v_mfma_f32_16x16x32_bf16 v[196:199], v[108:111], a[184:187], v[196:199]
buffer_load_dwordx4 a[180:183], v222, s[40:43], s9 offen offset:2048 sc1
s_waitcnt vmcnt(12)
v_mfma_f32_16x16x32_bf16 v[200:203], v[110:113], a[116:119], v[200:203]
v_mfma_f32_16x16x32_bf16 v[204:207], v[108:111], a[116:119], v[204:207]
buffer_load_dwordx4 a[192:195], v222, s[40:43], s10 offen offset:2048 sc1
s_mov_b64 exec, 0xff
buffer_store_dword v223, v144, s[40:43], s71 offen sc1
s_mov_b64 exec, -1
s_waitcnt vmcnt(13)
v_mfma_f32_16x16x32_bf16 v[200:203], v[110:113], a[128:131], v[200:203]
v_mfma_f32_16x16x32_bf16 v[204:207], v[108:111], a[128:131], v[204:207]
v_cvt_pk_bf16_f32 v120, v192, v193
v_cvt_pk_bf16_f32 v121, v194, v195
v_cvt_pk_bf16_f32 v122, v196, v197
v_cvt_pk_bf16_f32 v123, v198, v199
s_nop 0
v_permlane16_swap_b32 v120, v122
v_permlane16_swap_b32 v121, v123
buffer_store_dwordx4 v[120:123], v99, s[44:47], s17 offen
s_add_u32 s17, s17, 28672
s_waitcnt vmcnt(13)
v_mfma_f32_16x16x32_bf16 v[200:203], v[110:113], a[140:143], v[200:203]
v_mfma_f32_16x16x32_bf16 v[204:207], v[108:111], a[140:143], v[204:207]
s_waitcnt vmcnt(12)
v_mfma_f32_16x16x32_bf16 v[200:203], v[110:113], a[152:155], v[200:203]
v_mfma_f32_16x16x32_bf16 v[204:207], v[108:111], a[152:155], v[204:207]
s_waitcnt vmcnt(11)
v_mfma_f32_16x16x32_bf16 v[200:203], v[110:113], a[164:167], v[200:203]
v_mfma_f32_16x16x32_bf16 v[204:207], v[108:111], a[164:167], v[204:207]
s_waitcnt vmcnt(10)
v_mfma_f32_16x16x32_bf16 v[200:203], v[110:113], a[176:179], v[200:203]
v_mfma_f32_16x16x32_bf16 v[204:207], v[108:111], a[176:179], v[204:207]
s_waitcnt vmcnt(9)
v_mfma_f32_16x16x32_bf16 v[200:203], v[110:113], a[188:191], v[200:203]
v_mfma_f32_16x16x32_bf16 v[204:207], v[108:111], a[188:191], v[204:207]
s_waitcnt vmcnt(8)
v_mfma_f32_16x16x32_bf16 v[208:211], v[110:113], a[120:123], v[208:211]
v_mfma_f32_16x16x32_bf16 v[212:215], v[108:111], a[120:123], v[212:215]
s_waitcnt vmcnt(7)
v_mfma_f32_16x16x32_bf16 v[208:211], v[110:113], a[132:135], v[208:211]
v_mfma_f32_16x16x32_bf16 v[212:215], v[108:111], a[132:135], v[212:215]
s_nop 0
v_cvt_pk_bf16_f32 v124, v200, v201
v_cvt_pk_bf16_f32 v125, v202, v203
v_cvt_pk_bf16_f32 v126, v204, v205
v_cvt_pk_bf16_f32 v127, v206, v207
s_nop 0
v_permlane16_swap_b32 v124, v126
v_permlane16_swap_b32 v125, v127
buffer_store_dwordx4 v[124:127], v99, s[44:47], s17 offen
s_add_u32 s17, s17, 28672
s_waitcnt vmcnt(7)
v_mfma_f32_16x16x32_bf16 v[208:211], v[110:113], a[144:147], v[208:211]
v_mfma_f32_16x16x32_bf16 v[212:215], v[108:111], a[144:147], v[212:215]
s_waitcnt vmcnt(6)
v_mfma_f32_16x16x32_bf16 v[208:211], v[110:113], a[156:159], v[208:211]
v_mfma_f32_16x16x32_bf16 v[212:215], v[108:111], a[156:159], v[212:215]
s_waitcnt vmcnt(5)
v_mfma_f32_16x16x32_bf16 v[208:211], v[110:113], a[168:171], v[208:211]
v_mfma_f32_16x16x32_bf16 v[212:215], v[108:111], a[168:171], v[212:215]
s_waitcnt vmcnt(4)
v_mfma_f32_16x16x32_bf16 v[208:211], v[110:113], a[180:183], v[208:211]
v_mfma_f32_16x16x32_bf16 v[212:215], v[108:111], a[180:183], v[212:215]
s_waitcnt vmcnt(3)
v_mfma_f32_16x16x32_bf16 v[208:211], v[110:113], a[192:195], v[208:211]
v_mfma_f32_16x16x32_bf16 v[212:215], v[108:111], a[192:195], v[212:215]
s_nop 6
v_cvt_pk_bf16_f32 v128, v208, v209
v_cvt_pk_bf16_f32 v129, v210, v211
v_cvt_pk_bf16_f32 v130, v212, v213
v_cvt_pk_bf16_f32 v131, v214, v215
s_nop 0
v_permlane16_swap_b32 v128, v130
v_permlane16_swap_b32 v129, v131
buffer_store_dwordx4 v[128:131], v99, s[44:47], s17 offen
s_add_u32 s17, s17, 28672
s_branch L_fin
L_last:
s_mov_b64 exec, 0xff
buffer_store_dword v223, v144, s[40:43], s71 offen sc1
s_mov_b64 exec, -1
L_fin:
s_mov_b64 exec, -1
s_endpgm
L_codeend:
L_rare0_0:
s_mov_b32 s65, 0xff800000
v_max3_f32 v244, v0, v1, v2
v_max3_f32 v244, v3, v4, v244
v_max3_f32 v244, v5, v6, v244
v_max_f32 v244, v7, v244
v_mov_b32 v245, v244
s_nop 1
v_permlane32_swap_b32 v244, v245
v_max_f32 v244, v244, v245
v_mov_b32 v245, v244
s_nop 1
v_permlane16_swap_b32 v244, v245
v_max_f32 v244, v244, v245
v_sub_f32 v0, v0, v244
v_sub_f32 v1, v1, v244
v_sub_f32 v2, v2, v244
v_sub_f32 v3, v3, v244
v_sub_f32 v4, v4, v244
v_sub_f32 v5, v5, v244
v_sub_f32 v6, v6, v244
v_sub_f32 v7, v7, v244
v_sub_f32 v245, v232, v244
v_mov_b32 v232, v244
v_max3_f32 v244, v8, v9, v10
v_max3_f32 v244, v11, v12, v244
v_max3_f32 v244, v13, v14, v244
v_max_f32 v244, v15, v244
v_mov_b32 v245, v244
s_nop 1
v_permlane32_swap_b32 v244, v245
v_max_f32 v244, v244, v245
v_mov_b32 v245, v244
s_nop 1
v_permlane16_swap_b32 v244, v245
v_max_f32 v244, v244, v245
v_sub_f32 v8, v8, v244
v_sub_f32 v9, v9, v244
v_sub_f32 v10, v10, v244
v_sub_f32 v11, v11, v244
v_sub_f32 v12, v12, v244
v_sub_f32 v13, v13, v244
v_sub_f32 v14, v14, v244
v_sub_f32 v15, v15, v244
v_sub_f32 v245, v233, v244
v_mov_b32 v233, v244
v_max3_f32 v244, v16, v17, v18
v_max3_f32 v244, v19, v20, v244
v_max3_f32 v244, v21, v22, v244
v_max_f32 v244, v23, v244
v_mov_b32 v245, v244
s_nop 1
v_permlane32_swap_b32 v244, v245
v_max_f32 v244, v244, v245
v_mov_b32 v245, v244
s_nop 1
v_permlane16_swap_b32 v244, v245
v_max_f32 v244, v244, v245
v_sub_f32 v16, v16, v244
v_sub_f32 v17, v17, v244
v_sub_f32 v18, v18, v244
v_sub_f32 v19, v19, v244
v_sub_f32 v20, v20, v244
v_sub_f32 v21, v21, v244
v_sub_f32 v22, v22, v244
v_sub_f32 v23, v23, v244
v_sub_f32 v245, v234, v244
v_mov_b32 v234, v244
s_nop 1
s_branch L_back0_0
L_rare0_1:
s_mov_b32 s65, 0xff800000
v_max3_f32 v244, v24, v25, v26
v_max3_f32 v244, v27, v28, v244
v_max3_f32 v244, v29, v30, v244
v_max3_f32 v244, v31, v244, v232
v_mov_b32 v245, v244
s_nop 1
v_permlane32_swap_b32 v244, v245
v_max_f32 v244, v244, v245
v_mov_b32 v245, v244
s_nop 1
v_permlane16_swap_b32 v244, v245
v_max_f32 v244, v244, v245
v_sub_f32 v24, v24, v244
v_sub_f32 v25, v25, v244
v_sub_f32 v26, v26, v244
v_sub_f32 v27, v27, v244
v_sub_f32 v28, v28, v244
v_sub_f32 v29, v29, v244
v_sub_f32 v30, v30, v244
v_sub_f32 v31, v31, v244
v_sub_f32 v245, v232, v244
v_mov_b32 v232, v244
v_exp_f32 v244, v245
v_lshlrev_b32 v245, 16, v0
v_and_b32 v231, 0xffff0000, v0
v_mul_f32 v245, v244, v245
v_mul_f32 v231, v244, v231
v_cvt_pk_bf16_f32 v0, v245, v231
v_lshlrev_b32 v245, 16, v1
v_and_b32 v231, 0xffff0000, v1
v_mul_f32 v245, v244, v245
v_mul_f32 v231, v244, v231
v_cvt_pk_bf16_f32 v1, v245, v231
v_lshlrev_b32 v245, 16, v2
v_and_b32 v231, 0xffff0000, v2
v_mul_f32 v245, v244, v245
v_mul_f32 v231, v244, v231
v_cvt_pk_bf16_f32 v2, v245, v231
v_lshlrev_b32 v245, 16, v3
v_and_b32 v231, 0xffff0000, v3
v_mul_f32 v245, v244, v245
v_mul_f32 v231, v244, v231
v_cvt_pk_bf16_f32 v3, v245, v231
v_max3_f32 v244, v32, v33, v34
v_max3_f32 v244, v35, v36, v244
v_max3_f32 v244, v37, v38, v244
v_max3_f32 v244, v39, v244, v233
v_mov_b32 v245, v244
s_nop 1
v_permlane32_swap_b32 v244, v245
v_max_f32 v244, v244, v245
v_mov_b32 v245, v244
s_nop 1
v_permlane16_swap_b32 v244, v245
v_max_f32 v244, v244, v245
v_sub_f32 v32, v32, v244
v_sub_f32 v33, v33, v244
v_sub_f32 v34, v34, v244
v_sub_f32 v35, v35, v244
v_sub_f32 v36, v36, v244
v_sub_f32 v37, v37, v244
v_sub_f32 v38, v38, v244
v_sub_f32 v39, v39, v244
v_sub_f32 v245, v233, v244
v_mov_b32 v233, v244
v_exp_f32 v244, v245
v_lshlrev_b32 v245, 16, v4
v_and_b32 v231, 0xffff0000, v4
v_mul_f32 v245, v244, v245
v_mul_f32 v231, v244, v231
v_cvt_pk_bf16_f32 v4, v245, v231
v_lshlrev_b32 v245, 16, v5
v_and_b32 v231, 0xffff0000, v5
v_mul_f32 v245, v244, v245
v_mul_f32 v231, v244, v231
v_cvt_pk_bf16_f32 v5, v245, v231
v_lshlrev_b32 v245, 16, v6
v_and_b32 v231, 0xffff0000, v6
v_mul_f32 v245, v244, v245
v_mul_f32 v231, v244, v231
v_cvt_pk_bf16_f32 v6, v245, v231
v_lshlrev_b32 v245, 16, v7
v_and_b32 v231, 0xffff0000, v7
v_mul_f32 v245, v244, v245
v_mul_f32 v231, v244, v231
v_cvt_pk_bf16_f32 v7, v245, v231
v_max3_f32 v244, v40, v41, v42
v_max3_f32 v244, v43, v44, v244
v_max3_f32 v244, v45, v46, v244
v_max3_f32 v244, v47, v244, v234
v_mov_b32 v245, v244
s_nop 1
v_permlane32_swap_b32 v244, v245
v_max_f32 v244, v244, v245
v_mov_b32 v245, v244
s_nop 1
v_permlane16_swap_b32 v244, v245
v_max_f32 v244, v244, v245
v_sub_f32 v40, v40, v244
v_sub_f32 v41, v41, v244
v_sub_f32 v42, v42, v244
v_sub_f32 v43, v43, v244
v_sub_f32 v44, v44, v244
v_sub_f32 v45, v45, v244
v_sub_f32 v46, v46, v244
v_sub_f32 v47, v47, v244
v_sub_f32 v245, v234, v244
v_mov_b32 v234, v244
v_exp_f32 v244, v245
v_lshlrev_b32 v245, 16, v8
v_and_b32 v231, 0xffff0000, v8
v_mul_f32 v245, v244, v245
v_mul_f32 v231, v244, v231
v_cvt_pk_bf16_f32 v8, v245, v231
v_lshlrev_b32 v245, 16, v9
v_and_b32 v231, 0xffff0000, v9
v_mul_f32 v245, v244, v245
v_mul_f32 v231, v244, v231
v_cvt_pk_bf16_f32 v9, v245, v231
v_lshlrev_b32 v245, 16, v10
v_and_b32 v231, 0xffff0000, v10
v_mul_f32 v245, v244, v245
v_mul_f32 v231, v244, v231
v_cvt_pk_bf16_f32 v10, v245, v231
v_lshlrev_b32 v245, 16, v11
v_and_b32 v231, 0xffff0000, v11
v_mul_f32 v245, v244, v245
v_mul_f32 v231, v244, v231
v_cvt_pk_bf16_f32 v11, v245, v231
s_nop 1
s_branch L_back0_1
L_rare0_2:
s_mov_b32 s65, 0xff800000
v_max3_f32 v244, v48, v49, v50
v_max3_f32 v244, v51, v52, v244
v_max3_f32 v244, v53, v54, v244
v_max3_f32 v244, v55, v244, v232
v_mov_b32 v245, v244
s_nop 1
v_permlane32_swap_b32 v244, v245
v_max_f32 v244, v244, v245
v_mov_b32 v245, v244
s_nop 1
v_permlane16_swap_b32 v244, v245
v_max_f32 v244, v244, v245
v_sub_f32 v48, v48, v244
v_sub_f32 v49, v49, v244
v_sub_f32 v50, v50, v244
v_sub_f32 v51, v51, v244
v_sub_f32 v52, v52, v244
v_sub_f32 v53, v53, v244
v_sub_f32 v54, v54, v244
v_sub_f32 v55, v55, v244
v_sub_f32 v245, v232, v244
v_mov_b32 v232, v244
v_exp_f32 v244, v245
v_lshlrev_b32 v245, 16, v0
v_and_b32 v231, 0xffff0000, v0
v_mul_f32 v245, v244, v245
v_mul_f32 v231, v244, v231
v_cvt_pk_bf16_f32 v0, v245, v231
v_lshlrev_b32 v245, 16, v1
v_and_b32 v231, 0xffff0000, v1
v_mul_f32 v245, v244, v245
v_mul_f32 v231, v244, v231
v_cvt_pk_bf16_f32 v1, v245, v231
v_lshlrev_b32 v245, 16, v2
v_and_b32 v231, 0xffff0000, v2
v_mul_f32 v245, v244, v245
v_mul_f32 v231, v244, v231
v_cvt_pk_bf16_f32 v2, v245, v231
v_lshlrev_b32 v245, 16, v3
v_and_b32 v231, 0xffff0000, v3
v_mul_f32 v245, v244, v245
v_mul_f32 v231, v244, v231
v_cvt_pk_bf16_f32 v3, v245, v231
v_lshlrev_b32 v245, 16, v12
v_and_b32 v231, 0xffff0000, v12
v_mul_f32 v245, v244, v245
v_mul_f32 v231, v244, v231
v_cvt_pk_bf16_f32 v12, v245, v231
v_lshlrev_b32 v245, 16, v13
v_and_b32 v231, 0xffff0000, v13
v_mul_f32 v245, v244, v245
v_mul_f32 v231, v244, v231
v_cvt_pk_bf16_f32 v13, v245, v231
v_lshlrev_b32 v245, 16, v14
v_and_b32 v231, 0xffff0000, v14
v_mul_f32 v245, v244, v245
v_mul_f32 v231, v244, v231
v_cvt_pk_bf16_f32 v14, v245, v231
v_lshlrev_b32 v245, 16, v15
v_and_b32 v231, 0xffff0000, v15
v_mul_f32 v245, v244, v245
v_mul_f32 v231, v244, v231
v_cvt_pk_bf16_f32 v15, v245, v231
v_max3_f32 v244, v56, v57, v58
v_max3_f32 v244, v59, v60, v244
v_max3_f32 v244, v61, v62, v244
v_max3_f32 v244, v63, v244, v233
v_mov_b32 v245, v244
s_nop 1
v_permlane32_swap_b32 v244, v245
v_max_f32 v244, v244, v245
v_mov_b32 v245, v244
s_nop 1
v_permlane16_swap_b32 v244, v245
v_max_f32 v244, v244, v245
v_sub_f32 v56, v56, v244
v_sub_f32 v57, v57, v244
v_sub_f32 v58, v58, v244
v_sub_f32 v59, v59, v244
v_sub_f32 v60, v60, v244
v_sub_f32 v61, v61, v244
v_sub_f32 v62, v62, v244
v_sub_f32 v63, v63, v244
v_sub_f32 v245, v233, v244
v_mov_b32 v233, v244
v_exp_f32 v244, v245
v_lshlrev_b32 v245, 16, v4
v_and_b32 v231, 0xffff0000, v4
v_mul_f32 v245, v244, v245
v_mul_f32 v231, v244, v231
v_cvt_pk_bf16_f32 v4, v245, v231
v_lshlrev_b32 v245, 16, v5
v_and_b32 v231, 0xffff0000, v5
v_mul_f32 v245, v244, v245
v_mul_f32 v231, v244, v231
v_cvt_pk_bf16_f32 v5, v245, v231
v_lshlrev_b32 v245, 16, v6
v_and_b32 v231, 0xffff0000, v6
v_mul_f32 v245, v244, v245
v_mul_f32 v231, v244, v231
v_cvt_pk_bf16_f32 v6, v245, v231
v_lshlrev_b32 v245, 16, v7
v_and_b32 v231, 0xffff0000, v7
v_mul_f32 v245, v244, v245
v_mul_f32 v231, v244, v231
v_cvt_pk_bf16_f32 v7, v245, v231
v_lshlrev_b32 v245, 16, v16
v_and_b32 v231, 0xffff0000, v16
v_mul_f32 v245, v244, v245
v_mul_f32 v231, v244, v231
v_cvt_pk_bf16_f32 v16, v245, v231
v_lshlrev_b32 v245, 16, v17
v_and_b32 v231, 0xffff0000, v17
v_mul_f32 v245, v244, v245
v_mul_f32 v231, v244, v231
v_cvt_pk_bf16_f32 v17, v245, v231
v_lshlrev_b32 v245, 16, v18
v_and_b32 v231, 0xffff0000, v18
v_mul_f32 v245, v244, v245
v_mul_f32 v231, v244, v231
v_cvt_pk_bf16_f32 v18, v245, v231
v_lshlrev_b32 v245, 16, v19
v_and_b32 v231, 0xffff0000, v19
v_mul_f32 v245, v244, v245
v_mul_f32 v231, v244, v231
v_cvt_pk_bf16_f32 v19, v245, v231
v_max3_f32 v244, v64, v65, v66
v_max3_f32 v244, v67, v68, v244
v_max3_f32 v244, v69, v70, v244
v_max3_f32 v244, v71, v244, v234
v_mov_b32 v245, v244
s_nop 1
v_permlane32_swap_b32 v244, v245
v_max_f32 v244, v244, v245
v_mov_b32 v245, v244
s_nop 1
v_permlane16_swap_b32 v244, v245
v_max_f32 v244, v244, v245
v_sub_f32 v64, v64, v244
v_sub_f32 v65, v65, v244
v_sub_f32 v66, v66, v244
v_sub_f32 v67, v67, v244
v_sub_f32 v68, v68, v244
v_sub_f32 v69, v69, v244
v_sub_f32 v70, v70, v244
v_sub_f32 v71, v71, v244
v_sub_f32 v245, v234, v244
v_mov_b32 v234, v244
v_exp_f32 v244, v245
v_lshlrev_b32 v245, 16, v8
v_and_b32 v231, 0xffff0000, v8
v_mul_f32 v245, v244, v245
v_mul_f32 v231, v244, v231
v_cvt_pk_bf16_f32 v8, v245, v231
v_lshlrev_b32 v245, 16, v9
v_and_b32 v231, 0xffff0000, v9
v_mul_f32 v245, v244, v245
v_mul_f32 v231, v244, v231
v_cvt_pk_bf16_f32 v9, v245, v231
v_lshlrev_b32 v245, 16, v10
v_and_b32 v231, 0xffff0000, v10
v_mul_f32 v245, v244, v245
v_mul_f32 v231, v244, v231
v_cvt_pk_bf16_f32 v10, v245, v231
v_lshlrev_b32 v245, 16, v11
v_and_b32 v231, 0xffff0000, v11
v_mul_f32 v245, v244, v245
v_mul_f32 v231, v244, v231
v_cvt_pk_bf16_f32 v11, v245, v231
v_lshlrev_b32 v245, 16, v20
v_and_b32 v231, 0xffff0000, v20
v_mul_f32 v245, v244, v245
v_mul_f32 v231, v244, v231
v_cvt_pk_bf16_f32 v20, v245, v231
v_lshlrev_b32 v245, 16, v21
v_and_b32 v231, 0xffff0000, v21
v_mul_f32 v245, v244, v245
v_mul_f32 v231, v244, v231
v_cvt_pk_bf16_f32 v21, v245, v231
v_lshlrev_b32 v245, 16, v22
v_and_b32 v231, 0xffff0000, v22
v_mul_f32 v245, v244, v245
v_mul_f32 v231, v244, v231
v_cvt_pk_bf16_f32 v22, v245, v231
v_lshlrev_b32 v245, 16, v23
v_and_b32 v231, 0xffff0000, v23
v_mul_f32 v245, v244, v245
v_mul_f32 v231, v244, v231
v_cvt_pk_bf16_f32 v23, v245, v231
s_nop 1
s_branch L_back0_2
L_rare0_3:
s_mov_b32 s65, 0xff800000
v_max3_f32 v244, v72, v73, v74
v_max3_f32 v244, v75, v76, v244
v_max3_f32 v244, v77, v78, v244
v_max3_f32 v244, v79, v244, v232
v_mov_b32 v245, v244
s_nop 1
v_permlane32_swap_b32 v244, v245
v_max_f32 v244, v244, v245
v_mov_b32 v245, v244
s_nop 1
v_permlane16_swap_b32 v244, v245
v_max_f32 v244, v244, v245
v_sub_f32 v72, v72, v244
v_sub_f32 v73, v73, v244
v_sub_f32 v74, v74, v244
v_sub_f32 v75, v75, v244
v_sub_f32 v76, v76, v244
v_sub_f32 v77, v77, v244
v_sub_f32 v78, v78, v244
v_sub_f32 v79, v79, v244
v_sub_f32 v245, v232, v244
v_mov_b32 v232, v244
v_exp_f32 v244, v245
v_lshlrev_b32 v245, 16, v0
v_and_b32 v231, 0xffff0000, v0
v_mul_f32 v245, v244, v245
v_mul_f32 v231, v244, v231
v_cvt_pk_bf16_f32 v0, v245, v231
v_lshlrev_b32 v245, 16, v1
v_and_b32 v231, 0xffff0000, v1
v_mul_f32 v245, v244, v245
v_mul_f32 v231, v244, v231
v_cvt_pk_bf16_f32 v1, v245, v231
v_lshlrev_b32 v245, 16, v2
v_and_b32 v231, 0xffff0000, v2
v_mul_f32 v245, v244, v245
v_mul_f32 v231, v244, v231
v_cvt_pk_bf16_f32 v2, v245, v231
v_lshlrev_b32 v245, 16, v3
v_and_b32 v231, 0xffff0000, v3
v_mul_f32 v245, v244, v245
v_mul_f32 v231, v244, v231
v_cvt_pk_bf16_f32 v3, v245, v231
v_lshlrev_b32 v245, 16, v12
v_and_b32 v231, 0xffff0000, v12
v_mul_f32 v245, v244, v245
v_mul_f32 v231, v244, v231
v_cvt_pk_bf16_f32 v12, v245, v231
v_lshlrev_b32 v245, 16, v13
v_and_b32 v231, 0xffff0000, v13
v_mul_f32 v245, v244, v245
v_mul_f32 v231, v244, v231
v_cvt_pk_bf16_f32 v13, v245, v231
v_lshlrev_b32 v245, 16, v14
v_and_b32 v231, 0xffff0000, v14
v_mul_f32 v245, v244, v245
v_mul_f32 v231, v244, v231
v_cvt_pk_bf16_f32 v14, v245, v231
v_lshlrev_b32 v245, 16, v15
v_and_b32 v231, 0xffff0000, v15
v_mul_f32 v245, v244, v245
v_mul_f32 v231, v244, v231
v_cvt_pk_bf16_f32 v15, v245, v231
v_lshlrev_b32 v245, 16, v24
v_and_b32 v231, 0xffff0000, v24
v_mul_f32 v245, v244, v245
v_mul_f32 v231, v244, v231
v_cvt_pk_bf16_f32 v24, v245, v231
v_lshlrev_b32 v245, 16, v25
v_and_b32 v231, 0xffff0000, v25
v_mul_f32 v245, v244, v245
v_mul_f32 v231, v244, v231
v_cvt_pk_bf16_f32 v25, v245, v231
v_lshlrev_b32 v245, 16, v26
v_and_b32 v231, 0xffff0000, v26
v_mul_f32 v245, v244, v245
v_mul_f32 v231, v244, v231
v_cvt_pk_bf16_f32 v26, v245, v231
v_lshlrev_b32 v245, 16, v27
v_and_b32 v231, 0xffff0000, v27
v_mul_f32 v245, v244, v245
v_mul_f32 v231, v244, v231
v_cvt_pk_bf16_f32 v27, v245, v231
v_max3_f32 v244, v80, v81, v82
v_max3_f32 v244, v83, v84, v244
v_max3_f32 v244, v85, v86, v244
v_max3_f32 v244, v87, v244, v233
v_mov_b32 v245, v244
s_nop 1
v_permlane32_swap_b32 v244, v245
v_max_f32 v244, v244, v245
v_mov_b32 v245, v244
s_nop 1
v_permlane16_swap_b32 v244, v245
v_max_f32 v244, v244, v245
v_sub_f32 v80, v80, v244
v_sub_f32 v81, v81, v244
v_sub_f32 v82, v82, v244
v_sub_f32 v83, v83, v244
v_sub_f32 v84, v84, v244
v_sub_f32 v85, v85, v244
v_sub_f32 v86, v86, v244
v_sub_f32 v87, v87, v244
v_sub_f32 v245, v233, v244
v_mov_b32 v233, v244
v_exp_f32 v244, v245
v_lshlrev_b32 v245, 16, v4
v_and_b32 v231, 0xffff0000, v4
v_mul_f32 v245, v244, v245
v_mul_f32 v231, v244, v231
v_cvt_pk_bf16_f32 v4, v245, v231
v_lshlrev_b32 v245, 16, v5
v_and_b32 v231, 0xffff0000, v5
v_mul_f32 v245, v244, v245
v_mul_f32 v231, v244, v231
v_cvt_pk_bf16_f32 v5, v245, v231
v_lshlrev_b32 v245, 16, v6
v_and_b32 v231, 0xffff0000, v6
v_mul_f32 v245, v244, v245
v_mul_f32 v231, v244, v231
v_cvt_pk_bf16_f32 v6, v245, v231
v_lshlrev_b32 v245, 16, v7
v_and_b32 v231, 0xffff0000, v7
v_mul_f32 v245, v244, v245
v_mul_f32 v231, v244, v231
v_cvt_pk_bf16_f32 v7, v245, v231
v_lshlrev_b32 v245, 16, v16
v_and_b32 v231, 0xffff0000, v16
v_mul_f32 v245, v244, v245
v_mul_f32 v231, v244, v231
v_cvt_pk_bf16_f32 v16, v245, v231
v_lshlrev_b32 v245, 16, v17
v_and_b32 v231, 0xffff0000, v17
v_mul_f32 v245, v244, v245
v_mul_f32 v231, v244, v231
v_cvt_pk_bf16_f32 v17, v245, v231
v_lshlrev_b32 v245, 16, v18
v_and_b32 v231, 0xffff0000, v18
v_mul_f32 v245, v244, v245
v_mul_f32 v231, v244, v231
v_cvt_pk_bf16_f32 v18, v245, v231
v_lshlrev_b32 v245, 16, v19
v_and_b32 v231, 0xffff0000, v19
v_mul_f32 v245, v244, v245
v_mul_f32 v231, v244, v231
v_cvt_pk_bf16_f32 v19, v245, v231
v_lshlrev_b32 v245, 16, v28
v_and_b32 v231, 0xffff0000, v28
v_mul_f32 v245, v244, v245
v_mul_f32 v231, v244, v231
v_cvt_pk_bf16_f32 v28, v245, v231
v_lshlrev_b32 v245, 16, v29
v_and_b32 v231, 0xffff0000, v29
v_mul_f32 v245, v244, v245
v_mul_f32 v231, v244, v231
v_cvt_pk_bf16_f32 v29, v245, v231
v_lshlrev_b32 v245, 16, v30
v_and_b32 v231, 0xffff0000, v30
v_mul_f32 v245, v244, v245
v_mul_f32 v231, v244, v231
v_cvt_pk_bf16_f32 v30, v245, v231
v_lshlrev_b32 v245, 16, v31
v_and_b32 v231, 0xffff0000, v31
v_mul_f32 v245, v244, v245
v_mul_f32 v231, v244, v231
v_cvt_pk_bf16_f32 v31, v245, v231
v_max3_f32 v244, v88, v89, v90
v_max3_f32 v244, v91, v92, v244
v_max3_f32 v244, v93, v94, v244
v_max3_f32 v244, v95, v244, v234
v_mov_b32 v245, v244
s_nop 1
v_permlane32_swap_b32 v244, v245
v_max_f32 v244, v244, v245
v_mov_b32 v245, v244
s_nop 1
v_permlane16_swap_b32 v244, v245
v_max_f32 v244, v244, v245
v_sub_f32 v88, v88, v244
v_sub_f32 v89, v89, v244
v_sub_f32 v90, v90, v244
v_sub_f32 v91, v91, v244
v_sub_f32 v92, v92, v244
v_sub_f32 v93, v93, v244
v_sub_f32 v94, v94, v244
v_sub_f32 v95, v95, v244
v_sub_f32 v245, v234, v244
v_mov_b32 v234, v244
v_exp_f32 v244, v245
v_lshlrev_b32 v245, 16, v8
v_and_b32 v231, 0xffff0000, v8
v_mul_f32 v245, v244, v245
v_mul_f32 v231, v244, v231
v_cvt_pk_bf16_f32 v8, v245, v231
v_lshlrev_b32 v245, 16, v9
v_and_b32 v231, 0xffff0000, v9
v_mul_f32 v245, v244, v245
v_mul_f32 v231, v244, v231
v_cvt_pk_bf16_f32 v9, v245, v231
v_lshlrev_b32 v245, 16, v10
v_and_b32 v231, 0xffff0000, v10
v_mul_f32 v245, v244, v245
v_mul_f32 v231, v244, v231
v_cvt_pk_bf16_f32 v10, v245, v231
v_lshlrev_b32 v245, 16, v11
v_and_b32 v231, 0xffff0000, v11
v_mul_f32 v245, v244, v245
v_mul_f32 v231, v244, v231
v_cvt_pk_bf16_f32 v11, v245, v231
v_lshlrev_b32 v245, 16, v20
v_and_b32 v231, 0xffff0000, v20
v_mul_f32 v245, v244, v245
v_mul_f32 v231, v244, v231
v_cvt_pk_bf16_f32 v20, v245, v231
v_lshlrev_b32 v245, 16, v21
v_and_b32 v231, 0xffff0000, v21
v_mul_f32 v245, v244, v245
v_mul_f32 v231, v244, v231
v_cvt_pk_bf16_f32 v21, v245, v231
v_lshlrev_b32 v245, 16, v22
v_and_b32 v231, 0xffff0000, v22
v_mul_f32 v245, v244, v245
v_mul_f32 v231, v244, v231
v_cvt_pk_bf16_f32 v22, v245, v231
v_lshlrev_b32 v245, 16, v23
v_and_b32 v231, 0xffff0000, v23
v_mul_f32 v245, v244, v245
v_mul_f32 v231, v244, v231
v_cvt_pk_bf16_f32 v23, v245, v231
v_lshlrev_b32 v245, 16, v32
v_and_b32 v231, 0xffff0000, v32
v_mul_f32 v245, v244, v245
v_mul_f32 v231, v244, v231
v_cvt_pk_bf16_f32 v32, v245, v231
v_lshlrev_b32 v245, 16, v33
v_and_b32 v231, 0xffff0000, v33
v_mul_f32 v245, v244, v245
v_mul_f32 v231, v244, v231
v_cvt_pk_bf16_f32 v33, v245, v231
v_lshlrev_b32 v245, 16, v34
v_and_b32 v231, 0xffff0000, v34
v_mul_f32 v245, v244, v245
v_mul_f32 v231, v244, v231
v_cvt_pk_bf16_f32 v34, v245, v231
v_lshlrev_b32 v245, 16, v35
v_and_b32 v231, 0xffff0000, v35
v_mul_f32 v245, v244, v245
v_mul_f32 v231, v244, v231
v_cvt_pk_bf16_f32 v35, v245, v231
s_nop 1
s_branch L_back0_3
L_rare0_4:
s_mov_b32 s65, 0xff800000
v_max3_f32 v244, v96, v97, v98
v_max3_f32 v244, v99, v100, v244
v_max3_f32 v244, v101, v102, v244
v_max3_f32 v244, v103, v244, v232
v_mov_b32 v245, v244
s_nop 1
v_permlane32_swap_b32 v244, v245
v_max_f32 v244, v244, v245
v_mov_b32 v245, v244
s_nop 1
v_permlane16_swap_b32 v244, v245
v_max_f32 v244, v244, v245
v_sub_f32 v96, v96, v244
v_sub_f32 v97, v97, v244
v_sub_f32 v98, v98, v244
v_sub_f32 v99, v99, v244
v_sub_f32 v100, v100, v244
v_sub_f32 v101, v101, v244
v_sub_f32 v102, v102, v244
v_sub_f32 v103, v103, v244
v_sub_f32 v245, v232, v244
v_mov_b32 v232, v244
v_exp_f32 v244, v245
v_lshlrev_b32 v245, 16, v0
v_and_b32 v231, 0xffff0000, v0
v_mul_f32 v245, v244, v245
v_mul_f32 v231, v244, v231
v_cvt_pk_bf16_f32 v0, v245, v231
v_lshlrev_b32 v245, 16, v1
v_and_b32 v231, 0xffff0000, v1
v_mul_f32 v245, v244, v245
v_mul_f32 v231, v244, v231
v_cvt_pk_bf16_f32 v1, v245, v231
v_lshlrev_b32 v245, 16, v2
v_and_b32 v231, 0xffff0000, v2
v_mul_f32 v245, v244, v245
v_mul_f32 v231, v244, v231
v_cvt_pk_bf16_f32 v2, v245, v231
v_lshlrev_b32 v245, 16, v3
v_and_b32 v231, 0xffff0000, v3
v_mul_f32 v245, v244, v245
v_mul_f32 v231, v244, v231
v_cvt_pk_bf16_f32 v3, v245, v231
v_lshlrev_b32 v245, 16, v12
v_and_b32 v231, 0xffff0000, v12
v_mul_f32 v245, v244, v245
v_mul_f32 v231, v244, v231
v_cvt_pk_bf16_f32 v12, v245, v231
v_lshlrev_b32 v245, 16, v13
v_and_b32 v231, 0xffff0000, v13
v_mul_f32 v245, v244, v245
v_mul_f32 v231, v244, v231
v_cvt_pk_bf16_f32 v13, v245, v231
v_lshlrev_b32 v245, 16, v14
v_and_b32 v231, 0xffff0000, v14
v_mul_f32 v245, v244, v245
v_mul_f32 v231, v244, v231
v_cvt_pk_bf16_f32 v14, v245, v231
v_lshlrev_b32 v245, 16, v15
v_and_b32 v231, 0xffff0000, v15
v_mul_f32 v245, v244, v245
v_mul_f32 v231, v244, v231
v_cvt_pk_bf16_f32 v15, v245, v231
v_lshlrev_b32 v245, 16, v24
v_and_b32 v231, 0xffff0000, v24
v_mul_f32 v245, v244, v245
v_mul_f32 v231, v244, v231
v_cvt_pk_bf16_f32 v24, v245, v231
v_lshlrev_b32 v245, 16, v25
v_and_b32 v231, 0xffff0000, v25
v_mul_f32 v245, v244, v245
v_mul_f32 v231, v244, v231
v_cvt_pk_bf16_f32 v25, v245, v231
v_lshlrev_b32 v245, 16, v26
v_and_b32 v231, 0xffff0000, v26
v_mul_f32 v245, v244, v245
v_mul_f32 v231, v244, v231
v_cvt_pk_bf16_f32 v26, v245, v231
v_lshlrev_b32 v245, 16, v27
v_and_b32 v231, 0xffff0000, v27
v_mul_f32 v245, v244, v245
v_mul_f32 v231, v244, v231
v_cvt_pk_bf16_f32 v27, v245, v231
v_lshlrev_b32 v245, 16, v36
v_and_b32 v231, 0xffff0000, v36
v_mul_f32 v245, v244, v245
v_mul_f32 v231, v244, v231
v_cvt_pk_bf16_f32 v36, v245, v231
v_lshlrev_b32 v245, 16, v37
v_and_b32 v231, 0xffff0000, v37
v_mul_f32 v245, v244, v245
v_mul_f32 v231, v244, v231
v_cvt_pk_bf16_f32 v37, v245, v231
v_lshlrev_b32 v245, 16, v38
v_and_b32 v231, 0xffff0000, v38
v_mul_f32 v245, v244, v245
v_mul_f32 v231, v244, v231
v_cvt_pk_bf16_f32 v38, v245, v231
v_lshlrev_b32 v245, 16, v39
v_and_b32 v231, 0xffff0000, v39
v_mul_f32 v245, v244, v245
v_mul_f32 v231, v244, v231
v_cvt_pk_bf16_f32 v39, v245, v231
v_max3_f32 v244, v104, v105, v106
v_max3_f32 v244, v107, v108, v244
v_max3_f32 v244, v109, v110, v244
v_max3_f32 v244, v111, v244, v233
v_mov_b32 v245, v244
s_nop 1
v_permlane32_swap_b32 v244, v245
v_max_f32 v244, v244, v245
v_mov_b32 v245, v244
s_nop 1
v_permlane16_swap_b32 v244, v245
v_max_f32 v244, v244, v245
v_sub_f32 v104, v104, v244
v_sub_f32 v105, v105, v244
v_sub_f32 v106, v106, v244
v_sub_f32 v107, v107, v244
v_sub_f32 v108, v108, v244
v_sub_f32 v109, v109, v244
v_sub_f32 v110, v110, v244
v_sub_f32 v111, v111, v244
v_sub_f32 v245, v233, v244
v_mov_b32 v233, v244
v_exp_f32 v244, v245
v_lshlrev_b32 v245, 16, v4
v_and_b32 v231, 0xffff0000, v4
v_mul_f32 v245, v244, v245
v_mul_f32 v231, v244, v231
v_cvt_pk_bf16_f32 v4, v245, v231
v_lshlrev_b32 v245, 16, v5
v_and_b32 v231, 0xffff0000, v5
v_mul_f32 v245, v244, v245
v_mul_f32 v231, v244, v231
v_cvt_pk_bf16_f32 v5, v245, v231
v_lshlrev_b32 v245, 16, v6
v_and_b32 v231, 0xffff0000, v6
v_mul_f32 v245, v244, v245
v_mul_f32 v231, v244, v231
v_cvt_pk_bf16_f32 v6, v245, v231
v_lshlrev_b32 v245, 16, v7
v_and_b32 v231, 0xffff0000, v7
v_mul_f32 v245, v244, v245
v_mul_f32 v231, v244, v231
v_cvt_pk_bf16_f32 v7, v245, v231
v_lshlrev_b32 v245, 16, v16
v_and_b32 v231, 0xffff0000, v16
v_mul_f32 v245, v244, v245
v_mul_f32 v231, v244, v231
v_cvt_pk_bf16_f32 v16, v245, v231
v_lshlrev_b32 v245, 16, v17
v_and_b32 v231, 0xffff0000, v17
v_mul_f32 v245, v244, v245
v_mul_f32 v231, v244, v231
v_cvt_pk_bf16_f32 v17, v245, v231
v_lshlrev_b32 v245, 16, v18
v_and_b32 v231, 0xffff0000, v18
v_mul_f32 v245, v244, v245
v_mul_f32 v231, v244, v231
v_cvt_pk_bf16_f32 v18, v245, v231
v_lshlrev_b32 v245, 16, v19
v_and_b32 v231, 0xffff0000, v19
v_mul_f32 v245, v244, v245
v_mul_f32 v231, v244, v231
v_cvt_pk_bf16_f32 v19, v245, v231
v_lshlrev_b32 v245, 16, v28
v_and_b32 v231, 0xffff0000, v28
v_mul_f32 v245, v244, v245
v_mul_f32 v231, v244, v231
v_cvt_pk_bf16_f32 v28, v245, v231
v_lshlrev_b32 v245, 16, v29
v_and_b32 v231, 0xffff0000, v29
v_mul_f32 v245, v244, v245
v_mul_f32 v231, v244, v231
v_cvt_pk_bf16_f32 v29, v245, v231
v_lshlrev_b32 v245, 16, v30
v_and_b32 v231, 0xffff0000, v30
v_mul_f32 v245, v244, v245
v_mul_f32 v231, v244, v231
v_cvt_pk_bf16_f32 v30, v245, v231
v_lshlrev_b32 v245, 16, v31
v_and_b32 v231, 0xffff0000, v31
v_mul_f32 v245, v244, v245
v_mul_f32 v231, v244, v231
v_cvt_pk_bf16_f32 v31, v245, v231
v_lshlrev_b32 v245, 16, v40
v_and_b32 v231, 0xffff0000, v40
v_mul_f32 v245, v244, v245
v_mul_f32 v231, v244, v231
v_cvt_pk_bf16_f32 v40, v245, v231
v_lshlrev_b32 v245, 16, v41
v_and_b32 v231, 0xffff0000, v41
v_mul_f32 v245, v244, v245
v_mul_f32 v231, v244, v231
v_cvt_pk_bf16_f32 v41, v245, v231
v_lshlrev_b32 v245, 16, v42
v_and_b32 v231, 0xffff0000, v42
v_mul_f32 v245, v244, v245
v_mul_f32 v231, v244, v231
v_cvt_pk_bf16_f32 v42, v245, v231
v_lshlrev_b32 v245, 16, v43
v_and_b32 v231, 0xffff0000, v43
v_mul_f32 v245, v244, v245
v_mul_f32 v231, v244, v231
v_cvt_pk_bf16_f32 v43, v245, v231
v_max3_f32 v244, v112, v113, v114
v_max3_f32 v244, v115, v116, v244
v_max3_f32 v244, v117, v118, v244
v_max3_f32 v244, v119, v244, v234
v_mov_b32 v245, v244
s_nop 1
v_permlane32_swap_b32 v244, v245
v_max_f32 v244, v244, v245
v_mov_b32 v245, v244
s_nop 1
v_permlane16_swap_b32 v244, v245
v_max_f32 v244, v244, v245
v_sub_f32 v112, v112, v244
v_sub_f32 v113, v113, v244
v_sub_f32 v114, v114, v244
v_sub_f32 v115, v115, v244
v_sub_f32 v116, v116, v244
v_sub_f32 v117, v117, v244
v_sub_f32 v118, v118, v244
v_sub_f32 v119, v119, v244
v_sub_f32 v245, v234, v244
v_mov_b32 v234, v244
v_exp_f32 v244, v245
v_lshlrev_b32 v245, 16, v8
v_and_b32 v231, 0xffff0000, v8
v_mul_f32 v245, v244, v245
v_mul_f32 v231, v244, v231
v_cvt_pk_bf16_f32 v8, v245, v231
v_lshlrev_b32 v245, 16, v9
v_and_b32 v231, 0xffff0000, v9
v_mul_f32 v245, v244, v245
v_mul_f32 v231, v244, v231
v_cvt_pk_bf16_f32 v9, v245, v231
v_lshlrev_b32 v245, 16, v10
v_and_b32 v231, 0xffff0000, v10
v_mul_f32 v245, v244, v245
v_mul_f32 v231, v244, v231
v_cvt_pk_bf16_f32 v10, v245, v231
v_lshlrev_b32 v245, 16, v11
v_and_b32 v231, 0xffff0000, v11
v_mul_f32 v245, v244, v245
v_mul_f32 v231, v244, v231
v_cvt_pk_bf16_f32 v11, v245, v231
v_lshlrev_b32 v245, 16, v20
v_and_b32 v231, 0xffff0000, v20
v_mul_f32 v245, v244, v245
v_mul_f32 v231, v244, v231
v_cvt_pk_bf16_f32 v20, v245, v231
v_lshlrev_b32 v245, 16, v21
v_and_b32 v231, 0xffff0000, v21
v_mul_f32 v245, v244, v245
v_mul_f32 v231, v244, v231
v_cvt_pk_bf16_f32 v21, v245, v231
v_lshlrev_b32 v245, 16, v22
v_and_b32 v231, 0xffff0000, v22
v_mul_f32 v245, v244, v245
v_mul_f32 v231, v244, v231
v_cvt_pk_bf16_f32 v22, v245, v231
v_lshlrev_b32 v245, 16, v23
v_and_b32 v231, 0xffff0000, v23
v_mul_f32 v245, v244, v245
v_mul_f32 v231, v244, v231
v_cvt_pk_bf16_f32 v23, v245, v231
v_lshlrev_b32 v245, 16, v32
v_and_b32 v231, 0xffff0000, v32
v_mul_f32 v245, v244, v245
v_mul_f32 v231, v244, v231
v_cvt_pk_bf16_f32 v32, v245, v231
v_lshlrev_b32 v245, 16, v33
v_and_b32 v231, 0xffff0000, v33
v_mul_f32 v245, v244, v245
v_mul_f32 v231, v244, v231
v_cvt_pk_bf16_f32 v33, v245, v231
v_lshlrev_b32 v245, 16, v34
v_and_b32 v231, 0xffff0000, v34
v_mul_f32 v245, v244, v245
v_mul_f32 v231, v244, v231
v_cvt_pk_bf16_f32 v34, v245, v231
v_lshlrev_b32 v245, 16, v35
v_and_b32 v231, 0xffff0000, v35
v_mul_f32 v245, v244, v245
v_mul_f32 v231, v244, v231
v_cvt_pk_bf16_f32 v35, v245, v231
v_lshlrev_b32 v245, 16, v44
v_and_b32 v231, 0xffff0000, v44
v_mul_f32 v245, v244, v245
v_mul_f32 v231, v244, v231
v_cvt_pk_bf16_f32 v44, v245, v231
v_lshlrev_b32 v245, 16, v45
v_and_b32 v231, 0xffff0000, v45
v_mul_f32 v245, v244, v245
v_mul_f32 v231, v244, v231
v_cvt_pk_bf16_f32 v45, v245, v231
v_lshlrev_b32 v245, 16, v46
v_and_b32 v231, 0xffff0000, v46
v_mul_f32 v245, v244, v245
v_mul_f32 v231, v244, v231
v_cvt_pk_bf16_f32 v46, v245, v231
v_lshlrev_b32 v245, 16, v47
v_and_b32 v231, 0xffff0000, v47
v_mul_f32 v245, v244, v245
v_mul_f32 v231, v244, v231
v_cvt_pk_bf16_f32 v47, v245, v231
s_nop 1
s_branch L_back0_4
L_rare0_5:
s_mov_b32 s65, 0xff800000
v_max3_f32 v244, v120, v121, v122
v_max3_f32 v244, v123, v124, v244
v_max3_f32 v244, v125, v126, v244
v_max3_f32 v244, v127, v244, v232
v_mov_b32 v245, v244
s_nop 1
v_permlane32_swap_b32 v244, v245
v_max_f32 v244, v244, v245
v_mov_b32 v245, v244
s_nop 1
v_permlane16_swap_b32 v244, v245
v_max_f32 v244, v244, v245
v_sub_f32 v120, v120, v244
v_sub_f32 v121, v121, v244
v_sub_f32 v122, v122, v244
v_sub_f32 v123, v123, v244
v_sub_f32 v124, v124, v244
v_sub_f32 v125, v125, v244
v_sub_f32 v126, v126, v244
v_sub_f32 v127, v127, v244
v_sub_f32 v245, v232, v244
v_mov_b32 v232, v244
v_exp_f32 v244, v245
v_lshlrev_b32 v245, 16, v0
v_and_b32 v231, 0xffff0000, v0
v_mul_f32 v245, v244, v245
v_mul_f32 v231, v244, v231
v_cvt_pk_bf16_f32 v0, v245, v231
v_lshlrev_b32 v245, 16, v1
v_and_b32 v231, 0xffff0000, v1
v_mul_f32 v245, v244, v245
v_mul_f32 v231, v244, v231
v_cvt_pk_bf16_f32 v1, v245, v231
v_lshlrev_b32 v245, 16, v2
v_and_b32 v231, 0xffff0000, v2
v_mul_f32 v245, v244, v245
v_mul_f32 v231, v244, v231
v_cvt_pk_bf16_f32 v2, v245, v231
v_lshlrev_b32 v245, 16, v3
v_and_b32 v231, 0xffff0000, v3
v_mul_f32 v245, v244, v245
v_mul_f32 v231, v244, v231
v_cvt_pk_bf16_f32 v3, v245, v231
v_lshlrev_b32 v245, 16, v12
v_and_b32 v231, 0xffff0000, v12
v_mul_f32 v245, v244, v245
v_mul_f32 v231, v244, v231
v_cvt_pk_bf16_f32 v12, v245, v231
v_lshlrev_b32 v245, 16, v13
v_and_b32 v231, 0xffff0000, v13
v_mul_f32 v245, v244, v245
v_mul_f32 v231, v244, v231
v_cvt_pk_bf16_f32 v13, v245, v231
v_lshlrev_b32 v245, 16, v14
v_and_b32 v231, 0xffff0000, v14
v_mul_f32 v245, v244, v245
v_mul_f32 v231, v244, v231
v_cvt_pk_bf16_f32 v14, v245, v231
v_lshlrev_b32 v245, 16, v15
v_and_b32 v231, 0xffff0000, v15
v_mul_f32 v245, v244, v245
v_mul_f32 v231, v244, v231
v_cvt_pk_bf16_f32 v15, v245, v231
v_lshlrev_b32 v245, 16, v24
v_and_b32 v231, 0xffff0000, v24
v_mul_f32 v245, v244, v245
v_mul_f32 v231, v244, v231
v_cvt_pk_bf16_f32 v24, v245, v231
v_lshlrev_b32 v245, 16, v25
v_and_b32 v231, 0xffff0000, v25
v_mul_f32 v245, v244, v245
v_mul_f32 v231, v244, v231
v_cvt_pk_bf16_f32 v25, v245, v231
v_lshlrev_b32 v245, 16, v26
v_and_b32 v231, 0xffff0000, v26
v_mul_f32 v245, v244, v245
v_mul_f32 v231, v244, v231
v_cvt_pk_bf16_f32 v26, v245, v231
v_lshlrev_b32 v245, 16, v27
v_and_b32 v231, 0xffff0000, v27
v_mul_f32 v245, v244, v245
v_mul_f32 v231, v244, v231
v_cvt_pk_bf16_f32 v27, v245, v231
v_lshlrev_b32 v245, 16, v36
v_and_b32 v231, 0xffff0000, v36
v_mul_f32 v245, v244, v245
v_mul_f32 v231, v244, v231
v_cvt_pk_bf16_f32 v36, v245, v231
v_lshlrev_b32 v245, 16, v37
v_and_b32 v231, 0xffff0000, v37
v_mul_f32 v245, v244, v245
v_mul_f32 v231, v244, v231
v_cvt_pk_bf16_f32 v37, v245, v231
v_lshlrev_b32 v245, 16, v38
v_and_b32 v231, 0xffff0000, v38
v_mul_f32 v245, v244, v245
v_mul_f32 v231, v244, v231
v_cvt_pk_bf16_f32 v38, v245, v231
v_lshlrev_b32 v245, 16, v39
v_and_b32 v231, 0xffff0000, v39
v_mul_f32 v245, v244, v245
v_mul_f32 v231, v244, v231
v_cvt_pk_bf16_f32 v39, v245, v231
v_lshlrev_b32 v245, 16, v48
v_and_b32 v231, 0xffff0000, v48
v_mul_f32 v245, v244, v245
v_mul_f32 v231, v244, v231
v_cvt_pk_bf16_f32 v48, v245, v231
v_lshlrev_b32 v245, 16, v49
v_and_b32 v231, 0xffff0000, v49
v_mul_f32 v245, v244, v245
v_mul_f32 v231, v244, v231
v_cvt_pk_bf16_f32 v49, v245, v231
v_lshlrev_b32 v245, 16, v50
v_and_b32 v231, 0xffff0000, v50
v_mul_f32 v245, v244, v245
v_mul_f32 v231, v244, v231
v_cvt_pk_bf16_f32 v50, v245, v231
v_lshlrev_b32 v245, 16, v51
v_and_b32 v231, 0xffff0000, v51
v_mul_f32 v245, v244, v245
v_mul_f32 v231, v244, v231
v_cvt_pk_bf16_f32 v51, v245, v231
v_max3_f32 v244, v128, v129, v130
v_max3_f32 v244, v131, v132, v244
v_max3_f32 v244, v133, v134, v244
v_max3_f32 v244, v135, v244, v233
v_mov_b32 v245, v244
s_nop 1
v_permlane32_swap_b32 v244, v245
v_max_f32 v244, v244, v245
v_mov_b32 v245, v244
s_nop 1
v_permlane16_swap_b32 v244, v245
v_max_f32 v244, v244, v245
v_sub_f32 v128, v128, v244
v_sub_f32 v129, v129, v244
v_sub_f32 v130, v130, v244
v_sub_f32 v131, v131, v244
v_sub_f32 v132, v132, v244
v_sub_f32 v133, v133, v244
v_sub_f32 v134, v134, v244
v_sub_f32 v135, v135, v244
v_sub_f32 v245, v233, v244
v_mov_b32 v233, v244
v_exp_f32 v244, v245
v_lshlrev_b32 v245, 16, v4
v_and_b32 v231, 0xffff0000, v4
v_mul_f32 v245, v244, v245
v_mul_f32 v231, v244, v231
v_cvt_pk_bf16_f32 v4, v245, v231
v_lshlrev_b32 v245, 16, v5
v_and_b32 v231, 0xffff0000, v5
v_mul_f32 v245, v244, v245
v_mul_f32 v231, v244, v231
v_cvt_pk_bf16_f32 v5, v245, v231
v_lshlrev_b32 v245, 16, v6
v_and_b32 v231, 0xffff0000, v6
v_mul_f32 v245, v244, v245
v_mul_f32 v231, v244, v231
v_cvt_pk_bf16_f32 v6, v245, v231
v_lshlrev_b32 v245, 16, v7
v_and_b32 v231, 0xffff0000, v7
v_mul_f32 v245, v244, v245
v_mul_f32 v231, v244, v231
v_cvt_pk_bf16_f32 v7, v245, v231
v_lshlrev_b32 v245, 16, v16
v_and_b32 v231, 0xffff0000, v16
v_mul_f32 v245, v244, v245
v_mul_f32 v231, v244, v231
v_cvt_pk_bf16_f32 v16, v245, v231
v_lshlrev_b32 v245, 16, v17
v_and_b32 v231, 0xffff0000, v17
v_mul_f32 v245, v244, v245
v_mul_f32 v231, v244, v231
v_cvt_pk_bf16_f32 v17, v245, v231
v_lshlrev_b32 v245, 16, v18
v_and_b32 v231, 0xffff0000, v18
v_mul_f32 v245, v244, v245
v_mul_f32 v231, v244, v231
v_cvt_pk_bf16_f32 v18, v245, v231
v_lshlrev_b32 v245, 16, v19
v_and_b32 v231, 0xffff0000, v19
v_mul_f32 v245, v244, v245
v_mul_f32 v231, v244, v231
v_cvt_pk_bf16_f32 v19, v245, v231
v_lshlrev_b32 v245, 16, v28
v_and_b32 v231, 0xffff0000, v28
v_mul_f32 v245, v244, v245
v_mul_f32 v231, v244, v231
v_cvt_pk_bf16_f32 v28, v245, v231
v_lshlrev_b32 v245, 16, v29
v_and_b32 v231, 0xffff0000, v29
v_mul_f32 v245, v244, v245
v_mul_f32 v231, v244, v231
v_cvt_pk_bf16_f32 v29, v245, v231
v_lshlrev_b32 v245, 16, v30
v_and_b32 v231, 0xffff0000, v30
v_mul_f32 v245, v244, v245
v_mul_f32 v231, v244, v231
v_cvt_pk_bf16_f32 v30, v245, v231
v_lshlrev_b32 v245, 16, v31
v_and_b32 v231, 0xffff0000, v31
v_mul_f32 v245, v244, v245
v_mul_f32 v231, v244, v231
v_cvt_pk_bf16_f32 v31, v245, v231
v_lshlrev_b32 v245, 16, v40
v_and_b32 v231, 0xffff0000, v40
v_mul_f32 v245, v244, v245
v_mul_f32 v231, v244, v231
v_cvt_pk_bf16_f32 v40, v245, v231
v_lshlrev_b32 v245, 16, v41
v_and_b32 v231, 0xffff0000, v41
v_mul_f32 v245, v244, v245
v_mul_f32 v231, v244, v231
v_cvt_pk_bf16_f32 v41, v245, v231
v_lshlrev_b32 v245, 16, v42
v_and_b32 v231, 0xffff0000, v42
v_mul_f32 v245, v244, v245
v_mul_f32 v231, v244, v231
v_cvt_pk_bf16_f32 v42, v245, v231
v_lshlrev_b32 v245, 16, v43
v_and_b32 v231, 0xffff0000, v43
v_mul_f32 v245, v244, v245
v_mul_f32 v231, v244, v231
v_cvt_pk_bf16_f32 v43, v245, v231
v_lshlrev_b32 v245, 16, v52
v_and_b32 v231, 0xffff0000, v52
v_mul_f32 v245, v244, v245
v_mul_f32 v231, v244, v231
v_cvt_pk_bf16_f32 v52, v245, v231
v_lshlrev_b32 v245, 16, v53
v_and_b32 v231, 0xffff0000, v53
v_mul_f32 v245, v244, v245
v_mul_f32 v231, v244, v231
v_cvt_pk_bf16_f32 v53, v245, v231
v_lshlrev_b32 v245, 16, v54
v_and_b32 v231, 0xffff0000, v54
v_mul_f32 v245, v244, v245
v_mul_f32 v231, v244, v231
v_cvt_pk_bf16_f32 v54, v245, v231
v_lshlrev_b32 v245, 16, v55
v_and_b32 v231, 0xffff0000, v55
v_mul_f32 v245, v244, v245
v_mul_f32 v231, v244, v231
v_cvt_pk_bf16_f32 v55, v245, v231
v_max3_f32 v244, v136, v137, v138
v_max3_f32 v244, v139, v140, v244
v_max3_f32 v244, v141, v142, v244
v_max3_f32 v244, v143, v244, v234
v_mov_b32 v245, v244
s_nop 1
v_permlane32_swap_b32 v244, v245
v_max_f32 v244, v244, v245
v_mov_b32 v245, v244
s_nop 1
v_permlane16_swap_b32 v244, v245
v_max_f32 v244, v244, v245
v_sub_f32 v136, v136, v244
v_sub_f32 v137, v137, v244
v_sub_f32 v138, v138, v244
v_sub_f32 v139, v139, v244
v_sub_f32 v140, v140, v244
v_sub_f32 v141, v141, v244
v_sub_f32 v142, v142, v244
v_sub_f32 v143, v143, v244
v_sub_f32 v245, v234, v244
v_mov_b32 v234, v244
v_exp_f32 v244, v245
v_lshlrev_b32 v245, 16, v8
v_and_b32 v231, 0xffff0000, v8
v_mul_f32 v245, v244, v245
v_mul_f32 v231, v244, v231
v_cvt_pk_bf16_f32 v8, v245, v231
v_lshlrev_b32 v245, 16, v9
v_and_b32 v231, 0xffff0000, v9
v_mul_f32 v245, v244, v245
v_mul_f32 v231, v244, v231
v_cvt_pk_bf16_f32 v9, v245, v231
v_lshlrev_b32 v245, 16, v10
v_and_b32 v231, 0xffff0000, v10
v_mul_f32 v245, v244, v245
v_mul_f32 v231, v244, v231
v_cvt_pk_bf16_f32 v10, v245, v231
v_lshlrev_b32 v245, 16, v11
v_and_b32 v231, 0xffff0000, v11
v_mul_f32 v245, v244, v245
v_mul_f32 v231, v244, v231
v_cvt_pk_bf16_f32 v11, v245, v231
v_lshlrev_b32 v245, 16, v20
v_and_b32 v231, 0xffff0000, v20
v_mul_f32 v245, v244, v245
v_mul_f32 v231, v244, v231
v_cvt_pk_bf16_f32 v20, v245, v231
v_lshlrev_b32 v245, 16, v21
v_and_b32 v231, 0xffff0000, v21
v_mul_f32 v245, v244, v245
v_mul_f32 v231, v244, v231
v_cvt_pk_bf16_f32 v21, v245, v231
v_lshlrev_b32 v245, 16, v22
v_and_b32 v231, 0xffff0000, v22
v_mul_f32 v245, v244, v245
v_mul_f32 v231, v244, v231
v_cvt_pk_bf16_f32 v22, v245, v231
v_lshlrev_b32 v245, 16, v23
v_and_b32 v231, 0xffff0000, v23
v_mul_f32 v245, v244, v245
v_mul_f32 v231, v244, v231
v_cvt_pk_bf16_f32 v23, v245, v231
v_lshlrev_b32 v245, 16, v32
v_and_b32 v231, 0xffff0000, v32
v_mul_f32 v245, v244, v245
v_mul_f32 v231, v244, v231
v_cvt_pk_bf16_f32 v32, v245, v231
v_lshlrev_b32 v245, 16, v33
v_and_b32 v231, 0xffff0000, v33
v_mul_f32 v245, v244, v245
v_mul_f32 v231, v244, v231
v_cvt_pk_bf16_f32 v33, v245, v231
v_lshlrev_b32 v245, 16, v34
v_and_b32 v231, 0xffff0000, v34
v_mul_f32 v245, v244, v245
v_mul_f32 v231, v244, v231
v_cvt_pk_bf16_f32 v34, v245, v231
v_lshlrev_b32 v245, 16, v35
v_and_b32 v231, 0xffff0000, v35
v_mul_f32 v245, v244, v245
v_mul_f32 v231, v244, v231
v_cvt_pk_bf16_f32 v35, v245, v231
v_lshlrev_b32 v245, 16, v44
v_and_b32 v231, 0xffff0000, v44
v_mul_f32 v245, v244, v245
v_mul_f32 v231, v244, v231
v_cvt_pk_bf16_f32 v44, v245, v231
v_lshlrev_b32 v245, 16, v45
v_and_b32 v231, 0xffff0000, v45
v_mul_f32 v245, v244, v245
v_mul_f32 v231, v244, v231
v_cvt_pk_bf16_f32 v45, v245, v231
v_lshlrev_b32 v245, 16, v46
v_and_b32 v231, 0xffff0000, v46
v_mul_f32 v245, v244, v245
v_mul_f32 v231, v244, v231
v_cvt_pk_bf16_f32 v46, v245, v231
v_lshlrev_b32 v245, 16, v47
v_and_b32 v231, 0xffff0000, v47
v_mul_f32 v245, v244, v245
v_mul_f32 v231, v244, v231
v_cvt_pk_bf16_f32 v47, v245, v231
v_lshlrev_b32 v245, 16, v56
v_and_b32 v231, 0xffff0000, v56
v_mul_f32 v245, v244, v245
v_mul_f32 v231, v244, v231
v_cvt_pk_bf16_f32 v56, v245, v231
v_lshlrev_b32 v245, 16, v57
v_and_b32 v231, 0xffff0000, v57
v_mul_f32 v245, v244, v245
v_mul_f32 v231, v244, v231
v_cvt_pk_bf16_f32 v57, v245, v231
v_lshlrev_b32 v245, 16, v58
v_and_b32 v231, 0xffff0000, v58
v_mul_f32 v245, v244, v245
v_mul_f32 v231, v244, v231
v_cvt_pk_bf16_f32 v58, v245, v231
v_lshlrev_b32 v245, 16, v59
v_and_b32 v231, 0xffff0000, v59
v_mul_f32 v245, v244, v245
v_mul_f32 v231, v244, v231
v_cvt_pk_bf16_f32 v59, v245, v231
s_nop 1
s_branch L_back0_5
L_rare0_6:
s_mov_b32 s65, 0xff800000
v_max3_f32 v244, v144, v145, v146
v_max3_f32 v244, v147, v148, v244
v_max3_f32 v244, v149, v150, v244
v_max3_f32 v244, v151, v244, v232
v_mov_b32 v245, v244
s_nop 1
v_permlane32_swap_b32 v244, v245
v_max_f32 v244, v244, v245
v_mov_b32 v245, v244
s_nop 1
v_permlane16_swap_b32 v244, v245
v_max_f32 v244, v244, v245
v_sub_f32 v144, v144, v244
v_sub_f32 v145, v145, v244
v_sub_f32 v146, v146, v244
v_sub_f32 v147, v147, v244
v_sub_f32 v148, v148, v244
v_sub_f32 v149, v149, v244
v_sub_f32 v150, v150, v244
v_sub_f32 v151, v151, v244
v_sub_f32 v245, v232, v244
v_mov_b32 v232, v244
v_exp_f32 v244, v245
v_lshlrev_b32 v245, 16, v0
v_and_b32 v231, 0xffff0000, v0
v_mul_f32 v245, v244, v245
v_mul_f32 v231, v244, v231
v_cvt_pk_bf16_f32 v0, v245, v231
v_lshlrev_b32 v245, 16, v1
v_and_b32 v231, 0xffff0000, v1
v_mul_f32 v245, v244, v245
v_mul_f32 v231, v244, v231
v_cvt_pk_bf16_f32 v1, v245, v231
v_lshlrev_b32 v245, 16, v2
v_and_b32 v231, 0xffff0000, v2
v_mul_f32 v245, v244, v245
v_mul_f32 v231, v244, v231
v_cvt_pk_bf16_f32 v2, v245, v231
v_lshlrev_b32 v245, 16, v3
v_and_b32 v231, 0xffff0000, v3
v_mul_f32 v245, v244, v245
v_mul_f32 v231, v244, v231
v_cvt_pk_bf16_f32 v3, v245, v231
v_lshlrev_b32 v245, 16, v12
v_and_b32 v231, 0xffff0000, v12
v_mul_f32 v245, v244, v245
v_mul_f32 v231, v244, v231
v_cvt_pk_bf16_f32 v12, v245, v231
v_lshlrev_b32 v245, 16, v13
v_and_b32 v231, 0xffff0000, v13
v_mul_f32 v245, v244, v245
v_mul_f32 v231, v244, v231
v_cvt_pk_bf16_f32 v13, v245, v231
v_lshlrev_b32 v245, 16, v14
v_and_b32 v231, 0xffff0000, v14
v_mul_f32 v245, v244, v245
v_mul_f32 v231, v244, v231
v_cvt_pk_bf16_f32 v14, v245, v231
v_lshlrev_b32 v245, 16, v15
v_and_b32 v231, 0xffff0000, v15
v_mul_f32 v245, v244, v245
v_mul_f32 v231, v244, v231
v_cvt_pk_bf16_f32 v15, v245, v231
v_lshlrev_b32 v245, 16, v24
v_and_b32 v231, 0xffff0000, v24
v_mul_f32 v245, v244, v245
v_mul_f32 v231, v244, v231
v_cvt_pk_bf16_f32 v24, v245, v231
v_lshlrev_b32 v245, 16, v25
v_and_b32 v231, 0xffff0000, v25
v_mul_f32 v245, v244, v245
v_mul_f32 v231, v244, v231
v_cvt_pk_bf16_f32 v25, v245, v231
v_lshlrev_b32 v245, 16, v26
v_and_b32 v231, 0xffff0000, v26
v_mul_f32 v245, v244, v245
v_mul_f32 v231, v244, v231
v_cvt_pk_bf16_f32 v26, v245, v231
v_lshlrev_b32 v245, 16, v27
v_and_b32 v231, 0xffff0000, v27
v_mul_f32 v245, v244, v245
v_mul_f32 v231, v244, v231
v_cvt_pk_bf16_f32 v27, v245, v231
v_lshlrev_b32 v245, 16, v36
v_and_b32 v231, 0xffff0000, v36
v_mul_f32 v245, v244, v245
v_mul_f32 v231, v244, v231
v_cvt_pk_bf16_f32 v36, v245, v231
v_lshlrev_b32 v245, 16, v37
v_and_b32 v231, 0xffff0000, v37
v_mul_f32 v245, v244, v245
v_mul_f32 v231, v244, v231
v_cvt_pk_bf16_f32 v37, v245, v231
v_lshlrev_b32 v245, 16, v38
v_and_b32 v231, 0xffff0000, v38
v_mul_f32 v245, v244, v245
v_mul_f32 v231, v244, v231
v_cvt_pk_bf16_f32 v38, v245, v231
v_lshlrev_b32 v245, 16, v39
v_and_b32 v231, 0xffff0000, v39
v_mul_f32 v245, v244, v245
v_mul_f32 v231, v244, v231
v_cvt_pk_bf16_f32 v39, v245, v231
v_lshlrev_b32 v245, 16, v48
v_and_b32 v231, 0xffff0000, v48
v_mul_f32 v245, v244, v245
v_mul_f32 v231, v244, v231
v_cvt_pk_bf16_f32 v48, v245, v231
v_lshlrev_b32 v245, 16, v49
v_and_b32 v231, 0xffff0000, v49
v_mul_f32 v245, v244, v245
v_mul_f32 v231, v244, v231
v_cvt_pk_bf16_f32 v49, v245, v231
v_lshlrev_b32 v245, 16, v50
v_and_b32 v231, 0xffff0000, v50
v_mul_f32 v245, v244, v245
v_mul_f32 v231, v244, v231
v_cvt_pk_bf16_f32 v50, v245, v231
v_lshlrev_b32 v245, 16, v51
v_and_b32 v231, 0xffff0000, v51
v_mul_f32 v245, v244, v245
v_mul_f32 v231, v244, v231
v_cvt_pk_bf16_f32 v51, v245, v231
v_lshlrev_b32 v245, 16, v60
v_and_b32 v231, 0xffff0000, v60
v_mul_f32 v245, v244, v245
v_mul_f32 v231, v244, v231
v_cvt_pk_bf16_f32 v60, v245, v231
v_lshlrev_b32 v245, 16, v61
v_and_b32 v231, 0xffff0000, v61
v_mul_f32 v245, v244, v245
v_mul_f32 v231, v244, v231
v_cvt_pk_bf16_f32 v61, v245, v231
v_lshlrev_b32 v245, 16, v62
v_and_b32 v231, 0xffff0000, v62
v_mul_f32 v245, v244, v245
v_mul_f32 v231, v244, v231
v_cvt_pk_bf16_f32 v62, v245, v231
v_lshlrev_b32 v245, 16, v63
v_and_b32 v231, 0xffff0000, v63
v_mul_f32 v245, v244, v245
v_mul_f32 v231, v244, v231
v_cvt_pk_bf16_f32 v63, v245, v231
v_max3_f32 v244, v152, v153, v154
v_max3_f32 v244, v155, v156, v244
v_max3_f32 v244, v157, v158, v244
v_max3_f32 v244, v159, v244, v233
v_mov_b32 v245, v244
s_nop 1
v_permlane32_swap_b32 v244, v245
v_max_f32 v244, v244, v245
v_mov_b32 v245, v244
s_nop 1
v_permlane16_swap_b32 v244, v245
v_max_f32 v244, v244, v245
v_sub_f32 v152, v152, v244
v_sub_f32 v153, v153, v244
v_sub_f32 v154, v154, v244
v_sub_f32 v155, v155, v244
v_sub_f32 v156, v156, v244
v_sub_f32 v157, v157, v244
v_sub_f32 v158, v158, v244
v_sub_f32 v159, v159, v244
v_sub_f32 v245, v233, v244
v_mov_b32 v233, v244
v_exp_f32 v244, v245
v_lshlrev_b32 v245, 16, v4
v_and_b32 v231, 0xffff0000, v4
v_mul_f32 v245, v244, v245
v_mul_f32 v231, v244, v231
v_cvt_pk_bf16_f32 v4, v245, v231
v_lshlrev_b32 v245, 16, v5
v_and_b32 v231, 0xffff0000, v5
v_mul_f32 v245, v244, v245
v_mul_f32 v231, v244, v231
v_cvt_pk_bf16_f32 v5, v245, v231
v_lshlrev_b32 v245, 16, v6
v_and_b32 v231, 0xffff0000, v6
v_mul_f32 v245, v244, v245
v_mul_f32 v231, v244, v231
v_cvt_pk_bf16_f32 v6, v245, v231
v_lshlrev_b32 v245, 16, v7
v_and_b32 v231, 0xffff0000, v7
v_mul_f32 v245, v244, v245
v_mul_f32 v231, v244, v231
v_cvt_pk_bf16_f32 v7, v245, v231
v_lshlrev_b32 v245, 16, v16
v_and_b32 v231, 0xffff0000, v16
v_mul_f32 v245, v244, v245
v_mul_f32 v231, v244, v231
v_cvt_pk_bf16_f32 v16, v245, v231
v_lshlrev_b32 v245, 16, v17
v_and_b32 v231, 0xffff0000, v17
v_mul_f32 v245, v244, v245
v_mul_f32 v231, v244, v231
v_cvt_pk_bf16_f32 v17, v245, v231
v_lshlrev_b32 v245, 16, v18
v_and_b32 v231, 0xffff0000, v18
v_mul_f32 v245, v244, v245
v_mul_f32 v231, v244, v231
v_cvt_pk_bf16_f32 v18, v245, v231
v_lshlrev_b32 v245, 16, v19
v_and_b32 v231, 0xffff0000, v19
v_mul_f32 v245, v244, v245
v_mul_f32 v231, v244, v231
v_cvt_pk_bf16_f32 v19, v245, v231
v_lshlrev_b32 v245, 16, v28
v_and_b32 v231, 0xffff0000, v28
v_mul_f32 v245, v244, v245
v_mul_f32 v231, v244, v231
v_cvt_pk_bf16_f32 v28, v245, v231
v_lshlrev_b32 v245, 16, v29
v_and_b32 v231, 0xffff0000, v29
v_mul_f32 v245, v244, v245
v_mul_f32 v231, v244, v231
v_cvt_pk_bf16_f32 v29, v245, v231
v_lshlrev_b32 v245, 16, v30
v_and_b32 v231, 0xffff0000, v30
v_mul_f32 v245, v244, v245
v_mul_f32 v231, v244, v231
v_cvt_pk_bf16_f32 v30, v245, v231
v_lshlrev_b32 v245, 16, v31
v_and_b32 v231, 0xffff0000, v31
v_mul_f32 v245, v244, v245
v_mul_f32 v231, v244, v231
v_cvt_pk_bf16_f32 v31, v245, v231
v_lshlrev_b32 v245, 16, v40
v_and_b32 v231, 0xffff0000, v40
v_mul_f32 v245, v244, v245
v_mul_f32 v231, v244, v231
v_cvt_pk_bf16_f32 v40, v245, v231
v_lshlrev_b32 v245, 16, v41
v_and_b32 v231, 0xffff0000, v41
v_mul_f32 v245, v244, v245
v_mul_f32 v231, v244, v231
v_cvt_pk_bf16_f32 v41, v245, v231
v_lshlrev_b32 v245, 16, v42
v_and_b32 v231, 0xffff0000, v42
v_mul_f32 v245, v244, v245
v_mul_f32 v231, v244, v231
v_cvt_pk_bf16_f32 v42, v245, v231
v_lshlrev_b32 v245, 16, v43
v_and_b32 v231, 0xffff0000, v43
v_mul_f32 v245, v244, v245
v_mul_f32 v231, v244, v231
v_cvt_pk_bf16_f32 v43, v245, v231
v_lshlrev_b32 v245, 16, v52
v_and_b32 v231, 0xffff0000, v52
v_mul_f32 v245, v244, v245
v_mul_f32 v231, v244, v231
v_cvt_pk_bf16_f32 v52, v245, v231
v_lshlrev_b32 v245, 16, v53
v_and_b32 v231, 0xffff0000, v53
v_mul_f32 v245, v244, v245
v_mul_f32 v231, v244, v231
v_cvt_pk_bf16_f32 v53, v245, v231
v_lshlrev_b32 v245, 16, v54
v_and_b32 v231, 0xffff0000, v54
v_mul_f32 v245, v244, v245
v_mul_f32 v231, v244, v231
v_cvt_pk_bf16_f32 v54, v245, v231
v_lshlrev_b32 v245, 16, v55
v_and_b32 v231, 0xffff0000, v55
v_mul_f32 v245, v244, v245
v_mul_f32 v231, v244, v231
v_cvt_pk_bf16_f32 v55, v245, v231
v_lshlrev_b32 v245, 16, v64
v_and_b32 v231, 0xffff0000, v64
v_mul_f32 v245, v244, v245
v_mul_f32 v231, v244, v231
v_cvt_pk_bf16_f32 v64, v245, v231
v_lshlrev_b32 v245, 16, v65
v_and_b32 v231, 0xffff0000, v65
v_mul_f32 v245, v244, v245
v_mul_f32 v231, v244, v231
v_cvt_pk_bf16_f32 v65, v245, v231
v_lshlrev_b32 v245, 16, v66
v_and_b32 v231, 0xffff0000, v66
v_mul_f32 v245, v244, v245
v_mul_f32 v231, v244, v231
v_cvt_pk_bf16_f32 v66, v245, v231
v_lshlrev_b32 v245, 16, v67
v_and_b32 v231, 0xffff0000, v67
v_mul_f32 v245, v244, v245
v_mul_f32 v231, v244, v231
v_cvt_pk_bf16_f32 v67, v245, v231
v_max3_f32 v244, v160, v161, v162
v_max3_f32 v244, v163, v164, v244
v_max3_f32 v244, v165, v166, v244
v_max3_f32 v244, v167, v244, v234
v_mov_b32 v245, v244
s_nop 1
v_permlane32_swap_b32 v244, v245
v_max_f32 v244, v244, v245
v_mov_b32 v245, v244
s_nop 1
v_permlane16_swap_b32 v244, v245
v_max_f32 v244, v244, v245
v_sub_f32 v160, v160, v244
v_sub_f32 v161, v161, v244
v_sub_f32 v162, v162, v244
v_sub_f32 v163, v163, v244
v_sub_f32 v164, v164, v244
v_sub_f32 v165, v165, v244
v_sub_f32 v166, v166, v244
v_sub_f32 v167, v167, v244
v_sub_f32 v245, v234, v244
v_mov_b32 v234, v244
v_exp_f32 v244, v245
v_lshlrev_b32 v245, 16, v8
v_and_b32 v231, 0xffff0000, v8
v_mul_f32 v245, v244, v245
v_mul_f32 v231, v244, v231
v_cvt_pk_bf16_f32 v8, v245, v231
v_lshlrev_b32 v245, 16, v9
v_and_b32 v231, 0xffff0000, v9
v_mul_f32 v245, v244, v245
v_mul_f32 v231, v244, v231
v_cvt_pk_bf16_f32 v9, v245, v231
v_lshlrev_b32 v245, 16, v10
v_and_b32 v231, 0xffff0000, v10
v_mul_f32 v245, v244, v245
v_mul_f32 v231, v244, v231
v_cvt_pk_bf16_f32 v10, v245, v231
v_lshlrev_b32 v245, 16, v11
v_and_b32 v231, 0xffff0000, v11
v_mul_f32 v245, v244, v245
v_mul_f32 v231, v244, v231
v_cvt_pk_bf16_f32 v11, v245, v231
v_lshlrev_b32 v245, 16, v20
v_and_b32 v231, 0xffff0000, v20
v_mul_f32 v245, v244, v245
v_mul_f32 v231, v244, v231
v_cvt_pk_bf16_f32 v20, v245, v231
v_lshlrev_b32 v245, 16, v21
v_and_b32 v231, 0xffff0000, v21
v_mul_f32 v245, v244, v245
v_mul_f32 v231, v244, v231
v_cvt_pk_bf16_f32 v21, v245, v231
v_lshlrev_b32 v245, 16, v22
v_and_b32 v231, 0xffff0000, v22
v_mul_f32 v245, v244, v245
v_mul_f32 v231, v244, v231
v_cvt_pk_bf16_f32 v22, v245, v231
v_lshlrev_b32 v245, 16, v23
v_and_b32 v231, 0xffff0000, v23
v_mul_f32 v245, v244, v245
v_mul_f32 v231, v244, v231
v_cvt_pk_bf16_f32 v23, v245, v231
v_lshlrev_b32 v245, 16, v32
v_and_b32 v231, 0xffff0000, v32
v_mul_f32 v245, v244, v245
v_mul_f32 v231, v244, v231
v_cvt_pk_bf16_f32 v32, v245, v231
v_lshlrev_b32 v245, 16, v33
v_and_b32 v231, 0xffff0000, v33
v_mul_f32 v245, v244, v245
v_mul_f32 v231, v244, v231
v_cvt_pk_bf16_f32 v33, v245, v231
v_lshlrev_b32 v245, 16, v34
v_and_b32 v231, 0xffff0000, v34
v_mul_f32 v245, v244, v245
v_mul_f32 v231, v244, v231
v_cvt_pk_bf16_f32 v34, v245, v231
v_lshlrev_b32 v245, 16, v35
v_and_b32 v231, 0xffff0000, v35
v_mul_f32 v245, v244, v245
v_mul_f32 v231, v244, v231
v_cvt_pk_bf16_f32 v35, v245, v231
v_lshlrev_b32 v245, 16, v44
v_and_b32 v231, 0xffff0000, v44
v_mul_f32 v245, v244, v245
v_mul_f32 v231, v244, v231
v_cvt_pk_bf16_f32 v44, v245, v231
v_lshlrev_b32 v245, 16, v45
v_and_b32 v231, 0xffff0000, v45
v_mul_f32 v245, v244, v245
v_mul_f32 v231, v244, v231
v_cvt_pk_bf16_f32 v45, v245, v231
v_lshlrev_b32 v245, 16, v46
v_and_b32 v231, 0xffff0000, v46
v_mul_f32 v245, v244, v245
v_mul_f32 v231, v244, v231
v_cvt_pk_bf16_f32 v46, v245, v231
v_lshlrev_b32 v245, 16, v47
v_and_b32 v231, 0xffff0000, v47
v_mul_f32 v245, v244, v245
v_mul_f32 v231, v244, v231
v_cvt_pk_bf16_f32 v47, v245, v231
v_lshlrev_b32 v245, 16, v56
v_and_b32 v231, 0xffff0000, v56
v_mul_f32 v245, v244, v245
v_mul_f32 v231, v244, v231
v_cvt_pk_bf16_f32 v56, v245, v231
v_lshlrev_b32 v245, 16, v57
v_and_b32 v231, 0xffff0000, v57
v_mul_f32 v245, v244, v245
v_mul_f32 v231, v244, v231
v_cvt_pk_bf16_f32 v57, v245, v231
v_lshlrev_b32 v245, 16, v58
v_and_b32 v231, 0xffff0000, v58
v_mul_f32 v245, v244, v245
v_mul_f32 v231, v244, v231
v_cvt_pk_bf16_f32 v58, v245, v231
v_lshlrev_b32 v245, 16, v59
v_and_b32 v231, 0xffff0000, v59
v_mul_f32 v245, v244, v245
v_mul_f32 v231, v244, v231
v_cvt_pk_bf16_f32 v59, v245, v231
v_lshlrev_b32 v245, 16, v68
v_and_b32 v231, 0xffff0000, v68
v_mul_f32 v245, v244, v245
v_mul_f32 v231, v244, v231
v_cvt_pk_bf16_f32 v68, v245, v231
v_lshlrev_b32 v245, 16, v69
v_and_b32 v231, 0xffff0000, v69
v_mul_f32 v245, v244, v245
v_mul_f32 v231, v244, v231
v_cvt_pk_bf16_f32 v69, v245, v231
v_lshlrev_b32 v245, 16, v70
v_and_b32 v231, 0xffff0000, v70
v_mul_f32 v245, v244, v245
v_mul_f32 v231, v244, v231
v_cvt_pk_bf16_f32 v70, v245, v231
v_lshlrev_b32 v245, 16, v71
v_and_b32 v231, 0xffff0000, v71
v_mul_f32 v245, v244, v245
v_mul_f32 v231, v244, v231
v_cvt_pk_bf16_f32 v71, v245, v231
s_nop 1
s_branch L_back0_6
L_rare0_7:
s_mov_b32 s65, 0xff800000
v_max3_f32 v244, v168, v169, v170
v_max3_f32 v244, v171, v172, v244
v_max3_f32 v244, v173, v174, v244
v_max3_f32 v244, v175, v244, v232
v_mov_b32 v245, v244
s_nop 1
v_permlane32_swap_b32 v244, v245
v_max_f32 v244, v244, v245
v_mov_b32 v245, v244
s_nop 1
v_permlane16_swap_b32 v244, v245
v_max_f32 v244, v244, v245
v_sub_f32 v168, v168, v244
v_sub_f32 v169, v169, v244
v_sub_f32 v170, v170, v244
v_sub_f32 v171, v171, v244
v_sub_f32 v172, v172, v244
v_sub_f32 v173, v173, v244
v_sub_f32 v174, v174, v244
v_sub_f32 v175, v175, v244
v_sub_f32 v245, v232, v244
v_mov_b32 v232, v244
v_exp_f32 v244, v245
v_lshlrev_b32 v245, 16, v0
v_and_b32 v231, 0xffff0000, v0
v_mul_f32 v245, v244, v245
v_mul_f32 v231, v244, v231
v_cvt_pk_bf16_f32 v0, v245, v231
v_lshlrev_b32 v245, 16, v1
v_and_b32 v231, 0xffff0000, v1
v_mul_f32 v245, v244, v245
v_mul_f32 v231, v244, v231
v_cvt_pk_bf16_f32 v1, v245, v231
v_lshlrev_b32 v245, 16, v2
v_and_b32 v231, 0xffff0000, v2
v_mul_f32 v245, v244, v245
v_mul_f32 v231, v244, v231
v_cvt_pk_bf16_f32 v2, v245, v231
v_lshlrev_b32 v245, 16, v3
v_and_b32 v231, 0xffff0000, v3
v_mul_f32 v245, v244, v245
v_mul_f32 v231, v244, v231
v_cvt_pk_bf16_f32 v3, v245, v231
v_lshlrev_b32 v245, 16, v12
v_and_b32 v231, 0xffff0000, v12
v_mul_f32 v245, v244, v245
v_mul_f32 v231, v244, v231
v_cvt_pk_bf16_f32 v12, v245, v231
v_lshlrev_b32 v245, 16, v13
v_and_b32 v231, 0xffff0000, v13
v_mul_f32 v245, v244, v245
v_mul_f32 v231, v244, v231
v_cvt_pk_bf16_f32 v13, v245, v231
v_lshlrev_b32 v245, 16, v14
v_and_b32 v231, 0xffff0000, v14
v_mul_f32 v245, v244, v245
v_mul_f32 v231, v244, v231
v_cvt_pk_bf16_f32 v14, v245, v231
v_lshlrev_b32 v245, 16, v15
v_and_b32 v231, 0xffff0000, v15
v_mul_f32 v245, v244, v245
v_mul_f32 v231, v244, v231
v_cvt_pk_bf16_f32 v15, v245, v231
v_lshlrev_b32 v245, 16, v24
v_and_b32 v231, 0xffff0000, v24
v_mul_f32 v245, v244, v245
v_mul_f32 v231, v244, v231
v_cvt_pk_bf16_f32 v24, v245, v231
v_lshlrev_b32 v245, 16, v25
v_and_b32 v231, 0xffff0000, v25
v_mul_f32 v245, v244, v245
v_mul_f32 v231, v244, v231
v_cvt_pk_bf16_f32 v25, v245, v231
v_lshlrev_b32 v245, 16, v26
v_and_b32 v231, 0xffff0000, v26
v_mul_f32 v245, v244, v245
v_mul_f32 v231, v244, v231
v_cvt_pk_bf16_f32 v26, v245, v231
v_lshlrev_b32 v245, 16, v27
v_and_b32 v231, 0xffff0000, v27
v_mul_f32 v245, v244, v245
v_mul_f32 v231, v244, v231
v_cvt_pk_bf16_f32 v27, v245, v231
v_lshlrev_b32 v245, 16, v36
v_and_b32 v231, 0xffff0000, v36
v_mul_f32 v245, v244, v245
v_mul_f32 v231, v244, v231
v_cvt_pk_bf16_f32 v36, v245, v231
v_lshlrev_b32 v245, 16, v37
v_and_b32 v231, 0xffff0000, v37
v_mul_f32 v245, v244, v245
v_mul_f32 v231, v244, v231
v_cvt_pk_bf16_f32 v37, v245, v231
v_lshlrev_b32 v245, 16, v38
v_and_b32 v231, 0xffff0000, v38
v_mul_f32 v245, v244, v245
v_mul_f32 v231, v244, v231
v_cvt_pk_bf16_f32 v38, v245, v231
v_lshlrev_b32 v245, 16, v39
v_and_b32 v231, 0xffff0000, v39
v_mul_f32 v245, v244, v245
v_mul_f32 v231, v244, v231
v_cvt_pk_bf16_f32 v39, v245, v231
v_lshlrev_b32 v245, 16, v48
v_and_b32 v231, 0xffff0000, v48
v_mul_f32 v245, v244, v245
v_mul_f32 v231, v244, v231
v_cvt_pk_bf16_f32 v48, v245, v231
v_lshlrev_b32 v245, 16, v49
v_and_b32 v231, 0xffff0000, v49
v_mul_f32 v245, v244, v245
v_mul_f32 v231, v244, v231
v_cvt_pk_bf16_f32 v49, v245, v231
v_lshlrev_b32 v245, 16, v50
v_and_b32 v231, 0xffff0000, v50
v_mul_f32 v245, v244, v245
v_mul_f32 v231, v244, v231
v_cvt_pk_bf16_f32 v50, v245, v231
v_lshlrev_b32 v245, 16, v51
v_and_b32 v231, 0xffff0000, v51
v_mul_f32 v245, v244, v245
v_mul_f32 v231, v244, v231
v_cvt_pk_bf16_f32 v51, v245, v231
v_lshlrev_b32 v245, 16, v60
v_and_b32 v231, 0xffff0000, v60
v_mul_f32 v245, v244, v245
v_mul_f32 v231, v244, v231
v_cvt_pk_bf16_f32 v60, v245, v231
v_lshlrev_b32 v245, 16, v61
v_and_b32 v231, 0xffff0000, v61
v_mul_f32 v245, v244, v245
v_mul_f32 v231, v244, v231
v_cvt_pk_bf16_f32 v61, v245, v231
v_lshlrev_b32 v245, 16, v62
v_and_b32 v231, 0xffff0000, v62
v_mul_f32 v245, v244, v245
v_mul_f32 v231, v244, v231
v_cvt_pk_bf16_f32 v62, v245, v231
v_lshlrev_b32 v245, 16, v63
v_and_b32 v231, 0xffff0000, v63
v_mul_f32 v245, v244, v245
v_mul_f32 v231, v244, v231
v_cvt_pk_bf16_f32 v63, v245, v231
v_lshlrev_b32 v245, 16, v72
v_and_b32 v231, 0xffff0000, v72
v_mul_f32 v245, v244, v245
v_mul_f32 v231, v244, v231
v_cvt_pk_bf16_f32 v72, v245, v231
v_lshlrev_b32 v245, 16, v73
v_and_b32 v231, 0xffff0000, v73
v_mul_f32 v245, v244, v245
v_mul_f32 v231, v244, v231
v_cvt_pk_bf16_f32 v73, v245, v231
v_lshlrev_b32 v245, 16, v74
v_and_b32 v231, 0xffff0000, v74
v_mul_f32 v245, v244, v245
v_mul_f32 v231, v244, v231
v_cvt_pk_bf16_f32 v74, v245, v231
v_lshlrev_b32 v245, 16, v75
v_and_b32 v231, 0xffff0000, v75
v_mul_f32 v245, v244, v245
v_mul_f32 v231, v244, v231
v_cvt_pk_bf16_f32 v75, v245, v231
v_max3_f32 v244, v176, v177, v178
v_max3_f32 v244, v179, v180, v244
v_max3_f32 v244, v181, v182, v244
v_max3_f32 v244, v183, v244, v233
v_mov_b32 v245, v244
s_nop 1
v_permlane32_swap_b32 v244, v245
v_max_f32 v244, v244, v245
v_mov_b32 v245, v244
s_nop 1
v_permlane16_swap_b32 v244, v245
v_max_f32 v244, v244, v245
v_sub_f32 v176, v176, v244
v_sub_f32 v177, v177, v244
v_sub_f32 v178, v178, v244
v_sub_f32 v179, v179, v244
v_sub_f32 v180, v180, v244
v_sub_f32 v181, v181, v244
v_sub_f32 v182, v182, v244
v_sub_f32 v183, v183, v244
v_sub_f32 v245, v233, v244
v_mov_b32 v233, v244
v_exp_f32 v244, v245
v_lshlrev_b32 v245, 16, v4
v_and_b32 v231, 0xffff0000, v4
v_mul_f32 v245, v244, v245
v_mul_f32 v231, v244, v231
v_cvt_pk_bf16_f32 v4, v245, v231
v_lshlrev_b32 v245, 16, v5
v_and_b32 v231, 0xffff0000, v5
v_mul_f32 v245, v244, v245
v_mul_f32 v231, v244, v231
v_cvt_pk_bf16_f32 v5, v245, v231
v_lshlrev_b32 v245, 16, v6
v_and_b32 v231, 0xffff0000, v6
v_mul_f32 v245, v244, v245
v_mul_f32 v231, v244, v231
v_cvt_pk_bf16_f32 v6, v245, v231
v_lshlrev_b32 v245, 16, v7
v_and_b32 v231, 0xffff0000, v7
v_mul_f32 v245, v244, v245
v_mul_f32 v231, v244, v231
v_cvt_pk_bf16_f32 v7, v245, v231
v_lshlrev_b32 v245, 16, v16
v_and_b32 v231, 0xffff0000, v16
v_mul_f32 v245, v244, v245
v_mul_f32 v231, v244, v231
v_cvt_pk_bf16_f32 v16, v245, v231
v_lshlrev_b32 v245, 16, v17
v_and_b32 v231, 0xffff0000, v17
v_mul_f32 v245, v244, v245
v_mul_f32 v231, v244, v231
v_cvt_pk_bf16_f32 v17, v245, v231
v_lshlrev_b32 v245, 16, v18
v_and_b32 v231, 0xffff0000, v18
v_mul_f32 v245, v244, v245
v_mul_f32 v231, v244, v231
v_cvt_pk_bf16_f32 v18, v245, v231
v_lshlrev_b32 v245, 16, v19
v_and_b32 v231, 0xffff0000, v19
v_mul_f32 v245, v244, v245
v_mul_f32 v231, v244, v231
v_cvt_pk_bf16_f32 v19, v245, v231
v_lshlrev_b32 v245, 16, v28
v_and_b32 v231, 0xffff0000, v28
v_mul_f32 v245, v244, v245
v_mul_f32 v231, v244, v231
v_cvt_pk_bf16_f32 v28, v245, v231
v_lshlrev_b32 v245, 16, v29
v_and_b32 v231, 0xffff0000, v29
v_mul_f32 v245, v244, v245
v_mul_f32 v231, v244, v231
v_cvt_pk_bf16_f32 v29, v245, v231
v_lshlrev_b32 v245, 16, v30
v_and_b32 v231, 0xffff0000, v30
v_mul_f32 v245, v244, v245
v_mul_f32 v231, v244, v231
v_cvt_pk_bf16_f32 v30, v245, v231
v_lshlrev_b32 v245, 16, v31
v_and_b32 v231, 0xffff0000, v31
v_mul_f32 v245, v244, v245
v_mul_f32 v231, v244, v231
v_cvt_pk_bf16_f32 v31, v245, v231
v_lshlrev_b32 v245, 16, v40
v_and_b32 v231, 0xffff0000, v40
v_mul_f32 v245, v244, v245
v_mul_f32 v231, v244, v231
v_cvt_pk_bf16_f32 v40, v245, v231
v_lshlrev_b32 v245, 16, v41
v_and_b32 v231, 0xffff0000, v41
v_mul_f32 v245, v244, v245
v_mul_f32 v231, v244, v231
v_cvt_pk_bf16_f32 v41, v245, v231
v_lshlrev_b32 v245, 16, v42
v_and_b32 v231, 0xffff0000, v42
v_mul_f32 v245, v244, v245
v_mul_f32 v231, v244, v231
v_cvt_pk_bf16_f32 v42, v245, v231
v_lshlrev_b32 v245, 16, v43
v_and_b32 v231, 0xffff0000, v43
v_mul_f32 v245, v244, v245
v_mul_f32 v231, v244, v231
v_cvt_pk_bf16_f32 v43, v245, v231
v_lshlrev_b32 v245, 16, v52
v_and_b32 v231, 0xffff0000, v52
v_mul_f32 v245, v244, v245
v_mul_f32 v231, v244, v231
v_cvt_pk_bf16_f32 v52, v245, v231
v_lshlrev_b32 v245, 16, v53
v_and_b32 v231, 0xffff0000, v53
v_mul_f32 v245, v244, v245
v_mul_f32 v231, v244, v231
v_cvt_pk_bf16_f32 v53, v245, v231
v_lshlrev_b32 v245, 16, v54
v_and_b32 v231, 0xffff0000, v54
v_mul_f32 v245, v244, v245
v_mul_f32 v231, v244, v231
v_cvt_pk_bf16_f32 v54, v245, v231
v_lshlrev_b32 v245, 16, v55
v_and_b32 v231, 0xffff0000, v55
v_mul_f32 v245, v244, v245
v_mul_f32 v231, v244, v231
v_cvt_pk_bf16_f32 v55, v245, v231
v_lshlrev_b32 v245, 16, v64
v_and_b32 v231, 0xffff0000, v64
v_mul_f32 v245, v244, v245
v_mul_f32 v231, v244, v231
v_cvt_pk_bf16_f32 v64, v245, v231
v_lshlrev_b32 v245, 16, v65
v_and_b32 v231, 0xffff0000, v65
v_mul_f32 v245, v244, v245
v_mul_f32 v231, v244, v231
v_cvt_pk_bf16_f32 v65, v245, v231
v_lshlrev_b32 v245, 16, v66
v_and_b32 v231, 0xffff0000, v66
v_mul_f32 v245, v244, v245
v_mul_f32 v231, v244, v231
v_cvt_pk_bf16_f32 v66, v245, v231
v_lshlrev_b32 v245, 16, v67
v_and_b32 v231, 0xffff0000, v67
v_mul_f32 v245, v244, v245
v_mul_f32 v231, v244, v231
v_cvt_pk_bf16_f32 v67, v245, v231
v_lshlrev_b32 v245, 16, v76
v_and_b32 v231, 0xffff0000, v76
v_mul_f32 v245, v244, v245
v_mul_f32 v231, v244, v231
v_cvt_pk_bf16_f32 v76, v245, v231
v_lshlrev_b32 v245, 16, v77
v_and_b32 v231, 0xffff0000, v77
v_mul_f32 v245, v244, v245
v_mul_f32 v231, v244, v231
v_cvt_pk_bf16_f32 v77, v245, v231
v_lshlrev_b32 v245, 16, v78
v_and_b32 v231, 0xffff0000, v78
v_mul_f32 v245, v244, v245
v_mul_f32 v231, v244, v231
v_cvt_pk_bf16_f32 v78, v245, v231
v_lshlrev_b32 v245, 16, v79
v_and_b32 v231, 0xffff0000, v79
v_mul_f32 v245, v244, v245
v_mul_f32 v231, v244, v231
v_cvt_pk_bf16_f32 v79, v245, v231
v_max3_f32 v244, v184, v185, v186
v_max3_f32 v244, v187, v188, v244
v_max3_f32 v244, v189, v190, v244
v_max3_f32 v244, v191, v244, v234
v_mov_b32 v245, v244
s_nop 1
v_permlane32_swap_b32 v244, v245
v_max_f32 v244, v244, v245
v_mov_b32 v245, v244
s_nop 1
v_permlane16_swap_b32 v244, v245
v_max_f32 v244, v244, v245
v_sub_f32 v184, v184, v244
v_sub_f32 v185, v185, v244
v_sub_f32 v186, v186, v244
v_sub_f32 v187, v187, v244
v_sub_f32 v188, v188, v244
v_sub_f32 v189, v189, v244
v_sub_f32 v190, v190, v244
v_sub_f32 v191, v191, v244
v_sub_f32 v245, v234, v244
v_mov_b32 v234, v244
v_exp_f32 v244, v245
v_lshlrev_b32 v245, 16, v8
v_and_b32 v231, 0xffff0000, v8
v_mul_f32 v245, v244, v245
v_mul_f32 v231, v244, v231
v_cvt_pk_bf16_f32 v8, v245, v231
v_lshlrev_b32 v245, 16, v9
v_and_b32 v231, 0xffff0000, v9
v_mul_f32 v245, v244, v245
v_mul_f32 v231, v244, v231
v_cvt_pk_bf16_f32 v9, v245, v231
v_lshlrev_b32 v245, 16, v10
v_and_b32 v231, 0xffff0000, v10
v_mul_f32 v245, v244, v245
v_mul_f32 v231, v244, v231
v_cvt_pk_bf16_f32 v10, v245, v231
v_lshlrev_b32 v245, 16, v11
v_and_b32 v231, 0xffff0000, v11
v_mul_f32 v245, v244, v245
v_mul_f32 v231, v244, v231
v_cvt_pk_bf16_f32 v11, v245, v231
v_lshlrev_b32 v245, 16, v20
v_and_b32 v231, 0xffff0000, v20
v_mul_f32 v245, v244, v245
v_mul_f32 v231, v244, v231
v_cvt_pk_bf16_f32 v20, v245, v231
v_lshlrev_b32 v245, 16, v21
v_and_b32 v231, 0xffff0000, v21
v_mul_f32 v245, v244, v245
v_mul_f32 v231, v244, v231
v_cvt_pk_bf16_f32 v21, v245, v231
v_lshlrev_b32 v245, 16, v22
v_and_b32 v231, 0xffff0000, v22
v_mul_f32 v245, v244, v245
v_mul_f32 v231, v244, v231
v_cvt_pk_bf16_f32 v22, v245, v231
v_lshlrev_b32 v245, 16, v23
v_and_b32 v231, 0xffff0000, v23
v_mul_f32 v245, v244, v245
v_mul_f32 v231, v244, v231
v_cvt_pk_bf16_f32 v23, v245, v231
v_lshlrev_b32 v245, 16, v32
v_and_b32 v231, 0xffff0000, v32
v_mul_f32 v245, v244, v245
v_mul_f32 v231, v244, v231
v_cvt_pk_bf16_f32 v32, v245, v231
v_lshlrev_b32 v245, 16, v33
v_and_b32 v231, 0xffff0000, v33
v_mul_f32 v245, v244, v245
v_mul_f32 v231, v244, v231
v_cvt_pk_bf16_f32 v33, v245, v231
v_lshlrev_b32 v245, 16, v34
v_and_b32 v231, 0xffff0000, v34
v_mul_f32 v245, v244, v245
v_mul_f32 v231, v244, v231
v_cvt_pk_bf16_f32 v34, v245, v231
v_lshlrev_b32 v245, 16, v35
v_and_b32 v231, 0xffff0000, v35
v_mul_f32 v245, v244, v245
v_mul_f32 v231, v244, v231
v_cvt_pk_bf16_f32 v35, v245, v231
v_lshlrev_b32 v245, 16, v44
v_and_b32 v231, 0xffff0000, v44
v_mul_f32 v245, v244, v245
v_mul_f32 v231, v244, v231
v_cvt_pk_bf16_f32 v44, v245, v231
v_lshlrev_b32 v245, 16, v45
v_and_b32 v231, 0xffff0000, v45
v_mul_f32 v245, v244, v245
v_mul_f32 v231, v244, v231
v_cvt_pk_bf16_f32 v45, v245, v231
v_lshlrev_b32 v245, 16, v46
v_and_b32 v231, 0xffff0000, v46
v_mul_f32 v245, v244, v245
v_mul_f32 v231, v244, v231
v_cvt_pk_bf16_f32 v46, v245, v231
v_lshlrev_b32 v245, 16, v47
v_and_b32 v231, 0xffff0000, v47
v_mul_f32 v245, v244, v245
v_mul_f32 v231, v244, v231
v_cvt_pk_bf16_f32 v47, v245, v231
v_lshlrev_b32 v245, 16, v56
v_and_b32 v231, 0xffff0000, v56
v_mul_f32 v245, v244, v245
v_mul_f32 v231, v244, v231
v_cvt_pk_bf16_f32 v56, v245, v231
v_lshlrev_b32 v245, 16, v57
v_and_b32 v231, 0xffff0000, v57
v_mul_f32 v245, v244, v245
v_mul_f32 v231, v244, v231
v_cvt_pk_bf16_f32 v57, v245, v231
v_lshlrev_b32 v245, 16, v58
v_and_b32 v231, 0xffff0000, v58
v_mul_f32 v245, v244, v245
v_mul_f32 v231, v244, v231
v_cvt_pk_bf16_f32 v58, v245, v231
v_lshlrev_b32 v245, 16, v59
v_and_b32 v231, 0xffff0000, v59
v_mul_f32 v245, v244, v245
v_mul_f32 v231, v244, v231
v_cvt_pk_bf16_f32 v59, v245, v231
v_lshlrev_b32 v245, 16, v68
v_and_b32 v231, 0xffff0000, v68
v_mul_f32 v245, v244, v245
v_mul_f32 v231, v244, v231
v_cvt_pk_bf16_f32 v68, v245, v231
v_lshlrev_b32 v245, 16, v69
v_and_b32 v231, 0xffff0000, v69
v_mul_f32 v245, v244, v245
v_mul_f32 v231, v244, v231
v_cvt_pk_bf16_f32 v69, v245, v231
v_lshlrev_b32 v245, 16, v70
v_and_b32 v231, 0xffff0000, v70
v_mul_f32 v245, v244, v245
v_mul_f32 v231, v244, v231
v_cvt_pk_bf16_f32 v70, v245, v231
v_lshlrev_b32 v245, 16, v71
v_and_b32 v231, 0xffff0000, v71
v_mul_f32 v245, v244, v245
v_mul_f32 v231, v244, v231
v_cvt_pk_bf16_f32 v71, v245, v231
v_lshlrev_b32 v245, 16, v80
v_and_b32 v231, 0xffff0000, v80
v_mul_f32 v245, v244, v245
v_mul_f32 v231, v244, v231
v_cvt_pk_bf16_f32 v80, v245, v231
v_lshlrev_b32 v245, 16, v81
v_and_b32 v231, 0xffff0000, v81
v_mul_f32 v245, v244, v245
v_mul_f32 v231, v244, v231
v_cvt_pk_bf16_f32 v81, v245, v231
v_lshlrev_b32 v245, 16, v82
v_and_b32 v231, 0xffff0000, v82
v_mul_f32 v245, v244, v245
v_mul_f32 v231, v244, v231
v_cvt_pk_bf16_f32 v82, v245, v231
v_lshlrev_b32 v245, 16, v83
v_and_b32 v231, 0xffff0000, v83
v_mul_f32 v245, v244, v245
v_mul_f32 v231, v244, v231
v_cvt_pk_bf16_f32 v83, v245, v231
s_nop 1
s_branch L_back0_7
L_rare1_0:
s_mov_b32 s65, 0xff800000
v_max3_f32 v244, v120, v121, v122
v_max3_f32 v244, v123, v124, v244
v_max3_f32 v244, v125, v126, v244
v_max_f32 v244, v127, v244
v_mov_b32 v245, v244
s_nop 1
v_permlane32_swap_b32 v244, v245
v_max_f32 v244, v244, v245
v_mov_b32 v245, v244
s_nop 1
v_permlane16_swap_b32 v244, v245
v_max_f32 v244, v244, v245
v_sub_f32 v120, v120, v244
v_sub_f32 v121, v121, v244
v_sub_f32 v122, v122, v244
v_sub_f32 v123, v123, v244
v_sub_f32 v124, v124, v244
v_sub_f32 v125, v125, v244
v_sub_f32 v126, v126, v244
v_sub_f32 v127, v127, v244
v_sub_f32 v245, v232, v244
v_mov_b32 v232, v244
v_max3_f32 v244, v128, v129, v130
v_max3_f32 v244, v131, v132, v244
v_max3_f32 v244, v133, v134, v244
v_max_f32 v244, v135, v244
v_mov_b32 v245, v244
s_nop 1
v_permlane32_swap_b32 v244, v245
v_max_f32 v244, v244, v245
v_mov_b32 v245, v244
s_nop 1
v_permlane16_swap_b32 v244, v245
v_max_f32 v244, v244, v245
v_sub_f32 v128, v128, v244
v_sub_f32 v129, v129, v244
v_sub_f32 v130, v130, v244
v_sub_f32 v131, v131, v244
v_sub_f32 v132, v132, v244
v_sub_f32 v133, v133, v244
v_sub_f32 v134, v134, v244
v_sub_f32 v135, v135, v244
v_sub_f32 v245, v233, v244
v_mov_b32 v233, v244
v_max3_f32 v244, v136, v137, v138
v_max3_f32 v244, v139, v140, v244
v_max3_f32 v244, v141, v142, v244
v_max_f32 v244, v143, v244
v_mov_b32 v245, v244
s_nop 1
v_permlane32_swap_b32 v244, v245
v_max_f32 v244, v244, v245
v_mov_b32 v245, v244
s_nop 1
v_permlane16_swap_b32 v244, v245
v_max_f32 v244, v244, v245
v_sub_f32 v136, v136, v244
v_sub_f32 v137, v137, v244
v_sub_f32 v138, v138, v244
v_sub_f32 v139, v139, v244
v_sub_f32 v140, v140, v244
v_sub_f32 v141, v141, v244
v_sub_f32 v142, v142, v244
v_sub_f32 v143, v143, v244
v_sub_f32 v245, v234, v244
v_mov_b32 v234, v244
s_nop 1
s_branch L_back1_0
L_rare1_1:
s_mov_b32 s65, 0xff800000
v_max3_f32 v244, v96, v97, v98
v_max3_f32 v244, v99, v100, v244
v_max3_f32 v244, v101, v102, v244
v_max3_f32 v244, v103, v244, v232
v_mov_b32 v245, v244
s_nop 1
v_permlane32_swap_b32 v244, v245
v_max_f32 v244, v244, v245
v_mov_b32 v245, v244
s_nop 1
v_permlane16_swap_b32 v244, v245
v_max_f32 v244, v244, v245
v_sub_f32 v96, v96, v244
v_sub_f32 v97, v97, v244
v_sub_f32 v98, v98, v244
v_sub_f32 v99, v99, v244
v_sub_f32 v100, v100, v244
v_sub_f32 v101, v101, v244
v_sub_f32 v102, v102, v244
v_sub_f32 v103, v103, v244
v_sub_f32 v245, v232, v244
v_mov_b32 v232, v244
v_exp_f32 v244, v245
v_accvgpr_read_b32 v231, a112
v_lshlrev_b32 v245, 16, v231
v_and_b32 v231, 0xffff0000, v231
v_mul_f32 v245, v244, v245
v_mul_f32 v231, v244, v231
v_cvt_pk_bf16_f32 v231, v245, v231
v_accvgpr_write_b32 a112, v231
v_accvgpr_read_b32 v231, a113
v_lshlrev_b32 v245, 16, v231
v_and_b32 v231, 0xffff0000, v231
v_mul_f32 v245, v244, v245
v_mul_f32 v231, v244, v231
v_cvt_pk_bf16_f32 v231, v245, v231
v_accvgpr_write_b32 a113, v231
v_accvgpr_read_b32 v231, a114
v_lshlrev_b32 v245, 16, v231
v_and_b32 v231, 0xffff0000, v231
v_mul_f32 v245, v244, v245
v_mul_f32 v231, v244, v231
v_cvt_pk_bf16_f32 v231, v245, v231
v_accvgpr_write_b32 a114, v231
v_accvgpr_read_b32 v231, a115
v_lshlrev_b32 v245, 16, v231
v_and_b32 v231, 0xffff0000, v231
v_mul_f32 v245, v244, v245
v_mul_f32 v231, v244, v231
v_cvt_pk_bf16_f32 v231, v245, v231
v_accvgpr_write_b32 a115, v231
v_max3_f32 v244, v104, v105, v106
v_max3_f32 v244, v107, v108, v244
v_max3_f32 v244, v109, v110, v244
v_max3_f32 v244, v111, v244, v233
v_mov_b32 v245, v244
s_nop 1
v_permlane32_swap_b32 v244, v245
v_max_f32 v244, v244, v245
v_mov_b32 v245, v244
s_nop 1
v_permlane16_swap_b32 v244, v245
v_max_f32 v244, v244, v245
v_sub_f32 v104, v104, v244
v_sub_f32 v105, v105, v244
v_sub_f32 v106, v106, v244
v_sub_f32 v107, v107, v244
v_sub_f32 v108, v108, v244
v_sub_f32 v109, v109, v244
v_sub_f32 v110, v110, v244
v_sub_f32 v111, v111, v244
v_sub_f32 v245, v233, v244
v_mov_b32 v233, v244
v_exp_f32 v244, v245
v_accvgpr_read_b32 v231, a116
v_lshlrev_b32 v245, 16, v231
v_and_b32 v231, 0xffff0000, v231
v_mul_f32 v245, v244, v245
v_mul_f32 v231, v244, v231
v_cvt_pk_bf16_f32 v231, v245, v231
v_accvgpr_write_b32 a116, v231
v_accvgpr_read_b32 v231, a117
v_lshlrev_b32 v245, 16, v231
v_and_b32 v231, 0xffff0000, v231
v_mul_f32 v245, v244, v245
v_mul_f32 v231, v244, v231
v_cvt_pk_bf16_f32 v231, v245, v231
v_accvgpr_write_b32 a117, v231
v_accvgpr_read_b32 v231, a118
v_lshlrev_b32 v245, 16, v231
v_and_b32 v231, 0xffff0000, v231
v_mul_f32 v245, v244, v245
v_mul_f32 v231, v244, v231
v_cvt_pk_bf16_f32 v231, v245, v231
v_accvgpr_write_b32 a118, v231
v_accvgpr_read_b32 v231, a119
v_lshlrev_b32 v245, 16, v231
v_and_b32 v231, 0xffff0000, v231
v_mul_f32 v245, v244, v245
v_mul_f32 v231, v244, v231
v_cvt_pk_bf16_f32 v231, v245, v231
v_accvgpr_write_b32 a119, v231
v_max3_f32 v244, v112, v113, v114
v_max3_f32 v244, v115, v116, v244
v_max3_f32 v244, v117, v118, v244
v_max3_f32 v244, v119, v244, v234
v_mov_b32 v245, v244
s_nop 1
v_permlane32_swap_b32 v244, v245
v_max_f32 v244, v244, v245
v_mov_b32 v245, v244
s_nop 1
v_permlane16_swap_b32 v244, v245
v_max_f32 v244, v244, v245
v_sub_f32 v112, v112, v244
v_sub_f32 v113, v113, v244
v_sub_f32 v114, v114, v244
v_sub_f32 v115, v115, v244
v_sub_f32 v116, v116, v244
v_sub_f32 v117, v117, v244
v_sub_f32 v118, v118, v244
v_sub_f32 v119, v119, v244
v_sub_f32 v245, v234, v244
v_mov_b32 v234, v244
v_exp_f32 v244, v245
v_accvgpr_read_b32 v231, a120
v_lshlrev_b32 v245, 16, v231
v_and_b32 v231, 0xffff0000, v231
v_mul_f32 v245, v244, v245
v_mul_f32 v231, v244, v231
v_cvt_pk_bf16_f32 v231, v245, v231
v_accvgpr_write_b32 a120, v231
v_accvgpr_read_b32 v231, a121
v_lshlrev_b32 v245, 16, v231
v_and_b32 v231, 0xffff0000, v231
v_mul_f32 v245, v244, v245
v_mul_f32 v231, v244, v231
v_cvt_pk_bf16_f32 v231, v245, v231
v_accvgpr_write_b32 a121, v231
v_accvgpr_read_b32 v231, a122
v_lshlrev_b32 v245, 16, v231
v_and_b32 v231, 0xffff0000, v231
v_mul_f32 v245, v244, v245
v_mul_f32 v231, v244, v231
v_cvt_pk_bf16_f32 v231, v245, v231
v_accvgpr_write_b32 a122, v231
v_accvgpr_read_b32 v231, a123
v_lshlrev_b32 v245, 16, v231
v_and_b32 v231, 0xffff0000, v231
v_mul_f32 v245, v244, v245
v_mul_f32 v231, v244, v231
v_cvt_pk_bf16_f32 v231, v245, v231
v_accvgpr_write_b32 a123, v231
s_nop 1
s_branch L_back1_1
L_rare1_2:
s_mov_b32 s65, 0xff800000
v_max3_f32 v244, v120, v121, v122
v_max3_f32 v244, v123, v124, v244
v_max3_f32 v244, v125, v126, v244
v_max3_f32 v244, v127, v244, v232
v_mov_b32 v245, v244
s_nop 1
v_permlane32_swap_b32 v244, v245
v_max_f32 v244, v244, v245
v_mov_b32 v245, v244
s_nop 1
v_permlane16_swap_b32 v244, v245
v_max_f32 v244, v244, v245
v_sub_f32 v120, v120, v244
v_sub_f32 v121, v121, v244
v_sub_f32 v122, v122, v244
v_sub_f32 v123, v123, v244
v_sub_f32 v124, v124, v244
v_sub_f32 v125, v125, v244
v_sub_f32 v126, v126, v244
v_sub_f32 v127, v127, v244
v_sub_f32 v245, v232, v244
v_mov_b32 v232, v244
v_exp_f32 v244, v245
v_accvgpr_read_b32 v231, a112
v_lshlrev_b32 v245, 16, v231
v_and_b32 v231, 0xffff0000, v231
v_mul_f32 v245, v244, v245
v_mul_f32 v231, v244, v231
v_cvt_pk_bf16_f32 v231, v245, v231
v_accvgpr_write_b32 a112, v231
v_accvgpr_read_b32 v231, a113
v_lshlrev_b32 v245, 16, v231
v_and_b32 v231, 0xffff0000, v231
v_mul_f32 v245, v244, v245
v_mul_f32 v231, v244, v231
v_cvt_pk_bf16_f32 v231, v245, v231
v_accvgpr_write_b32 a113, v231
v_accvgpr_read_b32 v231, a114
v_lshlrev_b32 v245, 16, v231
v_and_b32 v231, 0xffff0000, v231
v_mul_f32 v245, v244, v245
v_mul_f32 v231, v244, v231
v_cvt_pk_bf16_f32 v231, v245, v231
v_accvgpr_write_b32 a114, v231
v_accvgpr_read_b32 v231, a115
v_lshlrev_b32 v245, 16, v231
v_and_b32 v231, 0xffff0000, v231
v_mul_f32 v245, v244, v245
v_mul_f32 v231, v244, v231
v_cvt_pk_bf16_f32 v231, v245, v231
v_accvgpr_write_b32 a115, v231
v_accvgpr_read_b32 v231, a124
v_lshlrev_b32 v245, 16, v231
v_and_b32 v231, 0xffff0000, v231
v_mul_f32 v245, v244, v245
v_mul_f32 v231, v244, v231
v_cvt_pk_bf16_f32 v231, v245, v231
v_accvgpr_write_b32 a124, v231
v_accvgpr_read_b32 v231, a125
v_lshlrev_b32 v245, 16, v231
v_and_b32 v231, 0xffff0000, v231
v_mul_f32 v245, v244, v245
v_mul_f32 v231, v244, v231
v_cvt_pk_bf16_f32 v231, v245, v231
v_accvgpr_write_b32 a125, v231
v_accvgpr_read_b32 v231, a126
v_lshlrev_b32 v245, 16, v231
v_and_b32 v231, 0xffff0000, v231
v_mul_f32 v245, v244, v245
v_mul_f32 v231, v244, v231
v_cvt_pk_bf16_f32 v231, v245, v231
v_accvgpr_write_b32 a126, v231
v_accvgpr_read_b32 v231, a127
v_lshlrev_b32 v245, 16, v231
v_and_b32 v231, 0xffff0000, v231
v_mul_f32 v245, v244, v245
v_mul_f32 v231, v244, v231
v_cvt_pk_bf16_f32 v231, v245, v231
v_accvgpr_write_b32 a127, v231
v_max3_f32 v244, v128, v129, v130
v_max3_f32 v244, v131, v132, v244
v_max3_f32 v244, v133, v134, v244
v_max3_f32 v244, v135, v244, v233
v_mov_b32 v245, v244
s_nop 1
v_permlane32_swap_b32 v244, v245
v_max_f32 v244, v244, v245
v_mov_b32 v245, v244
s_nop 1
v_permlane16_swap_b32 v244, v245
v_max_f32 v244, v244, v245
v_sub_f32 v128, v128, v244
v_sub_f32 v129, v129, v244
v_sub_f32 v130, v130, v244
v_sub_f32 v131, v131, v244
v_sub_f32 v132, v132, v244
v_sub_f32 v133, v133, v244
v_sub_f32 v134, v134, v244
v_sub_f32 v135, v135, v244
v_sub_f32 v245, v233, v244
v_mov_b32 v233, v244
v_exp_f32 v244, v245
v_accvgpr_read_b32 v231, a116
v_lshlrev_b32 v245, 16, v231
v_and_b32 v231, 0xffff0000, v231
v_mul_f32 v245, v244, v245
v_mul_f32 v231, v244, v231
v_cvt_pk_bf16_f32 v231, v245, v231
v_accvgpr_write_b32 a116, v231
v_accvgpr_read_b32 v231, a117
v_lshlrev_b32 v245, 16, v231
v_and_b32 v231, 0xffff0000, v231
v_mul_f32 v245, v244, v245
v_mul_f32 v231, v244, v231
v_cvt_pk_bf16_f32 v231, v245, v231
v_accvgpr_write_b32 a117, v231
v_accvgpr_read_b32 v231, a118
v_lshlrev_b32 v245, 16, v231
v_and_b32 v231, 0xffff0000, v231
v_mul_f32 v245, v244, v245
v_mul_f32 v231, v244, v231
v_cvt_pk_bf16_f32 v231, v245, v231
v_accvgpr_write_b32 a118, v231
v_accvgpr_read_b32 v231, a119
v_lshlrev_b32 v245, 16, v231
v_and_b32 v231, 0xffff0000, v231
v_mul_f32 v245, v244, v245
v_mul_f32 v231, v244, v231
v_cvt_pk_bf16_f32 v231, v245, v231
v_accvgpr_write_b32 a119, v231
v_accvgpr_read_b32 v231, a128
v_lshlrev_b32 v245, 16, v231
v_and_b32 v231, 0xffff0000, v231
v_mul_f32 v245, v244, v245
v_mul_f32 v231, v244, v231
v_cvt_pk_bf16_f32 v231, v245, v231
v_accvgpr_write_b32 a128, v231
v_accvgpr_read_b32 v231, a129
v_lshlrev_b32 v245, 16, v231
v_and_b32 v231, 0xffff0000, v231
v_mul_f32 v245, v244, v245
v_mul_f32 v231, v244, v231
v_cvt_pk_bf16_f32 v231, v245, v231
v_accvgpr_write_b32 a129, v231
v_accvgpr_read_b32 v231, a130
v_lshlrev_b32 v245, 16, v231
v_and_b32 v231, 0xffff0000, v231
v_mul_f32 v245, v244, v245
v_mul_f32 v231, v244, v231
v_cvt_pk_bf16_f32 v231, v245, v231
v_accvgpr_write_b32 a130, v231
v_accvgpr_read_b32 v231, a131
v_lshlrev_b32 v245, 16, v231
v_and_b32 v231, 0xffff0000, v231
v_mul_f32 v245, v244, v245
v_mul_f32 v231, v244, v231
v_cvt_pk_bf16_f32 v231, v245, v231
v_accvgpr_write_b32 a131, v231
v_max3_f32 v244, v136, v137, v138
v_max3_f32 v244, v139, v140, v244
v_max3_f32 v244, v141, v142, v244
v_max3_f32 v244, v143, v244, v234
v_mov_b32 v245, v244
s_nop 1
v_permlane32_swap_b32 v244, v245
v_max_f32 v244, v244, v245
v_mov_b32 v245, v244
s_nop 1
v_permlane16_swap_b32 v244, v245
v_max_f32 v244, v244, v245
v_sub_f32 v136, v136, v244
v_sub_f32 v137, v137, v244
v_sub_f32 v138, v138, v244
v_sub_f32 v139, v139, v244
v_sub_f32 v140, v140, v244
v_sub_f32 v141, v141, v244
v_sub_f32 v142, v142, v244
v_sub_f32 v143, v143, v244
v_sub_f32 v245, v234, v244
v_mov_b32 v234, v244
v_exp_f32 v244, v245
v_accvgpr_read_b32 v231, a120
v_lshlrev_b32 v245, 16, v231
v_and_b32 v231, 0xffff0000, v231
v_mul_f32 v245, v244, v245
v_mul_f32 v231, v244, v231
v_cvt_pk_bf16_f32 v231, v245, v231
v_accvgpr_write_b32 a120, v231
v_accvgpr_read_b32 v231, a121
v_lshlrev_b32 v245, 16, v231
v_and_b32 v231, 0xffff0000, v231
v_mul_f32 v245, v244, v245
v_mul_f32 v231, v244, v231
v_cvt_pk_bf16_f32 v231, v245, v231
v_accvgpr_write_b32 a121, v231
v_accvgpr_read_b32 v231, a122
v_lshlrev_b32 v245, 16, v231
v_and_b32 v231, 0xffff0000, v231
v_mul_f32 v245, v244, v245
v_mul_f32 v231, v244, v231
v_cvt_pk_bf16_f32 v231, v245, v231
v_accvgpr_write_b32 a122, v231
v_accvgpr_read_b32 v231, a123
v_lshlrev_b32 v245, 16, v231
v_and_b32 v231, 0xffff0000, v231
v_mul_f32 v245, v244, v245
v_mul_f32 v231, v244, v231
v_cvt_pk_bf16_f32 v231, v245, v231
v_accvgpr_write_b32 a123, v231
v_accvgpr_read_b32 v231, a132
v_lshlrev_b32 v245, 16, v231
v_and_b32 v231, 0xffff0000, v231
v_mul_f32 v245, v244, v245
v_mul_f32 v231, v244, v231
v_cvt_pk_bf16_f32 v231, v245, v231
v_accvgpr_write_b32 a132, v231
v_accvgpr_read_b32 v231, a133
v_lshlrev_b32 v245, 16, v231
v_and_b32 v231, 0xffff0000, v231
v_mul_f32 v245, v244, v245
v_mul_f32 v231, v244, v231
v_cvt_pk_bf16_f32 v231, v245, v231
v_accvgpr_write_b32 a133, v231
v_accvgpr_read_b32 v231, a134
v_lshlrev_b32 v245, 16, v231
v_and_b32 v231, 0xffff0000, v231
v_mul_f32 v245, v244, v245
v_mul_f32 v231, v244, v231
v_cvt_pk_bf16_f32 v231, v245, v231
v_accvgpr_write_b32 a134, v231
v_accvgpr_read_b32 v231, a135
v_lshlrev_b32 v245, 16, v231
v_and_b32 v231, 0xffff0000, v231
v_mul_f32 v245, v244, v245
v_mul_f32 v231, v244, v231
v_cvt_pk_bf16_f32 v231, v245, v231
v_accvgpr_write_b32 a135, v231
s_nop 1
s_branch L_back1_2
L_rare1_3:
s_mov_b32 s65, 0xff800000
v_max3_f32 v244, v96, v97, v98
v_max3_f32 v244, v99, v100, v244
v_max3_f32 v244, v101, v102, v244
v_max3_f32 v244, v103, v244, v232
v_mov_b32 v245, v244
s_nop 1
v_permlane32_swap_b32 v244, v245
v_max_f32 v244, v244, v245
v_mov_b32 v245, v244
s_nop 1
v_permlane16_swap_b32 v244, v245
v_max_f32 v244, v244, v245
v_sub_f32 v96, v96, v244
v_sub_f32 v97, v97, v244
v_sub_f32 v98, v98, v244
v_sub_f32 v99, v99, v244
v_sub_f32 v100, v100, v244
v_sub_f32 v101, v101, v244
v_sub_f32 v102, v102, v244
v_sub_f32 v103, v103, v244
v_sub_f32 v245, v232, v244
v_mov_b32 v232, v244
v_exp_f32 v244, v245
v_accvgpr_read_b32 v231, a112
v_lshlrev_b32 v245, 16, v231
v_and_b32 v231, 0xffff0000, v231
v_mul_f32 v245, v244, v245
v_mul_f32 v231, v244, v231
v_cvt_pk_bf16_f32 v231, v245, v231
v_accvgpr_write_b32 a112, v231
v_accvgpr_read_b32 v231, a113
v_lshlrev_b32 v245, 16, v231
v_and_b32 v231, 0xffff0000, v231
v_mul_f32 v245, v244, v245
v_mul_f32 v231, v244, v231
v_cvt_pk_bf16_f32 v231, v245, v231
v_accvgpr_write_b32 a113, v231
v_accvgpr_read_b32 v231, a114
v_lshlrev_b32 v245, 16, v231
v_and_b32 v231, 0xffff0000, v231
v_mul_f32 v245, v244, v245
v_mul_f32 v231, v244, v231
v_cvt_pk_bf16_f32 v231, v245, v231
v_accvgpr_write_b32 a114, v231
v_accvgpr_read_b32 v231, a115
v_lshlrev_b32 v245, 16, v231
v_and_b32 v231, 0xffff0000, v231
v_mul_f32 v245, v244, v245
v_mul_f32 v231, v244, v231
v_cvt_pk_bf16_f32 v231, v245, v231
v_accvgpr_write_b32 a115, v231
v_accvgpr_read_b32 v231, a124
v_lshlrev_b32 v245, 16, v231
v_and_b32 v231, 0xffff0000, v231
v_mul_f32 v245, v244, v245
v_mul_f32 v231, v244, v231
v_cvt_pk_bf16_f32 v231, v245, v231
v_accvgpr_write_b32 a124, v231
v_accvgpr_read_b32 v231, a125
v_lshlrev_b32 v245, 16, v231
v_and_b32 v231, 0xffff0000, v231
v_mul_f32 v245, v244, v245
v_mul_f32 v231, v244, v231
v_cvt_pk_bf16_f32 v231, v245, v231
v_accvgpr_write_b32 a125, v231
v_accvgpr_read_b32 v231, a126
v_lshlrev_b32 v245, 16, v231
v_and_b32 v231, 0xffff0000, v231
v_mul_f32 v245, v244, v245
v_mul_f32 v231, v244, v231
v_cvt_pk_bf16_f32 v231, v245, v231
v_accvgpr_write_b32 a126, v231
v_accvgpr_read_b32 v231, a127
v_lshlrev_b32 v245, 16, v231
v_and_b32 v231, 0xffff0000, v231
v_mul_f32 v245, v244, v245
v_mul_f32 v231, v244, v231
v_cvt_pk_bf16_f32 v231, v245, v231
v_accvgpr_write_b32 a127, v231
v_accvgpr_read_b32 v231, a136
v_lshlrev_b32 v245, 16, v231
v_and_b32 v231, 0xffff0000, v231
v_mul_f32 v245, v244, v245
v_mul_f32 v231, v244, v231
v_cvt_pk_bf16_f32 v231, v245, v231
v_accvgpr_write_b32 a136, v231
v_accvgpr_read_b32 v231, a137
v_lshlrev_b32 v245, 16, v231
v_and_b32 v231, 0xffff0000, v231
v_mul_f32 v245, v244, v245
v_mul_f32 v231, v244, v231
v_cvt_pk_bf16_f32 v231, v245, v231
v_accvgpr_write_b32 a137, v231
v_accvgpr_read_b32 v231, a138
v_lshlrev_b32 v245, 16, v231
v_and_b32 v231, 0xffff0000, v231
v_mul_f32 v245, v244, v245
v_mul_f32 v231, v244, v231
v_cvt_pk_bf16_f32 v231, v245, v231
v_accvgpr_write_b32 a138, v231
v_accvgpr_read_b32 v231, a139
v_lshlrev_b32 v245, 16, v231
v_and_b32 v231, 0xffff0000, v231
v_mul_f32 v245, v244, v245
v_mul_f32 v231, v244, v231
v_cvt_pk_bf16_f32 v231, v245, v231
v_accvgpr_write_b32 a139, v231
v_max3_f32 v244, v104, v105, v106
v_max3_f32 v244, v107, v108, v244
v_max3_f32 v244, v109, v110, v244
v_max3_f32 v244, v111, v244, v233
v_mov_b32 v245, v244
s_nop 1
v_permlane32_swap_b32 v244, v245
v_max_f32 v244, v244, v245
v_mov_b32 v245, v244
s_nop 1
v_permlane16_swap_b32 v244, v245
v_max_f32 v244, v244, v245
v_sub_f32 v104, v104, v244
v_sub_f32 v105, v105, v244
v_sub_f32 v106, v106, v244
v_sub_f32 v107, v107, v244
v_sub_f32 v108, v108, v244
v_sub_f32 v109, v109, v244
v_sub_f32 v110, v110, v244
v_sub_f32 v111, v111, v244
v_sub_f32 v245, v233, v244
v_mov_b32 v233, v244
v_exp_f32 v244, v245
v_accvgpr_read_b32 v231, a116
v_lshlrev_b32 v245, 16, v231
v_and_b32 v231, 0xffff0000, v231
v_mul_f32 v245, v244, v245
v_mul_f32 v231, v244, v231
v_cvt_pk_bf16_f32 v231, v245, v231
v_accvgpr_write_b32 a116, v231
v_accvgpr_read_b32 v231, a117
v_lshlrev_b32 v245, 16, v231
v_and_b32 v231, 0xffff0000, v231
v_mul_f32 v245, v244, v245
v_mul_f32 v231, v244, v231
v_cvt_pk_bf16_f32 v231, v245, v231
v_accvgpr_write_b32 a117, v231
v_accvgpr_read_b32 v231, a118
v_lshlrev_b32 v245, 16, v231
v_and_b32 v231, 0xffff0000, v231
v_mul_f32 v245, v244, v245
v_mul_f32 v231, v244, v231
v_cvt_pk_bf16_f32 v231, v245, v231
v_accvgpr_write_b32 a118, v231
v_accvgpr_read_b32 v231, a119
v_lshlrev_b32 v245, 16, v231
v_and_b32 v231, 0xffff0000, v231
v_mul_f32 v245, v244, v245
v_mul_f32 v231, v244, v231
v_cvt_pk_bf16_f32 v231, v245, v231
v_accvgpr_write_b32 a119, v231
v_accvgpr_read_b32 v231, a128
v_lshlrev_b32 v245, 16, v231
v_and_b32 v231, 0xffff0000, v231
v_mul_f32 v245, v244, v245
v_mul_f32 v231, v244, v231
v_cvt_pk_bf16_f32 v231, v245, v231
v_accvgpr_write_b32 a128, v231
v_accvgpr_read_b32 v231, a129
v_lshlrev_b32 v245, 16, v231
v_and_b32 v231, 0xffff0000, v231
v_mul_f32 v245, v244, v245
v_mul_f32 v231, v244, v231
v_cvt_pk_bf16_f32 v231, v245, v231
v_accvgpr_write_b32 a129, v231
v_accvgpr_read_b32 v231, a130
v_lshlrev_b32 v245, 16, v231
v_and_b32 v231, 0xffff0000, v231
v_mul_f32 v245, v244, v245
v_mul_f32 v231, v244, v231
v_cvt_pk_bf16_f32 v231, v245, v231
v_accvgpr_write_b32 a130, v231
v_accvgpr_read_b32 v231, a131
v_lshlrev_b32 v245, 16, v231
v_and_b32 v231, 0xffff0000, v231
v_mul_f32 v245, v244, v245
v_mul_f32 v231, v244, v231
v_cvt_pk_bf16_f32 v231, v245, v231
v_accvgpr_write_b32 a131, v231
v_accvgpr_read_b32 v231, a140
v_lshlrev_b32 v245, 16, v231
v_and_b32 v231, 0xffff0000, v231
v_mul_f32 v245, v244, v245
v_mul_f32 v231, v244, v231
v_cvt_pk_bf16_f32 v231, v245, v231
v_accvgpr_write_b32 a140, v231
v_accvgpr_read_b32 v231, a141
v_lshlrev_b32 v245, 16, v231
v_and_b32 v231, 0xffff0000, v231
v_mul_f32 v245, v244, v245
v_mul_f32 v231, v244, v231
v_cvt_pk_bf16_f32 v231, v245, v231
v_accvgpr_write_b32 a141, v231
v_accvgpr_read_b32 v231, a142
v_lshlrev_b32 v245, 16, v231
v_and_b32 v231, 0xffff0000, v231
v_mul_f32 v245, v244, v245
v_mul_f32 v231, v244, v231
v_cvt_pk_bf16_f32 v231, v245, v231
v_accvgpr_write_b32 a142, v231
v_accvgpr_read_b32 v231, a143
v_lshlrev_b32 v245, 16, v231
v_and_b32 v231, 0xffff0000, v231
v_mul_f32 v245, v244, v245
v_mul_f32 v231, v244, v231
v_cvt_pk_bf16_f32 v231, v245, v231
v_accvgpr_write_b32 a143, v231
v_max3_f32 v244, v112, v113, v114
v_max3_f32 v244, v115, v116, v244
v_max3_f32 v244, v117, v118, v244
v_max3_f32 v244, v119, v244, v234
v_mov_b32 v245, v244
s_nop 1
v_permlane32_swap_b32 v244, v245
v_max_f32 v244, v244, v245
v_mov_b32 v245, v244
s_nop 1
v_permlane16_swap_b32 v244, v245
v_max_f32 v244, v244, v245
v_sub_f32 v112, v112, v244
v_sub_f32 v113, v113, v244
v_sub_f32 v114, v114, v244
v_sub_f32 v115, v115, v244
v_sub_f32 v116, v116, v244
v_sub_f32 v117, v117, v244
v_sub_f32 v118, v118, v244
v_sub_f32 v119, v119, v244
v_sub_f32 v245, v234, v244
v_mov_b32 v234, v244
v_exp_f32 v244, v245
v_accvgpr_read_b32 v231, a120
v_lshlrev_b32 v245, 16, v231
v_and_b32 v231, 0xffff0000, v231
v_mul_f32 v245, v244, v245
v_mul_f32 v231, v244, v231
v_cvt_pk_bf16_f32 v231, v245, v231
v_accvgpr_write_b32 a120, v231
v_accvgpr_read_b32 v231, a121
v_lshlrev_b32 v245, 16, v231
v_and_b32 v231, 0xffff0000, v231
v_mul_f32 v245, v244, v245
v_mul_f32 v231, v244, v231
v_cvt_pk_bf16_f32 v231, v245, v231
v_accvgpr_write_b32 a121, v231
v_accvgpr_read_b32 v231, a122
v_lshlrev_b32 v245, 16, v231
v_and_b32 v231, 0xffff0000, v231
v_mul_f32 v245, v244, v245
v_mul_f32 v231, v244, v231
v_cvt_pk_bf16_f32 v231, v245, v231
v_accvgpr_write_b32 a122, v231
v_accvgpr_read_b32 v231, a123
v_lshlrev_b32 v245, 16, v231
v_and_b32 v231, 0xffff0000, v231
v_mul_f32 v245, v244, v245
v_mul_f32 v231, v244, v231
v_cvt_pk_bf16_f32 v231, v245, v231
v_accvgpr_write_b32 a123, v231
v_accvgpr_read_b32 v231, a132
v_lshlrev_b32 v245, 16, v231
v_and_b32 v231, 0xffff0000, v231
v_mul_f32 v245, v244, v245
v_mul_f32 v231, v244, v231
v_cvt_pk_bf16_f32 v231, v245, v231
v_accvgpr_write_b32 a132, v231
v_accvgpr_read_b32 v231, a133
v_lshlrev_b32 v245, 16, v231
v_and_b32 v231, 0xffff0000, v231
v_mul_f32 v245, v244, v245
v_mul_f32 v231, v244, v231
v_cvt_pk_bf16_f32 v231, v245, v231
v_accvgpr_write_b32 a133, v231
v_accvgpr_read_b32 v231, a134
v_lshlrev_b32 v245, 16, v231
v_and_b32 v231, 0xffff0000, v231
v_mul_f32 v245, v244, v245
v_mul_f32 v231, v244, v231
v_cvt_pk_bf16_f32 v231, v245, v231
v_accvgpr_write_b32 a134, v231
v_accvgpr_read_b32 v231, a135
v_lshlrev_b32 v245, 16, v231
v_and_b32 v231, 0xffff0000, v231
v_mul_f32 v245, v244, v245
v_mul_f32 v231, v244, v231
v_cvt_pk_bf16_f32 v231, v245, v231
v_accvgpr_write_b32 a135, v231
v_accvgpr_read_b32 v231, a144
v_lshlrev_b32 v245, 16, v231
v_and_b32 v231, 0xffff0000, v231
v_mul_f32 v245, v244, v245
v_mul_f32 v231, v244, v231
v_cvt_pk_bf16_f32 v231, v245, v231
v_accvgpr_write_b32 a144, v231
v_accvgpr_read_b32 v231, a145
v_lshlrev_b32 v245, 16, v231
v_and_b32 v231, 0xffff0000, v231
v_mul_f32 v245, v244, v245
v_mul_f32 v231, v244, v231
v_cvt_pk_bf16_f32 v231, v245, v231
v_accvgpr_write_b32 a145, v231
v_accvgpr_read_b32 v231, a146
v_lshlrev_b32 v245, 16, v231
v_and_b32 v231, 0xffff0000, v231
v_mul_f32 v245, v244, v245
v_mul_f32 v231, v244, v231
v_cvt_pk_bf16_f32 v231, v245, v231
v_accvgpr_write_b32 a146, v231
v_accvgpr_read_b32 v231, a147
v_lshlrev_b32 v245, 16, v231
v_and_b32 v231, 0xffff0000, v231
v_mul_f32 v245, v244, v245
v_mul_f32 v231, v244, v231
v_cvt_pk_bf16_f32 v231, v245, v231
v_accvgpr_write_b32 a147, v231
s_nop 1
s_branch L_back1_3
L_rare1_4:
s_mov_b32 s65, 0xff800000
v_max3_f32 v244, v120, v121, v122
v_max3_f32 v244, v123, v124, v244
v_max3_f32 v244, v125, v126, v244
v_max3_f32 v244, v127, v244, v232
v_mov_b32 v245, v244
s_nop 1
v_permlane32_swap_b32 v244, v245
v_max_f32 v244, v244, v245
v_mov_b32 v245, v244
s_nop 1
v_permlane16_swap_b32 v244, v245
v_max_f32 v244, v244, v245
v_sub_f32 v120, v120, v244
v_sub_f32 v121, v121, v244
v_sub_f32 v122, v122, v244
v_sub_f32 v123, v123, v244
v_sub_f32 v124, v124, v244
v_sub_f32 v125, v125, v244
v_sub_f32 v126, v126, v244
v_sub_f32 v127, v127, v244
v_sub_f32 v245, v232, v244
v_mov_b32 v232, v244
v_exp_f32 v244, v245
v_accvgpr_read_b32 v231, a112
v_lshlrev_b32 v245, 16, v231
v_and_b32 v231, 0xffff0000, v231
v_mul_f32 v245, v244, v245
v_mul_f32 v231, v244, v231
v_cvt_pk_bf16_f32 v231, v245, v231
v_accvgpr_write_b32 a112, v231
v_accvgpr_read_b32 v231, a113
v_lshlrev_b32 v245, 16, v231
v_and_b32 v231, 0xffff0000, v231
v_mul_f32 v245, v244, v245
v_mul_f32 v231, v244, v231
v_cvt_pk_bf16_f32 v231, v245, v231
v_accvgpr_write_b32 a113, v231
v_accvgpr_read_b32 v231, a114
v_lshlrev_b32 v245, 16, v231
v_and_b32 v231, 0xffff0000, v231
v_mul_f32 v245, v244, v245
v_mul_f32 v231, v244, v231
v_cvt_pk_bf16_f32 v231, v245, v231
v_accvgpr_write_b32 a114, v231
v_accvgpr_read_b32 v231, a115
v_lshlrev_b32 v245, 16, v231
v_and_b32 v231, 0xffff0000, v231
v_mul_f32 v245, v244, v245
v_mul_f32 v231, v244, v231
v_cvt_pk_bf16_f32 v231, v245, v231
v_accvgpr_write_b32 a115, v231
v_accvgpr_read_b32 v231, a124
v_lshlrev_b32 v245, 16, v231
v_and_b32 v231, 0xffff0000, v231
v_mul_f32 v245, v244, v245
v_mul_f32 v231, v244, v231
v_cvt_pk_bf16_f32 v231, v245, v231
v_accvgpr_write_b32 a124, v231
v_accvgpr_read_b32 v231, a125
v_lshlrev_b32 v245, 16, v231
v_and_b32 v231, 0xffff0000, v231
v_mul_f32 v245, v244, v245
v_mul_f32 v231, v244, v231
v_cvt_pk_bf16_f32 v231, v245, v231
v_accvgpr_write_b32 a125, v231
v_accvgpr_read_b32 v231, a126
v_lshlrev_b32 v245, 16, v231
v_and_b32 v231, 0xffff0000, v231
v_mul_f32 v245, v244, v245
v_mul_f32 v231, v244, v231
v_cvt_pk_bf16_f32 v231, v245, v231
v_accvgpr_write_b32 a126, v231
v_accvgpr_read_b32 v231, a127
v_lshlrev_b32 v245, 16, v231
v_and_b32 v231, 0xffff0000, v231
v_mul_f32 v245, v244, v245
v_mul_f32 v231, v244, v231
v_cvt_pk_bf16_f32 v231, v245, v231
v_accvgpr_write_b32 a127, v231
v_accvgpr_read_b32 v231, a136
v_lshlrev_b32 v245, 16, v231
v_and_b32 v231, 0xffff0000, v231
v_mul_f32 v245, v244, v245
v_mul_f32 v231, v244, v231
v_cvt_pk_bf16_f32 v231, v245, v231
v_accvgpr_write_b32 a136, v231
v_accvgpr_read_b32 v231, a137
v_lshlrev_b32 v245, 16, v231
v_and_b32 v231, 0xffff0000, v231
v_mul_f32 v245, v244, v245
v_mul_f32 v231, v244, v231
v_cvt_pk_bf16_f32 v231, v245, v231
v_accvgpr_write_b32 a137, v231
v_accvgpr_read_b32 v231, a138
v_lshlrev_b32 v245, 16, v231
v_and_b32 v231, 0xffff0000, v231
v_mul_f32 v245, v244, v245
v_mul_f32 v231, v244, v231
v_cvt_pk_bf16_f32 v231, v245, v231
v_accvgpr_write_b32 a138, v231
v_accvgpr_read_b32 v231, a139
v_lshlrev_b32 v245, 16, v231
v_and_b32 v231, 0xffff0000, v231
v_mul_f32 v245, v244, v245
v_mul_f32 v231, v244, v231
v_cvt_pk_bf16_f32 v231, v245, v231
v_accvgpr_write_b32 a139, v231
v_accvgpr_read_b32 v231, a148
v_lshlrev_b32 v245, 16, v231
v_and_b32 v231, 0xffff0000, v231
v_mul_f32 v245, v244, v245
v_mul_f32 v231, v244, v231
v_cvt_pk_bf16_f32 v231, v245, v231
v_accvgpr_write_b32 a148, v231
v_accvgpr_read_b32 v231, a149
v_lshlrev_b32 v245, 16, v231
v_and_b32 v231, 0xffff0000, v231
v_mul_f32 v245, v244, v245
v_mul_f32 v231, v244, v231
v_cvt_pk_bf16_f32 v231, v245, v231
v_accvgpr_write_b32 a149, v231
v_accvgpr_read_b32 v231, a150
v_lshlrev_b32 v245, 16, v231
v_and_b32 v231, 0xffff0000, v231
v_mul_f32 v245, v244, v245
v_mul_f32 v231, v244, v231
v_cvt_pk_bf16_f32 v231, v245, v231
v_accvgpr_write_b32 a150, v231
v_accvgpr_read_b32 v231, a151
v_lshlrev_b32 v245, 16, v231
v_and_b32 v231, 0xffff0000, v231
v_mul_f32 v245, v244, v245
v_mul_f32 v231, v244, v231
v_cvt_pk_bf16_f32 v231, v245, v231
v_accvgpr_write_b32 a151, v231
v_max3_f32 v244, v128, v129, v130
v_max3_f32 v244, v131, v132, v244
v_max3_f32 v244, v133, v134, v244
v_max3_f32 v244, v135, v244, v233
v_mov_b32 v245, v244
s_nop 1
v_permlane32_swap_b32 v244, v245
v_max_f32 v244, v244, v245
v_mov_b32 v245, v244
s_nop 1
v_permlane16_swap_b32 v244, v245
v_max_f32 v244, v244, v245
v_sub_f32 v128, v128, v244
v_sub_f32 v129, v129, v244
v_sub_f32 v130, v130, v244
v_sub_f32 v131, v131, v244
v_sub_f32 v132, v132, v244
v_sub_f32 v133, v133, v244
v_sub_f32 v134, v134, v244
v_sub_f32 v135, v135, v244
v_sub_f32 v245, v233, v244
v_mov_b32 v233, v244
v_exp_f32 v244, v245
v_accvgpr_read_b32 v231, a116
v_lshlrev_b32 v245, 16, v231
v_and_b32 v231, 0xffff0000, v231
v_mul_f32 v245, v244, v245
v_mul_f32 v231, v244, v231
v_cvt_pk_bf16_f32 v231, v245, v231
v_accvgpr_write_b32 a116, v231
v_accvgpr_read_b32 v231, a117
v_lshlrev_b32 v245, 16, v231
v_and_b32 v231, 0xffff0000, v231
v_mul_f32 v245, v244, v245
v_mul_f32 v231, v244, v231
v_cvt_pk_bf16_f32 v231, v245, v231
v_accvgpr_write_b32 a117, v231
v_accvgpr_read_b32 v231, a118
v_lshlrev_b32 v245, 16, v231
v_and_b32 v231, 0xffff0000, v231
v_mul_f32 v245, v244, v245
v_mul_f32 v231, v244, v231
v_cvt_pk_bf16_f32 v231, v245, v231
v_accvgpr_write_b32 a118, v231
v_accvgpr_read_b32 v231, a119
v_lshlrev_b32 v245, 16, v231
v_and_b32 v231, 0xffff0000, v231
v_mul_f32 v245, v244, v245
v_mul_f32 v231, v244, v231
v_cvt_pk_bf16_f32 v231, v245, v231
v_accvgpr_write_b32 a119, v231
v_accvgpr_read_b32 v231, a128
v_lshlrev_b32 v245, 16, v231
v_and_b32 v231, 0xffff0000, v231
v_mul_f32 v245, v244, v245
v_mul_f32 v231, v244, v231
v_cvt_pk_bf16_f32 v231, v245, v231
v_accvgpr_write_b32 a128, v231
v_accvgpr_read_b32 v231, a129
v_lshlrev_b32 v245, 16, v231
v_and_b32 v231, 0xffff0000, v231
v_mul_f32 v245, v244, v245
v_mul_f32 v231, v244, v231
v_cvt_pk_bf16_f32 v231, v245, v231
v_accvgpr_write_b32 a129, v231
v_accvgpr_read_b32 v231, a130
v_lshlrev_b32 v245, 16, v231
v_and_b32 v231, 0xffff0000, v231
v_mul_f32 v245, v244, v245
v_mul_f32 v231, v244, v231
v_cvt_pk_bf16_f32 v231, v245, v231
v_accvgpr_write_b32 a130, v231
v_accvgpr_read_b32 v231, a131
v_lshlrev_b32 v245, 16, v231
v_and_b32 v231, 0xffff0000, v231
v_mul_f32 v245, v244, v245
v_mul_f32 v231, v244, v231
v_cvt_pk_bf16_f32 v231, v245, v231
v_accvgpr_write_b32 a131, v231
v_accvgpr_read_b32 v231, a140
v_lshlrev_b32 v245, 16, v231
v_and_b32 v231, 0xffff0000, v231
v_mul_f32 v245, v244, v245
v_mul_f32 v231, v244, v231
v_cvt_pk_bf16_f32 v231, v245, v231
v_accvgpr_write_b32 a140, v231
v_accvgpr_read_b32 v231, a141
v_lshlrev_b32 v245, 16, v231
v_and_b32 v231, 0xffff0000, v231
v_mul_f32 v245, v244, v245
v_mul_f32 v231, v244, v231
v_cvt_pk_bf16_f32 v231, v245, v231
v_accvgpr_write_b32 a141, v231
v_accvgpr_read_b32 v231, a142
v_lshlrev_b32 v245, 16, v231
v_and_b32 v231, 0xffff0000, v231
v_mul_f32 v245, v244, v245
v_mul_f32 v231, v244, v231
v_cvt_pk_bf16_f32 v231, v245, v231
v_accvgpr_write_b32 a142, v231
v_accvgpr_read_b32 v231, a143
v_lshlrev_b32 v245, 16, v231
v_and_b32 v231, 0xffff0000, v231
v_mul_f32 v245, v244, v245
v_mul_f32 v231, v244, v231
v_cvt_pk_bf16_f32 v231, v245, v231
v_accvgpr_write_b32 a143, v231
v_accvgpr_read_b32 v231, a152
v_lshlrev_b32 v245, 16, v231
v_and_b32 v231, 0xffff0000, v231
v_mul_f32 v245, v244, v245
v_mul_f32 v231, v244, v231
v_cvt_pk_bf16_f32 v231, v245, v231
v_accvgpr_write_b32 a152, v231
v_accvgpr_read_b32 v231, a153
v_lshlrev_b32 v245, 16, v231
v_and_b32 v231, 0xffff0000, v231
v_mul_f32 v245, v244, v245
v_mul_f32 v231, v244, v231
v_cvt_pk_bf16_f32 v231, v245, v231
v_accvgpr_write_b32 a153, v231
v_accvgpr_read_b32 v231, a154
v_lshlrev_b32 v245, 16, v231
v_and_b32 v231, 0xffff0000, v231
v_mul_f32 v245, v244, v245
v_mul_f32 v231, v244, v231
v_cvt_pk_bf16_f32 v231, v245, v231
v_accvgpr_write_b32 a154, v231
v_accvgpr_read_b32 v231, a155
v_lshlrev_b32 v245, 16, v231
v_and_b32 v231, 0xffff0000, v231
v_mul_f32 v245, v244, v245
v_mul_f32 v231, v244, v231
v_cvt_pk_bf16_f32 v231, v245, v231
v_accvgpr_write_b32 a155, v231
v_max3_f32 v244, v136, v137, v138
v_max3_f32 v244, v139, v140, v244
v_max3_f32 v244, v141, v142, v244
v_max3_f32 v244, v143, v244, v234
v_mov_b32 v245, v244
s_nop 1
v_permlane32_swap_b32 v244, v245
v_max_f32 v244, v244, v245
v_mov_b32 v245, v244
s_nop 1
v_permlane16_swap_b32 v244, v245
v_max_f32 v244, v244, v245
v_sub_f32 v136, v136, v244
v_sub_f32 v137, v137, v244
v_sub_f32 v138, v138, v244
v_sub_f32 v139, v139, v244
v_sub_f32 v140, v140, v244
v_sub_f32 v141, v141, v244
v_sub_f32 v142, v142, v244
v_sub_f32 v143, v143, v244
v_sub_f32 v245, v234, v244
v_mov_b32 v234, v244
v_exp_f32 v244, v245
v_accvgpr_read_b32 v231, a120
v_lshlrev_b32 v245, 16, v231
v_and_b32 v231, 0xffff0000, v231
v_mul_f32 v245, v244, v245
v_mul_f32 v231, v244, v231
v_cvt_pk_bf16_f32 v231, v245, v231
v_accvgpr_write_b32 a120, v231
v_accvgpr_read_b32 v231, a121
v_lshlrev_b32 v245, 16, v231
v_and_b32 v231, 0xffff0000, v231
v_mul_f32 v245, v244, v245
v_mul_f32 v231, v244, v231
v_cvt_pk_bf16_f32 v231, v245, v231
v_accvgpr_write_b32 a121, v231
v_accvgpr_read_b32 v231, a122
v_lshlrev_b32 v245, 16, v231
v_and_b32 v231, 0xffff0000, v231
v_mul_f32 v245, v244, v245
v_mul_f32 v231, v244, v231
v_cvt_pk_bf16_f32 v231, v245, v231
v_accvgpr_write_b32 a122, v231
v_accvgpr_read_b32 v231, a123
v_lshlrev_b32 v245, 16, v231
v_and_b32 v231, 0xffff0000, v231
v_mul_f32 v245, v244, v245
v_mul_f32 v231, v244, v231
v_cvt_pk_bf16_f32 v231, v245, v231
v_accvgpr_write_b32 a123, v231
v_accvgpr_read_b32 v231, a132
v_lshlrev_b32 v245, 16, v231
v_and_b32 v231, 0xffff0000, v231
v_mul_f32 v245, v244, v245
v_mul_f32 v231, v244, v231
v_cvt_pk_bf16_f32 v231, v245, v231
v_accvgpr_write_b32 a132, v231
v_accvgpr_read_b32 v231, a133
v_lshlrev_b32 v245, 16, v231
v_and_b32 v231, 0xffff0000, v231
v_mul_f32 v245, v244, v245
v_mul_f32 v231, v244, v231
v_cvt_pk_bf16_f32 v231, v245, v231
v_accvgpr_write_b32 a133, v231
v_accvgpr_read_b32 v231, a134
v_lshlrev_b32 v245, 16, v231
v_and_b32 v231, 0xffff0000, v231
v_mul_f32 v245, v244, v245
v_mul_f32 v231, v244, v231
v_cvt_pk_bf16_f32 v231, v245, v231
v_accvgpr_write_b32 a134, v231
v_accvgpr_read_b32 v231, a135
v_lshlrev_b32 v245, 16, v231
v_and_b32 v231, 0xffff0000, v231
v_mul_f32 v245, v244, v245
v_mul_f32 v231, v244, v231
v_cvt_pk_bf16_f32 v231, v245, v231
v_accvgpr_write_b32 a135, v231
v_accvgpr_read_b32 v231, a144
v_lshlrev_b32 v245, 16, v231
v_and_b32 v231, 0xffff0000, v231
v_mul_f32 v245, v244, v245
v_mul_f32 v231, v244, v231
v_cvt_pk_bf16_f32 v231, v245, v231
v_accvgpr_write_b32 a144, v231
v_accvgpr_read_b32 v231, a145
v_lshlrev_b32 v245, 16, v231
v_and_b32 v231, 0xffff0000, v231
v_mul_f32 v245, v244, v245
v_mul_f32 v231, v244, v231
v_cvt_pk_bf16_f32 v231, v245, v231
v_accvgpr_write_b32 a145, v231
v_accvgpr_read_b32 v231, a146
v_lshlrev_b32 v245, 16, v231
v_and_b32 v231, 0xffff0000, v231
v_mul_f32 v245, v244, v245
v_mul_f32 v231, v244, v231
v_cvt_pk_bf16_f32 v231, v245, v231
v_accvgpr_write_b32 a146, v231
v_accvgpr_read_b32 v231, a147
v_lshlrev_b32 v245, 16, v231
v_and_b32 v231, 0xffff0000, v231
v_mul_f32 v245, v244, v245
v_mul_f32 v231, v244, v231
v_cvt_pk_bf16_f32 v231, v245, v231
v_accvgpr_write_b32 a147, v231
v_accvgpr_read_b32 v231, a156
v_lshlrev_b32 v245, 16, v231
v_and_b32 v231, 0xffff0000, v231
v_mul_f32 v245, v244, v245
v_mul_f32 v231, v244, v231
v_cvt_pk_bf16_f32 v231, v245, v231
v_accvgpr_write_b32 a156, v231
v_accvgpr_read_b32 v231, a157
v_lshlrev_b32 v245, 16, v231
v_and_b32 v231, 0xffff0000, v231
v_mul_f32 v245, v244, v245
v_mul_f32 v231, v244, v231
v_cvt_pk_bf16_f32 v231, v245, v231
v_accvgpr_write_b32 a157, v231
v_accvgpr_read_b32 v231, a158
v_lshlrev_b32 v245, 16, v231
v_and_b32 v231, 0xffff0000, v231
v_mul_f32 v245, v244, v245
v_mul_f32 v231, v244, v231
v_cvt_pk_bf16_f32 v231, v245, v231
v_accvgpr_write_b32 a158, v231
v_accvgpr_read_b32 v231, a159
v_lshlrev_b32 v245, 16, v231
v_and_b32 v231, 0xffff0000, v231
v_mul_f32 v245, v244, v245
v_mul_f32 v231, v244, v231
v_cvt_pk_bf16_f32 v231, v245, v231
v_accvgpr_write_b32 a159, v231
s_nop 1
s_branch L_back1_4
L_rare1_5:
s_mov_b32 s65, 0xff800000
v_max3_f32 v244, v96, v97, v98
v_max3_f32 v244, v99, v100, v244
v_max3_f32 v244, v101, v102, v244
v_max3_f32 v244, v103, v244, v232
v_mov_b32 v245, v244
s_nop 1
v_permlane32_swap_b32 v244, v245
v_max_f32 v244, v244, v245
v_mov_b32 v245, v244
s_nop 1
v_permlane16_swap_b32 v244, v245
v_max_f32 v244, v244, v245
v_sub_f32 v96, v96, v244
v_sub_f32 v97, v97, v244
v_sub_f32 v98, v98, v244
v_sub_f32 v99, v99, v244
v_sub_f32 v100, v100, v244
v_sub_f32 v101, v101, v244
v_sub_f32 v102, v102, v244
v_sub_f32 v103, v103, v244
v_sub_f32 v245, v232, v244
v_mov_b32 v232, v244
v_exp_f32 v244, v245
v_accvgpr_read_b32 v231, a112
v_lshlrev_b32 v245, 16, v231
v_and_b32 v231, 0xffff0000, v231
v_mul_f32 v245, v244, v245
v_mul_f32 v231, v244, v231
v_cvt_pk_bf16_f32 v231, v245, v231
v_accvgpr_write_b32 a112, v231
v_accvgpr_read_b32 v231, a113
v_lshlrev_b32 v245, 16, v231
v_and_b32 v231, 0xffff0000, v231
v_mul_f32 v245, v244, v245
v_mul_f32 v231, v244, v231
v_cvt_pk_bf16_f32 v231, v245, v231
v_accvgpr_write_b32 a113, v231
v_accvgpr_read_b32 v231, a114
v_lshlrev_b32 v245, 16, v231
v_and_b32 v231, 0xffff0000, v231
v_mul_f32 v245, v244, v245
v_mul_f32 v231, v244, v231
v_cvt_pk_bf16_f32 v231, v245, v231
v_accvgpr_write_b32 a114, v231
v_accvgpr_read_b32 v231, a115
v_lshlrev_b32 v245, 16, v231
v_and_b32 v231, 0xffff0000, v231
v_mul_f32 v245, v244, v245
v_mul_f32 v231, v244, v231
v_cvt_pk_bf16_f32 v231, v245, v231
v_accvgpr_write_b32 a115, v231
v_accvgpr_read_b32 v231, a124
v_lshlrev_b32 v245, 16, v231
v_and_b32 v231, 0xffff0000, v231
v_mul_f32 v245, v244, v245
v_mul_f32 v231, v244, v231
v_cvt_pk_bf16_f32 v231, v245, v231
v_accvgpr_write_b32 a124, v231
v_accvgpr_read_b32 v231, a125
v_lshlrev_b32 v245, 16, v231
v_and_b32 v231, 0xffff0000, v231
v_mul_f32 v245, v244, v245
v_mul_f32 v231, v244, v231
v_cvt_pk_bf16_f32 v231, v245, v231
v_accvgpr_write_b32 a125, v231
v_accvgpr_read_b32 v231, a126
v_lshlrev_b32 v245, 16, v231
v_and_b32 v231, 0xffff0000, v231
v_mul_f32 v245, v244, v245
v_mul_f32 v231, v244, v231
v_cvt_pk_bf16_f32 v231, v245, v231
v_accvgpr_write_b32 a126, v231
v_accvgpr_read_b32 v231, a127
v_lshlrev_b32 v245, 16, v231
v_and_b32 v231, 0xffff0000, v231
v_mul_f32 v245, v244, v245
v_mul_f32 v231, v244, v231
v_cvt_pk_bf16_f32 v231, v245, v231
v_accvgpr_write_b32 a127, v231
v_accvgpr_read_b32 v231, a136
v_lshlrev_b32 v245, 16, v231
v_and_b32 v231, 0xffff0000, v231
v_mul_f32 v245, v244, v245
v_mul_f32 v231, v244, v231
v_cvt_pk_bf16_f32 v231, v245, v231
v_accvgpr_write_b32 a136, v231
v_accvgpr_read_b32 v231, a137
v_lshlrev_b32 v245, 16, v231
v_and_b32 v231, 0xffff0000, v231
v_mul_f32 v245, v244, v245
v_mul_f32 v231, v244, v231
v_cvt_pk_bf16_f32 v231, v245, v231
v_accvgpr_write_b32 a137, v231
v_accvgpr_read_b32 v231, a138
v_lshlrev_b32 v245, 16, v231
v_and_b32 v231, 0xffff0000, v231
v_mul_f32 v245, v244, v245
v_mul_f32 v231, v244, v231
v_cvt_pk_bf16_f32 v231, v245, v231
v_accvgpr_write_b32 a138, v231
v_accvgpr_read_b32 v231, a139
v_lshlrev_b32 v245, 16, v231
v_and_b32 v231, 0xffff0000, v231
v_mul_f32 v245, v244, v245
v_mul_f32 v231, v244, v231
v_cvt_pk_bf16_f32 v231, v245, v231
v_accvgpr_write_b32 a139, v231
v_accvgpr_read_b32 v231, a148
v_lshlrev_b32 v245, 16, v231
v_and_b32 v231, 0xffff0000, v231
v_mul_f32 v245, v244, v245
v_mul_f32 v231, v244, v231
v_cvt_pk_bf16_f32 v231, v245, v231
v_accvgpr_write_b32 a148, v231
v_accvgpr_read_b32 v231, a149
v_lshlrev_b32 v245, 16, v231
v_and_b32 v231, 0xffff0000, v231
v_mul_f32 v245, v244, v245
v_mul_f32 v231, v244, v231
v_cvt_pk_bf16_f32 v231, v245, v231
v_accvgpr_write_b32 a149, v231
v_accvgpr_read_b32 v231, a150
v_lshlrev_b32 v245, 16, v231
v_and_b32 v231, 0xffff0000, v231
v_mul_f32 v245, v244, v245
v_mul_f32 v231, v244, v231
v_cvt_pk_bf16_f32 v231, v245, v231
v_accvgpr_write_b32 a150, v231
v_accvgpr_read_b32 v231, a151
v_lshlrev_b32 v245, 16, v231
v_and_b32 v231, 0xffff0000, v231
v_mul_f32 v245, v244, v245
v_mul_f32 v231, v244, v231
v_cvt_pk_bf16_f32 v231, v245, v231
v_accvgpr_write_b32 a151, v231
v_accvgpr_read_b32 v231, a160
v_lshlrev_b32 v245, 16, v231
v_and_b32 v231, 0xffff0000, v231
v_mul_f32 v245, v244, v245
v_mul_f32 v231, v244, v231
v_cvt_pk_bf16_f32 v231, v245, v231
v_accvgpr_write_b32 a160, v231
v_accvgpr_read_b32 v231, a161
v_lshlrev_b32 v245, 16, v231
v_and_b32 v231, 0xffff0000, v231
v_mul_f32 v245, v244, v245
v_mul_f32 v231, v244, v231
v_cvt_pk_bf16_f32 v231, v245, v231
v_accvgpr_write_b32 a161, v231
v_accvgpr_read_b32 v231, a162
v_lshlrev_b32 v245, 16, v231
v_and_b32 v231, 0xffff0000, v231
v_mul_f32 v245, v244, v245
v_mul_f32 v231, v244, v231
v_cvt_pk_bf16_f32 v231, v245, v231
v_accvgpr_write_b32 a162, v231
v_accvgpr_read_b32 v231, a163
v_lshlrev_b32 v245, 16, v231
v_and_b32 v231, 0xffff0000, v231
v_mul_f32 v245, v244, v245
v_mul_f32 v231, v244, v231
v_cvt_pk_bf16_f32 v231, v245, v231
v_accvgpr_write_b32 a163, v231
v_max3_f32 v244, v104, v105, v106
v_max3_f32 v244, v107, v108, v244
v_max3_f32 v244, v109, v110, v244
v_max3_f32 v244, v111, v244, v233
v_mov_b32 v245, v244
s_nop 1
v_permlane32_swap_b32 v244, v245
v_max_f32 v244, v244, v245
v_mov_b32 v245, v244
s_nop 1
v_permlane16_swap_b32 v244, v245
v_max_f32 v244, v244, v245
v_sub_f32 v104, v104, v244
v_sub_f32 v105, v105, v244
v_sub_f32 v106, v106, v244
v_sub_f32 v107, v107, v244
v_sub_f32 v108, v108, v244
v_sub_f32 v109, v109, v244
v_sub_f32 v110, v110, v244
v_sub_f32 v111, v111, v244
v_sub_f32 v245, v233, v244
v_mov_b32 v233, v244
v_exp_f32 v244, v245
v_accvgpr_read_b32 v231, a116
v_lshlrev_b32 v245, 16, v231
v_and_b32 v231, 0xffff0000, v231
v_mul_f32 v245, v244, v245
v_mul_f32 v231, v244, v231
v_cvt_pk_bf16_f32 v231, v245, v231
v_accvgpr_write_b32 a116, v231
v_accvgpr_read_b32 v231, a117
v_lshlrev_b32 v245, 16, v231
v_and_b32 v231, 0xffff0000, v231
v_mul_f32 v245, v244, v245
v_mul_f32 v231, v244, v231
v_cvt_pk_bf16_f32 v231, v245, v231
v_accvgpr_write_b32 a117, v231
v_accvgpr_read_b32 v231, a118
v_lshlrev_b32 v245, 16, v231
v_and_b32 v231, 0xffff0000, v231
v_mul_f32 v245, v244, v245
v_mul_f32 v231, v244, v231
v_cvt_pk_bf16_f32 v231, v245, v231
v_accvgpr_write_b32 a118, v231
v_accvgpr_read_b32 v231, a119
v_lshlrev_b32 v245, 16, v231
v_and_b32 v231, 0xffff0000, v231
v_mul_f32 v245, v244, v245
v_mul_f32 v231, v244, v231
v_cvt_pk_bf16_f32 v231, v245, v231
v_accvgpr_write_b32 a119, v231
v_accvgpr_read_b32 v231, a128
v_lshlrev_b32 v245, 16, v231
v_and_b32 v231, 0xffff0000, v231
v_mul_f32 v245, v244, v245
v_mul_f32 v231, v244, v231
v_cvt_pk_bf16_f32 v231, v245, v231
v_accvgpr_write_b32 a128, v231
v_accvgpr_read_b32 v231, a129
v_lshlrev_b32 v245, 16, v231
v_and_b32 v231, 0xffff0000, v231
v_mul_f32 v245, v244, v245
v_mul_f32 v231, v244, v231
v_cvt_pk_bf16_f32 v231, v245, v231
v_accvgpr_write_b32 a129, v231
v_accvgpr_read_b32 v231, a130
v_lshlrev_b32 v245, 16, v231
v_and_b32 v231, 0xffff0000, v231
v_mul_f32 v245, v244, v245
v_mul_f32 v231, v244, v231
v_cvt_pk_bf16_f32 v231, v245, v231
v_accvgpr_write_b32 a130, v231
v_accvgpr_read_b32 v231, a131
v_lshlrev_b32 v245, 16, v231
v_and_b32 v231, 0xffff0000, v231
v_mul_f32 v245, v244, v245
v_mul_f32 v231, v244, v231
v_cvt_pk_bf16_f32 v231, v245, v231
v_accvgpr_write_b32 a131, v231
v_accvgpr_read_b32 v231, a140
v_lshlrev_b32 v245, 16, v231
v_and_b32 v231, 0xffff0000, v231
v_mul_f32 v245, v244, v245
v_mul_f32 v231, v244, v231
v_cvt_pk_bf16_f32 v231, v245, v231
v_accvgpr_write_b32 a140, v231
v_accvgpr_read_b32 v231, a141
v_lshlrev_b32 v245, 16, v231
v_and_b32 v231, 0xffff0000, v231
v_mul_f32 v245, v244, v245
v_mul_f32 v231, v244, v231
v_cvt_pk_bf16_f32 v231, v245, v231
v_accvgpr_write_b32 a141, v231
v_accvgpr_read_b32 v231, a142
v_lshlrev_b32 v245, 16, v231
v_and_b32 v231, 0xffff0000, v231
v_mul_f32 v245, v244, v245
v_mul_f32 v231, v244, v231
v_cvt_pk_bf16_f32 v231, v245, v231
v_accvgpr_write_b32 a142, v231
v_accvgpr_read_b32 v231, a143
v_lshlrev_b32 v245, 16, v231
v_and_b32 v231, 0xffff0000, v231
v_mul_f32 v245, v244, v245
v_mul_f32 v231, v244, v231
v_cvt_pk_bf16_f32 v231, v245, v231
v_accvgpr_write_b32 a143, v231
v_accvgpr_read_b32 v231, a152
v_lshlrev_b32 v245, 16, v231
v_and_b32 v231, 0xffff0000, v231
v_mul_f32 v245, v244, v245
v_mul_f32 v231, v244, v231
v_cvt_pk_bf16_f32 v231, v245, v231
v_accvgpr_write_b32 a152, v231
v_accvgpr_read_b32 v231, a153
v_lshlrev_b32 v245, 16, v231
v_and_b32 v231, 0xffff0000, v231
v_mul_f32 v245, v244, v245
v_mul_f32 v231, v244, v231
v_cvt_pk_bf16_f32 v231, v245, v231
v_accvgpr_write_b32 a153, v231
v_accvgpr_read_b32 v231, a154
v_lshlrev_b32 v245, 16, v231
v_and_b32 v231, 0xffff0000, v231
v_mul_f32 v245, v244, v245
v_mul_f32 v231, v244, v231
v_cvt_pk_bf16_f32 v231, v245, v231
v_accvgpr_write_b32 a154, v231
v_accvgpr_read_b32 v231, a155
v_lshlrev_b32 v245, 16, v231
v_and_b32 v231, 0xffff0000, v231
v_mul_f32 v245, v244, v245
v_mul_f32 v231, v244, v231
v_cvt_pk_bf16_f32 v231, v245, v231
v_accvgpr_write_b32 a155, v231
v_accvgpr_read_b32 v231, a164
v_lshlrev_b32 v245, 16, v231
v_and_b32 v231, 0xffff0000, v231
v_mul_f32 v245, v244, v245
v_mul_f32 v231, v244, v231
v_cvt_pk_bf16_f32 v231, v245, v231
v_accvgpr_write_b32 a164, v231
v_accvgpr_read_b32 v231, a165
v_lshlrev_b32 v245, 16, v231
v_and_b32 v231, 0xffff0000, v231
v_mul_f32 v245, v244, v245
v_mul_f32 v231, v244, v231
v_cvt_pk_bf16_f32 v231, v245, v231
v_accvgpr_write_b32 a165, v231
v_accvgpr_read_b32 v231, a166
v_lshlrev_b32 v245, 16, v231
v_and_b32 v231, 0xffff0000, v231
v_mul_f32 v245, v244, v245
v_mul_f32 v231, v244, v231
v_cvt_pk_bf16_f32 v231, v245, v231
v_accvgpr_write_b32 a166, v231
v_accvgpr_read_b32 v231, a167
v_lshlrev_b32 v245, 16, v231
v_and_b32 v231, 0xffff0000, v231
v_mul_f32 v245, v244, v245
v_mul_f32 v231, v244, v231
v_cvt_pk_bf16_f32 v231, v245, v231
v_accvgpr_write_b32 a167, v231
v_max3_f32 v244, v112, v113, v114
v_max3_f32 v244, v115, v116, v244
v_max3_f32 v244, v117, v118, v244
v_max3_f32 v244, v119, v244, v234
v_mov_b32 v245, v244
s_nop 1
v_permlane32_swap_b32 v244, v245
v_max_f32 v244, v244, v245
v_mov_b32 v245, v244
s_nop 1
v_permlane16_swap_b32 v244, v245
v_max_f32 v244, v244, v245
v_sub_f32 v112, v112, v244
v_sub_f32 v113, v113, v244
v_sub_f32 v114, v114, v244
v_sub_f32 v115, v115, v244
v_sub_f32 v116, v116, v244
v_sub_f32 v117, v117, v244
v_sub_f32 v118, v118, v244
v_sub_f32 v119, v119, v244
v_sub_f32 v245, v234, v244
v_mov_b32 v234, v244
v_exp_f32 v244, v245
v_accvgpr_read_b32 v231, a120
v_lshlrev_b32 v245, 16, v231
v_and_b32 v231, 0xffff0000, v231
v_mul_f32 v245, v244, v245
v_mul_f32 v231, v244, v231
v_cvt_pk_bf16_f32 v231, v245, v231
v_accvgpr_write_b32 a120, v231
v_accvgpr_read_b32 v231, a121
v_lshlrev_b32 v245, 16, v231
v_and_b32 v231, 0xffff0000, v231
v_mul_f32 v245, v244, v245
v_mul_f32 v231, v244, v231
v_cvt_pk_bf16_f32 v231, v245, v231
v_accvgpr_write_b32 a121, v231
v_accvgpr_read_b32 v231, a122
v_lshlrev_b32 v245, 16, v231
v_and_b32 v231, 0xffff0000, v231
v_mul_f32 v245, v244, v245
v_mul_f32 v231, v244, v231
v_cvt_pk_bf16_f32 v231, v245, v231
v_accvgpr_write_b32 a122, v231
v_accvgpr_read_b32 v231, a123
v_lshlrev_b32 v245, 16, v231
v_and_b32 v231, 0xffff0000, v231
v_mul_f32 v245, v244, v245
v_mul_f32 v231, v244, v231
v_cvt_pk_bf16_f32 v231, v245, v231
v_accvgpr_write_b32 a123, v231
v_accvgpr_read_b32 v231, a132
v_lshlrev_b32 v245, 16, v231
v_and_b32 v231, 0xffff0000, v231
v_mul_f32 v245, v244, v245
v_mul_f32 v231, v244, v231
v_cvt_pk_bf16_f32 v231, v245, v231
v_accvgpr_write_b32 a132, v231
v_accvgpr_read_b32 v231, a133
v_lshlrev_b32 v245, 16, v231
v_and_b32 v231, 0xffff0000, v231
v_mul_f32 v245, v244, v245
v_mul_f32 v231, v244, v231
v_cvt_pk_bf16_f32 v231, v245, v231
v_accvgpr_write_b32 a133, v231
v_accvgpr_read_b32 v231, a134
v_lshlrev_b32 v245, 16, v231
v_and_b32 v231, 0xffff0000, v231
v_mul_f32 v245, v244, v245
v_mul_f32 v231, v244, v231
v_cvt_pk_bf16_f32 v231, v245, v231
v_accvgpr_write_b32 a134, v231
v_accvgpr_read_b32 v231, a135
v_lshlrev_b32 v245, 16, v231
v_and_b32 v231, 0xffff0000, v231
v_mul_f32 v245, v244, v245
v_mul_f32 v231, v244, v231
v_cvt_pk_bf16_f32 v231, v245, v231
v_accvgpr_write_b32 a135, v231
v_accvgpr_read_b32 v231, a144
v_lshlrev_b32 v245, 16, v231
v_and_b32 v231, 0xffff0000, v231
v_mul_f32 v245, v244, v245
v_mul_f32 v231, v244, v231
v_cvt_pk_bf16_f32 v231, v245, v231
v_accvgpr_write_b32 a144, v231
v_accvgpr_read_b32 v231, a145
v_lshlrev_b32 v245, 16, v231
v_and_b32 v231, 0xffff0000, v231
v_mul_f32 v245, v244, v245
v_mul_f32 v231, v244, v231
v_cvt_pk_bf16_f32 v231, v245, v231
v_accvgpr_write_b32 a145, v231
v_accvgpr_read_b32 v231, a146
v_lshlrev_b32 v245, 16, v231
v_and_b32 v231, 0xffff0000, v231
v_mul_f32 v245, v244, v245
v_mul_f32 v231, v244, v231
v_cvt_pk_bf16_f32 v231, v245, v231
v_accvgpr_write_b32 a146, v231
v_accvgpr_read_b32 v231, a147
v_lshlrev_b32 v245, 16, v231
v_and_b32 v231, 0xffff0000, v231
v_mul_f32 v245, v244, v245
v_mul_f32 v231, v244, v231
v_cvt_pk_bf16_f32 v231, v245, v231
v_accvgpr_write_b32 a147, v231
v_accvgpr_read_b32 v231, a156
v_lshlrev_b32 v245, 16, v231
v_and_b32 v231, 0xffff0000, v231
v_mul_f32 v245, v244, v245
v_mul_f32 v231, v244, v231
v_cvt_pk_bf16_f32 v231, v245, v231
v_accvgpr_write_b32 a156, v231
v_accvgpr_read_b32 v231, a157
v_lshlrev_b32 v245, 16, v231
v_and_b32 v231, 0xffff0000, v231
v_mul_f32 v245, v244, v245
v_mul_f32 v231, v244, v231
v_cvt_pk_bf16_f32 v231, v245, v231
v_accvgpr_write_b32 a157, v231
v_accvgpr_read_b32 v231, a158
v_lshlrev_b32 v245, 16, v231
v_and_b32 v231, 0xffff0000, v231
v_mul_f32 v245, v244, v245
v_mul_f32 v231, v244, v231
v_cvt_pk_bf16_f32 v231, v245, v231
v_accvgpr_write_b32 a158, v231
v_accvgpr_read_b32 v231, a159
v_lshlrev_b32 v245, 16, v231
v_and_b32 v231, 0xffff0000, v231
v_mul_f32 v245, v244, v245
v_mul_f32 v231, v244, v231
v_cvt_pk_bf16_f32 v231, v245, v231
v_accvgpr_write_b32 a159, v231
v_accvgpr_read_b32 v231, a168
v_lshlrev_b32 v245, 16, v231
v_and_b32 v231, 0xffff0000, v231
v_mul_f32 v245, v244, v245
v_mul_f32 v231, v244, v231
v_cvt_pk_bf16_f32 v231, v245, v231
v_accvgpr_write_b32 a168, v231
v_accvgpr_read_b32 v231, a169
v_lshlrev_b32 v245, 16, v231
v_and_b32 v231, 0xffff0000, v231
v_mul_f32 v245, v244, v245
v_mul_f32 v231, v244, v231
v_cvt_pk_bf16_f32 v231, v245, v231
v_accvgpr_write_b32 a169, v231
v_accvgpr_read_b32 v231, a170
v_lshlrev_b32 v245, 16, v231
v_and_b32 v231, 0xffff0000, v231
v_mul_f32 v245, v244, v245
v_mul_f32 v231, v244, v231
v_cvt_pk_bf16_f32 v231, v245, v231
v_accvgpr_write_b32 a170, v231
v_accvgpr_read_b32 v231, a171
v_lshlrev_b32 v245, 16, v231
v_and_b32 v231, 0xffff0000, v231
v_mul_f32 v245, v244, v245
v_mul_f32 v231, v244, v231
v_cvt_pk_bf16_f32 v231, v245, v231
v_accvgpr_write_b32 a171, v231
s_nop 1
s_branch L_back1_5
L_rare1_6:
s_mov_b32 s65, 0xff800000
v_max3_f32 v244, v120, v121, v122
v_max3_f32 v244, v123, v124, v244
v_max3_f32 v244, v125, v126, v244
v_max3_f32 v244, v127, v244, v232
v_mov_b32 v245, v244
s_nop 1
v_permlane32_swap_b32 v244, v245
v_max_f32 v244, v244, v245
v_mov_b32 v245, v244
s_nop 1
v_permlane16_swap_b32 v244, v245
v_max_f32 v244, v244, v245
v_sub_f32 v120, v120, v244
v_sub_f32 v121, v121, v244
v_sub_f32 v122, v122, v244
v_sub_f32 v123, v123, v244
v_sub_f32 v124, v124, v244
v_sub_f32 v125, v125, v244
v_sub_f32 v126, v126, v244
v_sub_f32 v127, v127, v244
v_sub_f32 v245, v232, v244
v_mov_b32 v232, v244
v_exp_f32 v244, v245
v_accvgpr_read_b32 v231, a112
v_lshlrev_b32 v245, 16, v231
v_and_b32 v231, 0xffff0000, v231
v_mul_f32 v245, v244, v245
v_mul_f32 v231, v244, v231
v_cvt_pk_bf16_f32 v231, v245, v231
v_accvgpr_write_b32 a112, v231
v_accvgpr_read_b32 v231, a113
v_lshlrev_b32 v245, 16, v231
v_and_b32 v231, 0xffff0000, v231
v_mul_f32 v245, v244, v245
v_mul_f32 v231, v244, v231
v_cvt_pk_bf16_f32 v231, v245, v231
v_accvgpr_write_b32 a113, v231
v_accvgpr_read_b32 v231, a114
v_lshlrev_b32 v245, 16, v231
v_and_b32 v231, 0xffff0000, v231
v_mul_f32 v245, v244, v245
v_mul_f32 v231, v244, v231
v_cvt_pk_bf16_f32 v231, v245, v231
v_accvgpr_write_b32 a114, v231
v_accvgpr_read_b32 v231, a115
v_lshlrev_b32 v245, 16, v231
v_and_b32 v231, 0xffff0000, v231
v_mul_f32 v245, v244, v245
v_mul_f32 v231, v244, v231
v_cvt_pk_bf16_f32 v231, v245, v231
v_accvgpr_write_b32 a115, v231
v_accvgpr_read_b32 v231, a124
v_lshlrev_b32 v245, 16, v231
v_and_b32 v231, 0xffff0000, v231
v_mul_f32 v245, v244, v245
v_mul_f32 v231, v244, v231
v_cvt_pk_bf16_f32 v231, v245, v231
v_accvgpr_write_b32 a124, v231
v_accvgpr_read_b32 v231, a125
v_lshlrev_b32 v245, 16, v231
v_and_b32 v231, 0xffff0000, v231
v_mul_f32 v245, v244, v245
v_mul_f32 v231, v244, v231
v_cvt_pk_bf16_f32 v231, v245, v231
v_accvgpr_write_b32 a125, v231
v_accvgpr_read_b32 v231, a126
v_lshlrev_b32 v245, 16, v231
v_and_b32 v231, 0xffff0000, v231
v_mul_f32 v245, v244, v245
v_mul_f32 v231, v244, v231
v_cvt_pk_bf16_f32 v231, v245, v231
v_accvgpr_write_b32 a126, v231
v_accvgpr_read_b32 v231, a127
v_lshlrev_b32 v245, 16, v231
v_and_b32 v231, 0xffff0000, v231
v_mul_f32 v245, v244, v245
v_mul_f32 v231, v244, v231
v_cvt_pk_bf16_f32 v231, v245, v231
v_accvgpr_write_b32 a127, v231
v_accvgpr_read_b32 v231, a136
v_lshlrev_b32 v245, 16, v231
v_and_b32 v231, 0xffff0000, v231
v_mul_f32 v245, v244, v245
v_mul_f32 v231, v244, v231
v_cvt_pk_bf16_f32 v231, v245, v231
v_accvgpr_write_b32 a136, v231
v_accvgpr_read_b32 v231, a137
v_lshlrev_b32 v245, 16, v231
v_and_b32 v231, 0xffff0000, v231
v_mul_f32 v245, v244, v245
v_mul_f32 v231, v244, v231
v_cvt_pk_bf16_f32 v231, v245, v231
v_accvgpr_write_b32 a137, v231
v_accvgpr_read_b32 v231, a138
v_lshlrev_b32 v245, 16, v231
v_and_b32 v231, 0xffff0000, v231
v_mul_f32 v245, v244, v245
v_mul_f32 v231, v244, v231
v_cvt_pk_bf16_f32 v231, v245, v231
v_accvgpr_write_b32 a138, v231
v_accvgpr_read_b32 v231, a139
v_lshlrev_b32 v245, 16, v231
v_and_b32 v231, 0xffff0000, v231
v_mul_f32 v245, v244, v245
v_mul_f32 v231, v244, v231
v_cvt_pk_bf16_f32 v231, v245, v231
v_accvgpr_write_b32 a139, v231
v_accvgpr_read_b32 v231, a148
v_lshlrev_b32 v245, 16, v231
v_and_b32 v231, 0xffff0000, v231
v_mul_f32 v245, v244, v245
v_mul_f32 v231, v244, v231
v_cvt_pk_bf16_f32 v231, v245, v231
v_accvgpr_write_b32 a148, v231
v_accvgpr_read_b32 v231, a149
v_lshlrev_b32 v245, 16, v231
v_and_b32 v231, 0xffff0000, v231
v_mul_f32 v245, v244, v245
v_mul_f32 v231, v244, v231
v_cvt_pk_bf16_f32 v231, v245, v231
v_accvgpr_write_b32 a149, v231
v_accvgpr_read_b32 v231, a150
v_lshlrev_b32 v245, 16, v231
v_and_b32 v231, 0xffff0000, v231
v_mul_f32 v245, v244, v245
v_mul_f32 v231, v244, v231
v_cvt_pk_bf16_f32 v231, v245, v231
v_accvgpr_write_b32 a150, v231
v_accvgpr_read_b32 v231, a151
v_lshlrev_b32 v245, 16, v231
v_and_b32 v231, 0xffff0000, v231
v_mul_f32 v245, v244, v245
v_mul_f32 v231, v244, v231
v_cvt_pk_bf16_f32 v231, v245, v231
v_accvgpr_write_b32 a151, v231
v_accvgpr_read_b32 v231, a160
v_lshlrev_b32 v245, 16, v231
v_and_b32 v231, 0xffff0000, v231
v_mul_f32 v245, v244, v245
v_mul_f32 v231, v244, v231
v_cvt_pk_bf16_f32 v231, v245, v231
v_accvgpr_write_b32 a160, v231
v_accvgpr_read_b32 v231, a161
v_lshlrev_b32 v245, 16, v231
v_and_b32 v231, 0xffff0000, v231
v_mul_f32 v245, v244, v245
v_mul_f32 v231, v244, v231
v_cvt_pk_bf16_f32 v231, v245, v231
v_accvgpr_write_b32 a161, v231
v_accvgpr_read_b32 v231, a162
v_lshlrev_b32 v245, 16, v231
v_and_b32 v231, 0xffff0000, v231
v_mul_f32 v245, v244, v245
v_mul_f32 v231, v244, v231
v_cvt_pk_bf16_f32 v231, v245, v231
v_accvgpr_write_b32 a162, v231
v_accvgpr_read_b32 v231, a163
v_lshlrev_b32 v245, 16, v231
v_and_b32 v231, 0xffff0000, v231
v_mul_f32 v245, v244, v245
v_mul_f32 v231, v244, v231
v_cvt_pk_bf16_f32 v231, v245, v231
v_accvgpr_write_b32 a163, v231
v_accvgpr_read_b32 v231, a172
v_lshlrev_b32 v245, 16, v231
v_and_b32 v231, 0xffff0000, v231
v_mul_f32 v245, v244, v245
v_mul_f32 v231, v244, v231
v_cvt_pk_bf16_f32 v231, v245, v231
v_accvgpr_write_b32 a172, v231
v_accvgpr_read_b32 v231, a173
v_lshlrev_b32 v245, 16, v231
v_and_b32 v231, 0xffff0000, v231
v_mul_f32 v245, v244, v245
v_mul_f32 v231, v244, v231
v_cvt_pk_bf16_f32 v231, v245, v231
v_accvgpr_write_b32 a173, v231
v_accvgpr_read_b32 v231, a174
v_lshlrev_b32 v245, 16, v231
v_and_b32 v231, 0xffff0000, v231
v_mul_f32 v245, v244, v245
v_mul_f32 v231, v244, v231
v_cvt_pk_bf16_f32 v231, v245, v231
v_accvgpr_write_b32 a174, v231
v_accvgpr_read_b32 v231, a175
v_lshlrev_b32 v245, 16, v231
v_and_b32 v231, 0xffff0000, v231
v_mul_f32 v245, v244, v245
v_mul_f32 v231, v244, v231
v_cvt_pk_bf16_f32 v231, v245, v231
v_accvgpr_write_b32 a175, v231
v_max3_f32 v244, v128, v129, v130
v_max3_f32 v244, v131, v132, v244
v_max3_f32 v244, v133, v134, v244
v_max3_f32 v244, v135, v244, v233
v_mov_b32 v245, v244
s_nop 1
v_permlane32_swap_b32 v244, v245
v_max_f32 v244, v244, v245
v_mov_b32 v245, v244
s_nop 1
v_permlane16_swap_b32 v244, v245
v_max_f32 v244, v244, v245
v_sub_f32 v128, v128, v244
v_sub_f32 v129, v129, v244
v_sub_f32 v130, v130, v244
v_sub_f32 v131, v131, v244
v_sub_f32 v132, v132, v244
v_sub_f32 v133, v133, v244
v_sub_f32 v134, v134, v244
v_sub_f32 v135, v135, v244
v_sub_f32 v245, v233, v244
v_mov_b32 v233, v244
v_exp_f32 v244, v245
v_accvgpr_read_b32 v231, a116
v_lshlrev_b32 v245, 16, v231
v_and_b32 v231, 0xffff0000, v231
v_mul_f32 v245, v244, v245
v_mul_f32 v231, v244, v231
v_cvt_pk_bf16_f32 v231, v245, v231
v_accvgpr_write_b32 a116, v231
v_accvgpr_read_b32 v231, a117
v_lshlrev_b32 v245, 16, v231
v_and_b32 v231, 0xffff0000, v231
v_mul_f32 v245, v244, v245
v_mul_f32 v231, v244, v231
v_cvt_pk_bf16_f32 v231, v245, v231
v_accvgpr_write_b32 a117, v231
v_accvgpr_read_b32 v231, a118
v_lshlrev_b32 v245, 16, v231
v_and_b32 v231, 0xffff0000, v231
v_mul_f32 v245, v244, v245
v_mul_f32 v231, v244, v231
v_cvt_pk_bf16_f32 v231, v245, v231
v_accvgpr_write_b32 a118, v231
v_accvgpr_read_b32 v231, a119
v_lshlrev_b32 v245, 16, v231
v_and_b32 v231, 0xffff0000, v231
v_mul_f32 v245, v244, v245
v_mul_f32 v231, v244, v231
v_cvt_pk_bf16_f32 v231, v245, v231
v_accvgpr_write_b32 a119, v231
v_accvgpr_read_b32 v231, a128
v_lshlrev_b32 v245, 16, v231
v_and_b32 v231, 0xffff0000, v231
v_mul_f32 v245, v244, v245
v_mul_f32 v231, v244, v231
v_cvt_pk_bf16_f32 v231, v245, v231
v_accvgpr_write_b32 a128, v231
v_accvgpr_read_b32 v231, a129
v_lshlrev_b32 v245, 16, v231
v_and_b32 v231, 0xffff0000, v231
v_mul_f32 v245, v244, v245
v_mul_f32 v231, v244, v231
v_cvt_pk_bf16_f32 v231, v245, v231
v_accvgpr_write_b32 a129, v231
v_accvgpr_read_b32 v231, a130
v_lshlrev_b32 v245, 16, v231
v_and_b32 v231, 0xffff0000, v231
v_mul_f32 v245, v244, v245
v_mul_f32 v231, v244, v231
v_cvt_pk_bf16_f32 v231, v245, v231
v_accvgpr_write_b32 a130, v231
v_accvgpr_read_b32 v231, a131
v_lshlrev_b32 v245, 16, v231
v_and_b32 v231, 0xffff0000, v231
v_mul_f32 v245, v244, v245
v_mul_f32 v231, v244, v231
v_cvt_pk_bf16_f32 v231, v245, v231
v_accvgpr_write_b32 a131, v231
v_accvgpr_read_b32 v231, a140
v_lshlrev_b32 v245, 16, v231
v_and_b32 v231, 0xffff0000, v231
v_mul_f32 v245, v244, v245
v_mul_f32 v231, v244, v231
v_cvt_pk_bf16_f32 v231, v245, v231
v_accvgpr_write_b32 a140, v231
v_accvgpr_read_b32 v231, a141
v_lshlrev_b32 v245, 16, v231
v_and_b32 v231, 0xffff0000, v231
v_mul_f32 v245, v244, v245
v_mul_f32 v231, v244, v231
v_cvt_pk_bf16_f32 v231, v245, v231
v_accvgpr_write_b32 a141, v231
v_accvgpr_read_b32 v231, a142
v_lshlrev_b32 v245, 16, v231
v_and_b32 v231, 0xffff0000, v231
v_mul_f32 v245, v244, v245
v_mul_f32 v231, v244, v231
v_cvt_pk_bf16_f32 v231, v245, v231
v_accvgpr_write_b32 a142, v231
v_accvgpr_read_b32 v231, a143
v_lshlrev_b32 v245, 16, v231
v_and_b32 v231, 0xffff0000, v231
v_mul_f32 v245, v244, v245
v_mul_f32 v231, v244, v231
v_cvt_pk_bf16_f32 v231, v245, v231
v_accvgpr_write_b32 a143, v231
v_accvgpr_read_b32 v231, a152
v_lshlrev_b32 v245, 16, v231
v_and_b32 v231, 0xffff0000, v231
v_mul_f32 v245, v244, v245
v_mul_f32 v231, v244, v231
v_cvt_pk_bf16_f32 v231, v245, v231
v_accvgpr_write_b32 a152, v231
v_accvgpr_read_b32 v231, a153
v_lshlrev_b32 v245, 16, v231
v_and_b32 v231, 0xffff0000, v231
v_mul_f32 v245, v244, v245
v_mul_f32 v231, v244, v231
v_cvt_pk_bf16_f32 v231, v245, v231
v_accvgpr_write_b32 a153, v231
v_accvgpr_read_b32 v231, a154
v_lshlrev_b32 v245, 16, v231
v_and_b32 v231, 0xffff0000, v231
v_mul_f32 v245, v244, v245
v_mul_f32 v231, v244, v231
v_cvt_pk_bf16_f32 v231, v245, v231
v_accvgpr_write_b32 a154, v231
v_accvgpr_read_b32 v231, a155
v_lshlrev_b32 v245, 16, v231
v_and_b32 v231, 0xffff0000, v231
v_mul_f32 v245, v244, v245
v_mul_f32 v231, v244, v231
v_cvt_pk_bf16_f32 v231, v245, v231
v_accvgpr_write_b32 a155, v231
v_accvgpr_read_b32 v231, a164
v_lshlrev_b32 v245, 16, v231
v_and_b32 v231, 0xffff0000, v231
v_mul_f32 v245, v244, v245
v_mul_f32 v231, v244, v231
v_cvt_pk_bf16_f32 v231, v245, v231
v_accvgpr_write_b32 a164, v231
v_accvgpr_read_b32 v231, a165
v_lshlrev_b32 v245, 16, v231
v_and_b32 v231, 0xffff0000, v231
v_mul_f32 v245, v244, v245
v_mul_f32 v231, v244, v231
v_cvt_pk_bf16_f32 v231, v245, v231
v_accvgpr_write_b32 a165, v231
v_accvgpr_read_b32 v231, a166
v_lshlrev_b32 v245, 16, v231
v_and_b32 v231, 0xffff0000, v231
v_mul_f32 v245, v244, v245
v_mul_f32 v231, v244, v231
v_cvt_pk_bf16_f32 v231, v245, v231
v_accvgpr_write_b32 a166, v231
v_accvgpr_read_b32 v231, a167
v_lshlrev_b32 v245, 16, v231
v_and_b32 v231, 0xffff0000, v231
v_mul_f32 v245, v244, v245
v_mul_f32 v231, v244, v231
v_cvt_pk_bf16_f32 v231, v245, v231
v_accvgpr_write_b32 a167, v231
v_accvgpr_read_b32 v231, a176
v_lshlrev_b32 v245, 16, v231
v_and_b32 v231, 0xffff0000, v231
v_mul_f32 v245, v244, v245
v_mul_f32 v231, v244, v231
v_cvt_pk_bf16_f32 v231, v245, v231
v_accvgpr_write_b32 a176, v231
v_accvgpr_read_b32 v231, a177
v_lshlrev_b32 v245, 16, v231
v_and_b32 v231, 0xffff0000, v231
v_mul_f32 v245, v244, v245
v_mul_f32 v231, v244, v231
v_cvt_pk_bf16_f32 v231, v245, v231
v_accvgpr_write_b32 a177, v231
v_accvgpr_read_b32 v231, a178
v_lshlrev_b32 v245, 16, v231
v_and_b32 v231, 0xffff0000, v231
v_mul_f32 v245, v244, v245
v_mul_f32 v231, v244, v231
v_cvt_pk_bf16_f32 v231, v245, v231
v_accvgpr_write_b32 a178, v231
v_accvgpr_read_b32 v231, a179
v_lshlrev_b32 v245, 16, v231
v_and_b32 v231, 0xffff0000, v231
v_mul_f32 v245, v244, v245
v_mul_f32 v231, v244, v231
v_cvt_pk_bf16_f32 v231, v245, v231
v_accvgpr_write_b32 a179, v231
v_max3_f32 v244, v136, v137, v138
v_max3_f32 v244, v139, v140, v244
v_max3_f32 v244, v141, v142, v244
v_max3_f32 v244, v143, v244, v234
v_mov_b32 v245, v244
s_nop 1
v_permlane32_swap_b32 v244, v245
v_max_f32 v244, v244, v245
v_mov_b32 v245, v244
s_nop 1
v_permlane16_swap_b32 v244, v245
v_max_f32 v244, v244, v245
v_sub_f32 v136, v136, v244
v_sub_f32 v137, v137, v244
v_sub_f32 v138, v138, v244
v_sub_f32 v139, v139, v244
v_sub_f32 v140, v140, v244
v_sub_f32 v141, v141, v244
v_sub_f32 v142, v142, v244
v_sub_f32 v143, v143, v244
v_sub_f32 v245, v234, v244
v_mov_b32 v234, v244
v_exp_f32 v244, v245
v_accvgpr_read_b32 v231, a120
v_lshlrev_b32 v245, 16, v231
v_and_b32 v231, 0xffff0000, v231
v_mul_f32 v245, v244, v245
v_mul_f32 v231, v244, v231
v_cvt_pk_bf16_f32 v231, v245, v231
v_accvgpr_write_b32 a120, v231
v_accvgpr_read_b32 v231, a121
v_lshlrev_b32 v245, 16, v231
v_and_b32 v231, 0xffff0000, v231
v_mul_f32 v245, v244, v245
v_mul_f32 v231, v244, v231
v_cvt_pk_bf16_f32 v231, v245, v231
v_accvgpr_write_b32 a121, v231
v_accvgpr_read_b32 v231, a122
v_lshlrev_b32 v245, 16, v231
v_and_b32 v231, 0xffff0000, v231
v_mul_f32 v245, v244, v245
v_mul_f32 v231, v244, v231
v_cvt_pk_bf16_f32 v231, v245, v231
v_accvgpr_write_b32 a122, v231
v_accvgpr_read_b32 v231, a123
v_lshlrev_b32 v245, 16, v231
v_and_b32 v231, 0xffff0000, v231
v_mul_f32 v245, v244, v245
v_mul_f32 v231, v244, v231
v_cvt_pk_bf16_f32 v231, v245, v231
v_accvgpr_write_b32 a123, v231
v_accvgpr_read_b32 v231, a132
v_lshlrev_b32 v245, 16, v231
v_and_b32 v231, 0xffff0000, v231
v_mul_f32 v245, v244, v245
v_mul_f32 v231, v244, v231
v_cvt_pk_bf16_f32 v231, v245, v231
v_accvgpr_write_b32 a132, v231
v_accvgpr_read_b32 v231, a133
v_lshlrev_b32 v245, 16, v231
v_and_b32 v231, 0xffff0000, v231
v_mul_f32 v245, v244, v245
v_mul_f32 v231, v244, v231
v_cvt_pk_bf16_f32 v231, v245, v231
v_accvgpr_write_b32 a133, v231
v_accvgpr_read_b32 v231, a134
v_lshlrev_b32 v245, 16, v231
v_and_b32 v231, 0xffff0000, v231
v_mul_f32 v245, v244, v245
v_mul_f32 v231, v244, v231
v_cvt_pk_bf16_f32 v231, v245, v231
v_accvgpr_write_b32 a134, v231
v_accvgpr_read_b32 v231, a135
v_lshlrev_b32 v245, 16, v231
v_and_b32 v231, 0xffff0000, v231
v_mul_f32 v245, v244, v245
v_mul_f32 v231, v244, v231
v_cvt_pk_bf16_f32 v231, v245, v231
v_accvgpr_write_b32 a135, v231
v_accvgpr_read_b32 v231, a144
v_lshlrev_b32 v245, 16, v231
v_and_b32 v231, 0xffff0000, v231
v_mul_f32 v245, v244, v245
v_mul_f32 v231, v244, v231
v_cvt_pk_bf16_f32 v231, v245, v231
v_accvgpr_write_b32 a144, v231
v_accvgpr_read_b32 v231, a145
v_lshlrev_b32 v245, 16, v231
v_and_b32 v231, 0xffff0000, v231
v_mul_f32 v245, v244, v245
v_mul_f32 v231, v244, v231
v_cvt_pk_bf16_f32 v231, v245, v231
v_accvgpr_write_b32 a145, v231
v_accvgpr_read_b32 v231, a146
v_lshlrev_b32 v245, 16, v231
v_and_b32 v231, 0xffff0000, v231
v_mul_f32 v245, v244, v245
v_mul_f32 v231, v244, v231
v_cvt_pk_bf16_f32 v231, v245, v231
v_accvgpr_write_b32 a146, v231
v_accvgpr_read_b32 v231, a147
v_lshlrev_b32 v245, 16, v231
v_and_b32 v231, 0xffff0000, v231
v_mul_f32 v245, v244, v245
v_mul_f32 v231, v244, v231
v_cvt_pk_bf16_f32 v231, v245, v231
v_accvgpr_write_b32 a147, v231
v_accvgpr_read_b32 v231, a156
v_lshlrev_b32 v245, 16, v231
v_and_b32 v231, 0xffff0000, v231
v_mul_f32 v245, v244, v245
v_mul_f32 v231, v244, v231
v_cvt_pk_bf16_f32 v231, v245, v231
v_accvgpr_write_b32 a156, v231
v_accvgpr_read_b32 v231, a157
v_lshlrev_b32 v245, 16, v231
v_and_b32 v231, 0xffff0000, v231
v_mul_f32 v245, v244, v245
v_mul_f32 v231, v244, v231
v_cvt_pk_bf16_f32 v231, v245, v231
v_accvgpr_write_b32 a157, v231
v_accvgpr_read_b32 v231, a158
v_lshlrev_b32 v245, 16, v231
v_and_b32 v231, 0xffff0000, v231
v_mul_f32 v245, v244, v245
v_mul_f32 v231, v244, v231
v_cvt_pk_bf16_f32 v231, v245, v231
v_accvgpr_write_b32 a158, v231
v_accvgpr_read_b32 v231, a159
v_lshlrev_b32 v245, 16, v231
v_and_b32 v231, 0xffff0000, v231
v_mul_f32 v245, v244, v245
v_mul_f32 v231, v244, v231
v_cvt_pk_bf16_f32 v231, v245, v231
v_accvgpr_write_b32 a159, v231
v_accvgpr_read_b32 v231, a168
v_lshlrev_b32 v245, 16, v231
v_and_b32 v231, 0xffff0000, v231
v_mul_f32 v245, v244, v245
v_mul_f32 v231, v244, v231
v_cvt_pk_bf16_f32 v231, v245, v231
v_accvgpr_write_b32 a168, v231
v_accvgpr_read_b32 v231, a169
v_lshlrev_b32 v245, 16, v231
v_and_b32 v231, 0xffff0000, v231
v_mul_f32 v245, v244, v245
v_mul_f32 v231, v244, v231
v_cvt_pk_bf16_f32 v231, v245, v231
v_accvgpr_write_b32 a169, v231
v_accvgpr_read_b32 v231, a170
v_lshlrev_b32 v245, 16, v231
v_and_b32 v231, 0xffff0000, v231
v_mul_f32 v245, v244, v245
v_mul_f32 v231, v244, v231
v_cvt_pk_bf16_f32 v231, v245, v231
v_accvgpr_write_b32 a170, v231
v_accvgpr_read_b32 v231, a171
v_lshlrev_b32 v245, 16, v231
v_and_b32 v231, 0xffff0000, v231
v_mul_f32 v245, v244, v245
v_mul_f32 v231, v244, v231
v_cvt_pk_bf16_f32 v231, v245, v231
v_accvgpr_write_b32 a171, v231
v_accvgpr_read_b32 v231, a180
v_lshlrev_b32 v245, 16, v231
v_and_b32 v231, 0xffff0000, v231
v_mul_f32 v245, v244, v245
v_mul_f32 v231, v244, v231
v_cvt_pk_bf16_f32 v231, v245, v231
v_accvgpr_write_b32 a180, v231
v_accvgpr_read_b32 v231, a181
v_lshlrev_b32 v245, 16, v231
v_and_b32 v231, 0xffff0000, v231
v_mul_f32 v245, v244, v245
v_mul_f32 v231, v244, v231
v_cvt_pk_bf16_f32 v231, v245, v231
v_accvgpr_write_b32 a181, v231
v_accvgpr_read_b32 v231, a182
v_lshlrev_b32 v245, 16, v231
v_and_b32 v231, 0xffff0000, v231
v_mul_f32 v245, v244, v245
v_mul_f32 v231, v244, v231
v_cvt_pk_bf16_f32 v231, v245, v231
v_accvgpr_write_b32 a182, v231
v_accvgpr_read_b32 v231, a183
v_lshlrev_b32 v245, 16, v231
v_and_b32 v231, 0xffff0000, v231
v_mul_f32 v245, v244, v245
v_mul_f32 v231, v244, v231
v_cvt_pk_bf16_f32 v231, v245, v231
v_accvgpr_write_b32 a183, v231
s_nop 1
s_branch L_back1_6
L_rare1_7:
s_mov_b32 s65, 0xff800000
v_max3_f32 v244, v96, v97, v98
v_max3_f32 v244, v99, v100, v244
v_max3_f32 v244, v101, v102, v244
v_max3_f32 v244, v103, v244, v232
v_mov_b32 v245, v244
s_nop 1
v_permlane32_swap_b32 v244, v245
v_max_f32 v244, v244, v245
v_mov_b32 v245, v244
s_nop 1
v_permlane16_swap_b32 v244, v245
v_max_f32 v244, v244, v245
v_sub_f32 v96, v96, v244
v_sub_f32 v97, v97, v244
v_sub_f32 v98, v98, v244
v_sub_f32 v99, v99, v244
v_sub_f32 v100, v100, v244
v_sub_f32 v101, v101, v244
v_sub_f32 v102, v102, v244
v_sub_f32 v103, v103, v244
v_sub_f32 v245, v232, v244
v_mov_b32 v232, v244
v_exp_f32 v244, v245
v_accvgpr_read_b32 v231, a112
v_lshlrev_b32 v245, 16, v231
v_and_b32 v231, 0xffff0000, v231
v_mul_f32 v245, v244, v245
v_mul_f32 v231, v244, v231
v_cvt_pk_bf16_f32 v231, v245, v231
v_accvgpr_write_b32 a112, v231
v_accvgpr_read_b32 v231, a113
v_lshlrev_b32 v245, 16, v231
v_and_b32 v231, 0xffff0000, v231
v_mul_f32 v245, v244, v245
v_mul_f32 v231, v244, v231
v_cvt_pk_bf16_f32 v231, v245, v231
v_accvgpr_write_b32 a113, v231
v_accvgpr_read_b32 v231, a114
v_lshlrev_b32 v245, 16, v231
v_and_b32 v231, 0xffff0000, v231
v_mul_f32 v245, v244, v245
v_mul_f32 v231, v244, v231
v_cvt_pk_bf16_f32 v231, v245, v231
v_accvgpr_write_b32 a114, v231
v_accvgpr_read_b32 v231, a115
v_lshlrev_b32 v245, 16, v231
v_and_b32 v231, 0xffff0000, v231
v_mul_f32 v245, v244, v245
v_mul_f32 v231, v244, v231
v_cvt_pk_bf16_f32 v231, v245, v231
v_accvgpr_write_b32 a115, v231
v_accvgpr_read_b32 v231, a124
v_lshlrev_b32 v245, 16, v231
v_and_b32 v231, 0xffff0000, v231
v_mul_f32 v245, v244, v245
v_mul_f32 v231, v244, v231
v_cvt_pk_bf16_f32 v231, v245, v231
v_accvgpr_write_b32 a124, v231
v_accvgpr_read_b32 v231, a125
v_lshlrev_b32 v245, 16, v231
v_and_b32 v231, 0xffff0000, v231
v_mul_f32 v245, v244, v245
v_mul_f32 v231, v244, v231
v_cvt_pk_bf16_f32 v231, v245, v231
v_accvgpr_write_b32 a125, v231
v_accvgpr_read_b32 v231, a126
v_lshlrev_b32 v245, 16, v231
v_and_b32 v231, 0xffff0000, v231
v_mul_f32 v245, v244, v245
v_mul_f32 v231, v244, v231
v_cvt_pk_bf16_f32 v231, v245, v231
v_accvgpr_write_b32 a126, v231
v_accvgpr_read_b32 v231, a127
v_lshlrev_b32 v245, 16, v231
v_and_b32 v231, 0xffff0000, v231
v_mul_f32 v245, v244, v245
v_mul_f32 v231, v244, v231
v_cvt_pk_bf16_f32 v231, v245, v231
v_accvgpr_write_b32 a127, v231
v_accvgpr_read_b32 v231, a136
v_lshlrev_b32 v245, 16, v231
v_and_b32 v231, 0xffff0000, v231
v_mul_f32 v245, v244, v245
v_mul_f32 v231, v244, v231
v_cvt_pk_bf16_f32 v231, v245, v231
v_accvgpr_write_b32 a136, v231
v_accvgpr_read_b32 v231, a137
v_lshlrev_b32 v245, 16, v231
v_and_b32 v231, 0xffff0000, v231
v_mul_f32 v245, v244, v245
v_mul_f32 v231, v244, v231
v_cvt_pk_bf16_f32 v231, v245, v231
v_accvgpr_write_b32 a137, v231
v_accvgpr_read_b32 v231, a138
v_lshlrev_b32 v245, 16, v231
v_and_b32 v231, 0xffff0000, v231
v_mul_f32 v245, v244, v245
v_mul_f32 v231, v244, v231
v_cvt_pk_bf16_f32 v231, v245, v231
v_accvgpr_write_b32 a138, v231
v_accvgpr_read_b32 v231, a139
v_lshlrev_b32 v245, 16, v231
v_and_b32 v231, 0xffff0000, v231
v_mul_f32 v245, v244, v245
v_mul_f32 v231, v244, v231
v_cvt_pk_bf16_f32 v231, v245, v231
v_accvgpr_write_b32 a139, v231
v_accvgpr_read_b32 v231, a148
v_lshlrev_b32 v245, 16, v231
v_and_b32 v231, 0xffff0000, v231
v_mul_f32 v245, v244, v245
v_mul_f32 v231, v244, v231
v_cvt_pk_bf16_f32 v231, v245, v231
v_accvgpr_write_b32 a148, v231
v_accvgpr_read_b32 v231, a149
v_lshlrev_b32 v245, 16, v231
v_and_b32 v231, 0xffff0000, v231
v_mul_f32 v245, v244, v245
v_mul_f32 v231, v244, v231
v_cvt_pk_bf16_f32 v231, v245, v231
v_accvgpr_write_b32 a149, v231
v_accvgpr_read_b32 v231, a150
v_lshlrev_b32 v245, 16, v231
v_and_b32 v231, 0xffff0000, v231
v_mul_f32 v245, v244, v245
v_mul_f32 v231, v244, v231
v_cvt_pk_bf16_f32 v231, v245, v231
v_accvgpr_write_b32 a150, v231
v_accvgpr_read_b32 v231, a151
v_lshlrev_b32 v245, 16, v231
v_and_b32 v231, 0xffff0000, v231
v_mul_f32 v245, v244, v245
v_mul_f32 v231, v244, v231
v_cvt_pk_bf16_f32 v231, v245, v231
v_accvgpr_write_b32 a151, v231
v_accvgpr_read_b32 v231, a160
v_lshlrev_b32 v245, 16, v231
v_and_b32 v231, 0xffff0000, v231
v_mul_f32 v245, v244, v245
v_mul_f32 v231, v244, v231
v_cvt_pk_bf16_f32 v231, v245, v231
v_accvgpr_write_b32 a160, v231
v_accvgpr_read_b32 v231, a161
v_lshlrev_b32 v245, 16, v231
v_and_b32 v231, 0xffff0000, v231
v_mul_f32 v245, v244, v245
v_mul_f32 v231, v244, v231
v_cvt_pk_bf16_f32 v231, v245, v231
v_accvgpr_write_b32 a161, v231
v_accvgpr_read_b32 v231, a162
v_lshlrev_b32 v245, 16, v231
v_and_b32 v231, 0xffff0000, v231
v_mul_f32 v245, v244, v245
v_mul_f32 v231, v244, v231
v_cvt_pk_bf16_f32 v231, v245, v231
v_accvgpr_write_b32 a162, v231
v_accvgpr_read_b32 v231, a163
v_lshlrev_b32 v245, 16, v231
v_and_b32 v231, 0xffff0000, v231
v_mul_f32 v245, v244, v245
v_mul_f32 v231, v244, v231
v_cvt_pk_bf16_f32 v231, v245, v231
v_accvgpr_write_b32 a163, v231
v_accvgpr_read_b32 v231, a172
v_lshlrev_b32 v245, 16, v231
v_and_b32 v231, 0xffff0000, v231
v_mul_f32 v245, v244, v245
v_mul_f32 v231, v244, v231
v_cvt_pk_bf16_f32 v231, v245, v231
v_accvgpr_write_b32 a172, v231
v_accvgpr_read_b32 v231, a173
v_lshlrev_b32 v245, 16, v231
v_and_b32 v231, 0xffff0000, v231
v_mul_f32 v245, v244, v245
v_mul_f32 v231, v244, v231
v_cvt_pk_bf16_f32 v231, v245, v231
v_accvgpr_write_b32 a173, v231
v_accvgpr_read_b32 v231, a174
v_lshlrev_b32 v245, 16, v231
v_and_b32 v231, 0xffff0000, v231
v_mul_f32 v245, v244, v245
v_mul_f32 v231, v244, v231
v_cvt_pk_bf16_f32 v231, v245, v231
v_accvgpr_write_b32 a174, v231
v_accvgpr_read_b32 v231, a175
v_lshlrev_b32 v245, 16, v231
v_and_b32 v231, 0xffff0000, v231
v_mul_f32 v245, v244, v245
v_mul_f32 v231, v244, v231
v_cvt_pk_bf16_f32 v231, v245, v231
v_accvgpr_write_b32 a175, v231
v_accvgpr_read_b32 v231, a184
v_lshlrev_b32 v245, 16, v231
v_and_b32 v231, 0xffff0000, v231
v_mul_f32 v245, v244, v245
v_mul_f32 v231, v244, v231
v_cvt_pk_bf16_f32 v231, v245, v231
v_accvgpr_write_b32 a184, v231
v_accvgpr_read_b32 v231, a185
v_lshlrev_b32 v245, 16, v231
v_and_b32 v231, 0xffff0000, v231
v_mul_f32 v245, v244, v245
v_mul_f32 v231, v244, v231
v_cvt_pk_bf16_f32 v231, v245, v231
v_accvgpr_write_b32 a185, v231
v_accvgpr_read_b32 v231, a186
v_lshlrev_b32 v245, 16, v231
v_and_b32 v231, 0xffff0000, v231
v_mul_f32 v245, v244, v245
v_mul_f32 v231, v244, v231
v_cvt_pk_bf16_f32 v231, v245, v231
v_accvgpr_write_b32 a186, v231
v_accvgpr_read_b32 v231, a187
v_lshlrev_b32 v245, 16, v231
v_and_b32 v231, 0xffff0000, v231
v_mul_f32 v245, v244, v245
v_mul_f32 v231, v244, v231
v_cvt_pk_bf16_f32 v231, v245, v231
v_accvgpr_write_b32 a187, v231
v_max3_f32 v244, v104, v105, v106
v_max3_f32 v244, v107, v108, v244
v_max3_f32 v244, v109, v110, v244
v_max3_f32 v244, v111, v244, v233
v_mov_b32 v245, v244
s_nop 1
v_permlane32_swap_b32 v244, v245
v_max_f32 v244, v244, v245
v_mov_b32 v245, v244
s_nop 1
v_permlane16_swap_b32 v244, v245
v_max_f32 v244, v244, v245
v_sub_f32 v104, v104, v244
v_sub_f32 v105, v105, v244
v_sub_f32 v106, v106, v244
v_sub_f32 v107, v107, v244
v_sub_f32 v108, v108, v244
v_sub_f32 v109, v109, v244
v_sub_f32 v110, v110, v244
v_sub_f32 v111, v111, v244
v_sub_f32 v245, v233, v244
v_mov_b32 v233, v244
v_exp_f32 v244, v245
v_accvgpr_read_b32 v231, a116
v_lshlrev_b32 v245, 16, v231
v_and_b32 v231, 0xffff0000, v231
v_mul_f32 v245, v244, v245
v_mul_f32 v231, v244, v231
v_cvt_pk_bf16_f32 v231, v245, v231
v_accvgpr_write_b32 a116, v231
v_accvgpr_read_b32 v231, a117
v_lshlrev_b32 v245, 16, v231
v_and_b32 v231, 0xffff0000, v231
v_mul_f32 v245, v244, v245
v_mul_f32 v231, v244, v231
v_cvt_pk_bf16_f32 v231, v245, v231
v_accvgpr_write_b32 a117, v231
v_accvgpr_read_b32 v231, a118
v_lshlrev_b32 v245, 16, v231
v_and_b32 v231, 0xffff0000, v231
v_mul_f32 v245, v244, v245
v_mul_f32 v231, v244, v231
v_cvt_pk_bf16_f32 v231, v245, v231
v_accvgpr_write_b32 a118, v231
v_accvgpr_read_b32 v231, a119
v_lshlrev_b32 v245, 16, v231
v_and_b32 v231, 0xffff0000, v231
v_mul_f32 v245, v244, v245
v_mul_f32 v231, v244, v231
v_cvt_pk_bf16_f32 v231, v245, v231
v_accvgpr_write_b32 a119, v231
v_accvgpr_read_b32 v231, a128
v_lshlrev_b32 v245, 16, v231
v_and_b32 v231, 0xffff0000, v231
v_mul_f32 v245, v244, v245
v_mul_f32 v231, v244, v231
v_cvt_pk_bf16_f32 v231, v245, v231
v_accvgpr_write_b32 a128, v231
v_accvgpr_read_b32 v231, a129
v_lshlrev_b32 v245, 16, v231
v_and_b32 v231, 0xffff0000, v231
v_mul_f32 v245, v244, v245
v_mul_f32 v231, v244, v231
v_cvt_pk_bf16_f32 v231, v245, v231
v_accvgpr_write_b32 a129, v231
v_accvgpr_read_b32 v231, a130
v_lshlrev_b32 v245, 16, v231
v_and_b32 v231, 0xffff0000, v231
v_mul_f32 v245, v244, v245
v_mul_f32 v231, v244, v231
v_cvt_pk_bf16_f32 v231, v245, v231
v_accvgpr_write_b32 a130, v231
v_accvgpr_read_b32 v231, a131
v_lshlrev_b32 v245, 16, v231
v_and_b32 v231, 0xffff0000, v231
v_mul_f32 v245, v244, v245
v_mul_f32 v231, v244, v231
v_cvt_pk_bf16_f32 v231, v245, v231
v_accvgpr_write_b32 a131, v231
v_accvgpr_read_b32 v231, a140
v_lshlrev_b32 v245, 16, v231
v_and_b32 v231, 0xffff0000, v231
v_mul_f32 v245, v244, v245
v_mul_f32 v231, v244, v231
v_cvt_pk_bf16_f32 v231, v245, v231
v_accvgpr_write_b32 a140, v231
v_accvgpr_read_b32 v231, a141
v_lshlrev_b32 v245, 16, v231
v_and_b32 v231, 0xffff0000, v231
v_mul_f32 v245, v244, v245
v_mul_f32 v231, v244, v231
v_cvt_pk_bf16_f32 v231, v245, v231
v_accvgpr_write_b32 a141, v231
v_accvgpr_read_b32 v231, a142
v_lshlrev_b32 v245, 16, v231
v_and_b32 v231, 0xffff0000, v231
v_mul_f32 v245, v244, v245
v_mul_f32 v231, v244, v231
v_cvt_pk_bf16_f32 v231, v245, v231
v_accvgpr_write_b32 a142, v231
v_accvgpr_read_b32 v231, a143
v_lshlrev_b32 v245, 16, v231
v_and_b32 v231, 0xffff0000, v231
v_mul_f32 v245, v244, v245
v_mul_f32 v231, v244, v231
v_cvt_pk_bf16_f32 v231, v245, v231
v_accvgpr_write_b32 a143, v231
v_accvgpr_read_b32 v231, a152
v_lshlrev_b32 v245, 16, v231
v_and_b32 v231, 0xffff0000, v231
v_mul_f32 v245, v244, v245
v_mul_f32 v231, v244, v231
v_cvt_pk_bf16_f32 v231, v245, v231
v_accvgpr_write_b32 a152, v231
v_accvgpr_read_b32 v231, a153
v_lshlrev_b32 v245, 16, v231
v_and_b32 v231, 0xffff0000, v231
v_mul_f32 v245, v244, v245
v_mul_f32 v231, v244, v231
v_cvt_pk_bf16_f32 v231, v245, v231
v_accvgpr_write_b32 a153, v231
v_accvgpr_read_b32 v231, a154
v_lshlrev_b32 v245, 16, v231
v_and_b32 v231, 0xffff0000, v231
v_mul_f32 v245, v244, v245
v_mul_f32 v231, v244, v231
v_cvt_pk_bf16_f32 v231, v245, v231
v_accvgpr_write_b32 a154, v231
v_accvgpr_read_b32 v231, a155
v_lshlrev_b32 v245, 16, v231
v_and_b32 v231, 0xffff0000, v231
v_mul_f32 v245, v244, v245
v_mul_f32 v231, v244, v231
v_cvt_pk_bf16_f32 v231, v245, v231
v_accvgpr_write_b32 a155, v231
v_accvgpr_read_b32 v231, a164
v_lshlrev_b32 v245, 16, v231
v_and_b32 v231, 0xffff0000, v231
v_mul_f32 v245, v244, v245
v_mul_f32 v231, v244, v231
v_cvt_pk_bf16_f32 v231, v245, v231
v_accvgpr_write_b32 a164, v231
v_accvgpr_read_b32 v231, a165
v_lshlrev_b32 v245, 16, v231
v_and_b32 v231, 0xffff0000, v231
v_mul_f32 v245, v244, v245
v_mul_f32 v231, v244, v231
v_cvt_pk_bf16_f32 v231, v245, v231
v_accvgpr_write_b32 a165, v231
v_accvgpr_read_b32 v231, a166
v_lshlrev_b32 v245, 16, v231
v_and_b32 v231, 0xffff0000, v231
v_mul_f32 v245, v244, v245
v_mul_f32 v231, v244, v231
v_cvt_pk_bf16_f32 v231, v245, v231
v_accvgpr_write_b32 a166, v231
v_accvgpr_read_b32 v231, a167
v_lshlrev_b32 v245, 16, v231
v_and_b32 v231, 0xffff0000, v231
v_mul_f32 v245, v244, v245
v_mul_f32 v231, v244, v231
v_cvt_pk_bf16_f32 v231, v245, v231
v_accvgpr_write_b32 a167, v231
v_accvgpr_read_b32 v231, a176
v_lshlrev_b32 v245, 16, v231
v_and_b32 v231, 0xffff0000, v231
v_mul_f32 v245, v244, v245
v_mul_f32 v231, v244, v231
v_cvt_pk_bf16_f32 v231, v245, v231
v_accvgpr_write_b32 a176, v231
v_accvgpr_read_b32 v231, a177
v_lshlrev_b32 v245, 16, v231
v_and_b32 v231, 0xffff0000, v231
v_mul_f32 v245, v244, v245
v_mul_f32 v231, v244, v231
v_cvt_pk_bf16_f32 v231, v245, v231
v_accvgpr_write_b32 a177, v231
v_accvgpr_read_b32 v231, a178
v_lshlrev_b32 v245, 16, v231
v_and_b32 v231, 0xffff0000, v231
v_mul_f32 v245, v244, v245
v_mul_f32 v231, v244, v231
v_cvt_pk_bf16_f32 v231, v245, v231
v_accvgpr_write_b32 a178, v231
v_accvgpr_read_b32 v231, a179
v_lshlrev_b32 v245, 16, v231
v_and_b32 v231, 0xffff0000, v231
v_mul_f32 v245, v244, v245
v_mul_f32 v231, v244, v231
v_cvt_pk_bf16_f32 v231, v245, v231
v_accvgpr_write_b32 a179, v231
v_accvgpr_read_b32 v231, a188
v_lshlrev_b32 v245, 16, v231
v_and_b32 v231, 0xffff0000, v231
v_mul_f32 v245, v244, v245
v_mul_f32 v231, v244, v231
v_cvt_pk_bf16_f32 v231, v245, v231
v_accvgpr_write_b32 a188, v231
v_accvgpr_read_b32 v231, a189
v_lshlrev_b32 v245, 16, v231
v_and_b32 v231, 0xffff0000, v231
v_mul_f32 v245, v244, v245
v_mul_f32 v231, v244, v231
v_cvt_pk_bf16_f32 v231, v245, v231
v_accvgpr_write_b32 a189, v231
v_accvgpr_read_b32 v231, a190
v_lshlrev_b32 v245, 16, v231
v_and_b32 v231, 0xffff0000, v231
v_mul_f32 v245, v244, v245
v_mul_f32 v231, v244, v231
v_cvt_pk_bf16_f32 v231, v245, v231
v_accvgpr_write_b32 a190, v231
v_accvgpr_read_b32 v231, a191
v_lshlrev_b32 v245, 16, v231
v_and_b32 v231, 0xffff0000, v231
v_mul_f32 v245, v244, v245
v_mul_f32 v231, v244, v231
v_cvt_pk_bf16_f32 v231, v245, v231
v_accvgpr_write_b32 a191, v231
v_max3_f32 v244, v112, v113, v114
v_max3_f32 v244, v115, v116, v244
v_max3_f32 v244, v117, v118, v244
v_max3_f32 v244, v119, v244, v234
v_mov_b32 v245, v244
s_nop 1
v_permlane32_swap_b32 v244, v245
v_max_f32 v244, v244, v245
v_mov_b32 v245, v244
s_nop 1
v_permlane16_swap_b32 v244, v245
v_max_f32 v244, v244, v245
v_sub_f32 v112, v112, v244
v_sub_f32 v113, v113, v244
v_sub_f32 v114, v114, v244
v_sub_f32 v115, v115, v244
v_sub_f32 v116, v116, v244
v_sub_f32 v117, v117, v244
v_sub_f32 v118, v118, v244
v_sub_f32 v119, v119, v244
v_sub_f32 v245, v234, v244
v_mov_b32 v234, v244
v_exp_f32 v244, v245
v_accvgpr_read_b32 v231, a120
v_lshlrev_b32 v245, 16, v231
v_and_b32 v231, 0xffff0000, v231
v_mul_f32 v245, v244, v245
v_mul_f32 v231, v244, v231
v_cvt_pk_bf16_f32 v231, v245, v231
v_accvgpr_write_b32 a120, v231
v_accvgpr_read_b32 v231, a121
v_lshlrev_b32 v245, 16, v231
v_and_b32 v231, 0xffff0000, v231
v_mul_f32 v245, v244, v245
v_mul_f32 v231, v244, v231
v_cvt_pk_bf16_f32 v231, v245, v231
v_accvgpr_write_b32 a121, v231
v_accvgpr_read_b32 v231, a122
v_lshlrev_b32 v245, 16, v231
v_and_b32 v231, 0xffff0000, v231
v_mul_f32 v245, v244, v245
v_mul_f32 v231, v244, v231
v_cvt_pk_bf16_f32 v231, v245, v231
v_accvgpr_write_b32 a122, v231
v_accvgpr_read_b32 v231, a123
v_lshlrev_b32 v245, 16, v231
v_and_b32 v231, 0xffff0000, v231
v_mul_f32 v245, v244, v245
v_mul_f32 v231, v244, v231
v_cvt_pk_bf16_f32 v231, v245, v231
v_accvgpr_write_b32 a123, v231
v_accvgpr_read_b32 v231, a132
v_lshlrev_b32 v245, 16, v231
v_and_b32 v231, 0xffff0000, v231
v_mul_f32 v245, v244, v245
v_mul_f32 v231, v244, v231
v_cvt_pk_bf16_f32 v231, v245, v231
v_accvgpr_write_b32 a132, v231
v_accvgpr_read_b32 v231, a133
v_lshlrev_b32 v245, 16, v231
v_and_b32 v231, 0xffff0000, v231
v_mul_f32 v245, v244, v245
v_mul_f32 v231, v244, v231
v_cvt_pk_bf16_f32 v231, v245, v231
v_accvgpr_write_b32 a133, v231
v_accvgpr_read_b32 v231, a134
v_lshlrev_b32 v245, 16, v231
v_and_b32 v231, 0xffff0000, v231
v_mul_f32 v245, v244, v245
v_mul_f32 v231, v244, v231
v_cvt_pk_bf16_f32 v231, v245, v231
v_accvgpr_write_b32 a134, v231
v_accvgpr_read_b32 v231, a135
v_lshlrev_b32 v245, 16, v231
v_and_b32 v231, 0xffff0000, v231
v_mul_f32 v245, v244, v245
v_mul_f32 v231, v244, v231
v_cvt_pk_bf16_f32 v231, v245, v231
v_accvgpr_write_b32 a135, v231
v_accvgpr_read_b32 v231, a144
v_lshlrev_b32 v245, 16, v231
v_and_b32 v231, 0xffff0000, v231
v_mul_f32 v245, v244, v245
v_mul_f32 v231, v244, v231
v_cvt_pk_bf16_f32 v231, v245, v231
v_accvgpr_write_b32 a144, v231
v_accvgpr_read_b32 v231, a145
v_lshlrev_b32 v245, 16, v231
v_and_b32 v231, 0xffff0000, v231
v_mul_f32 v245, v244, v245
v_mul_f32 v231, v244, v231
v_cvt_pk_bf16_f32 v231, v245, v231
v_accvgpr_write_b32 a145, v231
v_accvgpr_read_b32 v231, a146
v_lshlrev_b32 v245, 16, v231
v_and_b32 v231, 0xffff0000, v231
v_mul_f32 v245, v244, v245
v_mul_f32 v231, v244, v231
v_cvt_pk_bf16_f32 v231, v245, v231
v_accvgpr_write_b32 a146, v231
v_accvgpr_read_b32 v231, a147
v_lshlrev_b32 v245, 16, v231
v_and_b32 v231, 0xffff0000, v231
v_mul_f32 v245, v244, v245
v_mul_f32 v231, v244, v231
v_cvt_pk_bf16_f32 v231, v245, v231
v_accvgpr_write_b32 a147, v231
v_accvgpr_read_b32 v231, a156
v_lshlrev_b32 v245, 16, v231
v_and_b32 v231, 0xffff0000, v231
v_mul_f32 v245, v244, v245
v_mul_f32 v231, v244, v231
v_cvt_pk_bf16_f32 v231, v245, v231
v_accvgpr_write_b32 a156, v231
v_accvgpr_read_b32 v231, a157
v_lshlrev_b32 v245, 16, v231
v_and_b32 v231, 0xffff0000, v231
v_mul_f32 v245, v244, v245
v_mul_f32 v231, v244, v231
v_cvt_pk_bf16_f32 v231, v245, v231
v_accvgpr_write_b32 a157, v231
v_accvgpr_read_b32 v231, a158
v_lshlrev_b32 v245, 16, v231
v_and_b32 v231, 0xffff0000, v231
v_mul_f32 v245, v244, v245
v_mul_f32 v231, v244, v231
v_cvt_pk_bf16_f32 v231, v245, v231
v_accvgpr_write_b32 a158, v231
v_accvgpr_read_b32 v231, a159
v_lshlrev_b32 v245, 16, v231
v_and_b32 v231, 0xffff0000, v231
v_mul_f32 v245, v244, v245
v_mul_f32 v231, v244, v231
v_cvt_pk_bf16_f32 v231, v245, v231
v_accvgpr_write_b32 a159, v231
v_accvgpr_read_b32 v231, a168
v_lshlrev_b32 v245, 16, v231
v_and_b32 v231, 0xffff0000, v231
v_mul_f32 v245, v244, v245
v_mul_f32 v231, v244, v231
v_cvt_pk_bf16_f32 v231, v245, v231
v_accvgpr_write_b32 a168, v231
v_accvgpr_read_b32 v231, a169
v_lshlrev_b32 v245, 16, v231
v_and_b32 v231, 0xffff0000, v231
v_mul_f32 v245, v244, v245
v_mul_f32 v231, v244, v231
v_cvt_pk_bf16_f32 v231, v245, v231
v_accvgpr_write_b32 a169, v231
v_accvgpr_read_b32 v231, a170
v_lshlrev_b32 v245, 16, v231
v_and_b32 v231, 0xffff0000, v231
v_mul_f32 v245, v244, v245
v_mul_f32 v231, v244, v231
v_cvt_pk_bf16_f32 v231, v245, v231
v_accvgpr_write_b32 a170, v231
v_accvgpr_read_b32 v231, a171
v_lshlrev_b32 v245, 16, v231
v_and_b32 v231, 0xffff0000, v231
v_mul_f32 v245, v244, v245
v_mul_f32 v231, v244, v231
v_cvt_pk_bf16_f32 v231, v245, v231
v_accvgpr_write_b32 a171, v231
v_accvgpr_read_b32 v231, a180
v_lshlrev_b32 v245, 16, v231
v_and_b32 v231, 0xffff0000, v231
v_mul_f32 v245, v244, v245
v_mul_f32 v231, v244, v231
v_cvt_pk_bf16_f32 v231, v245, v231
v_accvgpr_write_b32 a180, v231
v_accvgpr_read_b32 v231, a181
v_lshlrev_b32 v245, 16, v231
v_and_b32 v231, 0xffff0000, v231
v_mul_f32 v245, v244, v245
v_mul_f32 v231, v244, v231
v_cvt_pk_bf16_f32 v231, v245, v231
v_accvgpr_write_b32 a181, v231
v_accvgpr_read_b32 v231, a182
v_lshlrev_b32 v245, 16, v231
v_and_b32 v231, 0xffff0000, v231
v_mul_f32 v245, v244, v245
v_mul_f32 v231, v244, v231
v_cvt_pk_bf16_f32 v231, v245, v231
v_accvgpr_write_b32 a182, v231
v_accvgpr_read_b32 v231, a183
v_lshlrev_b32 v245, 16, v231
v_and_b32 v231, 0xffff0000, v231
v_mul_f32 v245, v244, v245
v_mul_f32 v231, v244, v231
v_cvt_pk_bf16_f32 v231, v245, v231
v_accvgpr_write_b32 a183, v231
v_accvgpr_read_b32 v231, a192
v_lshlrev_b32 v245, 16, v231
v_and_b32 v231, 0xffff0000, v231
v_mul_f32 v245, v244, v245
v_mul_f32 v231, v244, v231
v_cvt_pk_bf16_f32 v231, v245, v231
v_accvgpr_write_b32 a192, v231
v_accvgpr_read_b32 v231, a193
v_lshlrev_b32 v245, 16, v231
v_and_b32 v231, 0xffff0000, v231
v_mul_f32 v245, v244, v245
v_mul_f32 v231, v244, v231
v_cvt_pk_bf16_f32 v231, v245, v231
v_accvgpr_write_b32 a193, v231
v_accvgpr_read_b32 v231, a194
v_lshlrev_b32 v245, 16, v231
v_and_b32 v231, 0xffff0000, v231
v_mul_f32 v245, v244, v245
v_mul_f32 v231, v244, v231
v_cvt_pk_bf16_f32 v231, v245, v231
v_accvgpr_write_b32 a194, v231
v_accvgpr_read_b32 v231, a195
v_lshlrev_b32 v245, 16, v231
v_and_b32 v231, 0xffff0000, v231
v_mul_f32 v245, v244, v245
v_mul_f32 v231, v244, v231
v_cvt_pk_bf16_f32 v231, v245, v231
v_accvgpr_write_b32 a195, v231
s_nop 1
s_branch L_back1_7
s_endpgm
.fill 64, 4, 0xbf800000
.section .rodata,"a"
.p2align 6
.amdhsa_kernel concat_heads__mha_block_cached__gqa_block_cached__near_ridge_kernel
  .amdhsa_next_free_vgpr 512
  .amdhsa_next_free_sgpr 102
  .amdhsa_accum_offset 256
  .amdhsa_group_segment_fixed_size 0
  .amdhsa_kernarg_size 104
  .amdhsa_user_sgpr_count 2
  .amdhsa_user_sgpr_kernarg_segment_ptr 1
  .amdhsa_system_sgpr_workgroup_id_x 1
  .amdhsa_float_denorm_mode_32 3
.end_amdhsa_kernel
```
